```python
import torch

def _softmax(x, axis=-1):
    return torch.softmax(x, dim=axis)

def _gelu(x):
    return torch.nn.functional.gelu(x, approximate='tanh')

def _silu(x):
    return torch.nn.functional.silu(x)

def _sigmoid(x):
    return torch.sigmoid(x)

def _layernorm(x, axis=-1, eps=1e-05):
    m = x.mean(dim=axis, keepdim=True)
    v = x.var(dim=axis, keepdim=True, unbiased=False)
    return (x - m) / torch.sqrt(v + eps)

def _scatter_add(tgt, idx, src, axis=0):
    return tgt.clone().index_add_(axis, idx, src)

def _segment_sum(src, seg, n):
    out = torch.zeros((n,) + src.shape[1:], dtype=src.dtype)
    return out.index_add_(0, seg, src)

def _pad(x, pw):
    flat = tuple((v for pair in reversed(pw) for v in pair))
    return torch.nn.functional.pad(x, flat)
kernel_name = 'adaLN_cond__gqa_block_cached__mixer_s_mlp__prompt'

def setup_inputs():

    _w = lambda a: (lambda t: t.to(torch.bfloat16) if t.is_floating_point() else t)(torch.as_tensor(a))

    def _A_setup():
        B, Sq, D = (1, 2048, 512)
        Hq, Hkv, Sk, Dh = (32, 8, 2048, 128)
        assert Hq % Hkv == 0, (Hq, Hkv)
        return {'x': _w((lambda *s: torch.randn(*s, dtype=torch.bfloat16) * 0.1)(B, Sq, D)), 'k_cache': _w((lambda *s: torch.randn(*s, dtype=torch.bfloat16) * 0.8)(B, Hkv, Sk, Dh)), 'v_cache': _w((lambda *s: torch.randn(*s, dtype=torch.bfloat16) * 0.8)(B, Hkv, Sk, Dh)), 'wq': _w((lambda *s: torch.randn(*s, dtype=torch.bfloat16) * 0.8)(D, Hq * Dh) * D ** (-0.5)), 'wo': _w((lambda *s: torch.randn(*s, dtype=torch.bfloat16) * 0.8)(Hq * Dh, D) * (Hq * Dh) ** (-0.5))}
    _A_in = _A_setup()

    def _B_setup():
        B, S, D, F = (1, 2048, 512, 1792)
        return {'x': _w((lambda *s: torch.randn(*s, dtype=torch.bfloat16) * 0.1)(B, S, D)), 'w1': _w((lambda *s: torch.randn(*s, dtype=torch.bfloat16) * 3.2)(D, D) * D ** (-0.5)), 'w2': _w((lambda *s: torch.randn(*s, dtype=torch.bfloat16) * 3.2)(D, D) * D ** (-0.5)), 'w3': _w((lambda *s: torch.randn(*s, dtype=torch.bfloat16) * 3.2)(D, F) * D ** (-0.5)), 'w4': _w((lambda *s: torch.randn(*s, dtype=torch.bfloat16) * 3.2)(F, D) * F ** (-0.5))}
    _B_in = _B_setup()
    return {'A_x': _A_in['x'], 'A_k_cache': _A_in['k_cache'], 'A_v_cache': _A_in['v_cache'], 'A_wq': _A_in['wq'], 'A_wo': _A_in['wo'], 'B_x': _B_in['x'], 'B_w1': _B_in['w1'], 'B_w2': _B_in['w2'], 'B_w3': _B_in['w3'], 'B_w4': _B_in['w4'], 'c': _w((lambda *s: torch.randn(*s, dtype=torch.bfloat16) * 0.2)(1, 512) * 8.0), 'w_mod': _w((lambda *s: torch.randn(*s, dtype=torch.bfloat16) * 0.2)(512, 6 * 512) * 512 ** (-0.5) * 8.0)}

def reference(A_x, A_k_cache, A_v_cache, A_wq, A_wo, B_x, B_w1, B_w2, B_w3, B_w4, c, w_mod):

    def _A_ref(x, k_cache, v_cache, wq, wo):
        B, Sq, D = x.shape
        Hq, Dh = (32, 128)
        Hkv = k_cache.shape[1]
        rep = Hq // Hkv
        q = (lambda x, *d: x.permute(*d))((x @ wq).reshape(B, Sq, Hq, Dh), 0, 2, 1, 3)
        k = (lambda x, n, axis: torch.repeat_interleave(x, n, dim=axis))(k_cache, rep, axis=1)
        v = (lambda x, n, axis: torch.repeat_interleave(x, n, dim=axis))(v_cache, rep, axis=1)
        scores = torch.einsum('bhqd,bhkd->bhqk', q, k) * Dh ** (-0.5)
        p = _softmax(scores, axis=-1)
        o = torch.einsum('bhqk,bhkd->bhqd', p, v)
        return (lambda x, *d: x.permute(*d))(o, 0, 2, 1, 3).reshape(B, Sq, Hq * Dh) @ wo

    def _B_ref(x, w1, w2, w3, w4):
        B, S, D = x.shape
        h = _gelu(_layernorm(x, axis=-1) @ w1)
        c = D // 4
        g0 = _pad(h[:, :, 0 * c:1 * c], ((0, 0), (1, 0), (0, 0)))[:, :S, :]
        g1 = _pad(h[:, :, 1 * c:2 * c], ((0, 0), (0, 1), (0, 0)))[:, 1:, :]
        g2 = _pad(h[:, :, 2 * c:3 * c], ((0, 0), (2, 0), (0, 0)))[:, :S, :]
        g3 = _pad(h[:, :, 3 * c:], ((0, 0), (0, 2), (0, 0)))[:, 2:, :]
        hs = torch.concatenate([g0, g1, g2, g3], axis=-1) @ w2
        x1 = x + hs
        h2 = _gelu(_layernorm(x1, axis=-1) @ w3) @ w4
        return x1 + h2
    x = A_x
    mod = (_silu(c) @ w_mod).reshape(c.shape[0], 6, 1, -1)
    sa, ca, ga, sb, cb, gb = (mod[:, 0].clone(), mod[:, 1].clone(), mod[:, 2].clone(), mod[:, 3].clone(), mod[:, 4].clone(), mod[:, 5].clone())
    h = _layernorm(x, axis=-1) * (1 + ca) + sa
    x = x + ga * _A_ref(h, A_k_cache, A_v_cache, A_wq, A_wo)
    h = _layernorm(x, axis=-1) * (1 + cb) + sb
    x = x + gb * _B_ref(h, B_w1, B_w2, B_w3, B_w4)
    return x
```

```asm
; @launch grid=(256,1,1) block=(256,1,1) lds=163840
.amdgcn_target "amdgcn-amd-amdhsa--gfx950"
.text
.globl adaLN_cond__gqa_block_cached__mixer_s_mlp__prompt_kernel
.p2align 8
.type adaLN_cond__gqa_block_cached__mixer_s_mlp__prompt_kernel,@function
adaLN_cond__gqa_block_cached__mixer_s_mlp__prompt_kernel:
    s_cmp_ge_u32 s2, 256
    s_cbranch_scc1 K1_END
    s_load_dwordx4 s[44:47], s[0:1], 0
    s_load_dwordx4 s[48:51], s[0:1], 16
    s_load_dwordx2 s[42:43], s[0:1], 32
    s_load_dwordx2 s[40:41], s[0:1], 112
    s_load_dwordx4 s[56:59], s[0:1], 80
    s_load_dwordx2 s[60:61], s[0:1], 64
    s_load_dwordx2 s[62:63], s[0:1], 104
    v_lshrrev_b32 v1, 6, v0
    s_and_b32 s3, s2, 7
    s_lshr_b32 s4, s2, 3
    v_readfirstlane_b32 s5, v1
    v_and_b32 v1, 63, v0
    v_and_b32 v24, 15, v1
    v_lshrrev_b32 v25, 4, v1
    s_lshl_b32 s32, s5, 12
    s_mul_i32 s33, s5, 24576
    s_add_u32 s33, s33, 65536
    s_mov_b32 s34, 0
    s_mov_b32 s30, 0
    v_lshlrev_b32 v29, 4, v24
    v_lshl_add_u32 v30, v25, 10, v29
    v_lshlrev_b32 v31, 6, v1
    v_lshlrev_b32 v26, 6, v24
    v_lshl_add_u32 v18, v25, 13, v26
    v_lshlrev_b32 v26, 1, v25
    v_xor_b32 v26, v24, v26
    v_lshlrev_b32 v28, 4, v26
    v_lshl_add_u32 v14, v25, 13, v28
    v_xor_b32 v15, 0x80, v14
    v_add_u32 v16, 63488, v14
    v_add_u32 v17, 95232, v15
    v_add_u32 v15, 31744, v15
    s_lshl_b32 s36, s4, 16
    s_lshl_b32 s7, s5, 14
    s_add_u32 s36, s36, s7
    s_lshl_b32 s35, s4, 14
    s_add_u32 s35, s35, s32
    s_lshl_b32 s37, s35, 3
    s_lshl_b32 s6, s3, 19
    s_lshl_b32 s7, s5, 8
    s_lshl_b32 s38, s3, 10
    s_sub_u32 s39, s3, s4
    s_and_b32 s39, s39, 7
    s_lshl_b32 s39, s39, 5
    s_and_b32 s31, s4, 7
    s_lshl2_add_u32 s39, s31, s39
    s_lshr_b32 s31, s4, 3
    s_add_u32 s39, s39, s31
    s_mov_b32 s31, 40960
    s_waitcnt lgkmcnt(0)
    s_mov_b32 s8, s40
    s_mov_b32 s9, s41
    s_mov_b32 s10, 0x10000000
    s_mov_b32 s11, 0x00020000
    s_add_u32 s42, s42, s6
    s_addc_u32 s43, s43, 0
    s_add_u32 s42, s42, s7
    s_addc_u32 s43, s43, 0
    s_mov_b32 s24, s42
    s_mov_b32 s25, s43
    s_mov_b32 s26, 0x0
    s_mov_b32 s27, 0x00020000
    s_mov_b32 s40, s62
    s_mov_b32 s41, s63
    s_mov_b32 s42, 0x100
    s_mov_b32 s43, 0x00020000
    s_cmp_ge_u32 s39, 32
    s_cbranch_scc1 K1_T9
    s_mov_b32 s16, s56
    s_mov_b32 s17, s57
    s_mov_b32 s18, 0x400
    s_mov_b32 s19, 0x00020000
    s_mov_b32 s12, s58
    s_mov_b32 s13, s59
    s_mov_b32 s14, 0x300000
    s_mov_b32 s15, 0x00020000
    s_lshr_b32 s56, s39, 3
    s_lshl_b32 s57, s56, 8
    v_lshrrev_b32 v136, 4, v0
    v_lshlrev_b32 v137, 1, v136
    buffer_load_ushort v128, v137, s[16:19], s57 offen offset:0
    buffer_load_ushort v129, v137, s[16:19], s57 offen offset:32
    buffer_load_ushort v130, v137, s[16:19], s57 offen offset:64
    buffer_load_ushort v131, v137, s[16:19], s57 offen offset:96
    buffer_load_ushort v132, v137, s[16:19], s57 offen offset:128
    buffer_load_ushort v133, v137, s[16:19], s57 offen offset:160
    buffer_load_ushort v134, v137, s[16:19], s57 offen offset:192
    buffer_load_ushort v135, v137, s[16:19], s57 offen offset:224
    v_mul_u32_u24 v136, 6144, v136
    v_add_u32 v136, v29, v136
    s_mul_i32 s57, s56, 786432
    s_and_b32 s58, s39, 7
    s_lshl_b32 s58, s58, 8
    s_add_u32 s57, s57, s58
    buffer_load_dwordx4 v[96:99], v136, s[12:15], s57 offen
    s_add_u32 s57, s57, 98304
    buffer_load_dwordx4 v[100:103], v136, s[12:15], s57 offen
    s_add_u32 s57, s57, 98304
    buffer_load_dwordx4 v[104:107], v136, s[12:15], s57 offen
    s_add_u32 s57, s57, 98304
    buffer_load_dwordx4 v[108:111], v136, s[12:15], s57 offen
    s_add_u32 s57, s57, 98304
    buffer_load_dwordx4 v[112:115], v136, s[12:15], s57 offen
    s_add_u32 s57, s57, 98304
    buffer_load_dwordx4 v[116:119], v136, s[12:15], s57 offen
    s_add_u32 s57, s57, 98304
    buffer_load_dwordx4 v[120:123], v136, s[12:15], s57 offen
    s_add_u32 s57, s57, 98304
    buffer_load_dwordx4 v[124:127], v136, s[12:15], s57 offen
    s_add_u32 s57, s57, 98304
    s_waitcnt vmcnt(8)
    v_lshlrev_b32 v128, 16, v128
    v_lshlrev_b32 v129, 16, v129
    v_lshlrev_b32 v130, 16, v130
    v_lshlrev_b32 v131, 16, v131
    v_lshlrev_b32 v132, 16, v132
    v_lshlrev_b32 v133, 16, v133
    v_lshlrev_b32 v134, 16, v134
    v_lshlrev_b32 v135, 16, v135
    v_mul_f32 v136, 0xbfb8aa3b, v128
    v_mul_f32 v137, 0xbfb8aa3b, v129
    v_mul_f32 v138, 0xbfb8aa3b, v130
    v_mul_f32 v139, 0xbfb8aa3b, v131
    v_mul_f32 v140, 0xbfb8aa3b, v132
    v_mul_f32 v141, 0xbfb8aa3b, v133
    v_mul_f32 v142, 0xbfb8aa3b, v134
    v_mul_f32 v143, 0xbfb8aa3b, v135
    v_exp_f32 v136, v136
    v_exp_f32 v137, v137
    v_exp_f32 v138, v138
    v_exp_f32 v139, v139
    v_exp_f32 v140, v140
    v_exp_f32 v141, v141
    v_exp_f32 v142, v142
    v_exp_f32 v143, v143
    v_add_f32 v136, 1.0, v136
    v_add_f32 v137, 1.0, v137
    v_add_f32 v138, 1.0, v138
    v_add_f32 v139, 1.0, v139
    v_add_f32 v140, 1.0, v140
    v_add_f32 v141, 1.0, v141
    v_add_f32 v142, 1.0, v142
    v_add_f32 v143, 1.0, v143
    v_rcp_f32 v136, v136
    v_rcp_f32 v137, v137
    v_rcp_f32 v138, v138
    v_rcp_f32 v139, v139
    v_rcp_f32 v140, v140
    v_rcp_f32 v141, v141
    v_rcp_f32 v142, v142
    v_rcp_f32 v143, v143
    v_mul_f32 v128, v128, v136
    v_mul_f32 v129, v129, v137
    v_mul_f32 v130, v130, v138
    v_mul_f32 v131, v131, v139
    v_mul_f32 v132, v132, v140
    v_mul_f32 v133, v133, v141
    v_mul_f32 v134, v134, v142
    v_mul_f32 v135, v135, v143
    v_cvt_pk_bf16_f32 v128, v128, v128
    v_cvt_pk_bf16_f32 v129, v129, v129
    v_cvt_pk_bf16_f32 v130, v130, v130
    v_cvt_pk_bf16_f32 v131, v131, v131
    v_cvt_pk_bf16_f32 v132, v132, v132
    v_cvt_pk_bf16_f32 v133, v133, v133
    v_cvt_pk_bf16_f32 v134, v134, v134
    v_cvt_pk_bf16_f32 v135, v135, v135
    v_lshlrev_b32 v128, 16, v128
    v_lshlrev_b32 v129, 16, v129
    v_lshlrev_b32 v130, 16, v130
    v_lshlrev_b32 v131, 16, v131
    v_lshlrev_b32 v132, 16, v132
    v_lshlrev_b32 v133, 16, v133
    v_lshlrev_b32 v134, 16, v134
    v_lshlrev_b32 v135, 16, v135
    s_waitcnt vmcnt(7)
    v_lshlrev_b32 v136, 16, v96
    v_and_b32 v137, 0xffff0000, v96
    v_lshlrev_b32 v138, 16, v97
    v_and_b32 v139, 0xffff0000, v97
    v_lshlrev_b32 v140, 16, v98
    v_and_b32 v141, 0xffff0000, v98
    v_lshlrev_b32 v142, 16, v99
    v_and_b32 v143, 0xffff0000, v99
    v_pk_mul_f32 v[144:145], v[136:137], v[128:129] op_sel:[0,0] op_sel_hi:[1,0]
    v_pk_mul_f32 v[146:147], v[138:139], v[128:129] op_sel:[0,0] op_sel_hi:[1,0]
    v_pk_mul_f32 v[148:149], v[140:141], v[128:129] op_sel:[0,0] op_sel_hi:[1,0]
    v_pk_mul_f32 v[150:151], v[142:143], v[128:129] op_sel:[0,0] op_sel_hi:[1,0]
    s_waitcnt vmcnt(6)
    v_lshlrev_b32 v136, 16, v100
    v_and_b32 v137, 0xffff0000, v100
    v_lshlrev_b32 v138, 16, v101
    v_and_b32 v139, 0xffff0000, v101
    v_lshlrev_b32 v140, 16, v102
    v_and_b32 v141, 0xffff0000, v102
    v_lshlrev_b32 v142, 16, v103
    v_and_b32 v143, 0xffff0000, v103
    v_pk_fma_f32 v[144:145], v[136:137], v[128:129], v[144:145] op_sel:[0,1,0] op_sel_hi:[1,1,1]
    v_pk_fma_f32 v[146:147], v[138:139], v[128:129], v[146:147] op_sel:[0,1,0] op_sel_hi:[1,1,1]
    v_pk_fma_f32 v[148:149], v[140:141], v[128:129], v[148:149] op_sel:[0,1,0] op_sel_hi:[1,1,1]
    v_pk_fma_f32 v[150:151], v[142:143], v[128:129], v[150:151] op_sel:[0,1,0] op_sel_hi:[1,1,1]
    s_waitcnt vmcnt(5)
    v_lshlrev_b32 v136, 16, v104
    v_and_b32 v137, 0xffff0000, v104
    v_lshlrev_b32 v138, 16, v105
    v_and_b32 v139, 0xffff0000, v105
    v_lshlrev_b32 v140, 16, v106
    v_and_b32 v141, 0xffff0000, v106
    v_lshlrev_b32 v142, 16, v107
    v_and_b32 v143, 0xffff0000, v107
    v_pk_fma_f32 v[144:145], v[136:137], v[130:131], v[144:145] op_sel:[0,0,0] op_sel_hi:[1,0,1]
    v_pk_fma_f32 v[146:147], v[138:139], v[130:131], v[146:147] op_sel:[0,0,0] op_sel_hi:[1,0,1]
    v_pk_fma_f32 v[148:149], v[140:141], v[130:131], v[148:149] op_sel:[0,0,0] op_sel_hi:[1,0,1]
    v_pk_fma_f32 v[150:151], v[142:143], v[130:131], v[150:151] op_sel:[0,0,0] op_sel_hi:[1,0,1]
    s_waitcnt vmcnt(4)
    v_lshlrev_b32 v136, 16, v108
    v_and_b32 v137, 0xffff0000, v108
    v_lshlrev_b32 v138, 16, v109
    v_and_b32 v139, 0xffff0000, v109
    v_lshlrev_b32 v140, 16, v110
    v_and_b32 v141, 0xffff0000, v110
    v_lshlrev_b32 v142, 16, v111
    v_and_b32 v143, 0xffff0000, v111
    v_pk_fma_f32 v[144:145], v[136:137], v[130:131], v[144:145] op_sel:[0,1,0] op_sel_hi:[1,1,1]
    v_pk_fma_f32 v[146:147], v[138:139], v[130:131], v[146:147] op_sel:[0,1,0] op_sel_hi:[1,1,1]
    v_pk_fma_f32 v[148:149], v[140:141], v[130:131], v[148:149] op_sel:[0,1,0] op_sel_hi:[1,1,1]
    v_pk_fma_f32 v[150:151], v[142:143], v[130:131], v[150:151] op_sel:[0,1,0] op_sel_hi:[1,1,1]
    s_waitcnt vmcnt(3)
    v_lshlrev_b32 v136, 16, v112
    v_and_b32 v137, 0xffff0000, v112
    v_lshlrev_b32 v138, 16, v113
    v_and_b32 v139, 0xffff0000, v113
    v_lshlrev_b32 v140, 16, v114
    v_and_b32 v141, 0xffff0000, v114
    v_lshlrev_b32 v142, 16, v115
    v_and_b32 v143, 0xffff0000, v115
    v_pk_fma_f32 v[144:145], v[136:137], v[132:133], v[144:145] op_sel:[0,0,0] op_sel_hi:[1,0,1]
    v_pk_fma_f32 v[146:147], v[138:139], v[132:133], v[146:147] op_sel:[0,0,0] op_sel_hi:[1,0,1]
    v_pk_fma_f32 v[148:149], v[140:141], v[132:133], v[148:149] op_sel:[0,0,0] op_sel_hi:[1,0,1]
    v_pk_fma_f32 v[150:151], v[142:143], v[132:133], v[150:151] op_sel:[0,0,0] op_sel_hi:[1,0,1]
    s_waitcnt vmcnt(2)
    v_lshlrev_b32 v136, 16, v116
    v_and_b32 v137, 0xffff0000, v116
    v_lshlrev_b32 v138, 16, v117
    v_and_b32 v139, 0xffff0000, v117
    v_lshlrev_b32 v140, 16, v118
    v_and_b32 v141, 0xffff0000, v118
    v_lshlrev_b32 v142, 16, v119
    v_and_b32 v143, 0xffff0000, v119
    v_pk_fma_f32 v[144:145], v[136:137], v[132:133], v[144:145] op_sel:[0,1,0] op_sel_hi:[1,1,1]
    v_pk_fma_f32 v[146:147], v[138:139], v[132:133], v[146:147] op_sel:[0,1,0] op_sel_hi:[1,1,1]
    v_pk_fma_f32 v[148:149], v[140:141], v[132:133], v[148:149] op_sel:[0,1,0] op_sel_hi:[1,1,1]
    v_pk_fma_f32 v[150:151], v[142:143], v[132:133], v[150:151] op_sel:[0,1,0] op_sel_hi:[1,1,1]
    s_waitcnt vmcnt(1)
    v_lshlrev_b32 v136, 16, v120
    v_and_b32 v137, 0xffff0000, v120
    v_lshlrev_b32 v138, 16, v121
    v_and_b32 v139, 0xffff0000, v121
    v_lshlrev_b32 v140, 16, v122
    v_and_b32 v141, 0xffff0000, v122
    v_lshlrev_b32 v142, 16, v123
    v_and_b32 v143, 0xffff0000, v123
    v_pk_fma_f32 v[144:145], v[136:137], v[134:135], v[144:145] op_sel:[0,0,0] op_sel_hi:[1,0,1]
    v_pk_fma_f32 v[146:147], v[138:139], v[134:135], v[146:147] op_sel:[0,0,0] op_sel_hi:[1,0,1]
    v_pk_fma_f32 v[148:149], v[140:141], v[134:135], v[148:149] op_sel:[0,0,0] op_sel_hi:[1,0,1]
    v_pk_fma_f32 v[150:151], v[142:143], v[134:135], v[150:151] op_sel:[0,0,0] op_sel_hi:[1,0,1]
    s_waitcnt vmcnt(0)
    v_lshlrev_b32 v136, 16, v124
    v_and_b32 v137, 0xffff0000, v124
    v_lshlrev_b32 v138, 16, v125
    v_and_b32 v139, 0xffff0000, v125
    v_lshlrev_b32 v140, 16, v126
    v_and_b32 v141, 0xffff0000, v126
    v_lshlrev_b32 v142, 16, v127
    v_and_b32 v143, 0xffff0000, v127
    v_pk_fma_f32 v[144:145], v[136:137], v[134:135], v[144:145] op_sel:[0,1,0] op_sel_hi:[1,1,1]
    v_pk_fma_f32 v[146:147], v[138:139], v[134:135], v[146:147] op_sel:[0,1,0] op_sel_hi:[1,1,1]
    v_pk_fma_f32 v[148:149], v[140:141], v[134:135], v[148:149] op_sel:[0,1,0] op_sel_hi:[1,1,1]
    v_pk_fma_f32 v[150:151], v[142:143], v[134:135], v[150:151] op_sel:[0,1,0] op_sel_hi:[1,1,1]
    v_lshlrev_b32 v136, 5, v0
    ds_write_b128 v136, v[144:147]
    ds_write_b128 v136, v[148:151] offset:16
    v_and_b32 v136, 31, v0
    v_lshlrev_b32 v136, 4, v136
    s_lshl_b32 s56, s56, 12
    s_lshl1_add_u32 s56, s58, s56
    s_waitcnt lgkmcnt(0)
    s_barrier
    s_cmp_lg_u32 s5, 0
    s_cbranch_scc1 K1_T9
    ds_read_b128 v[160:163], v136 offset:0
    ds_read_b128 v[164:167], v136 offset:512
    ds_read_b128 v[168:171], v136 offset:1024
    ds_read_b128 v[172:175], v136 offset:1536
    ds_read_b128 v[176:179], v136 offset:2048
    ds_read_b128 v[180:183], v136 offset:2560
    ds_read_b128 v[184:187], v136 offset:3072
    ds_read_b128 v[188:191], v136 offset:3584
    s_waitcnt lgkmcnt(0)
    ds_read_b128 v[192:195], v136 offset:4096
    ds_read_b128 v[196:199], v136 offset:4608
    ds_read_b128 v[200:203], v136 offset:5120
    ds_read_b128 v[204:207], v136 offset:5632
    ds_read_b128 v[208:211], v136 offset:6144
    ds_read_b128 v[212:215], v136 offset:6656
    ds_read_b128 v[216:219], v136 offset:7168
    ds_read_b128 v[220:223], v136 offset:7680
    s_waitcnt lgkmcnt(0)
    v_pk_add_f32 v[160:161], v[160:161], v[192:193]
    v_pk_add_f32 v[162:163], v[162:163], v[194:195]
    v_pk_add_f32 v[164:165], v[164:165], v[196:197]
    v_pk_add_f32 v[166:167], v[166:167], v[198:199]
    v_pk_add_f32 v[168:169], v[168:169], v[200:201]
    v_pk_add_f32 v[170:171], v[170:171], v[202:203]
    v_pk_add_f32 v[172:173], v[172:173], v[204:205]
    v_pk_add_f32 v[174:175], v[174:175], v[206:207]
    v_pk_add_f32 v[176:177], v[176:177], v[208:209]
    v_pk_add_f32 v[178:179], v[178:179], v[210:211]
    v_pk_add_f32 v[180:181], v[180:181], v[212:213]
    v_pk_add_f32 v[182:183], v[182:183], v[214:215]
    v_pk_add_f32 v[184:185], v[184:185], v[216:217]
    v_pk_add_f32 v[186:187], v[186:187], v[218:219]
    v_pk_add_f32 v[188:189], v[188:189], v[220:221]
    v_pk_add_f32 v[190:191], v[190:191], v[222:223]
    v_pk_add_f32 v[160:161], v[160:161], v[176:177]
    v_pk_add_f32 v[162:163], v[162:163], v[178:179]
    v_pk_add_f32 v[164:165], v[164:165], v[180:181]
    v_pk_add_f32 v[166:167], v[166:167], v[182:183]
    v_pk_add_f32 v[168:169], v[168:169], v[184:185]
    v_pk_add_f32 v[170:171], v[170:171], v[186:187]
    v_pk_add_f32 v[172:173], v[172:173], v[188:189]
    v_pk_add_f32 v[174:175], v[174:175], v[190:191]
    v_pk_add_f32 v[160:161], v[160:161], v[168:169]
    v_pk_add_f32 v[162:163], v[162:163], v[170:171]
    v_pk_add_f32 v[164:165], v[164:165], v[172:173]
    v_pk_add_f32 v[166:167], v[166:167], v[174:175]
    v_pk_add_f32 v[160:161], v[160:161], v[164:165]
    v_pk_add_f32 v[162:163], v[162:163], v[166:167]
    s_mov_b64 exec, 0xffffffff
    buffer_store_dwordx4 v[160:163], v136, s[8:11], s56 offen sc1
    s_mov_b64 exec, 1
    v_mov_b32 v144, 1
    s_waitcnt vmcnt(0)
    buffer_atomic_add v144, off, s[40:43], 0 offset:132 sc0 sc1
    s_waitcnt vmcnt(0)
    v_readfirstlane_b32 s56, v144
    s_cmp_lg_u32 s56, 31
    s_cbranch_scc1 K1_T5
    buffer_store_dword v144, off, s[40:43], 0 sc1
K1_T5:
    s_mov_b64 exec, -1
K1_T9:
    s_mov_b32 s52, s44
    s_mov_b32 s53, s45
    s_mov_b32 s54, 0x200000
    s_mov_b32 s55, 0x00020000
    buffer_load_dwordx4 v[32:35], v30, s[52:55], s36 offen offset:0
    buffer_load_dwordx4 v[36:39], v30, s[52:55], s36 offen offset:256
    buffer_load_dwordx4 v[40:43], v30, s[52:55], s36 offen offset:512
    buffer_load_dwordx4 v[44:47], v30, s[52:55], s36 offen offset:768
    s_add_u32 s36, s36, 4096
    buffer_load_dwordx4 v[48:51], v30, s[52:55], s36 offen offset:0
    buffer_load_dwordx4 v[52:55], v30, s[52:55], s36 offen offset:256
    buffer_load_dwordx4 v[56:59], v30, s[52:55], s36 offen offset:512
    buffer_load_dwordx4 v[60:63], v30, s[52:55], s36 offen offset:768
    s_add_u32 s36, s36, 4096
    buffer_load_dwordx4 v[64:67], v30, s[52:55], s36 offen offset:0
    buffer_load_dwordx4 v[68:71], v30, s[52:55], s36 offen offset:256
    buffer_load_dwordx4 v[72:75], v30, s[52:55], s36 offen offset:512
    buffer_load_dwordx4 v[76:79], v30, s[52:55], s36 offen offset:768
    s_add_u32 s36, s36, 4096
    buffer_load_dwordx4 v[80:83], v30, s[52:55], s36 offen offset:0
    buffer_load_dwordx4 v[84:87], v30, s[52:55], s36 offen offset:256
    buffer_load_dwordx4 v[88:91], v30, s[52:55], s36 offen offset:512
    buffer_load_dwordx4 v[92:95], v30, s[52:55], s36 offen offset:768
    s_add_u32 s50, s50, s38
    s_addc_u32 s51, s51, 0
    s_mov_b32 s20, s50
    s_mov_b32 s21, s51
    s_mov_b32 s22, 0x0
    s_mov_b32 s23, 0x00020000
    s_sub_u32 s22, 4194304, s38
    buffer_load_dword a248, v18, s[20:23], s37 offen
    s_lshl_b32 s38, s5, 14
    v_add_u32 v20, s38, v29
    v_lshlrev_b32 v21, 4, v1
    s_add_u32 s20, s20, s7
    s_addc_u32 s21, s21, 0
    s_sub_u32 s22, s22, s7
    s_add_u32 s46, s46, s6
    s_addc_u32 s47, s47, 0
    s_add_u32 s48, s48, s6
    s_addc_u32 s49, s49, 0
    s_mov_b32 s12, s46
    s_mov_b32 s13, s47
    s_mov_b32 s14, 0x80000
    s_mov_b32 s15, 0x00020000
    s_mov_b32 s16, s48
    s_mov_b32 s17, s49
    s_mov_b32 s18, 0x80000
    s_mov_b32 s19, 0x00020000
    v_add_u32 v19, s35, v31
    s_sub_u32 s35, s35, s7
    s_sub_u32 s26, 524288, s7
    s_mov_b32 s28, s32
    s_sub_u32 s29, s32, 8192
    v_xor_b32 v26, v25, v24
    v_lshlrev_b32 v26, 4, v26
    v_lshl_add_u32 v2, v24, 10, v26
    v_xor_b32 v3, 64, v2
    v_xor_b32 v4, 128, v2
    v_xor_b32 v5, 192, v2
    v_lshrrev_b32 v26, 2, v1
    v_and_b32 v27, 7, v26
    v_lshlrev_b32 v27, 5, v27
    v_lshl_add_u32 v26, v26, 8, v27
    v_and_b32 v27, 3, v1
    v_lshl_add_u32 v26, v27, 3, v26
    v_add_u32 v6, s33, v26
    v_xor_b32 v7, 32, v6
    v_xor_b32 v8, 64, v6
    v_xor_b32 v9, 96, v6
    v_xor_b32 v10, 128, v6
    v_xor_b32 v11, 160, v6
    v_xor_b32 v12, 192, v6
    v_xor_b32 v13, 224, v6
    v_and_b32 v26, 1, v24
    v_lshlrev_b32 v26, 1, v26
    v_and_or_b32 v26, v24, 12, v26
    v_xor_b32 v26, v25, v26
    v_lshlrev_b32 v26, 4, v26
    v_lshl_add_u32 v26, v25, 10, v26
    v_bfe_u32 v27, v24, 1, 1
    v_lshl_add_u32 v26, v27, 3, v26
    s_lshl_b32 s7, s5, 14
    v_add_u32 v22, s7, v26
    s_sub_u32 s6, s39, 32
    s_cmp_ge_u32 s6, 85
    s_cbranch_scc1 K1_L1
    s_cmp_lt_u32 s39, 92
    s_cbranch_scc1 K1_L0
    s_sub_u32 s56, s39, 92
    s_cmp_lt_u32 s56, 8
    s_cselect_b32 s57, 0, -1
    s_lshl_b32 s56, s56, 12
    s_add_u32 s56, s56, 131072
    v_lshlrev_b32 v96, 4, v0
    v_mov_b32 v100, s57
    v_mov_b32 v101, s57
    v_mov_b32 v102, s57
    v_mov_b32 v103, s57
    buffer_store_dwordx4 v[100:103], v96, s[8:11], s56 offen sc1
    s_branch K1_L1
K1_L0:
    s_mov_b32 s44, s56
    s_mov_b32 s45, s57
    s_mov_b32 s46, 0x400
    s_mov_b32 s47, 0x00020000
    v_lshrrev_b32 v96, 3, v0
    v_lshlrev_b32 v97, 1, v96
    buffer_load_ushort a64, v97, s[44:47], 0 offen offset:0
    buffer_load_ushort a65, v97, s[44:47], 0 offen offset:64
    buffer_load_ushort a66, v97, s[44:47], 0 offen offset:128
    buffer_load_ushort a67, v97, s[44:47], 0 offen offset:192
    buffer_load_ushort a68, v97, s[44:47], 0 offen offset:256
    buffer_load_ushort a69, v97, s[44:47], 0 offen offset:320
    buffer_load_ushort a70, v97, s[44:47], 0 offen offset:384
    buffer_load_ushort a71, v97, s[44:47], 0 offen offset:448
    buffer_load_ushort a72, v97, s[44:47], 0 offen offset:512
    buffer_load_ushort a73, v97, s[44:47], 0 offen offset:576
    buffer_load_ushort a74, v97, s[44:47], 0 offen offset:640
    buffer_load_ushort a75, v97, s[44:47], 0 offen offset:704
    buffer_load_ushort a76, v97, s[44:47], 0 offen offset:768
    buffer_load_ushort a77, v97, s[44:47], 0 offen offset:832
    buffer_load_ushort a78, v97, s[44:47], 0 offen offset:896
    buffer_load_ushort a79, v97, s[44:47], 0 offen offset:960
    s_sub_u32 s57, s39, 64
    s_sub_u32 s56, s39, 16
    s_cmp_lt_u32 s39, 64
    s_cselect_b32 s48, s58, s60
    s_cselect_b32 s49, s59, s61
    s_cselect_b32 s57, s56, s57
    s_mov_b32 s56, 3584
    s_cselect_b32 s56, 6144, s56
    s_lshl_b32 s50, s56, 9
    s_mov_b32 s51, 0x00020000
    s_lshl_b32 s57, s57, 7
    v_mul_lo_u32 v96, v96, s56
    v_and_b32 v97, 7, v0
    v_lshl_add_u32 v96, v97, 4, v96
    s_lshl_b32 s56, s56, 5
    buffer_load_dwordx4 a[0:3], v96, s[48:51], s57 offen
    s_add_u32 s57, s57, s56
    buffer_load_dwordx4 a[4:7], v96, s[48:51], s57 offen
    s_add_u32 s57, s57, s56
    buffer_load_dwordx4 a[8:11], v96, s[48:51], s57 offen
    s_add_u32 s57, s57, s56
    buffer_load_dwordx4 a[12:15], v96, s[48:51], s57 offen
    s_add_u32 s57, s57, s56
    buffer_load_dwordx4 a[16:19], v96, s[48:51], s57 offen
    s_add_u32 s57, s57, s56
    buffer_load_dwordx4 a[20:23], v96, s[48:51], s57 offen
    s_add_u32 s57, s57, s56
    buffer_load_dwordx4 a[24:27], v96, s[48:51], s57 offen
    s_add_u32 s57, s57, s56
    buffer_load_dwordx4 a[28:31], v96, s[48:51], s57 offen
    s_add_u32 s57, s57, s56
    buffer_load_dwordx4 a[32:35], v96, s[48:51], s57 offen
    s_add_u32 s57, s57, s56
    buffer_load_dwordx4 a[36:39], v96, s[48:51], s57 offen
    s_add_u32 s57, s57, s56
    buffer_load_dwordx4 a[40:43], v96, s[48:51], s57 offen
    s_add_u32 s57, s57, s56
    buffer_load_dwordx4 a[44:47], v96, s[48:51], s57 offen
    s_add_u32 s57, s57, s56
    buffer_load_dwordx4 a[48:51], v96, s[48:51], s57 offen
    s_add_u32 s57, s57, s56
    buffer_load_dwordx4 a[52:55], v96, s[48:51], s57 offen
    s_add_u32 s57, s57, s56
    buffer_load_dwordx4 a[56:59], v96, s[48:51], s57 offen
    s_add_u32 s57, s57, s56
    buffer_load_dwordx4 a[60:63], v96, s[48:51], s57 offen
    s_add_u32 s57, s57, s56
K1_L1:
    s_sub_u32 s6, s39, 32
    s_cmp_ge_u32 s6, 60
    s_cbranch_scc1 K1_X00
    s_waitcnt vmcnt(45)
    s_branch K1_X01
K1_X00:
    s_waitcnt vmcnt(13)
K1_X01:
    v_lshlrev_b32 v96, 16, v32
    v_and_b32 v97, 0xffff0000, v32
    v_lshlrev_b32 v98, 16, v33
    v_and_b32 v99, 0xffff0000, v33
    v_pk_add_f32 v[24:25], v[96:97], v[98:99]
    v_lshlrev_b32 v100, 16, v34
    v_and_b32 v101, 0xffff0000, v34
    v_pk_add_f32 v[24:25], v[24:25], v[100:101]
    v_lshlrev_b32 v102, 16, v35
    v_and_b32 v103, 0xffff0000, v35
    v_pk_add_f32 v[24:25], v[24:25], v[102:103]
    v_lshlrev_b32 v104, 16, v36
    v_and_b32 v105, 0xffff0000, v36
    v_pk_add_f32 v[24:25], v[24:25], v[104:105]
    v_lshlrev_b32 v106, 16, v37
    v_and_b32 v107, 0xffff0000, v37
    v_pk_add_f32 v[24:25], v[24:25], v[106:107]
    v_lshlrev_b32 v108, 16, v38
    v_and_b32 v109, 0xffff0000, v38
    v_pk_add_f32 v[24:25], v[24:25], v[108:109]
    v_lshlrev_b32 v110, 16, v39
    v_and_b32 v111, 0xffff0000, v39
    v_pk_add_f32 v[24:25], v[24:25], v[110:111]
    v_lshlrev_b32 v112, 16, v40
    v_and_b32 v113, 0xffff0000, v40
    v_pk_add_f32 v[24:25], v[24:25], v[112:113]
    v_lshlrev_b32 v114, 16, v41
    v_and_b32 v115, 0xffff0000, v41
    v_pk_add_f32 v[24:25], v[24:25], v[114:115]
    v_lshlrev_b32 v116, 16, v42
    v_and_b32 v117, 0xffff0000, v42
    v_pk_add_f32 v[24:25], v[24:25], v[116:117]
    v_lshlrev_b32 v118, 16, v43
    v_and_b32 v119, 0xffff0000, v43
    v_pk_add_f32 v[24:25], v[24:25], v[118:119]
    v_lshlrev_b32 v120, 16, v44
    v_and_b32 v121, 0xffff0000, v44
    v_pk_add_f32 v[24:25], v[24:25], v[120:121]
    v_lshlrev_b32 v122, 16, v45
    v_and_b32 v123, 0xffff0000, v45
    v_pk_add_f32 v[24:25], v[24:25], v[122:123]
    v_lshlrev_b32 v124, 16, v46
    v_and_b32 v125, 0xffff0000, v46
    v_pk_add_f32 v[24:25], v[24:25], v[124:125]
    v_lshlrev_b32 v126, 16, v47
    v_and_b32 v127, 0xffff0000, v47
    v_pk_add_f32 v[24:25], v[24:25], v[126:127]
    s_sub_u32 s6, s39, 32
    s_cmp_ge_u32 s6, 60
    s_cbranch_scc1 K1_X10
    s_waitcnt vmcnt(41)
    s_branch K1_X11
K1_X10:
    s_waitcnt vmcnt(9)
K1_X11:
    v_lshlrev_b32 v128, 16, v48
    v_and_b32 v129, 0xffff0000, v48
    v_lshlrev_b32 v130, 16, v49
    v_and_b32 v131, 0xffff0000, v49
    v_pk_add_f32 v[26:27], v[128:129], v[130:131]
    v_lshlrev_b32 v132, 16, v50
    v_and_b32 v133, 0xffff0000, v50
    v_pk_add_f32 v[26:27], v[26:27], v[132:133]
    v_lshlrev_b32 v134, 16, v51
    v_and_b32 v135, 0xffff0000, v51
    v_pk_add_f32 v[26:27], v[26:27], v[134:135]
    v_lshlrev_b32 v136, 16, v52
    v_and_b32 v137, 0xffff0000, v52
    v_pk_add_f32 v[26:27], v[26:27], v[136:137]
    v_lshlrev_b32 v138, 16, v53
    v_and_b32 v139, 0xffff0000, v53
    v_pk_add_f32 v[26:27], v[26:27], v[138:139]
    v_lshlrev_b32 v140, 16, v54
    v_and_b32 v141, 0xffff0000, v54
    v_pk_add_f32 v[26:27], v[26:27], v[140:141]
    v_lshlrev_b32 v142, 16, v55
    v_and_b32 v143, 0xffff0000, v55
    v_pk_add_f32 v[26:27], v[26:27], v[142:143]
    v_lshlrev_b32 v144, 16, v56
    v_and_b32 v145, 0xffff0000, v56
    v_pk_add_f32 v[26:27], v[26:27], v[144:145]
    v_lshlrev_b32 v146, 16, v57
    v_and_b32 v147, 0xffff0000, v57
    v_pk_add_f32 v[26:27], v[26:27], v[146:147]
    v_lshlrev_b32 v148, 16, v58
    v_and_b32 v149, 0xffff0000, v58
    v_pk_add_f32 v[26:27], v[26:27], v[148:149]
    v_lshlrev_b32 v150, 16, v59
    v_and_b32 v151, 0xffff0000, v59
    v_pk_add_f32 v[26:27], v[26:27], v[150:151]
    v_lshlrev_b32 v152, 16, v60
    v_and_b32 v153, 0xffff0000, v60
    v_pk_add_f32 v[26:27], v[26:27], v[152:153]
    v_lshlrev_b32 v154, 16, v61
    v_and_b32 v155, 0xffff0000, v61
    v_pk_add_f32 v[26:27], v[26:27], v[154:155]
    v_lshlrev_b32 v156, 16, v62
    v_and_b32 v157, 0xffff0000, v62
    v_pk_add_f32 v[26:27], v[26:27], v[156:157]
    v_lshlrev_b32 v158, 16, v63
    v_and_b32 v159, 0xffff0000, v63
    v_pk_add_f32 v[26:27], v[26:27], v[158:159]
    s_sub_u32 s6, s39, 32
    s_cmp_ge_u32 s6, 60
    s_cbranch_scc1 K1_X20
    s_waitcnt vmcnt(37)
    s_branch K1_X21
K1_X20:
    s_waitcnt vmcnt(5)
K1_X21:
    v_lshlrev_b32 v160, 16, v64
    v_and_b32 v161, 0xffff0000, v64
    v_lshlrev_b32 v162, 16, v65
    v_and_b32 v163, 0xffff0000, v65
    v_pk_add_f32 v[28:29], v[160:161], v[162:163]
    v_lshlrev_b32 v164, 16, v66
    v_and_b32 v165, 0xffff0000, v66
    v_pk_add_f32 v[28:29], v[28:29], v[164:165]
    v_lshlrev_b32 v166, 16, v67
    v_and_b32 v167, 0xffff0000, v67
    v_pk_add_f32 v[28:29], v[28:29], v[166:167]
    s_add_u32 m0, s33, 0
    s_nop 0
    buffer_load_dwordx4 v14, s[20:23], s30 offen offset:0 lds
    v_lshlrev_b32 v168, 16, v68
    v_and_b32 v169, 0xffff0000, v68
    v_pk_add_f32 v[28:29], v[28:29], v[168:169]
    v_lshlrev_b32 v170, 16, v69
    v_and_b32 v171, 0xffff0000, v69
    v_pk_add_f32 v[28:29], v[28:29], v[170:171]
    v_lshlrev_b32 v172, 16, v70
    v_and_b32 v173, 0xffff0000, v70
    v_pk_add_f32 v[28:29], v[28:29], v[172:173]
    v_lshlrev_b32 v174, 16, v71
    v_and_b32 v175, 0xffff0000, v71
    v_pk_add_f32 v[28:29], v[28:29], v[174:175]
    buffer_load_dwordx4 v15, s[20:23], s30 offen offset:1024 lds
    v_lshlrev_b32 v176, 16, v72
    v_and_b32 v177, 0xffff0000, v72
    v_pk_add_f32 v[28:29], v[28:29], v[176:177]
    v_lshlrev_b32 v178, 16, v73
    v_and_b32 v179, 0xffff0000, v73
    v_pk_add_f32 v[28:29], v[28:29], v[178:179]
    v_lshlrev_b32 v180, 16, v74
    v_and_b32 v181, 0xffff0000, v74
    v_pk_add_f32 v[28:29], v[28:29], v[180:181]
    v_lshlrev_b32 v182, 16, v75
    v_and_b32 v183, 0xffff0000, v75
    v_pk_add_f32 v[28:29], v[28:29], v[182:183]
    buffer_load_dwordx4 v16, s[20:23], s30 offen offset:2048 lds
    v_lshlrev_b32 v184, 16, v76
    v_and_b32 v185, 0xffff0000, v76
    v_pk_add_f32 v[28:29], v[28:29], v[184:185]
    v_lshlrev_b32 v186, 16, v77
    v_and_b32 v187, 0xffff0000, v77
    v_pk_add_f32 v[28:29], v[28:29], v[186:187]
    v_lshlrev_b32 v188, 16, v78
    v_and_b32 v189, 0xffff0000, v78
    v_pk_add_f32 v[28:29], v[28:29], v[188:189]
    v_lshlrev_b32 v190, 16, v79
    v_and_b32 v191, 0xffff0000, v79
    v_pk_add_f32 v[28:29], v[28:29], v[190:191]
    buffer_load_dwordx4 v17, s[20:23], s30 offen offset:3072 lds
    s_add_u32 s30, s30, 131072
    s_sub_u32 s6, s39, 32
    s_cmp_ge_u32 s6, 60
    s_cbranch_scc1 K1_X30
    s_waitcnt vmcnt(37)
    s_branch K1_X31
K1_X30:
    s_waitcnt vmcnt(5)
K1_X31:
    v_lshlrev_b32 v192, 16, v80
    v_and_b32 v193, 0xffff0000, v80
    v_lshlrev_b32 v194, 16, v81
    v_and_b32 v195, 0xffff0000, v81
    v_pk_add_f32 v[30:31], v[192:193], v[194:195]
    v_lshlrev_b32 v196, 16, v82
    v_and_b32 v197, 0xffff0000, v82
    v_pk_add_f32 v[30:31], v[30:31], v[196:197]
    v_lshlrev_b32 v198, 16, v83
    v_and_b32 v199, 0xffff0000, v83
    v_pk_add_f32 v[30:31], v[30:31], v[198:199]
    s_add_u32 m0, s33, 4096
    s_nop 0
    buffer_load_dwordx4 v14, s[20:23], s30 offen offset:0 lds
    v_lshlrev_b32 v200, 16, v84
    v_and_b32 v201, 0xffff0000, v84
    v_pk_add_f32 v[30:31], v[30:31], v[200:201]
    v_lshlrev_b32 v202, 16, v85
    v_and_b32 v203, 0xffff0000, v85
    v_pk_add_f32 v[30:31], v[30:31], v[202:203]
    v_lshlrev_b32 v204, 16, v86
    v_and_b32 v205, 0xffff0000, v86
    v_pk_add_f32 v[30:31], v[30:31], v[204:205]
    v_lshlrev_b32 v206, 16, v87
    v_and_b32 v207, 0xffff0000, v87
    v_pk_add_f32 v[30:31], v[30:31], v[206:207]
    buffer_load_dwordx4 v15, s[20:23], s30 offen offset:1024 lds
    v_lshlrev_b32 v208, 16, v88
    v_and_b32 v209, 0xffff0000, v88
    v_pk_add_f32 v[30:31], v[30:31], v[208:209]
    v_lshlrev_b32 v210, 16, v89
    v_and_b32 v211, 0xffff0000, v89
    v_pk_add_f32 v[30:31], v[30:31], v[210:211]
    v_lshlrev_b32 v212, 16, v90
    v_and_b32 v213, 0xffff0000, v90
    v_pk_add_f32 v[30:31], v[30:31], v[212:213]
    v_lshlrev_b32 v214, 16, v91
    v_and_b32 v215, 0xffff0000, v91
    v_pk_add_f32 v[30:31], v[30:31], v[214:215]
    buffer_load_dwordx4 v16, s[20:23], s30 offen offset:2048 lds
    v_lshlrev_b32 v216, 16, v92
    v_and_b32 v217, 0xffff0000, v92
    v_pk_add_f32 v[30:31], v[30:31], v[216:217]
    v_lshlrev_b32 v218, 16, v93
    v_and_b32 v219, 0xffff0000, v93
    v_pk_add_f32 v[30:31], v[30:31], v[218:219]
    v_lshlrev_b32 v220, 16, v94
    v_and_b32 v221, 0xffff0000, v94
    v_pk_add_f32 v[30:31], v[30:31], v[220:221]
    v_lshlrev_b32 v222, 16, v95
    v_and_b32 v223, 0xffff0000, v95
    v_pk_add_f32 v[30:31], v[30:31], v[222:223]
    buffer_load_dwordx4 v17, s[20:23], s30 offen offset:3072 lds
    s_add_u32 s30, s30, 131072
    v_add_f32 v24, v24, v25
    v_add_f32 v26, v26, v27
    v_add_f32 v28, v28, v29
    v_add_f32 v30, v30, v31
    v_add_f32_dpp v24, v24, v24 row_ror:8 row_mask:0xf bank_mask:0xf
    v_add_f32_dpp v26, v26, v26 row_ror:8 row_mask:0xf bank_mask:0xf
    v_add_f32_dpp v28, v28, v28 row_ror:8 row_mask:0xf bank_mask:0xf
    v_add_f32_dpp v30, v30, v30 row_ror:8 row_mask:0xf bank_mask:0xf
    v_add_f32_dpp v24, v24, v24 row_ror:4 row_mask:0xf bank_mask:0xf
    v_add_f32_dpp v26, v26, v26 row_ror:4 row_mask:0xf bank_mask:0xf
    v_add_f32_dpp v28, v28, v28 row_ror:4 row_mask:0xf bank_mask:0xf
    v_add_f32_dpp v30, v30, v30 row_ror:4 row_mask:0xf bank_mask:0xf
    v_add_f32_dpp v24, v24, v24 row_ror:2 row_mask:0xf bank_mask:0xf
    v_add_f32_dpp v26, v26, v26 row_ror:2 row_mask:0xf bank_mask:0xf
    v_add_f32_dpp v28, v28, v28 row_ror:2 row_mask:0xf bank_mask:0xf
    v_add_f32_dpp v30, v30, v30 row_ror:2 row_mask:0xf bank_mask:0xf
    v_add_f32_dpp v24, v24, v24 row_ror:1 row_mask:0xf bank_mask:0xf
    v_add_f32_dpp v26, v26, v26 row_ror:1 row_mask:0xf bank_mask:0xf
    v_add_f32_dpp v28, v28, v28 row_ror:1 row_mask:0xf bank_mask:0xf
    v_add_f32_dpp v30, v30, v30 row_ror:1 row_mask:0xf bank_mask:0xf
    v_mul_f32 v32, 0xbb000000, v24
    v_mul_f32 v34, 0xbb000000, v26
    v_mul_f32 v36, 0xbb000000, v28
    v_mul_f32 v38, 0xbb000000, v30
    v_pk_add_f32 v[96:97], v[96:97], v[32:33] op_sel_hi:[1,0]
    v_pk_add_f32 v[128:129], v[128:129], v[34:35] op_sel_hi:[1,0]
    v_pk_add_f32 v[160:161], v[160:161], v[36:37] op_sel_hi:[1,0]
    v_pk_add_f32 v[192:193], v[192:193], v[38:39] op_sel_hi:[1,0]
    v_pk_mul_f32 v[24:25], v[96:97], v[96:97]
    v_pk_mul_f32 v[26:27], v[128:129], v[128:129]
    v_pk_mul_f32 v[28:29], v[160:161], v[160:161]
    v_pk_mul_f32 v[30:31], v[192:193], v[192:193]
    s_add_u32 m0, s33, 8192
    s_nop 0
    buffer_load_dwordx4 v14, s[20:23], s30 offen offset:0 lds
    v_pk_add_f32 v[98:99], v[98:99], v[32:33] op_sel_hi:[1,0]
    v_pk_add_f32 v[130:131], v[130:131], v[34:35] op_sel_hi:[1,0]
    v_pk_add_f32 v[162:163], v[162:163], v[36:37] op_sel_hi:[1,0]
    v_pk_add_f32 v[194:195], v[194:195], v[38:39] op_sel_hi:[1,0]
    v_pk_fma_f32 v[24:25], v[98:99], v[98:99], v[24:25]
    v_pk_fma_f32 v[26:27], v[130:131], v[130:131], v[26:27]
    v_pk_fma_f32 v[28:29], v[162:163], v[162:163], v[28:29]
    v_pk_fma_f32 v[30:31], v[194:195], v[194:195], v[30:31]
    buffer_load_dwordx4 v15, s[20:23], s30 offen offset:1024 lds
    v_pk_add_f32 v[100:101], v[100:101], v[32:33] op_sel_hi:[1,0]
    v_pk_add_f32 v[132:133], v[132:133], v[34:35] op_sel_hi:[1,0]
    v_pk_add_f32 v[164:165], v[164:165], v[36:37] op_sel_hi:[1,0]
    v_pk_add_f32 v[196:197], v[196:197], v[38:39] op_sel_hi:[1,0]
    v_pk_fma_f32 v[24:25], v[100:101], v[100:101], v[24:25]
    v_pk_fma_f32 v[26:27], v[132:133], v[132:133], v[26:27]
    v_pk_fma_f32 v[28:29], v[164:165], v[164:165], v[28:29]
    v_pk_fma_f32 v[30:31], v[196:197], v[196:197], v[30:31]
    buffer_load_dwordx4 v16, s[20:23], s30 offen offset:2048 lds
    v_pk_add_f32 v[102:103], v[102:103], v[32:33] op_sel_hi:[1,0]
    v_pk_add_f32 v[134:135], v[134:135], v[34:35] op_sel_hi:[1,0]
    v_pk_add_f32 v[166:167], v[166:167], v[36:37] op_sel_hi:[1,0]
    v_pk_add_f32 v[198:199], v[198:199], v[38:39] op_sel_hi:[1,0]
    v_pk_fma_f32 v[24:25], v[102:103], v[102:103], v[24:25]
    v_pk_fma_f32 v[26:27], v[134:135], v[134:135], v[26:27]
    v_pk_fma_f32 v[28:29], v[166:167], v[166:167], v[28:29]
    v_pk_fma_f32 v[30:31], v[198:199], v[198:199], v[30:31]
    buffer_load_dwordx4 v17, s[20:23], s30 offen offset:3072 lds
    s_add_u32 s30, s30, 131072
    v_pk_add_f32 v[104:105], v[104:105], v[32:33] op_sel_hi:[1,0]
    v_pk_add_f32 v[136:137], v[136:137], v[34:35] op_sel_hi:[1,0]
    v_pk_add_f32 v[168:169], v[168:169], v[36:37] op_sel_hi:[1,0]
    v_pk_add_f32 v[200:201], v[200:201], v[38:39] op_sel_hi:[1,0]
    v_pk_fma_f32 v[24:25], v[104:105], v[104:105], v[24:25]
    v_pk_fma_f32 v[26:27], v[136:137], v[136:137], v[26:27]
    v_pk_fma_f32 v[28:29], v[168:169], v[168:169], v[28:29]
    v_pk_fma_f32 v[30:31], v[200:201], v[200:201], v[30:31]
    s_add_u32 m0, s33, 12288
    s_nop 0
    buffer_load_dwordx4 v14, s[20:23], s30 offen offset:0 lds
    v_pk_add_f32 v[106:107], v[106:107], v[32:33] op_sel_hi:[1,0]
    v_pk_add_f32 v[138:139], v[138:139], v[34:35] op_sel_hi:[1,0]
    v_pk_add_f32 v[170:171], v[170:171], v[36:37] op_sel_hi:[1,0]
    v_pk_add_f32 v[202:203], v[202:203], v[38:39] op_sel_hi:[1,0]
    v_pk_fma_f32 v[24:25], v[106:107], v[106:107], v[24:25]
    v_pk_fma_f32 v[26:27], v[138:139], v[138:139], v[26:27]
    v_pk_fma_f32 v[28:29], v[170:171], v[170:171], v[28:29]
    v_pk_fma_f32 v[30:31], v[202:203], v[202:203], v[30:31]
    buffer_load_dwordx4 v15, s[20:23], s30 offen offset:1024 lds
    v_pk_add_f32 v[108:109], v[108:109], v[32:33] op_sel_hi:[1,0]
    v_pk_add_f32 v[140:141], v[140:141], v[34:35] op_sel_hi:[1,0]
    v_pk_add_f32 v[172:173], v[172:173], v[36:37] op_sel_hi:[1,0]
    v_pk_add_f32 v[204:205], v[204:205], v[38:39] op_sel_hi:[1,0]
    v_pk_fma_f32 v[24:25], v[108:109], v[108:109], v[24:25]
    v_pk_fma_f32 v[26:27], v[140:141], v[140:141], v[26:27]
    v_pk_fma_f32 v[28:29], v[172:173], v[172:173], v[28:29]
    v_pk_fma_f32 v[30:31], v[204:205], v[204:205], v[30:31]
    buffer_load_dwordx4 v16, s[20:23], s30 offen offset:2048 lds
    v_pk_add_f32 v[110:111], v[110:111], v[32:33] op_sel_hi:[1,0]
    v_pk_add_f32 v[142:143], v[142:143], v[34:35] op_sel_hi:[1,0]
    v_pk_add_f32 v[174:175], v[174:175], v[36:37] op_sel_hi:[1,0]
    v_pk_add_f32 v[206:207], v[206:207], v[38:39] op_sel_hi:[1,0]
    v_pk_fma_f32 v[24:25], v[110:111], v[110:111], v[24:25]
    v_pk_fma_f32 v[26:27], v[142:143], v[142:143], v[26:27]
    v_pk_fma_f32 v[28:29], v[174:175], v[174:175], v[28:29]
    v_pk_fma_f32 v[30:31], v[206:207], v[206:207], v[30:31]
    buffer_load_dwordx4 v17, s[20:23], s30 offen offset:3072 lds
    s_add_u32 s30, s30, 131072
    v_pk_add_f32 v[112:113], v[112:113], v[32:33] op_sel_hi:[1,0]
    v_pk_add_f32 v[144:145], v[144:145], v[34:35] op_sel_hi:[1,0]
    v_pk_add_f32 v[176:177], v[176:177], v[36:37] op_sel_hi:[1,0]
    v_pk_add_f32 v[208:209], v[208:209], v[38:39] op_sel_hi:[1,0]
    v_pk_fma_f32 v[24:25], v[112:113], v[112:113], v[24:25]
    v_pk_fma_f32 v[26:27], v[144:145], v[144:145], v[26:27]
    v_pk_fma_f32 v[28:29], v[176:177], v[176:177], v[28:29]
    v_pk_fma_f32 v[30:31], v[208:209], v[208:209], v[30:31]
    v_pk_add_f32 v[114:115], v[114:115], v[32:33] op_sel_hi:[1,0]
    v_pk_add_f32 v[146:147], v[146:147], v[34:35] op_sel_hi:[1,0]
    v_pk_add_f32 v[178:179], v[178:179], v[36:37] op_sel_hi:[1,0]
    v_pk_add_f32 v[210:211], v[210:211], v[38:39] op_sel_hi:[1,0]
    v_pk_fma_f32 v[24:25], v[114:115], v[114:115], v[24:25]
    v_pk_fma_f32 v[26:27], v[146:147], v[146:147], v[26:27]
    v_pk_fma_f32 v[28:29], v[178:179], v[178:179], v[28:29]
    v_pk_fma_f32 v[30:31], v[210:211], v[210:211], v[30:31]
    v_pk_add_f32 v[116:117], v[116:117], v[32:33] op_sel_hi:[1,0]
    v_pk_add_f32 v[148:149], v[148:149], v[34:35] op_sel_hi:[1,0]
    v_pk_add_f32 v[180:181], v[180:181], v[36:37] op_sel_hi:[1,0]
    v_pk_add_f32 v[212:213], v[212:213], v[38:39] op_sel_hi:[1,0]
    v_pk_fma_f32 v[24:25], v[116:117], v[116:117], v[24:25]
    v_pk_fma_f32 v[26:27], v[148:149], v[148:149], v[26:27]
    v_pk_fma_f32 v[28:29], v[180:181], v[180:181], v[28:29]
    v_pk_fma_f32 v[30:31], v[212:213], v[212:213], v[30:31]
    v_pk_add_f32 v[118:119], v[118:119], v[32:33] op_sel_hi:[1,0]
    v_pk_add_f32 v[150:151], v[150:151], v[34:35] op_sel_hi:[1,0]
    v_pk_add_f32 v[182:183], v[182:183], v[36:37] op_sel_hi:[1,0]
    v_pk_add_f32 v[214:215], v[214:215], v[38:39] op_sel_hi:[1,0]
    v_pk_fma_f32 v[24:25], v[118:119], v[118:119], v[24:25]
    v_pk_fma_f32 v[26:27], v[150:151], v[150:151], v[26:27]
    v_pk_fma_f32 v[28:29], v[182:183], v[182:183], v[28:29]
    v_pk_fma_f32 v[30:31], v[214:215], v[214:215], v[30:31]
    v_pk_add_f32 v[120:121], v[120:121], v[32:33] op_sel_hi:[1,0]
    v_pk_add_f32 v[152:153], v[152:153], v[34:35] op_sel_hi:[1,0]
    v_pk_add_f32 v[184:185], v[184:185], v[36:37] op_sel_hi:[1,0]
    v_pk_add_f32 v[216:217], v[216:217], v[38:39] op_sel_hi:[1,0]
    v_pk_fma_f32 v[24:25], v[120:121], v[120:121], v[24:25]
    v_pk_fma_f32 v[26:27], v[152:153], v[152:153], v[26:27]
    v_pk_fma_f32 v[28:29], v[184:185], v[184:185], v[28:29]
    v_pk_fma_f32 v[30:31], v[216:217], v[216:217], v[30:31]
    v_pk_add_f32 v[122:123], v[122:123], v[32:33] op_sel_hi:[1,0]
    v_pk_add_f32 v[154:155], v[154:155], v[34:35] op_sel_hi:[1,0]
    v_pk_add_f32 v[186:187], v[186:187], v[36:37] op_sel_hi:[1,0]
    v_pk_add_f32 v[218:219], v[218:219], v[38:39] op_sel_hi:[1,0]
    v_pk_fma_f32 v[24:25], v[122:123], v[122:123], v[24:25]
    v_pk_fma_f32 v[26:27], v[154:155], v[154:155], v[26:27]
    v_pk_fma_f32 v[28:29], v[186:187], v[186:187], v[28:29]
    v_pk_fma_f32 v[30:31], v[218:219], v[218:219], v[30:31]
    v_pk_add_f32 v[124:125], v[124:125], v[32:33] op_sel_hi:[1,0]
    v_pk_add_f32 v[156:157], v[156:157], v[34:35] op_sel_hi:[1,0]
    v_pk_add_f32 v[188:189], v[188:189], v[36:37] op_sel_hi:[1,0]
    v_pk_add_f32 v[220:221], v[220:221], v[38:39] op_sel_hi:[1,0]
    v_pk_fma_f32 v[24:25], v[124:125], v[124:125], v[24:25]
    v_pk_fma_f32 v[26:27], v[156:157], v[156:157], v[26:27]
    v_pk_fma_f32 v[28:29], v[188:189], v[188:189], v[28:29]
    v_pk_fma_f32 v[30:31], v[220:221], v[220:221], v[30:31]
    v_pk_add_f32 v[126:127], v[126:127], v[32:33] op_sel_hi:[1,0]
    v_pk_add_f32 v[158:159], v[158:159], v[34:35] op_sel_hi:[1,0]
    v_pk_add_f32 v[190:191], v[190:191], v[36:37] op_sel_hi:[1,0]
    v_pk_add_f32 v[222:223], v[222:223], v[38:39] op_sel_hi:[1,0]
    v_pk_fma_f32 v[24:25], v[126:127], v[126:127], v[24:25]
    v_pk_fma_f32 v[26:27], v[158:159], v[158:159], v[26:27]
    v_pk_fma_f32 v[28:29], v[190:191], v[190:191], v[28:29]
    v_pk_fma_f32 v[30:31], v[222:223], v[222:223], v[30:31]
    v_add_f32 v24, v24, v25
    v_add_f32 v26, v26, v27
    v_add_f32 v28, v28, v29
    v_add_f32 v30, v30, v31
    v_add_f32_dpp v24, v24, v24 row_ror:8 row_mask:0xf bank_mask:0xf
    v_add_f32_dpp v26, v26, v26 row_ror:8 row_mask:0xf bank_mask:0xf
    v_add_f32_dpp v28, v28, v28 row_ror:8 row_mask:0xf bank_mask:0xf
    v_add_f32_dpp v30, v30, v30 row_ror:8 row_mask:0xf bank_mask:0xf
    v_add_f32_dpp v24, v24, v24 row_ror:4 row_mask:0xf bank_mask:0xf
    v_add_f32_dpp v26, v26, v26 row_ror:4 row_mask:0xf bank_mask:0xf
    v_add_f32_dpp v28, v28, v28 row_ror:4 row_mask:0xf bank_mask:0xf
    v_add_f32_dpp v30, v30, v30 row_ror:4 row_mask:0xf bank_mask:0xf
    v_add_f32_dpp v24, v24, v24 row_ror:2 row_mask:0xf bank_mask:0xf
    v_add_f32_dpp v26, v26, v26 row_ror:2 row_mask:0xf bank_mask:0xf
    v_add_f32_dpp v28, v28, v28 row_ror:2 row_mask:0xf bank_mask:0xf
    v_add_f32_dpp v30, v30, v30 row_ror:2 row_mask:0xf bank_mask:0xf
    v_add_f32_dpp v24, v24, v24 row_ror:1 row_mask:0xf bank_mask:0xf
    v_add_f32_dpp v26, v26, v26 row_ror:1 row_mask:0xf bank_mask:0xf
    v_add_f32_dpp v28, v28, v28 row_ror:1 row_mask:0xf bank_mask:0xf
    v_add_f32_dpp v30, v30, v30 row_ror:1 row_mask:0xf bank_mask:0xf
    s_sub_u32 s6, s39, 32
    s_cmp_ge_u32 s6, 60
    s_cbranch_scc1 K1_L2
    s_waitcnt vmcnt(16)
    v_accvgpr_read_b32 v72, a64
    v_accvgpr_read_b32 v73, a65
    v_accvgpr_read_b32 v74, a66
    v_accvgpr_read_b32 v75, a67
    v_accvgpr_read_b32 v76, a68
    v_accvgpr_read_b32 v77, a69
    v_accvgpr_read_b32 v78, a70
    v_accvgpr_read_b32 v79, a71
    v_accvgpr_read_b32 v40, a0
    v_accvgpr_read_b32 v41, a1
    v_accvgpr_read_b32 v42, a2
    v_accvgpr_read_b32 v43, a3
    v_accvgpr_read_b32 v44, a4
    v_accvgpr_read_b32 v45, a5
    v_accvgpr_read_b32 v46, a6
    v_accvgpr_read_b32 v47, a7
    v_accvgpr_read_b32 v48, a8
    v_accvgpr_read_b32 v49, a9
    v_accvgpr_read_b32 v50, a10
    v_accvgpr_read_b32 v51, a11
    v_accvgpr_read_b32 v52, a12
    v_accvgpr_read_b32 v53, a13
    v_accvgpr_read_b32 v54, a14
    v_accvgpr_read_b32 v55, a15
    v_accvgpr_read_b32 v56, a16
    v_accvgpr_read_b32 v57, a17
    v_accvgpr_read_b32 v58, a18
    v_accvgpr_read_b32 v59, a19
    v_accvgpr_read_b32 v60, a20
    v_accvgpr_read_b32 v61, a21
    v_accvgpr_read_b32 v62, a22
    v_accvgpr_read_b32 v63, a23
    v_accvgpr_read_b32 v64, a24
    v_accvgpr_read_b32 v65, a25
    v_accvgpr_read_b32 v66, a26
    v_accvgpr_read_b32 v67, a27
    v_accvgpr_read_b32 v68, a28
    v_accvgpr_read_b32 v69, a29
    v_accvgpr_read_b32 v70, a30
    v_accvgpr_read_b32 v71, a31
    v_lshlrev_b32 v72, 16, v72
    v_lshlrev_b32 v73, 16, v73
    v_lshlrev_b32 v74, 16, v74
    v_lshlrev_b32 v75, 16, v75
    v_lshlrev_b32 v76, 16, v76
    v_lshlrev_b32 v77, 16, v77
    v_lshlrev_b32 v78, 16, v78
    v_lshlrev_b32 v79, 16, v79
    v_mul_f32 v80, 0xbfb8aa3b, v72
    v_mul_f32 v81, 0xbfb8aa3b, v73
    v_mul_f32 v82, 0xbfb8aa3b, v74
    v_mul_f32 v83, 0xbfb8aa3b, v75
    v_mul_f32 v84, 0xbfb8aa3b, v76
    v_mul_f32 v85, 0xbfb8aa3b, v77
    v_mul_f32 v86, 0xbfb8aa3b, v78
    v_mul_f32 v87, 0xbfb8aa3b, v79
    v_exp_f32 v80, v80
    v_exp_f32 v81, v81
    v_exp_f32 v82, v82
    v_exp_f32 v83, v83
    v_exp_f32 v84, v84
    v_exp_f32 v85, v85
    v_exp_f32 v86, v86
    v_exp_f32 v87, v87
    v_add_f32 v80, 1.0, v80
    v_add_f32 v81, 1.0, v81
    v_add_f32 v82, 1.0, v82
    v_add_f32 v83, 1.0, v83
    v_add_f32 v84, 1.0, v84
    v_add_f32 v85, 1.0, v85
    v_add_f32 v86, 1.0, v86
    v_add_f32 v87, 1.0, v87
    v_rcp_f32 v80, v80
    v_rcp_f32 v81, v81
    v_rcp_f32 v82, v82
    v_rcp_f32 v83, v83
    v_rcp_f32 v84, v84
    v_rcp_f32 v85, v85
    v_rcp_f32 v86, v86
    v_rcp_f32 v87, v87
    v_mul_f32 v72, v72, v80
    v_mul_f32 v73, v73, v81
    v_mul_f32 v74, v74, v82
    v_mul_f32 v75, v75, v83
    v_mul_f32 v76, v76, v84
    v_mul_f32 v77, v77, v85
    v_mul_f32 v78, v78, v86
    v_mul_f32 v79, v79, v87
    v_cvt_pk_bf16_f32 v72, v72, v72
    v_cvt_pk_bf16_f32 v73, v73, v73
    v_cvt_pk_bf16_f32 v74, v74, v74
    v_cvt_pk_bf16_f32 v75, v75, v75
    v_cvt_pk_bf16_f32 v76, v76, v76
    v_cvt_pk_bf16_f32 v77, v77, v77
    v_cvt_pk_bf16_f32 v78, v78, v78
    v_cvt_pk_bf16_f32 v79, v79, v79
    v_lshlrev_b32 v72, 16, v72
    v_lshlrev_b32 v73, 16, v73
    v_lshlrev_b32 v74, 16, v74
    v_lshlrev_b32 v75, 16, v75
    v_lshlrev_b32 v76, 16, v76
    v_lshlrev_b32 v77, 16, v77
    v_lshlrev_b32 v78, 16, v78
    v_lshlrev_b32 v79, 16, v79
    s_cmp_lt_u32 s39, 64
    s_cbranch_scc1 K1_T30
    v_mov_b32 v72, 1.0
    v_mov_b32 v73, 1.0
    v_mov_b32 v74, 1.0
    v_mov_b32 v75, 1.0
    v_mov_b32 v76, 1.0
    v_mov_b32 v77, 1.0
    v_mov_b32 v78, 1.0
    v_mov_b32 v79, 1.0
K1_T30:
    v_lshlrev_b32 v80, 16, v40
    v_and_b32 v81, 0xffff0000, v40
    v_lshlrev_b32 v82, 16, v41
    v_and_b32 v83, 0xffff0000, v41
    v_lshlrev_b32 v84, 16, v42
    v_and_b32 v85, 0xffff0000, v42
    v_lshlrev_b32 v86, 16, v43
    v_and_b32 v87, 0xffff0000, v43
    v_pk_mul_f32 v[88:89], v[80:81], v[72:73] op_sel:[0,0] op_sel_hi:[1,0]
    v_pk_mul_f32 v[90:91], v[82:83], v[72:73] op_sel:[0,0] op_sel_hi:[1,0]
    v_pk_mul_f32 v[92:93], v[84:85], v[72:73] op_sel:[0,0] op_sel_hi:[1,0]
    v_pk_mul_f32 v[94:95], v[86:87], v[72:73] op_sel:[0,0] op_sel_hi:[1,0]
    v_lshlrev_b32 v80, 16, v44
    v_and_b32 v81, 0xffff0000, v44
    v_lshlrev_b32 v82, 16, v45
    v_and_b32 v83, 0xffff0000, v45
    v_lshlrev_b32 v84, 16, v46
    v_and_b32 v85, 0xffff0000, v46
    v_lshlrev_b32 v86, 16, v47
    v_and_b32 v87, 0xffff0000, v47
    v_pk_fma_f32 v[88:89], v[80:81], v[72:73], v[88:89] op_sel:[0,1,0] op_sel_hi:[1,1,1]
    v_pk_fma_f32 v[90:91], v[82:83], v[72:73], v[90:91] op_sel:[0,1,0] op_sel_hi:[1,1,1]
    v_pk_fma_f32 v[92:93], v[84:85], v[72:73], v[92:93] op_sel:[0,1,0] op_sel_hi:[1,1,1]
    v_pk_fma_f32 v[94:95], v[86:87], v[72:73], v[94:95] op_sel:[0,1,0] op_sel_hi:[1,1,1]
    v_lshlrev_b32 v80, 16, v48
    v_and_b32 v81, 0xffff0000, v48
    v_lshlrev_b32 v82, 16, v49
    v_and_b32 v83, 0xffff0000, v49
    v_lshlrev_b32 v84, 16, v50
    v_and_b32 v85, 0xffff0000, v50
    v_lshlrev_b32 v86, 16, v51
    v_and_b32 v87, 0xffff0000, v51
    v_pk_fma_f32 v[88:89], v[80:81], v[74:75], v[88:89] op_sel:[0,0,0] op_sel_hi:[1,0,1]
    v_pk_fma_f32 v[90:91], v[82:83], v[74:75], v[90:91] op_sel:[0,0,0] op_sel_hi:[1,0,1]
    v_pk_fma_f32 v[92:93], v[84:85], v[74:75], v[92:93] op_sel:[0,0,0] op_sel_hi:[1,0,1]
    v_pk_fma_f32 v[94:95], v[86:87], v[74:75], v[94:95] op_sel:[0,0,0] op_sel_hi:[1,0,1]
    v_lshlrev_b32 v80, 16, v52
    v_and_b32 v81, 0xffff0000, v52
    v_lshlrev_b32 v82, 16, v53
    v_and_b32 v83, 0xffff0000, v53
    v_lshlrev_b32 v84, 16, v54
    v_and_b32 v85, 0xffff0000, v54
    v_lshlrev_b32 v86, 16, v55
    v_and_b32 v87, 0xffff0000, v55
    v_pk_fma_f32 v[88:89], v[80:81], v[74:75], v[88:89] op_sel:[0,1,0] op_sel_hi:[1,1,1]
    v_pk_fma_f32 v[90:91], v[82:83], v[74:75], v[90:91] op_sel:[0,1,0] op_sel_hi:[1,1,1]
    v_pk_fma_f32 v[92:93], v[84:85], v[74:75], v[92:93] op_sel:[0,1,0] op_sel_hi:[1,1,1]
    v_pk_fma_f32 v[94:95], v[86:87], v[74:75], v[94:95] op_sel:[0,1,0] op_sel_hi:[1,1,1]
    v_lshlrev_b32 v80, 16, v56
    v_and_b32 v81, 0xffff0000, v56
    v_lshlrev_b32 v82, 16, v57
    v_and_b32 v83, 0xffff0000, v57
    v_lshlrev_b32 v84, 16, v58
    v_and_b32 v85, 0xffff0000, v58
    v_lshlrev_b32 v86, 16, v59
    v_and_b32 v87, 0xffff0000, v59
    v_pk_fma_f32 v[88:89], v[80:81], v[76:77], v[88:89] op_sel:[0,0,0] op_sel_hi:[1,0,1]
    v_pk_fma_f32 v[90:91], v[82:83], v[76:77], v[90:91] op_sel:[0,0,0] op_sel_hi:[1,0,1]
    v_pk_fma_f32 v[92:93], v[84:85], v[76:77], v[92:93] op_sel:[0,0,0] op_sel_hi:[1,0,1]
    v_pk_fma_f32 v[94:95], v[86:87], v[76:77], v[94:95] op_sel:[0,0,0] op_sel_hi:[1,0,1]
    v_lshlrev_b32 v80, 16, v60
    v_and_b32 v81, 0xffff0000, v60
    v_lshlrev_b32 v82, 16, v61
    v_and_b32 v83, 0xffff0000, v61
    v_lshlrev_b32 v84, 16, v62
    v_and_b32 v85, 0xffff0000, v62
    v_lshlrev_b32 v86, 16, v63
    v_and_b32 v87, 0xffff0000, v63
    v_pk_fma_f32 v[88:89], v[80:81], v[76:77], v[88:89] op_sel:[0,1,0] op_sel_hi:[1,1,1]
    v_pk_fma_f32 v[90:91], v[82:83], v[76:77], v[90:91] op_sel:[0,1,0] op_sel_hi:[1,1,1]
    v_pk_fma_f32 v[92:93], v[84:85], v[76:77], v[92:93] op_sel:[0,1,0] op_sel_hi:[1,1,1]
    v_pk_fma_f32 v[94:95], v[86:87], v[76:77], v[94:95] op_sel:[0,1,0] op_sel_hi:[1,1,1]
    v_lshlrev_b32 v80, 16, v64
    v_and_b32 v81, 0xffff0000, v64
    v_lshlrev_b32 v82, 16, v65
    v_and_b32 v83, 0xffff0000, v65
    v_lshlrev_b32 v84, 16, v66
    v_and_b32 v85, 0xffff0000, v66
    v_lshlrev_b32 v86, 16, v67
    v_and_b32 v87, 0xffff0000, v67
    v_pk_fma_f32 v[88:89], v[80:81], v[78:79], v[88:89] op_sel:[0,0,0] op_sel_hi:[1,0,1]
    v_pk_fma_f32 v[90:91], v[82:83], v[78:79], v[90:91] op_sel:[0,0,0] op_sel_hi:[1,0,1]
    v_pk_fma_f32 v[92:93], v[84:85], v[78:79], v[92:93] op_sel:[0,0,0] op_sel_hi:[1,0,1]
    v_pk_fma_f32 v[94:95], v[86:87], v[78:79], v[94:95] op_sel:[0,0,0] op_sel_hi:[1,0,1]
    v_lshlrev_b32 v80, 16, v68
    v_and_b32 v81, 0xffff0000, v68
    v_lshlrev_b32 v82, 16, v69
    v_and_b32 v83, 0xffff0000, v69
    v_lshlrev_b32 v84, 16, v70
    v_and_b32 v85, 0xffff0000, v70
    v_lshlrev_b32 v86, 16, v71
    v_and_b32 v87, 0xffff0000, v71
    v_pk_fma_f32 v[88:89], v[80:81], v[78:79], v[88:89] op_sel:[0,1,0] op_sel_hi:[1,1,1]
    v_pk_fma_f32 v[90:91], v[82:83], v[78:79], v[90:91] op_sel:[0,1,0] op_sel_hi:[1,1,1]
    v_pk_fma_f32 v[92:93], v[84:85], v[78:79], v[92:93] op_sel:[0,1,0] op_sel_hi:[1,1,1]
    v_pk_fma_f32 v[94:95], v[86:87], v[78:79], v[94:95] op_sel:[0,1,0] op_sel_hi:[1,1,1]
    v_accvgpr_read_b32 v72, a72
    v_accvgpr_read_b32 v73, a73
    v_accvgpr_read_b32 v74, a74
    v_accvgpr_read_b32 v75, a75
    v_accvgpr_read_b32 v76, a76
    v_accvgpr_read_b32 v77, a77
    v_accvgpr_read_b32 v78, a78
    v_accvgpr_read_b32 v79, a79
    v_accvgpr_read_b32 v40, a32
    v_accvgpr_read_b32 v41, a33
    v_accvgpr_read_b32 v42, a34
    v_accvgpr_read_b32 v43, a35
    v_accvgpr_read_b32 v44, a36
    v_accvgpr_read_b32 v45, a37
    v_accvgpr_read_b32 v46, a38
    v_accvgpr_read_b32 v47, a39
    v_accvgpr_read_b32 v48, a40
    v_accvgpr_read_b32 v49, a41
    v_accvgpr_read_b32 v50, a42
    v_accvgpr_read_b32 v51, a43
    v_accvgpr_read_b32 v52, a44
    v_accvgpr_read_b32 v53, a45
    v_accvgpr_read_b32 v54, a46
    v_accvgpr_read_b32 v55, a47
    v_accvgpr_read_b32 v56, a48
    v_accvgpr_read_b32 v57, a49
    v_accvgpr_read_b32 v58, a50
    v_accvgpr_read_b32 v59, a51
    v_accvgpr_read_b32 v60, a52
    v_accvgpr_read_b32 v61, a53
    v_accvgpr_read_b32 v62, a54
    v_accvgpr_read_b32 v63, a55
    v_accvgpr_read_b32 v64, a56
    v_accvgpr_read_b32 v65, a57
    v_accvgpr_read_b32 v66, a58
    v_accvgpr_read_b32 v67, a59
    v_accvgpr_read_b32 v68, a60
    v_accvgpr_read_b32 v69, a61
    v_accvgpr_read_b32 v70, a62
    v_accvgpr_read_b32 v71, a63
    v_lshlrev_b32 v72, 16, v72
    v_lshlrev_b32 v73, 16, v73
    v_lshlrev_b32 v74, 16, v74
    v_lshlrev_b32 v75, 16, v75
    v_lshlrev_b32 v76, 16, v76
    v_lshlrev_b32 v77, 16, v77
    v_lshlrev_b32 v78, 16, v78
    v_lshlrev_b32 v79, 16, v79
    v_mul_f32 v80, 0xbfb8aa3b, v72
    v_mul_f32 v81, 0xbfb8aa3b, v73
    v_mul_f32 v82, 0xbfb8aa3b, v74
    v_mul_f32 v83, 0xbfb8aa3b, v75
    v_mul_f32 v84, 0xbfb8aa3b, v76
    v_mul_f32 v85, 0xbfb8aa3b, v77
    v_mul_f32 v86, 0xbfb8aa3b, v78
    v_mul_f32 v87, 0xbfb8aa3b, v79
    v_exp_f32 v80, v80
    v_exp_f32 v81, v81
    v_exp_f32 v82, v82
    v_exp_f32 v83, v83
    v_exp_f32 v84, v84
    v_exp_f32 v85, v85
    v_exp_f32 v86, v86
    v_exp_f32 v87, v87
    v_add_f32 v80, 1.0, v80
    v_add_f32 v81, 1.0, v81
    v_add_f32 v82, 1.0, v82
    v_add_f32 v83, 1.0, v83
    v_add_f32 v84, 1.0, v84
    v_add_f32 v85, 1.0, v85
    v_add_f32 v86, 1.0, v86
    v_add_f32 v87, 1.0, v87
    v_rcp_f32 v80, v80
    v_rcp_f32 v81, v81
    v_rcp_f32 v82, v82
    v_rcp_f32 v83, v83
    v_rcp_f32 v84, v84
    v_rcp_f32 v85, v85
    v_rcp_f32 v86, v86
    v_rcp_f32 v87, v87
    v_mul_f32 v72, v72, v80
    v_mul_f32 v73, v73, v81
    v_mul_f32 v74, v74, v82
    v_mul_f32 v75, v75, v83
    v_mul_f32 v76, v76, v84
    v_mul_f32 v77, v77, v85
    v_mul_f32 v78, v78, v86
    v_mul_f32 v79, v79, v87
    v_cvt_pk_bf16_f32 v72, v72, v72
    v_cvt_pk_bf16_f32 v73, v73, v73
    v_cvt_pk_bf16_f32 v74, v74, v74
    v_cvt_pk_bf16_f32 v75, v75, v75
    v_cvt_pk_bf16_f32 v76, v76, v76
    v_cvt_pk_bf16_f32 v77, v77, v77
    v_cvt_pk_bf16_f32 v78, v78, v78
    v_cvt_pk_bf16_f32 v79, v79, v79
    v_lshlrev_b32 v72, 16, v72
    v_lshlrev_b32 v73, 16, v73
    v_lshlrev_b32 v74, 16, v74
    v_lshlrev_b32 v75, 16, v75
    v_lshlrev_b32 v76, 16, v76
    v_lshlrev_b32 v77, 16, v77
    v_lshlrev_b32 v78, 16, v78
    v_lshlrev_b32 v79, 16, v79
    s_cmp_lt_u32 s39, 64
    s_cbranch_scc1 K1_T31
    v_mov_b32 v72, 1.0
    v_mov_b32 v73, 1.0
    v_mov_b32 v74, 1.0
    v_mov_b32 v75, 1.0
    v_mov_b32 v76, 1.0
    v_mov_b32 v77, 1.0
    v_mov_b32 v78, 1.0
    v_mov_b32 v79, 1.0
K1_T31:
    v_lshlrev_b32 v80, 16, v40
    v_and_b32 v81, 0xffff0000, v40
    v_lshlrev_b32 v82, 16, v41
    v_and_b32 v83, 0xffff0000, v41
    v_lshlrev_b32 v84, 16, v42
    v_and_b32 v85, 0xffff0000, v42
    v_lshlrev_b32 v86, 16, v43
    v_and_b32 v87, 0xffff0000, v43
    v_pk_fma_f32 v[88:89], v[80:81], v[72:73], v[88:89] op_sel:[0,0,0] op_sel_hi:[1,0,1]
    v_pk_fma_f32 v[90:91], v[82:83], v[72:73], v[90:91] op_sel:[0,0,0] op_sel_hi:[1,0,1]
    v_pk_fma_f32 v[92:93], v[84:85], v[72:73], v[92:93] op_sel:[0,0,0] op_sel_hi:[1,0,1]
    v_pk_fma_f32 v[94:95], v[86:87], v[72:73], v[94:95] op_sel:[0,0,0] op_sel_hi:[1,0,1]
    v_lshlrev_b32 v80, 16, v44
    v_and_b32 v81, 0xffff0000, v44
    v_lshlrev_b32 v82, 16, v45
    v_and_b32 v83, 0xffff0000, v45
    v_lshlrev_b32 v84, 16, v46
    v_and_b32 v85, 0xffff0000, v46
    v_lshlrev_b32 v86, 16, v47
    v_and_b32 v87, 0xffff0000, v47
    v_pk_fma_f32 v[88:89], v[80:81], v[72:73], v[88:89] op_sel:[0,1,0] op_sel_hi:[1,1,1]
    v_pk_fma_f32 v[90:91], v[82:83], v[72:73], v[90:91] op_sel:[0,1,0] op_sel_hi:[1,1,1]
    v_pk_fma_f32 v[92:93], v[84:85], v[72:73], v[92:93] op_sel:[0,1,0] op_sel_hi:[1,1,1]
    v_pk_fma_f32 v[94:95], v[86:87], v[72:73], v[94:95] op_sel:[0,1,0] op_sel_hi:[1,1,1]
    v_lshlrev_b32 v80, 16, v48
    v_and_b32 v81, 0xffff0000, v48
    v_lshlrev_b32 v82, 16, v49
    v_and_b32 v83, 0xffff0000, v49
    v_lshlrev_b32 v84, 16, v50
    v_and_b32 v85, 0xffff0000, v50
    v_lshlrev_b32 v86, 16, v51
    v_and_b32 v87, 0xffff0000, v51
    v_pk_fma_f32 v[88:89], v[80:81], v[74:75], v[88:89] op_sel:[0,0,0] op_sel_hi:[1,0,1]
    v_pk_fma_f32 v[90:91], v[82:83], v[74:75], v[90:91] op_sel:[0,0,0] op_sel_hi:[1,0,1]
    v_pk_fma_f32 v[92:93], v[84:85], v[74:75], v[92:93] op_sel:[0,0,0] op_sel_hi:[1,0,1]
    v_pk_fma_f32 v[94:95], v[86:87], v[74:75], v[94:95] op_sel:[0,0,0] op_sel_hi:[1,0,1]
    v_lshlrev_b32 v80, 16, v52
    v_and_b32 v81, 0xffff0000, v52
    v_lshlrev_b32 v82, 16, v53
    v_and_b32 v83, 0xffff0000, v53
    v_lshlrev_b32 v84, 16, v54
    v_and_b32 v85, 0xffff0000, v54
    v_lshlrev_b32 v86, 16, v55
    v_and_b32 v87, 0xffff0000, v55
    v_pk_fma_f32 v[88:89], v[80:81], v[74:75], v[88:89] op_sel:[0,1,0] op_sel_hi:[1,1,1]
    v_pk_fma_f32 v[90:91], v[82:83], v[74:75], v[90:91] op_sel:[0,1,0] op_sel_hi:[1,1,1]
    v_pk_fma_f32 v[92:93], v[84:85], v[74:75], v[92:93] op_sel:[0,1,0] op_sel_hi:[1,1,1]
    v_pk_fma_f32 v[94:95], v[86:87], v[74:75], v[94:95] op_sel:[0,1,0] op_sel_hi:[1,1,1]
    v_lshlrev_b32 v80, 16, v56
    v_and_b32 v81, 0xffff0000, v56
    v_lshlrev_b32 v82, 16, v57
    v_and_b32 v83, 0xffff0000, v57
    v_lshlrev_b32 v84, 16, v58
    v_and_b32 v85, 0xffff0000, v58
    v_lshlrev_b32 v86, 16, v59
    v_and_b32 v87, 0xffff0000, v59
    v_pk_fma_f32 v[88:89], v[80:81], v[76:77], v[88:89] op_sel:[0,0,0] op_sel_hi:[1,0,1]
    v_pk_fma_f32 v[90:91], v[82:83], v[76:77], v[90:91] op_sel:[0,0,0] op_sel_hi:[1,0,1]
    v_pk_fma_f32 v[92:93], v[84:85], v[76:77], v[92:93] op_sel:[0,0,0] op_sel_hi:[1,0,1]
    v_pk_fma_f32 v[94:95], v[86:87], v[76:77], v[94:95] op_sel:[0,0,0] op_sel_hi:[1,0,1]
    v_lshlrev_b32 v80, 16, v60
    v_and_b32 v81, 0xffff0000, v60
    v_lshlrev_b32 v82, 16, v61
    v_and_b32 v83, 0xffff0000, v61
    v_lshlrev_b32 v84, 16, v62
    v_and_b32 v85, 0xffff0000, v62
    v_lshlrev_b32 v86, 16, v63
    v_and_b32 v87, 0xffff0000, v63
    v_pk_fma_f32 v[88:89], v[80:81], v[76:77], v[88:89] op_sel:[0,1,0] op_sel_hi:[1,1,1]
    v_pk_fma_f32 v[90:91], v[82:83], v[76:77], v[90:91] op_sel:[0,1,0] op_sel_hi:[1,1,1]
    v_pk_fma_f32 v[92:93], v[84:85], v[76:77], v[92:93] op_sel:[0,1,0] op_sel_hi:[1,1,1]
    v_pk_fma_f32 v[94:95], v[86:87], v[76:77], v[94:95] op_sel:[0,1,0] op_sel_hi:[1,1,1]
    v_lshlrev_b32 v80, 16, v64
    v_and_b32 v81, 0xffff0000, v64
    v_lshlrev_b32 v82, 16, v65
    v_and_b32 v83, 0xffff0000, v65
    v_lshlrev_b32 v84, 16, v66
    v_and_b32 v85, 0xffff0000, v66
    v_lshlrev_b32 v86, 16, v67
    v_and_b32 v87, 0xffff0000, v67
    v_pk_fma_f32 v[88:89], v[80:81], v[78:79], v[88:89] op_sel:[0,0,0] op_sel_hi:[1,0,1]
    v_pk_fma_f32 v[90:91], v[82:83], v[78:79], v[90:91] op_sel:[0,0,0] op_sel_hi:[1,0,1]
    v_pk_fma_f32 v[92:93], v[84:85], v[78:79], v[92:93] op_sel:[0,0,0] op_sel_hi:[1,0,1]
    v_pk_fma_f32 v[94:95], v[86:87], v[78:79], v[94:95] op_sel:[0,0,0] op_sel_hi:[1,0,1]
    v_lshlrev_b32 v80, 16, v68
    v_and_b32 v81, 0xffff0000, v68
    v_lshlrev_b32 v82, 16, v69
    v_and_b32 v83, 0xffff0000, v69
    v_lshlrev_b32 v84, 16, v70
    v_and_b32 v85, 0xffff0000, v70
    v_lshlrev_b32 v86, 16, v71
    v_and_b32 v87, 0xffff0000, v71
    v_pk_fma_f32 v[88:89], v[80:81], v[78:79], v[88:89] op_sel:[0,1,0] op_sel_hi:[1,1,1]
    v_pk_fma_f32 v[90:91], v[82:83], v[78:79], v[90:91] op_sel:[0,1,0] op_sel_hi:[1,1,1]
    v_pk_fma_f32 v[92:93], v[84:85], v[78:79], v[92:93] op_sel:[0,1,0] op_sel_hi:[1,1,1]
    v_pk_fma_f32 v[94:95], v[86:87], v[78:79], v[94:95] op_sel:[0,1,0] op_sel_hi:[1,1,1]
    v_add_f32_dpp v88, v88, v88 row_ror:8 row_mask:0xf bank_mask:0xf
    v_add_f32_dpp v89, v89, v89 row_ror:8 row_mask:0xf bank_mask:0xf
    v_add_f32_dpp v90, v90, v90 row_ror:8 row_mask:0xf bank_mask:0xf
    v_add_f32_dpp v91, v91, v91 row_ror:8 row_mask:0xf bank_mask:0xf
    v_add_f32_dpp v92, v92, v92 row_ror:8 row_mask:0xf bank_mask:0xf
    v_add_f32_dpp v93, v93, v93 row_ror:8 row_mask:0xf bank_mask:0xf
    v_add_f32_dpp v94, v94, v94 row_ror:8 row_mask:0xf bank_mask:0xf
    v_add_f32_dpp v95, v95, v95 row_ror:8 row_mask:0xf bank_mask:0xf
    v_lshrrev_b32 v80, 4, v0
    v_lshlrev_b32 v80, 8, v80
    v_and_b32 v81, 7, v0
    v_lshl_add_u32 v80, v81, 5, v80
    ds_write_b128 v80, v[88:91]
    ds_write_b128 v80, v[92:95] offset:16
    v_lshlrev_b32 v80, 2, v1
    s_waitcnt lgkmcnt(0)
    s_barrier
    s_cmp_lg_u32 s5, 0
    s_cbranch_scc1 K1_L2
    ds_read_b32 v40, v80 offset:0
    ds_read_b32 v41, v80 offset:256
    ds_read_b32 v42, v80 offset:512
    ds_read_b32 v43, v80 offset:768
    ds_read_b32 v44, v80 offset:1024
    ds_read_b32 v45, v80 offset:1280
    ds_read_b32 v46, v80 offset:1536
    ds_read_b32 v47, v80 offset:1792
    s_waitcnt lgkmcnt(0)
    ds_read_b32 v48, v80 offset:2048
    ds_read_b32 v49, v80 offset:2304
    ds_read_b32 v50, v80 offset:2560
    ds_read_b32 v51, v80 offset:2816
    ds_read_b32 v52, v80 offset:3072
    ds_read_b32 v53, v80 offset:3328
    ds_read_b32 v54, v80 offset:3584
    ds_read_b32 v55, v80 offset:3840
    s_waitcnt lgkmcnt(0)
    v_add_f32 v40, v40, v48
    v_add_f32 v41, v41, v49
    v_add_f32 v42, v42, v50
    v_add_f32 v43, v43, v51
    v_add_f32 v44, v44, v52
    v_add_f32 v45, v45, v53
    v_add_f32 v46, v46, v54
    v_add_f32 v47, v47, v55
    v_add_f32 v40, v40, v44
    v_add_f32 v41, v41, v45
    v_add_f32 v42, v42, v46
    v_add_f32 v43, v43, v47
    v_add_f32 v40, v40, v42
    v_add_f32 v41, v41, v43
    v_add_f32 v40, v40, v41
    s_cmp_lt_u32 s39, 64
    s_cbranch_scc1 K1_T4
    s_lshl_b32 s56, s39, 8
    buffer_store_dword v40, v80, s[8:11], s56 offen offset:0 sc1
    s_branch K1_L2
K1_T4:
    v_cvt_pk_bf16_f32 v40, v40, v40
    s_lshr_b32 s56, s39, 3
    s_cmp_eq_u32 s56, 6
    s_cselect_b32 s57, 1.0, 0
    v_lshlrev_b32 v40, 16, v40
    v_add_f32 v40, s57, v40
    s_nop 1
    v_mov_b32_dpp v41, v40 quad_perm:[1,1,3,3] row_mask:0xf bank_mask:0xf
    v_cvt_pk_bf16_f32 v44, v40, v41
    s_nop 1
    v_mov_b32_dpp v45, v44 row_shl:2 row_mask:0xf bank_mask:0xf
    v_mov_b32_dpp v46, v44 row_shl:4 row_mask:0xf bank_mask:0xf
    v_mov_b32_dpp v47, v44 row_shl:6 row_mask:0xf bank_mask:0xf
    v_lshrrev_b32 v80, 1, v80
    s_lshl_b32 s56, s39, 7
    s_add_u32 s56, s56, 22528
    s_mov_b32 exec_lo, 0x01010101
    s_mov_b32 exec_hi, 0x01010101
    buffer_store_dwordx4 v[44:47], v80, s[8:11], s56 offen sc1
    s_mov_b64 exec, -1
K1_L2:
    s_cmp_lg_u32 s5, 1
    s_cbranch_scc1 K1_MD1
    buffer_load_dword v224, off, s[40:43], 0 sc1
    s_mov_b32 s6, 30000
    s_waitcnt vmcnt(0)
K1_MD0:
    v_cmp_eq_u32 vcc, 0, v224
    s_sub_u32 s6, s6, 1
    s_cbranch_vccz K1_MD1
    s_cmp_eq_u32 s6, 0
    s_cbranch_scc1 K1_MD1
    buffer_load_dword v224, off, s[40:43], 0 sc1
    s_waitcnt vmcnt(0)
    s_branch K1_MD0
K1_MD1:
    s_barrier
    s_lshl_b32 s36, s5, 10
    buffer_load_dwordx4 v[224:227], v21, s[8:11], s36 offen sc1
    s_add_u32 s36, s36, 4096
    buffer_load_dwordx4 v[228:231], v21, s[8:11], s36 offen sc1
    s_add_u32 s36, s36, 4096
    buffer_load_dwordx4 v[232:235], v21, s[8:11], s36 offen sc1
    s_add_u32 s36, s36, 4096
    buffer_load_dwordx4 v[236:239], v21, s[8:11], s36 offen sc1
    s_add_u32 s36, s36, 4096
    v_mov_b32 v25, 0x3727c5ac
    v_mov_b32 v27, 0x3727c5ac
    v_mov_b32 v29, 0x3727c5ac
    v_mov_b32 v31, 0x3727c5ac
    v_fmac_f32 v25, 0x3b000000, v24
    v_fmac_f32 v27, 0x3b000000, v26
    v_fmac_f32 v29, 0x3b000000, v28
    v_fmac_f32 v31, 0x3b000000, v30
    v_rsq_f32 v24, v25
    v_rsq_f32 v26, v27
    v_rsq_f32 v28, v29
    v_rsq_f32 v30, v31
    v_mul_f32 v24, 0x3e0293ee, v24
    v_mul_f32 v26, 0x3e0293ee, v26
    v_mul_f32 v28, 0x3e0293ee, v28
    v_mul_f32 v30, 0x3e0293ee, v30
    v_pk_mul_f32 v[96:97], v[96:97], v[24:25] op_sel_hi:[1,0]
    v_pk_mul_f32 v[128:129], v[128:129], v[26:27] op_sel_hi:[1,0]
    v_pk_mul_f32 v[160:161], v[160:161], v[28:29] op_sel_hi:[1,0]
    v_pk_mul_f32 v[192:193], v[192:193], v[30:31] op_sel_hi:[1,0]
    s_add_u32 m0, s33, 16384
    s_nop 0
    buffer_load_dwordx4 v14, s[20:23], s30 offen offset:0 lds
    v_pk_mul_f32 v[98:99], v[98:99], v[24:25] op_sel_hi:[1,0]
    v_pk_mul_f32 v[130:131], v[130:131], v[26:27] op_sel_hi:[1,0]
    v_pk_mul_f32 v[162:163], v[162:163], v[28:29] op_sel_hi:[1,0]
    v_pk_mul_f32 v[194:195], v[194:195], v[30:31] op_sel_hi:[1,0]
    buffer_load_dwordx4 v15, s[20:23], s30 offen offset:1024 lds
    v_pk_mul_f32 v[100:101], v[100:101], v[24:25] op_sel_hi:[1,0]
    v_pk_mul_f32 v[132:133], v[132:133], v[26:27] op_sel_hi:[1,0]
    v_pk_mul_f32 v[164:165], v[164:165], v[28:29] op_sel_hi:[1,0]
    v_pk_mul_f32 v[196:197], v[196:197], v[30:31] op_sel_hi:[1,0]
    buffer_load_dwordx4 v16, s[20:23], s30 offen offset:2048 lds
    v_pk_mul_f32 v[102:103], v[102:103], v[24:25] op_sel_hi:[1,0]
    v_pk_mul_f32 v[134:135], v[134:135], v[26:27] op_sel_hi:[1,0]
    v_pk_mul_f32 v[166:167], v[166:167], v[28:29] op_sel_hi:[1,0]
    v_pk_mul_f32 v[198:199], v[198:199], v[30:31] op_sel_hi:[1,0]
    buffer_load_dwordx4 v17, s[20:23], s30 offen offset:3072 lds
    s_add_u32 s30, s30, 131072
    v_pk_mul_f32 v[104:105], v[104:105], v[24:25] op_sel_hi:[1,0]
    v_pk_mul_f32 v[136:137], v[136:137], v[26:27] op_sel_hi:[1,0]
    v_pk_mul_f32 v[168:169], v[168:169], v[28:29] op_sel_hi:[1,0]
    v_pk_mul_f32 v[200:201], v[200:201], v[30:31] op_sel_hi:[1,0]
    s_add_u32 m0, s33, 20480
    s_nop 0
    buffer_load_dwordx4 v14, s[20:23], s30 offen offset:0 lds
    v_pk_mul_f32 v[106:107], v[106:107], v[24:25] op_sel_hi:[1,0]
    v_pk_mul_f32 v[138:139], v[138:139], v[26:27] op_sel_hi:[1,0]
    v_pk_mul_f32 v[170:171], v[170:171], v[28:29] op_sel_hi:[1,0]
    v_pk_mul_f32 v[202:203], v[202:203], v[30:31] op_sel_hi:[1,0]
    buffer_load_dwordx4 v15, s[20:23], s30 offen offset:1024 lds
    v_pk_mul_f32 v[108:109], v[108:109], v[24:25] op_sel_hi:[1,0]
    v_pk_mul_f32 v[140:141], v[140:141], v[26:27] op_sel_hi:[1,0]
    v_pk_mul_f32 v[172:173], v[172:173], v[28:29] op_sel_hi:[1,0]
    v_pk_mul_f32 v[204:205], v[204:205], v[30:31] op_sel_hi:[1,0]
    buffer_load_dwordx4 v16, s[20:23], s30 offen offset:2048 lds
    v_pk_mul_f32 v[110:111], v[110:111], v[24:25] op_sel_hi:[1,0]
    v_pk_mul_f32 v[142:143], v[142:143], v[26:27] op_sel_hi:[1,0]
    v_pk_mul_f32 v[174:175], v[174:175], v[28:29] op_sel_hi:[1,0]
    v_pk_mul_f32 v[206:207], v[206:207], v[30:31] op_sel_hi:[1,0]
    buffer_load_dwordx4 v17, s[20:23], s30 offen offset:3072 lds
    s_add_u32 s30, s30, 131072
    v_pk_mul_f32 v[112:113], v[112:113], v[24:25] op_sel_hi:[1,0]
    v_pk_mul_f32 v[144:145], v[144:145], v[26:27] op_sel_hi:[1,0]
    v_pk_mul_f32 v[176:177], v[176:177], v[28:29] op_sel_hi:[1,0]
    v_pk_mul_f32 v[208:209], v[208:209], v[30:31] op_sel_hi:[1,0]
    buffer_load_dword a249, v19, s[12:15], 0 offen
    v_pk_mul_f32 v[114:115], v[114:115], v[24:25] op_sel_hi:[1,0]
    v_pk_mul_f32 v[146:147], v[146:147], v[26:27] op_sel_hi:[1,0]
    v_pk_mul_f32 v[178:179], v[178:179], v[28:29] op_sel_hi:[1,0]
    v_pk_mul_f32 v[210:211], v[210:211], v[30:31] op_sel_hi:[1,0]
    buffer_load_dword a250, v19, s[16:19], 0 offen
    v_pk_mul_f32 v[116:117], v[116:117], v[24:25] op_sel_hi:[1,0]
    v_pk_mul_f32 v[148:149], v[148:149], v[26:27] op_sel_hi:[1,0]
    v_pk_mul_f32 v[180:181], v[180:181], v[28:29] op_sel_hi:[1,0]
    v_pk_mul_f32 v[212:213], v[212:213], v[30:31] op_sel_hi:[1,0]
    v_pk_mul_f32 v[118:119], v[118:119], v[24:25] op_sel_hi:[1,0]
    v_pk_mul_f32 v[150:151], v[150:151], v[26:27] op_sel_hi:[1,0]
    v_pk_mul_f32 v[182:183], v[182:183], v[28:29] op_sel_hi:[1,0]
    v_pk_mul_f32 v[214:215], v[214:215], v[30:31] op_sel_hi:[1,0]
    v_pk_mul_f32 v[120:121], v[120:121], v[24:25] op_sel_hi:[1,0]
    v_pk_mul_f32 v[152:153], v[152:153], v[26:27] op_sel_hi:[1,0]
    v_pk_mul_f32 v[184:185], v[184:185], v[28:29] op_sel_hi:[1,0]
    v_pk_mul_f32 v[216:217], v[216:217], v[30:31] op_sel_hi:[1,0]
    v_pk_mul_f32 v[122:123], v[122:123], v[24:25] op_sel_hi:[1,0]
    v_pk_mul_f32 v[154:155], v[154:155], v[26:27] op_sel_hi:[1,0]
    v_pk_mul_f32 v[186:187], v[186:187], v[28:29] op_sel_hi:[1,0]
    v_pk_mul_f32 v[218:219], v[218:219], v[30:31] op_sel_hi:[1,0]
    v_pk_mul_f32 v[124:125], v[124:125], v[24:25] op_sel_hi:[1,0]
    v_pk_mul_f32 v[156:157], v[156:157], v[26:27] op_sel_hi:[1,0]
    v_pk_mul_f32 v[188:189], v[188:189], v[28:29] op_sel_hi:[1,0]
    v_pk_mul_f32 v[220:221], v[220:221], v[30:31] op_sel_hi:[1,0]
    v_pk_mul_f32 v[126:127], v[126:127], v[24:25] op_sel_hi:[1,0]
    v_pk_mul_f32 v[158:159], v[158:159], v[26:27] op_sel_hi:[1,0]
    v_pk_mul_f32 v[190:191], v[190:191], v[28:29] op_sel_hi:[1,0]
    v_pk_mul_f32 v[222:223], v[222:223], v[30:31] op_sel_hi:[1,0]
    v_xor_b32 v24, 0, v22
    v_xor_b32 v25, 16, v22
    v_xor_b32 v26, 64, v22
    v_xor_b32 v27, 80, v22
    v_xor_b32 v28, 128, v22
    v_xor_b32 v29, 144, v22
    v_xor_b32 v30, 192, v22
    v_xor_b32 v31, 208, v22
    v_mov_b32 v22, 0x3e0293ee
    s_waitcnt vmcnt(10)
    v_pk_add_f32 v[224:225], v[224:225], v[228:229]
    v_pk_add_f32 v[226:227], v[226:227], v[230:231]
    v_pk_add_f32 v[232:233], v[232:233], v[236:237]
    v_pk_add_f32 v[234:235], v[234:235], v[238:239]
    v_pk_add_f32 v[224:225], v[224:225], v[232:233]
    v_pk_add_f32 v[226:227], v[226:227], v[234:235]
    s_cmp_ge_u32 s5, 2
    s_cselect_b32 s36, 1.0, 0
    s_lshl_b32 s6, s5, 9
    v_lshrrev_b32 v21, 1, v21
    v_add_u32 v21, s6, v21
    v_cvt_pk_bf16_f32 v228, v224, v225
    v_cvt_pk_bf16_f32 v229, v226, v227
    v_lshlrev_b32 v224, 16, v228
    v_and_b32 v225, 0xffff0000, v228
    v_lshlrev_b32 v226, 16, v229
    v_and_b32 v227, 0xffff0000, v229
    v_add_f32 v224, s36, v224
    v_add_f32 v225, s36, v225
    v_add_f32 v226, s36, v226
    v_add_f32 v227, s36, v227
    v_cvt_pk_bf16_f32 v228, v224, v225
    v_cvt_pk_bf16_f32 v229, v226, v227
    ds_write_b64 v21, v[228:229] offset:0
    ds_write_b64 v21, v[228:229] offset:16384
    ds_write_b64 v21, v[228:229] offset:32768
    ds_write_b64 v21, v[228:229] offset:49152
    s_waitcnt lgkmcnt(0)
    s_barrier
    ds_read_b128 v[224:227], v20 offset:1024
    ds_read_b128 v[240:243], v20 offset:0
    ds_read_b128 v[228:231], v20 offset:1280
    ds_read_b128 v[244:247], v20 offset:256
    ds_read_b128 v[232:235], v20 offset:1536
    ds_read_b128 v[248:251], v20 offset:512
    ds_read_b128 v[236:239], v20 offset:1792
    ds_read_b128 v[252:255], v20 offset:768
    s_waitcnt lgkmcnt(0)
    ds_read_b64_tr_b16 a[128:129], v6 offset:0
    ds_read_b64_tr_b16 a[132:133], v7 offset:0
    ds_read_b64_tr_b16 a[136:137], v8 offset:0
    ds_read_b64_tr_b16 a[140:141], v9 offset:0
    ds_read_b64_tr_b16 a[144:145], v10 offset:0
    ds_read_b64_tr_b16 a[148:149], v11 offset:0
    ds_read_b64_tr_b16 a[152:153], v12 offset:0
    ds_read_b64_tr_b16 a[156:157], v13 offset:0
    ds_read_b64_tr_b16 a[130:131], v6 offset:4096
    ds_read_b64_tr_b16 a[134:135], v7 offset:4096
    ds_read_b64_tr_b16 a[138:139], v8 offset:4096
    ds_read_b64_tr_b16 a[142:143], v9 offset:4096
    ds_read_b64_tr_b16 a[146:147], v10 offset:4096
    ds_read_b64_tr_b16 a[150:151], v11 offset:4096
    ds_read_b64_tr_b16 a[154:155], v12 offset:4096
    ds_read_b64_tr_b16 a[158:159], v13 offset:4096
    v_lshlrev_b32 v32, 16, v224
    v_and_b32 v33, 0xffff0000, v224
    v_lshlrev_b32 v34, 16, v225
    v_and_b32 v35, 0xffff0000, v225
    v_lshlrev_b32 v36, 16, v226
    v_and_b32 v37, 0xffff0000, v226
    v_lshlrev_b32 v38, 16, v227
    v_and_b32 v39, 0xffff0000, v227
    v_lshlrev_b32 v64, 16, v240
    v_and_b32 v65, 0xffff0000, v240
    v_lshlrev_b32 v66, 16, v241
    v_and_b32 v67, 0xffff0000, v241
    v_lshlrev_b32 v68, 16, v242
    v_and_b32 v69, 0xffff0000, v242
    v_lshlrev_b32 v70, 16, v243
    v_and_b32 v71, 0xffff0000, v243
    v_pk_mul_f32 v[64:65], v[64:65], v[22:23] op_sel_hi:[1,0]
    v_pk_mul_f32 v[66:67], v[66:67], v[22:23] op_sel_hi:[1,0]
    v_pk_mul_f32 v[68:69], v[68:69], v[22:23] op_sel_hi:[1,0]
    v_pk_mul_f32 v[70:71], v[70:71], v[22:23] op_sel_hi:[1,0]
    s_waitcnt lgkmcnt(0)
    s_add_u32 m0, s33, 0
    s_nop 0
    buffer_load_dwordx4 v14, s[20:23], s30 offen offset:0 lds
    buffer_load_dwordx4 v15, s[20:23], s30 offen offset:1024 lds
    buffer_load_dwordx4 v16, s[20:23], s30 offen offset:2048 lds
    buffer_load_dwordx4 v17, s[20:23], s30 offen offset:3072 lds
    s_add_u32 s30, s30, 131072
    v_pk_fma_f32 v[96:97], v[96:97], v[32:33], v[64:65]
    v_pk_fma_f32 v[98:99], v[98:99], v[34:35], v[66:67]
    v_pk_fma_f32 v[100:101], v[100:101], v[36:37], v[68:69]
    v_pk_fma_f32 v[102:103], v[102:103], v[38:39], v[70:71]
    v_cvt_pk_bf16_f32 v96, v96, v97
    v_cvt_pk_bf16_f32 v97, v98, v99
    v_cvt_pk_bf16_f32 v98, v100, v101
    v_cvt_pk_bf16_f32 v99, v102, v103
    ds_write_b64 v24, v[96:97] offset:0
    ds_write_b64 v25, v[98:99] offset:0
    v_pk_fma_f32 v[128:129], v[128:129], v[32:33], v[64:65]
    v_pk_fma_f32 v[130:131], v[130:131], v[34:35], v[66:67]
    v_pk_fma_f32 v[132:133], v[132:133], v[36:37], v[68:69]
    v_pk_fma_f32 v[134:135], v[134:135], v[38:39], v[70:71]
    v_cvt_pk_bf16_f32 v128, v128, v129
    v_cvt_pk_bf16_f32 v129, v130, v131
    v_cvt_pk_bf16_f32 v130, v132, v133
    v_cvt_pk_bf16_f32 v131, v134, v135
    ds_write_b64 v26, v[128:129] offset:4096
    ds_write_b64 v27, v[130:131] offset:4096
    v_pk_fma_f32 v[160:161], v[160:161], v[32:33], v[64:65]
    v_pk_fma_f32 v[162:163], v[162:163], v[34:35], v[66:67]
    v_pk_fma_f32 v[164:165], v[164:165], v[36:37], v[68:69]
    v_pk_fma_f32 v[166:167], v[166:167], v[38:39], v[70:71]
    v_cvt_pk_bf16_f32 v160, v160, v161
    v_cvt_pk_bf16_f32 v161, v162, v163
    v_cvt_pk_bf16_f32 v162, v164, v165
    v_cvt_pk_bf16_f32 v163, v166, v167
    ds_write_b64 v28, v[160:161] offset:8192
    ds_write_b64 v29, v[162:163] offset:8192
    v_pk_fma_f32 v[192:193], v[192:193], v[32:33], v[64:65]
    v_pk_fma_f32 v[194:195], v[194:195], v[34:35], v[66:67]
    v_pk_fma_f32 v[196:197], v[196:197], v[36:37], v[68:69]
    v_pk_fma_f32 v[198:199], v[198:199], v[38:39], v[70:71]
    v_cvt_pk_bf16_f32 v192, v192, v193
    v_cvt_pk_bf16_f32 v193, v194, v195
    v_cvt_pk_bf16_f32 v194, v196, v197
    v_cvt_pk_bf16_f32 v195, v198, v199
    ds_write_b64 v30, v[192:193] offset:12288
    ds_write_b64 v31, v[194:195] offset:12288
    v_lshlrev_b32 v40, 16, v228
    v_and_b32 v41, 0xffff0000, v228
    v_lshlrev_b32 v42, 16, v229
    v_and_b32 v43, 0xffff0000, v229
    v_lshlrev_b32 v44, 16, v230
    v_and_b32 v45, 0xffff0000, v230
    v_lshlrev_b32 v46, 16, v231
    v_and_b32 v47, 0xffff0000, v231
    v_lshlrev_b32 v72, 16, v244
    v_and_b32 v73, 0xffff0000, v244
    v_lshlrev_b32 v74, 16, v245
    v_and_b32 v75, 0xffff0000, v245
    v_lshlrev_b32 v76, 16, v246
    v_and_b32 v77, 0xffff0000, v246
    v_lshlrev_b32 v78, 16, v247
    v_and_b32 v79, 0xffff0000, v247
    v_pk_mul_f32 v[72:73], v[72:73], v[22:23] op_sel_hi:[1,0]
    v_pk_mul_f32 v[74:75], v[74:75], v[22:23] op_sel_hi:[1,0]
    v_pk_mul_f32 v[76:77], v[76:77], v[22:23] op_sel_hi:[1,0]
    v_pk_mul_f32 v[78:79], v[78:79], v[22:23] op_sel_hi:[1,0]
    v_pk_fma_f32 v[104:105], v[104:105], v[40:41], v[72:73]
    v_pk_fma_f32 v[106:107], v[106:107], v[42:43], v[74:75]
    v_pk_fma_f32 v[108:109], v[108:109], v[44:45], v[76:77]
    v_pk_fma_f32 v[110:111], v[110:111], v[46:47], v[78:79]
    v_cvt_pk_bf16_f32 v104, v104, v105
    v_cvt_pk_bf16_f32 v105, v106, v107
    v_cvt_pk_bf16_f32 v106, v108, v109
    v_cvt_pk_bf16_f32 v107, v110, v111
    ds_write_b64 v24, v[104:105] offset:256
    ds_write_b64 v25, v[106:107] offset:256
    v_pk_fma_f32 v[136:137], v[136:137], v[40:41], v[72:73]
    v_pk_fma_f32 v[138:139], v[138:139], v[42:43], v[74:75]
    v_pk_fma_f32 v[140:141], v[140:141], v[44:45], v[76:77]
    v_pk_fma_f32 v[142:143], v[142:143], v[46:47], v[78:79]
    v_cvt_pk_bf16_f32 v136, v136, v137
    v_cvt_pk_bf16_f32 v137, v138, v139
    v_cvt_pk_bf16_f32 v138, v140, v141
    v_cvt_pk_bf16_f32 v139, v142, v143
    ds_write_b64 v26, v[136:137] offset:4352
    ds_write_b64 v27, v[138:139] offset:4352
    v_pk_fma_f32 v[168:169], v[168:169], v[40:41], v[72:73]
    v_pk_fma_f32 v[170:171], v[170:171], v[42:43], v[74:75]
    v_pk_fma_f32 v[172:173], v[172:173], v[44:45], v[76:77]
    v_pk_fma_f32 v[174:175], v[174:175], v[46:47], v[78:79]
    v_cvt_pk_bf16_f32 v168, v168, v169
    v_cvt_pk_bf16_f32 v169, v170, v171
    v_cvt_pk_bf16_f32 v170, v172, v173
    v_cvt_pk_bf16_f32 v171, v174, v175
    ds_write_b64 v28, v[168:169] offset:8448
    ds_write_b64 v29, v[170:171] offset:8448
    v_pk_fma_f32 v[200:201], v[200:201], v[40:41], v[72:73]
    v_pk_fma_f32 v[202:203], v[202:203], v[42:43], v[74:75]
    v_pk_fma_f32 v[204:205], v[204:205], v[44:45], v[76:77]
    v_pk_fma_f32 v[206:207], v[206:207], v[46:47], v[78:79]
    v_cvt_pk_bf16_f32 v200, v200, v201
    v_cvt_pk_bf16_f32 v201, v202, v203
    v_cvt_pk_bf16_f32 v202, v204, v205
    v_cvt_pk_bf16_f32 v203, v206, v207
    ds_write_b64 v30, v[200:201] offset:12544
    ds_write_b64 v31, v[202:203] offset:12544
    v_lshlrev_b32 v48, 16, v232
    v_and_b32 v49, 0xffff0000, v232
    v_lshlrev_b32 v50, 16, v233
    v_and_b32 v51, 0xffff0000, v233
    v_lshlrev_b32 v52, 16, v234
    v_and_b32 v53, 0xffff0000, v234
    v_lshlrev_b32 v54, 16, v235
    v_and_b32 v55, 0xffff0000, v235
    v_lshlrev_b32 v80, 16, v248
    v_and_b32 v81, 0xffff0000, v248
    v_lshlrev_b32 v82, 16, v249
    v_and_b32 v83, 0xffff0000, v249
    v_lshlrev_b32 v84, 16, v250
    v_and_b32 v85, 0xffff0000, v250
    v_lshlrev_b32 v86, 16, v251
    v_and_b32 v87, 0xffff0000, v251
    v_pk_mul_f32 v[80:81], v[80:81], v[22:23] op_sel_hi:[1,0]
    v_pk_mul_f32 v[82:83], v[82:83], v[22:23] op_sel_hi:[1,0]
    v_pk_mul_f32 v[84:85], v[84:85], v[22:23] op_sel_hi:[1,0]
    v_pk_mul_f32 v[86:87], v[86:87], v[22:23] op_sel_hi:[1,0]
    v_pk_fma_f32 v[112:113], v[112:113], v[48:49], v[80:81]
    v_pk_fma_f32 v[114:115], v[114:115], v[50:51], v[82:83]
    v_pk_fma_f32 v[116:117], v[116:117], v[52:53], v[84:85]
    v_pk_fma_f32 v[118:119], v[118:119], v[54:55], v[86:87]
    v_cvt_pk_bf16_f32 v112, v112, v113
    v_cvt_pk_bf16_f32 v113, v114, v115
    v_cvt_pk_bf16_f32 v114, v116, v117
    v_cvt_pk_bf16_f32 v115, v118, v119
    ds_write_b64 v24, v[112:113] offset:512
    ds_write_b64 v25, v[114:115] offset:512
    v_pk_fma_f32 v[144:145], v[144:145], v[48:49], v[80:81]
    v_pk_fma_f32 v[146:147], v[146:147], v[50:51], v[82:83]
    v_pk_fma_f32 v[148:149], v[148:149], v[52:53], v[84:85]
    v_pk_fma_f32 v[150:151], v[150:151], v[54:55], v[86:87]
    v_cvt_pk_bf16_f32 v144, v144, v145
    v_cvt_pk_bf16_f32 v145, v146, v147
    v_cvt_pk_bf16_f32 v146, v148, v149
    v_cvt_pk_bf16_f32 v147, v150, v151
    ds_write_b64 v26, v[144:145] offset:4608
    ds_write_b64 v27, v[146:147] offset:4608
    v_pk_fma_f32 v[176:177], v[176:177], v[48:49], v[80:81]
    v_pk_fma_f32 v[178:179], v[178:179], v[50:51], v[82:83]
    v_pk_fma_f32 v[180:181], v[180:181], v[52:53], v[84:85]
    v_pk_fma_f32 v[182:183], v[182:183], v[54:55], v[86:87]
    v_cvt_pk_bf16_f32 v176, v176, v177
    v_cvt_pk_bf16_f32 v177, v178, v179
    v_cvt_pk_bf16_f32 v178, v180, v181
    v_cvt_pk_bf16_f32 v179, v182, v183
    ds_write_b64 v28, v[176:177] offset:8704
    ds_write_b64 v29, v[178:179] offset:8704
    v_pk_fma_f32 v[208:209], v[208:209], v[48:49], v[80:81]
    v_pk_fma_f32 v[210:211], v[210:211], v[50:51], v[82:83]
    v_pk_fma_f32 v[212:213], v[212:213], v[52:53], v[84:85]
    v_pk_fma_f32 v[214:215], v[214:215], v[54:55], v[86:87]
    v_cvt_pk_bf16_f32 v208, v208, v209
    v_cvt_pk_bf16_f32 v209, v210, v211
    v_cvt_pk_bf16_f32 v210, v212, v213
    v_cvt_pk_bf16_f32 v211, v214, v215
    ds_write_b64 v30, v[208:209] offset:12800
    ds_write_b64 v31, v[210:211] offset:12800
    v_lshlrev_b32 v56, 16, v236
    v_and_b32 v57, 0xffff0000, v236
    v_lshlrev_b32 v58, 16, v237
    v_and_b32 v59, 0xffff0000, v237
    v_lshlrev_b32 v60, 16, v238
    v_and_b32 v61, 0xffff0000, v238
    v_lshlrev_b32 v62, 16, v239
    v_and_b32 v63, 0xffff0000, v239
    v_lshlrev_b32 v88, 16, v252
    v_and_b32 v89, 0xffff0000, v252
    v_lshlrev_b32 v90, 16, v253
    v_and_b32 v91, 0xffff0000, v253
    v_lshlrev_b32 v92, 16, v254
    v_and_b32 v93, 0xffff0000, v254
    v_lshlrev_b32 v94, 16, v255
    v_and_b32 v95, 0xffff0000, v255
    v_pk_mul_f32 v[88:89], v[88:89], v[22:23] op_sel_hi:[1,0]
    v_pk_mul_f32 v[90:91], v[90:91], v[22:23] op_sel_hi:[1,0]
    v_pk_mul_f32 v[92:93], v[92:93], v[22:23] op_sel_hi:[1,0]
    v_pk_mul_f32 v[94:95], v[94:95], v[22:23] op_sel_hi:[1,0]
    v_pk_fma_f32 v[120:121], v[120:121], v[56:57], v[88:89]
    v_pk_fma_f32 v[122:123], v[122:123], v[58:59], v[90:91]
    v_pk_fma_f32 v[124:125], v[124:125], v[60:61], v[92:93]
    v_pk_fma_f32 v[126:127], v[126:127], v[62:63], v[94:95]
    v_cvt_pk_bf16_f32 v120, v120, v121
    v_cvt_pk_bf16_f32 v121, v122, v123
    v_cvt_pk_bf16_f32 v122, v124, v125
    v_cvt_pk_bf16_f32 v123, v126, v127
    ds_write_b64 v24, v[120:121] offset:768
    ds_write_b64 v25, v[122:123] offset:768
    v_pk_fma_f32 v[152:153], v[152:153], v[56:57], v[88:89]
    v_pk_fma_f32 v[154:155], v[154:155], v[58:59], v[90:91]
    v_pk_fma_f32 v[156:157], v[156:157], v[60:61], v[92:93]
    v_pk_fma_f32 v[158:159], v[158:159], v[62:63], v[94:95]
    v_cvt_pk_bf16_f32 v152, v152, v153
    v_cvt_pk_bf16_f32 v153, v154, v155
    v_cvt_pk_bf16_f32 v154, v156, v157
    v_cvt_pk_bf16_f32 v155, v158, v159
    ds_write_b64 v26, v[152:153] offset:4864
    ds_write_b64 v27, v[154:155] offset:4864
    v_pk_fma_f32 v[184:185], v[184:185], v[56:57], v[88:89]
    v_pk_fma_f32 v[186:187], v[186:187], v[58:59], v[90:91]
    v_pk_fma_f32 v[188:189], v[188:189], v[60:61], v[92:93]
    v_pk_fma_f32 v[190:191], v[190:191], v[62:63], v[94:95]
    v_cvt_pk_bf16_f32 v184, v184, v185
    v_cvt_pk_bf16_f32 v185, v186, v187
    v_cvt_pk_bf16_f32 v186, v188, v189
    v_cvt_pk_bf16_f32 v187, v190, v191
    ds_write_b64 v28, v[184:185] offset:8960
    ds_write_b64 v29, v[186:187] offset:8960
    v_pk_fma_f32 v[216:217], v[216:217], v[56:57], v[88:89]
    v_pk_fma_f32 v[218:219], v[218:219], v[58:59], v[90:91]
    v_pk_fma_f32 v[220:221], v[220:221], v[60:61], v[92:93]
    v_pk_fma_f32 v[222:223], v[222:223], v[62:63], v[94:95]
    v_cvt_pk_bf16_f32 v216, v216, v217
    v_cvt_pk_bf16_f32 v217, v218, v219
    v_cvt_pk_bf16_f32 v218, v220, v221
    v_cvt_pk_bf16_f32 v219, v222, v223
    ds_write_b64 v30, v[216:217] offset:13056
    ds_write_b64 v31, v[218:219] offset:13056
    s_waitcnt lgkmcnt(0)
    s_barrier
    s_sub_u32 s6, s39, 32
    s_cmp_lt_u32 s6, 85
    s_cselect_b32 s6, s5, 1
    s_cmp_lg_u32 s6, 0
    s_cbranch_scc1 K1_L3
    s_mov_b64 exec, 1
    v_mov_b32 v32, 1
    buffer_atomic_add v32, off, s[40:43], 0 offset:128 sc1
    s_mov_b64 exec, -1
K1_L3:
K1_QP:
    ds_read_b128 a[192:195], v2 offset:0
    ds_read_b128 a[196:199], v2 offset:16384
    ds_read_b128 a[200:203], v2 offset:32768
    ds_read_b128 a[204:207], v2 offset:49152
    s_waitcnt lgkmcnt(0) vmcnt(14)
    v_mfma_f32_16x16x32_bf16 v[32:35], a[128:131], a[192:195], 0
    ds_read_b128 a[208:211], v3 offset:0
    s_add_u32 m0, s33, 4096
    v_mfma_f32_16x16x32_bf16 v[36:39], a[128:131], a[196:199], 0
    ds_read_b128 a[212:215], v3 offset:16384
    buffer_load_dwordx4 v14, s[20:23], s30 offen offset:0 lds
    v_mfma_f32_16x16x32_bf16 v[40:43], a[128:131], a[200:203], 0
    ds_read_b128 a[216:219], v3 offset:32768
    v_mfma_f32_16x16x32_bf16 v[44:47], a[128:131], a[204:207], 0
    ds_read_b128 a[220:223], v3 offset:49152
    v_mfma_f32_16x16x32_bf16 v[48:51], a[132:135], a[192:195], 0
    ds_read_b64_tr_b16 a[160:161], v6 offset:8192
    v_mfma_f32_16x16x32_bf16 v[52:55], a[132:135], a[196:199], 0
    ds_read_b64_tr_b16 a[164:165], v7 offset:8192
    buffer_load_dwordx4 v15, s[20:23], s30 offen offset:1024 lds
    v_mfma_f32_16x16x32_bf16 v[56:59], a[132:135], a[200:203], 0
    ds_read_b64_tr_b16 a[168:169], v8 offset:8192
    v_mfma_f32_16x16x32_bf16 v[60:63], a[132:135], a[204:207], 0
    ds_read_b64_tr_b16 a[172:173], v9 offset:8192
    v_mfma_f32_16x16x32_bf16 v[64:67], a[136:139], a[192:195], 0
    ds_read_b64_tr_b16 a[176:177], v10 offset:8192
    v_mfma_f32_16x16x32_bf16 v[68:71], a[136:139], a[196:199], 0
    ds_read_b64_tr_b16 a[180:181], v11 offset:8192
    buffer_load_dwordx4 v16, s[20:23], s30 offen offset:2048 lds
    v_mfma_f32_16x16x32_bf16 v[72:75], a[136:139], a[200:203], 0
    ds_read_b64_tr_b16 a[184:185], v12 offset:8192
    v_mfma_f32_16x16x32_bf16 v[76:79], a[136:139], a[204:207], 0
    ds_read_b64_tr_b16 a[188:189], v13 offset:8192
    v_mfma_f32_16x16x32_bf16 v[80:83], a[140:143], a[192:195], 0
    v_mfma_f32_16x16x32_bf16 v[84:87], a[140:143], a[196:199], 0
    buffer_load_dwordx4 v17, s[20:23], s30 offen offset:3072 lds
    v_mfma_f32_16x16x32_bf16 v[88:91], a[140:143], a[200:203], 0
    s_add_u32 s30, s30, 131072
    v_mfma_f32_16x16x32_bf16 v[92:95], a[140:143], a[204:207], 0
    s_waitcnt lgkmcnt(0) vmcnt(18)
    v_mfma_f32_16x16x32_bf16 v[96:99], a[144:147], a[192:195], 0
    ds_read_b64_tr_b16 a[162:163], v6 offset:12288
    s_add_u32 m0, s33, 8192
    v_mfma_f32_16x16x32_bf16 v[100:103], a[144:147], a[196:199], 0
    ds_read_b64_tr_b16 a[166:167], v7 offset:12288
    buffer_load_dwordx4 v14, s[20:23], s30 offen offset:0 lds
    v_mfma_f32_16x16x32_bf16 v[104:107], a[144:147], a[200:203], 0
    ds_read_b64_tr_b16 a[170:171], v8 offset:12288
    v_mfma_f32_16x16x32_bf16 v[108:111], a[144:147], a[204:207], 0
    ds_read_b64_tr_b16 a[174:175], v9 offset:12288
    v_mfma_f32_16x16x32_bf16 v[112:115], a[148:151], a[192:195], 0
    ds_read_b64_tr_b16 a[178:179], v10 offset:12288
    v_mfma_f32_16x16x32_bf16 v[116:119], a[148:151], a[196:199], 0
    ds_read_b64_tr_b16 a[182:183], v11 offset:12288
    buffer_load_dwordx4 v15, s[20:23], s30 offen offset:1024 lds
    v_mfma_f32_16x16x32_bf16 v[120:123], a[148:151], a[200:203], 0
    ds_read_b64_tr_b16 a[186:187], v12 offset:12288
    v_mfma_f32_16x16x32_bf16 v[124:127], a[148:151], a[204:207], 0
    ds_read_b64_tr_b16 a[190:191], v13 offset:12288
    v_mfma_f32_16x16x32_bf16 v[128:131], a[152:155], a[192:195], 0
    v_and_b32 v24, 15, v1
    v_mfma_f32_16x16x32_bf16 v[132:135], a[152:155], a[196:199], 0
    buffer_load_dwordx4 v16, s[20:23], s30 offen offset:2048 lds
    v_lshrrev_b32 v25, 4, v1
    v_mfma_f32_16x16x32_bf16 v[136:139], a[152:155], a[200:203], 0
    v_bfe_u32 v26, v1, 4, 1
    v_mfma_f32_16x16x32_bf16 v[140:143], a[152:155], a[204:207], 0
    v_lshrrev_b32 v27, 5, v1
    v_mfma_f32_16x16x32_bf16 v[144:147], a[156:159], a[192:195], 0
    v_lshl_or_b32 v29, v26, 1, v27
    v_mfma_f32_16x16x32_bf16 v[148:151], a[156:159], a[196:199], 0
    buffer_load_dwordx4 v17, s[20:23], s30 offen offset:3072 lds
    v_xor_b32 v26, v29, v24
    v_mfma_f32_16x16x32_bf16 v[152:155], a[156:159], a[200:203], 0
    s_add_u32 s30, s30, 131072
    v_lshlrev_b32 v26, 4, v26
    v_mfma_f32_16x16x32_bf16 v[156:159], a[156:159], a[204:207], 0
    v_lshl_add_u32 v26, v24, 8, v26
    s_waitcnt lgkmcnt(0) vmcnt(18)
    v_mfma_f32_16x16x32_bf16 v[32:35], a[160:163], a[208:211], v[32:35]
    ds_read_b128 a[192:195], v4 offset:0
    s_add_u32 m0, s33, 12288
    v_mfma_f32_16x16x32_bf16 v[36:39], a[160:163], a[212:215], v[36:39]
    ds_read_b128 a[196:199], v4 offset:16384
    buffer_load_dwordx4 v14, s[20:23], s30 offen offset:0 lds
    v_mfma_f32_16x16x32_bf16 v[40:43], a[160:163], a[216:219], v[40:43]
    ds_read_b128 a[200:203], v4 offset:32768
    v_mfma_f32_16x16x32_bf16 v[44:47], a[160:163], a[220:223], v[44:47]
    ds_read_b128 a[204:207], v4 offset:49152
    v_mfma_f32_16x16x32_bf16 v[48:51], a[164:167], a[208:211], v[48:51]
    ds_read_b64_tr_b16 a[128:129], v6 offset:16384
    v_mfma_f32_16x16x32_bf16 v[52:55], a[164:167], a[212:215], v[52:55]
    ds_read_b64_tr_b16 a[132:133], v7 offset:16384
    buffer_load_dwordx4 v15, s[20:23], s30 offen offset:1024 lds
    v_mfma_f32_16x16x32_bf16 v[56:59], a[164:167], a[216:219], v[56:59]
    ds_read_b64_tr_b16 a[136:137], v8 offset:16384
    v_mfma_f32_16x16x32_bf16 v[60:63], a[164:167], a[220:223], v[60:63]
    ds_read_b64_tr_b16 a[140:141], v9 offset:16384
    v_mfma_f32_16x16x32_bf16 v[64:67], a[168:171], a[208:211], v[64:67]
    ds_read_b64_tr_b16 a[144:145], v10 offset:16384
    v_mfma_f32_16x16x32_bf16 v[68:71], a[168:171], a[212:215], v[68:71]
    ds_read_b64_tr_b16 a[148:149], v11 offset:16384
    buffer_load_dwordx4 v16, s[20:23], s30 offen offset:2048 lds
    v_mfma_f32_16x16x32_bf16 v[72:75], a[168:171], a[216:219], v[72:75]
    ds_read_b64_tr_b16 a[152:153], v12 offset:16384
    v_mfma_f32_16x16x32_bf16 v[76:79], a[168:171], a[220:223], v[76:79]
    ds_read_b64_tr_b16 a[156:157], v13 offset:16384
    v_mfma_f32_16x16x32_bf16 v[80:83], a[172:175], a[208:211], v[80:83]
    v_mfma_f32_16x16x32_bf16 v[84:87], a[172:175], a[212:215], v[84:87]
    buffer_load_dwordx4 v17, s[20:23], s30 offen offset:3072 lds
    v_mfma_f32_16x16x32_bf16 v[88:91], a[172:175], a[216:219], v[88:91]
    s_add_u32 s30, s30, 131072
    v_mfma_f32_16x16x32_bf16 v[92:95], a[172:175], a[220:223], v[92:95]
    s_waitcnt lgkmcnt(0) vmcnt(18)
    v_mfma_f32_16x16x32_bf16 v[96:99], a[176:179], a[208:211], v[96:99]
    ds_read_b64_tr_b16 a[130:131], v6 offset:20480
    s_add_u32 m0, s33, 16384
    v_mfma_f32_16x16x32_bf16 v[100:103], a[176:179], a[212:215], v[100:103]
    ds_read_b64_tr_b16 a[134:135], v7 offset:20480
    buffer_load_dwordx4 v14, s[20:23], s30 offen offset:0 lds
    v_mfma_f32_16x16x32_bf16 v[104:107], a[176:179], a[216:219], v[104:107]
    ds_read_b64_tr_b16 a[138:139], v8 offset:20480
    v_mfma_f32_16x16x32_bf16 v[108:111], a[176:179], a[220:223], v[108:111]
    ds_read_b64_tr_b16 a[142:143], v9 offset:20480
    v_mfma_f32_16x16x32_bf16 v[112:115], a[180:183], a[208:211], v[112:115]
    ds_read_b64_tr_b16 a[146:147], v10 offset:20480
    v_mfma_f32_16x16x32_bf16 v[116:119], a[180:183], a[212:215], v[116:119]
    ds_read_b64_tr_b16 a[150:151], v11 offset:20480
    buffer_load_dwordx4 v15, s[20:23], s30 offen offset:1024 lds
    v_mfma_f32_16x16x32_bf16 v[120:123], a[180:183], a[216:219], v[120:123]
    ds_read_b64_tr_b16 a[154:155], v12 offset:20480
    v_mfma_f32_16x16x32_bf16 v[124:127], a[180:183], a[220:223], v[124:127]
    ds_read_b64_tr_b16 a[158:159], v13 offset:20480
    v_mfma_f32_16x16x32_bf16 v[128:131], a[184:187], a[208:211], v[128:131]
    v_add_u32 v224, 65536, v26
    v_mfma_f32_16x16x32_bf16 v[132:135], a[184:187], a[212:215], v[132:135]
    buffer_load_dwordx4 v16, s[20:23], s30 offen offset:2048 lds
    v_xor_b32 v225, 64, v224
    v_mfma_f32_16x16x32_bf16 v[136:139], a[184:187], a[216:219], v[136:139]
    v_xor_b32 v226, 128, v224
    v_mfma_f32_16x16x32_bf16 v[140:143], a[184:187], a[220:223], v[140:143]
    v_xor_b32 v227, 192, v224
    v_mfma_f32_16x16x32_bf16 v[144:147], a[188:191], a[208:211], v[144:147]
    v_add_u32 v228, 49152, v224
    v_mfma_f32_16x16x32_bf16 v[148:151], a[188:191], a[212:215], v[148:151]
    buffer_load_dwordx4 v17, s[20:23], s30 offen offset:3072 lds
    v_add_u32 v229, 49152, v225
    v_mfma_f32_16x16x32_bf16 v[152:155], a[188:191], a[216:219], v[152:155]
    s_add_u32 s30, s30, 131072
    v_add_u32 v230, 49152, v226
    v_mfma_f32_16x16x32_bf16 v[156:159], a[188:191], a[220:223], v[156:159]
    v_add_u32 v231, 49152, v227
    s_waitcnt lgkmcnt(0) vmcnt(16)
    v_mfma_f32_16x16x32_bf16 v[32:35], a[128:131], a[192:195], v[32:35]
    ds_read_b128 a[208:211], v5 offset:0
    s_add_u32 m0, s33, 20480
    v_mfma_f32_16x16x32_bf16 v[36:39], a[128:131], a[196:199], v[36:39]
    ds_read_b128 a[212:215], v5 offset:16384
    buffer_load_dwordx4 v14, s[20:23], s30 offen offset:0 lds
    v_mfma_f32_16x16x32_bf16 v[40:43], a[128:131], a[200:203], v[40:43]
    ds_read_b128 a[216:219], v5 offset:32768
    v_mfma_f32_16x16x32_bf16 v[44:47], a[128:131], a[204:207], v[44:47]
    ds_read_b128 a[220:223], v5 offset:49152
    v_mfma_f32_16x16x32_bf16 v[48:51], a[132:135], a[192:195], v[48:51]
    ds_read_b64_tr_b16 a[160:161], v6 offset:0
    v_mfma_f32_16x16x32_bf16 v[52:55], a[132:135], a[196:199], v[52:55]
    ds_read_b64_tr_b16 a[164:165], v7 offset:0
    buffer_load_dwordx4 v15, s[20:23], s30 offen offset:1024 lds
    v_mfma_f32_16x16x32_bf16 v[56:59], a[132:135], a[200:203], v[56:59]
    ds_read_b64_tr_b16 a[168:169], v8 offset:0
    v_mfma_f32_16x16x32_bf16 v[60:63], a[132:135], a[204:207], v[60:63]
    ds_read_b64_tr_b16 a[172:173], v9 offset:0
    v_mfma_f32_16x16x32_bf16 v[64:67], a[136:139], a[192:195], v[64:67]
    ds_read_b64_tr_b16 a[176:177], v10 offset:0
    v_mfma_f32_16x16x32_bf16 v[68:71], a[136:139], a[196:199], v[68:71]
    ds_read_b64_tr_b16 a[180:181], v11 offset:0
    buffer_load_dwordx4 v16, s[20:23], s30 offen offset:2048 lds
    v_mfma_f32_16x16x32_bf16 v[72:75], a[136:139], a[200:203], v[72:75]
    ds_read_b64_tr_b16 a[184:185], v12 offset:0
    v_mfma_f32_16x16x32_bf16 v[76:79], a[136:139], a[204:207], v[76:79]
    ds_read_b64_tr_b16 a[188:189], v13 offset:0
    v_mfma_f32_16x16x32_bf16 v[80:83], a[140:143], a[192:195], v[80:83]
    v_mfma_f32_16x16x32_bf16 v[84:87], a[140:143], a[196:199], v[84:87]
    buffer_load_dwordx4 v17, s[20:23], s30 offen offset:3072 lds
    v_mfma_f32_16x16x32_bf16 v[88:91], a[140:143], a[200:203], v[88:91]
    s_add_u32 s30, s30, 131072
    v_mfma_f32_16x16x32_bf16 v[92:95], a[140:143], a[204:207], v[92:95]
    s_waitcnt lgkmcnt(0) vmcnt(16)
    v_mfma_f32_16x16x32_bf16 v[96:99], a[144:147], a[192:195], v[96:99]
    ds_read_b64_tr_b16 a[162:163], v6 offset:4096
    s_add_u32 m0, s33, 0
    v_mfma_f32_16x16x32_bf16 v[100:103], a[144:147], a[196:199], v[100:103]
    ds_read_b64_tr_b16 a[166:167], v7 offset:4096
    buffer_load_dwordx4 v14, s[20:23], s30 offen offset:0 lds
    v_mfma_f32_16x16x32_bf16 v[104:107], a[144:147], a[200:203], v[104:107]
    ds_read_b64_tr_b16 a[170:171], v8 offset:4096
    v_mfma_f32_16x16x32_bf16 v[108:111], a[144:147], a[204:207], v[108:111]
    ds_read_b64_tr_b16 a[174:175], v9 offset:4096
    v_mfma_f32_16x16x32_bf16 v[112:115], a[148:151], a[192:195], v[112:115]
    ds_read_b64_tr_b16 a[178:179], v10 offset:4096
    v_mfma_f32_16x16x32_bf16 v[116:119], a[148:151], a[196:199], v[116:119]
    ds_read_b64_tr_b16 a[182:183], v11 offset:4096
    buffer_load_dwordx4 v15, s[20:23], s30 offen offset:1024 lds
    v_mfma_f32_16x16x32_bf16 v[120:123], a[148:151], a[200:203], v[120:123]
    ds_read_b64_tr_b16 a[186:187], v12 offset:4096
    v_mfma_f32_16x16x32_bf16 v[124:127], a[148:151], a[204:207], v[124:127]
    ds_read_b64_tr_b16 a[190:191], v13 offset:4096
    v_mfma_f32_16x16x32_bf16 v[128:131], a[152:155], a[192:195], v[128:131]
    s_sub_u32 s6, 65536, s33
    v_add_u32 v232, s6, v6
    v_mfma_f32_16x16x32_bf16 v[132:135], a[152:155], a[196:199], v[132:135]
    buffer_load_dwordx4 v16, s[20:23], s30 offen offset:2048 lds
    v_add_u32 v233, s6, v7
    v_mfma_f32_16x16x32_bf16 v[136:139], a[152:155], a[200:203], v[136:139]
    v_add_u32 v234, s6, v8
    v_mfma_f32_16x16x32_bf16 v[140:143], a[152:155], a[204:207], v[140:143]
    v_add_u32 v235, s6, v9
    v_mfma_f32_16x16x32_bf16 v[144:147], a[156:159], a[192:195], v[144:147]
    v_add_u32 v236, s6, v10
    v_mfma_f32_16x16x32_bf16 v[148:151], a[156:159], a[196:199], v[148:151]
    buffer_load_dwordx4 v17, s[20:23], s30 offen offset:3072 lds
    v_add_u32 v237, s6, v11
    v_mfma_f32_16x16x32_bf16 v[152:155], a[156:159], a[200:203], v[152:155]
    s_add_u32 s30, s30, 131072
    v_add_u32 v238, s6, v12
    v_mfma_f32_16x16x32_bf16 v[156:159], a[156:159], a[204:207], v[156:159]
    v_add_u32 v239, s6, v13
    s_waitcnt lgkmcnt(0) vmcnt(16)
    v_mfma_f32_16x16x32_bf16 v[32:35], a[160:163], a[208:211], v[32:35]
    ds_read_b128 a[192:195], v2 offset:256
    s_add_u32 m0, s33, 4096
    v_mfma_f32_16x16x32_bf16 v[36:39], a[160:163], a[212:215], v[36:39]
    ds_read_b128 a[196:199], v2 offset:16640
    buffer_load_dwordx4 v14, s[20:23], s30 offen offset:0 lds
    v_mfma_f32_16x16x32_bf16 v[40:43], a[160:163], a[216:219], v[40:43]
    ds_read_b128 a[200:203], v2 offset:33024
    v_mfma_f32_16x16x32_bf16 v[44:47], a[160:163], a[220:223], v[44:47]
    ds_read_b128 a[204:207], v2 offset:49408
    v_mfma_f32_16x16x32_bf16 v[48:51], a[164:167], a[208:211], v[48:51]
    ds_read_b64_tr_b16 a[128:129], v6 offset:8192
    v_mfma_f32_16x16x32_bf16 v[52:55], a[164:167], a[212:215], v[52:55]
    ds_read_b64_tr_b16 a[132:133], v7 offset:8192
    buffer_load_dwordx4 v15, s[20:23], s30 offen offset:1024 lds
    v_mfma_f32_16x16x32_bf16 v[56:59], a[164:167], a[216:219], v[56:59]
    ds_read_b64_tr_b16 a[136:137], v8 offset:8192
    v_mfma_f32_16x16x32_bf16 v[60:63], a[164:167], a[220:223], v[60:63]
    ds_read_b64_tr_b16 a[140:141], v9 offset:8192
    v_mfma_f32_16x16x32_bf16 v[64:67], a[168:171], a[208:211], v[64:67]
    ds_read_b64_tr_b16 a[144:145], v10 offset:8192
    v_mfma_f32_16x16x32_bf16 v[68:71], a[168:171], a[212:215], v[68:71]
    ds_read_b64_tr_b16 a[148:149], v11 offset:8192
    buffer_load_dwordx4 v16, s[20:23], s30 offen offset:2048 lds
    v_mfma_f32_16x16x32_bf16 v[72:75], a[168:171], a[216:219], v[72:75]
    ds_read_b64_tr_b16 a[152:153], v12 offset:8192
    v_mfma_f32_16x16x32_bf16 v[76:79], a[168:171], a[220:223], v[76:79]
    ds_read_b64_tr_b16 a[156:157], v13 offset:8192
    v_mfma_f32_16x16x32_bf16 v[80:83], a[172:175], a[208:211], v[80:83]
    v_mfma_f32_16x16x32_bf16 v[84:87], a[172:175], a[212:215], v[84:87]
    buffer_load_dwordx4 v17, s[20:23], s30 offen offset:3072 lds
    v_mfma_f32_16x16x32_bf16 v[88:91], a[172:175], a[216:219], v[88:91]
    s_add_u32 s30, s30, 131072
    v_mfma_f32_16x16x32_bf16 v[92:95], a[172:175], a[220:223], v[92:95]
    s_waitcnt lgkmcnt(0) vmcnt(16)
    v_mfma_f32_16x16x32_bf16 v[96:99], a[176:179], a[208:211], v[96:99]
    ds_read_b64_tr_b16 a[130:131], v6 offset:12288
    s_add_u32 m0, s33, 8192
    v_mfma_f32_16x16x32_bf16 v[100:103], a[176:179], a[212:215], v[100:103]
    ds_read_b64_tr_b16 a[134:135], v7 offset:12288
    buffer_load_dwordx4 v14, s[20:23], s30 offen offset:0 lds
    v_mfma_f32_16x16x32_bf16 v[104:107], a[176:179], a[216:219], v[104:107]
    ds_read_b64_tr_b16 a[138:139], v8 offset:12288
    v_mfma_f32_16x16x32_bf16 v[108:111], a[176:179], a[220:223], v[108:111]
    ds_read_b64_tr_b16 a[142:143], v9 offset:12288
    v_mfma_f32_16x16x32_bf16 v[112:115], a[180:183], a[208:211], v[112:115]
    ds_read_b64_tr_b16 a[146:147], v10 offset:12288
    v_mfma_f32_16x16x32_bf16 v[116:119], a[180:183], a[212:215], v[116:119]
    ds_read_b64_tr_b16 a[150:151], v11 offset:12288
    buffer_load_dwordx4 v15, s[20:23], s30 offen offset:1024 lds
    v_mfma_f32_16x16x32_bf16 v[120:123], a[180:183], a[216:219], v[120:123]
    ds_read_b64_tr_b16 a[154:155], v12 offset:12288
    v_mfma_f32_16x16x32_bf16 v[124:127], a[180:183], a[220:223], v[124:127]
    ds_read_b64_tr_b16 a[158:159], v13 offset:12288
    v_mfma_f32_16x16x32_bf16 v[128:131], a[184:187], a[208:211], v[128:131]
    v_add_u32 v240, 49152, v232
    v_mfma_f32_16x16x32_bf16 v[132:135], a[184:187], a[212:215], v[132:135]
    buffer_load_dwordx4 v16, s[20:23], s30 offen offset:2048 lds
    v_add_u32 v241, 49152, v233
    v_mfma_f32_16x16x32_bf16 v[136:139], a[184:187], a[216:219], v[136:139]
    v_add_u32 v242, 49152, v234
    v_mfma_f32_16x16x32_bf16 v[140:143], a[184:187], a[220:223], v[140:143]
    v_add_u32 v243, 49152, v235
    v_mfma_f32_16x16x32_bf16 v[144:147], a[188:191], a[208:211], v[144:147]
    v_add_u32 v244, 49152, v236
    v_mfma_f32_16x16x32_bf16 v[148:151], a[188:191], a[212:215], v[148:151]
    buffer_load_dwordx4 v17, s[20:23], s30 offen offset:3072 lds
    v_add_u32 v245, 49152, v237
    v_mfma_f32_16x16x32_bf16 v[152:155], a[188:191], a[216:219], v[152:155]
    s_add_u32 s30, s30, 131072
    v_add_u32 v246, 49152, v238
    v_mfma_f32_16x16x32_bf16 v[156:159], a[188:191], a[220:223], v[156:159]
    v_add_u32 v247, 49152, v239
    s_waitcnt lgkmcnt(0) vmcnt(16)
    v_mfma_f32_16x16x32_bf16 v[32:35], a[128:131], a[192:195], v[32:35]
    ds_read_b128 a[208:211], v3 offset:256
    s_add_u32 m0, s33, 12288
    v_mfma_f32_16x16x32_bf16 v[36:39], a[128:131], a[196:199], v[36:39]
    ds_read_b128 a[212:215], v3 offset:16640
    buffer_load_dwordx4 v14, s[20:23], s30 offen offset:0 lds
    v_mfma_f32_16x16x32_bf16 v[40:43], a[128:131], a[200:203], v[40:43]
    ds_read_b128 a[216:219], v3 offset:33024
    v_mfma_f32_16x16x32_bf16 v[44:47], a[128:131], a[204:207], v[44:47]
    ds_read_b128 a[220:223], v3 offset:49408
    v_mfma_f32_16x16x32_bf16 v[48:51], a[132:135], a[192:195], v[48:51]
    ds_read_b64_tr_b16 a[160:161], v6 offset:16384
    v_mfma_f32_16x16x32_bf16 v[52:55], a[132:135], a[196:199], v[52:55]
    ds_read_b64_tr_b16 a[164:165], v7 offset:16384
    buffer_load_dwordx4 v15, s[20:23], s30 offen offset:1024 lds
    v_mfma_f32_16x16x32_bf16 v[56:59], a[132:135], a[200:203], v[56:59]
    ds_read_b64_tr_b16 a[168:169], v8 offset:16384
    v_mfma_f32_16x16x32_bf16 v[60:63], a[132:135], a[204:207], v[60:63]
    ds_read_b64_tr_b16 a[172:173], v9 offset:16384
    v_mfma_f32_16x16x32_bf16 v[64:67], a[136:139], a[192:195], v[64:67]
    ds_read_b64_tr_b16 a[176:177], v10 offset:16384
    v_mfma_f32_16x16x32_bf16 v[68:71], a[136:139], a[196:199], v[68:71]
    ds_read_b64_tr_b16 a[180:181], v11 offset:16384
    buffer_load_dwordx4 v16, s[20:23], s30 offen offset:2048 lds
    v_mfma_f32_16x16x32_bf16 v[72:75], a[136:139], a[200:203], v[72:75]
    ds_read_b64_tr_b16 a[184:185], v12 offset:16384
    v_mfma_f32_16x16x32_bf16 v[76:79], a[136:139], a[204:207], v[76:79]
    ds_read_b64_tr_b16 a[188:189], v13 offset:16384
    v_mfma_f32_16x16x32_bf16 v[80:83], a[140:143], a[192:195], v[80:83]
    v_mfma_f32_16x16x32_bf16 v[84:87], a[140:143], a[196:199], v[84:87]
    buffer_load_dwordx4 v17, s[20:23], s30 offen offset:3072 lds
    v_mfma_f32_16x16x32_bf16 v[88:91], a[140:143], a[200:203], v[88:91]
    s_add_u32 s30, s30, 131072
    v_mfma_f32_16x16x32_bf16 v[92:95], a[140:143], a[204:207], v[92:95]
    s_waitcnt lgkmcnt(0) vmcnt(16)
    v_mfma_f32_16x16x32_bf16 v[96:99], a[144:147], a[192:195], v[96:99]
    ds_read_b64_tr_b16 a[162:163], v6 offset:20480
    s_add_u32 m0, s33, 16384
    v_mfma_f32_16x16x32_bf16 v[100:103], a[144:147], a[196:199], v[100:103]
    ds_read_b64_tr_b16 a[166:167], v7 offset:20480
    buffer_load_dwordx4 v14, s[20:23], s30 offen offset:0 lds
    v_mfma_f32_16x16x32_bf16 v[104:107], a[144:147], a[200:203], v[104:107]
    ds_read_b64_tr_b16 a[170:171], v8 offset:20480
    v_mfma_f32_16x16x32_bf16 v[108:111], a[144:147], a[204:207], v[108:111]
    ds_read_b64_tr_b16 a[174:175], v9 offset:20480
    v_mfma_f32_16x16x32_bf16 v[112:115], a[148:151], a[192:195], v[112:115]
    ds_read_b64_tr_b16 a[178:179], v10 offset:20480
    v_mfma_f32_16x16x32_bf16 v[116:119], a[148:151], a[196:199], v[116:119]
    ds_read_b64_tr_b16 a[182:183], v11 offset:20480
    buffer_load_dwordx4 v15, s[20:23], s30 offen offset:1024 lds
    v_mfma_f32_16x16x32_bf16 v[120:123], a[148:151], a[200:203], v[120:123]
    ds_read_b64_tr_b16 a[186:187], v12 offset:20480
    v_mfma_f32_16x16x32_bf16 v[124:127], a[148:151], a[204:207], v[124:127]
    ds_read_b64_tr_b16 a[190:191], v13 offset:20480
    v_mfma_f32_16x16x32_bf16 v[128:131], a[152:155], a[192:195], v[128:131]
    v_xor_b32 v26, v24, v25
    v_mfma_f32_16x16x32_bf16 v[132:135], a[152:155], a[196:199], v[132:135]
    buffer_load_dwordx4 v16, s[20:23], s30 offen offset:2048 lds
    v_lshlrev_b32 v26, 4, v26
    v_mfma_f32_16x16x32_bf16 v[136:139], a[152:155], a[200:203], v[136:139]
    v_lshl_add_u32 v18, v25, 8, v26
    v_mfma_f32_16x16x32_bf16 v[140:143], a[152:155], a[204:207], v[140:143]
    v_mfma_f32_16x16x32_bf16 v[144:147], a[156:159], a[192:195], v[144:147]
    v_xor_b32 v19, 64, v18
    v_mfma_f32_16x16x32_bf16 v[148:151], a[156:159], a[196:199], v[148:151]
    buffer_load_dwordx4 v17, s[20:23], s30 offen offset:3072 lds
    v_xor_b32 v20, 128, v18
    v_mfma_f32_16x16x32_bf16 v[152:155], a[156:159], a[200:203], v[152:155]
    s_add_u32 s30, s30, 131072
    v_xor_b32 v21, 192, v18
    v_mfma_f32_16x16x32_bf16 v[156:159], a[156:159], a[204:207], v[156:159]
    s_waitcnt lgkmcnt(0) vmcnt(16)
    v_mfma_f32_16x16x32_bf16 v[32:35], a[160:163], a[208:211], v[32:35]
    ds_read_b128 a[192:195], v4 offset:256
    s_add_u32 m0, s33, 20480
    v_mfma_f32_16x16x32_bf16 v[36:39], a[160:163], a[212:215], v[36:39]
    ds_read_b128 a[196:199], v4 offset:16640
    buffer_load_dwordx4 v14, s[20:23], s30 offen offset:0 lds
    v_mfma_f32_16x16x32_bf16 v[40:43], a[160:163], a[216:219], v[40:43]
    ds_read_b128 a[200:203], v4 offset:33024
    v_mfma_f32_16x16x32_bf16 v[44:47], a[160:163], a[220:223], v[44:47]
    ds_read_b128 a[204:207], v4 offset:49408
    v_mfma_f32_16x16x32_bf16 v[48:51], a[164:167], a[208:211], v[48:51]
    ds_read_b64_tr_b16 a[128:129], v6 offset:0
    v_mfma_f32_16x16x32_bf16 v[52:55], a[164:167], a[212:215], v[52:55]
    ds_read_b64_tr_b16 a[132:133], v7 offset:0
    buffer_load_dwordx4 v15, s[20:23], s30 offen offset:1024 lds
    v_mfma_f32_16x16x32_bf16 v[56:59], a[164:167], a[216:219], v[56:59]
    ds_read_b64_tr_b16 a[136:137], v8 offset:0
    v_mfma_f32_16x16x32_bf16 v[60:63], a[164:167], a[220:223], v[60:63]
    ds_read_b64_tr_b16 a[140:141], v9 offset:0
    v_mfma_f32_16x16x32_bf16 v[64:67], a[168:171], a[208:211], v[64:67]
    ds_read_b64_tr_b16 a[144:145], v10 offset:0
    v_mfma_f32_16x16x32_bf16 v[68:71], a[168:171], a[212:215], v[68:71]
    ds_read_b64_tr_b16 a[148:149], v11 offset:0
    buffer_load_dwordx4 v16, s[20:23], s30 offen offset:2048 lds
    v_mfma_f32_16x16x32_bf16 v[72:75], a[168:171], a[216:219], v[72:75]
    ds_read_b64_tr_b16 a[152:153], v12 offset:0
    v_mfma_f32_16x16x32_bf16 v[76:79], a[168:171], a[220:223], v[76:79]
    ds_read_b64_tr_b16 a[156:157], v13 offset:0
    v_mfma_f32_16x16x32_bf16 v[80:83], a[172:175], a[208:211], v[80:83]
    v_mfma_f32_16x16x32_bf16 v[84:87], a[172:175], a[212:215], v[84:87]
    buffer_load_dwordx4 v17, s[20:23], s30 offen offset:3072 lds
    v_mfma_f32_16x16x32_bf16 v[88:91], a[172:175], a[216:219], v[88:91]
    s_add_u32 s30, s30, 131072
    v_mfma_f32_16x16x32_bf16 v[92:95], a[172:175], a[220:223], v[92:95]
    s_waitcnt lgkmcnt(0) vmcnt(16)
    v_mfma_f32_16x16x32_bf16 v[96:99], a[176:179], a[208:211], v[96:99]
    ds_read_b64_tr_b16 a[130:131], v6 offset:4096
    s_add_u32 m0, s33, 0
    v_mfma_f32_16x16x32_bf16 v[100:103], a[176:179], a[212:215], v[100:103]
    ds_read_b64_tr_b16 a[134:135], v7 offset:4096
    buffer_load_dwordx4 v14, s[20:23], s30 offen offset:0 lds
    v_mfma_f32_16x16x32_bf16 v[104:107], a[176:179], a[216:219], v[104:107]
    ds_read_b64_tr_b16 a[138:139], v8 offset:4096
    v_mfma_f32_16x16x32_bf16 v[108:111], a[176:179], a[220:223], v[108:111]
    ds_read_b64_tr_b16 a[142:143], v9 offset:4096
    v_mfma_f32_16x16x32_bf16 v[112:115], a[180:183], a[208:211], v[112:115]
    ds_read_b64_tr_b16 a[146:147], v10 offset:4096
    v_mfma_f32_16x16x32_bf16 v[116:119], a[180:183], a[212:215], v[116:119]
    ds_read_b64_tr_b16 a[150:151], v11 offset:4096
    buffer_load_dwordx4 v15, s[20:23], s30 offen offset:1024 lds
    v_mfma_f32_16x16x32_bf16 v[120:123], a[180:183], a[216:219], v[120:123]
    ds_read_b64_tr_b16 a[154:155], v12 offset:4096
    v_mfma_f32_16x16x32_bf16 v[124:127], a[180:183], a[220:223], v[124:127]
    ds_read_b64_tr_b16 a[158:159], v13 offset:4096
    v_mfma_f32_16x16x32_bf16 v[128:131], a[184:187], a[208:211], v[128:131]
    v_lshlrev_b32 v26, 1, v25
    v_xor_b32 v26, v24, v26
    v_mfma_f32_16x16x32_bf16 v[132:135], a[184:187], a[212:215], v[132:135]
    buffer_load_dwordx4 v16, s[20:23], s30 offen offset:2048 lds
    v_lshlrev_b32 v28, 4, v26
    v_mfma_f32_16x16x32_bf16 v[136:139], a[184:187], a[216:219], v[136:139]
    v_lshl_add_u32 v22, v25, 8, v28
    v_xor_b32 v23, 0x80, v22
    v_mfma_f32_16x16x32_bf16 v[140:143], a[184:187], a[220:223], v[140:143]
    v_lshrrev_b32 v26, 1, v24
    v_mfma_f32_16x16x32_bf16 v[144:147], a[188:191], a[208:211], v[144:147]
    v_lshlrev_b32 v26, 11, v26
    v_mfma_f32_16x16x32_bf16 v[148:151], a[188:191], a[212:215], v[148:151]
    buffer_load_dwordx4 v17, s[20:23], s30 offen offset:3072 lds
    v_lshl_add_u32 v26, v29, 4, v26
    v_and_b32 v248, 1, v24
    v_mfma_f32_16x16x32_bf16 v[152:155], a[188:191], a[216:219], v[152:155]
    s_add_u32 s30, s30, 131072
    v_lshl_add_u32 v248, v248, 6, v26
    v_mfma_f32_16x16x32_bf16 v[156:159], a[188:191], a[220:223], v[156:159]
    v_lshlrev_b32 v249, 6, v1
    s_waitcnt lgkmcnt(0) vmcnt(16)
    v_mfma_f32_16x16x32_bf16 v[32:35], a[128:131], a[192:195], v[32:35]
    ds_read_b128 a[208:211], v5 offset:256
    s_add_u32 m0, s33, 4096
    v_mfma_f32_16x16x32_bf16 v[36:39], a[128:131], a[196:199], v[36:39]
    ds_read_b128 a[212:215], v5 offset:16640
    buffer_load_dwordx4 v14, s[20:23], s30 offen offset:0 lds
    v_mfma_f32_16x16x32_bf16 v[40:43], a[128:131], a[200:203], v[40:43]
    ds_read_b128 a[216:219], v5 offset:33024
    v_mfma_f32_16x16x32_bf16 v[44:47], a[128:131], a[204:207], v[44:47]
    ds_read_b128 a[220:223], v5 offset:49408
    v_mfma_f32_16x16x32_bf16 v[48:51], a[132:135], a[192:195], v[48:51]
    ds_read_b64_tr_b16 a[160:161], v6 offset:8192
    v_mfma_f32_16x16x32_bf16 v[52:55], a[132:135], a[196:199], v[52:55]
    ds_read_b64_tr_b16 a[164:165], v7 offset:8192
    buffer_load_dwordx4 v15, s[20:23], s30 offen offset:1024 lds
    v_mfma_f32_16x16x32_bf16 v[56:59], a[132:135], a[200:203], v[56:59]
    ds_read_b64_tr_b16 a[168:169], v8 offset:8192
    v_mfma_f32_16x16x32_bf16 v[60:63], a[132:135], a[204:207], v[60:63]
    ds_read_b64_tr_b16 a[172:173], v9 offset:8192
    v_mfma_f32_16x16x32_bf16 v[64:67], a[136:139], a[192:195], v[64:67]
    ds_read_b64_tr_b16 a[176:177], v10 offset:8192
    v_mfma_f32_16x16x32_bf16 v[68:71], a[136:139], a[196:199], v[68:71]
    ds_read_b64_tr_b16 a[180:181], v11 offset:8192
    buffer_load_dwordx4 v16, s[20:23], s30 offen offset:2048 lds
    v_mfma_f32_16x16x32_bf16 v[72:75], a[136:139], a[200:203], v[72:75]
    ds_read_b64_tr_b16 a[184:185], v12 offset:8192
    v_mfma_f32_16x16x32_bf16 v[76:79], a[136:139], a[204:207], v[76:79]
    ds_read_b64_tr_b16 a[188:189], v13 offset:8192
    v_mfma_f32_16x16x32_bf16 v[80:83], a[140:143], a[192:195], v[80:83]
    v_mfma_f32_16x16x32_bf16 v[84:87], a[140:143], a[196:199], v[84:87]
    buffer_load_dwordx4 v17, s[20:23], s30 offen offset:3072 lds
    v_mfma_f32_16x16x32_bf16 v[88:91], a[140:143], a[200:203], v[88:91]
    s_add_u32 s30, s30, 131072
    v_mfma_f32_16x16x32_bf16 v[92:95], a[140:143], a[204:207], v[92:95]
    s_waitcnt lgkmcnt(0) vmcnt(16)
    v_mfma_f32_16x16x32_bf16 v[96:99], a[144:147], a[192:195], v[96:99]
    ds_read_b64_tr_b16 a[162:163], v6 offset:12288
    s_add_u32 m0, s33, 8192
    v_mfma_f32_16x16x32_bf16 v[100:103], a[144:147], a[196:199], v[100:103]
    ds_read_b64_tr_b16 a[166:167], v7 offset:12288
    buffer_load_dwordx4 v14, s[20:23], s30 offen offset:0 lds
    v_mfma_f32_16x16x32_bf16 v[104:107], a[144:147], a[200:203], v[104:107]
    ds_read_b64_tr_b16 a[170:171], v8 offset:12288
    v_mfma_f32_16x16x32_bf16 v[108:111], a[144:147], a[204:207], v[108:111]
    ds_read_b64_tr_b16 a[174:175], v9 offset:12288
    v_mfma_f32_16x16x32_bf16 v[112:115], a[148:151], a[192:195], v[112:115]
    ds_read_b64_tr_b16 a[178:179], v10 offset:12288
    v_mfma_f32_16x16x32_bf16 v[116:119], a[148:151], a[196:199], v[116:119]
    ds_read_b64_tr_b16 a[182:183], v11 offset:12288
    buffer_load_dwordx4 v15, s[20:23], s30 offen offset:1024 lds
    v_mfma_f32_16x16x32_bf16 v[120:123], a[148:151], a[200:203], v[120:123]
    ds_read_b64_tr_b16 a[186:187], v12 offset:12288
    v_mfma_f32_16x16x32_bf16 v[124:127], a[148:151], a[204:207], v[124:127]
    ds_read_b64_tr_b16 a[190:191], v13 offset:12288
    v_mfma_f32_16x16x32_bf16 v[128:131], a[152:155], a[192:195], v[128:131]
    v_mov_b32 v26, 0x3f803f80
    v_mfma_f32_16x16x32_bf16 v[132:135], a[152:155], a[196:199], v[132:135]
    buffer_load_dwordx4 v16, s[20:23], s30 offen offset:2048 lds
    v_accvgpr_write_b32 a240, v26
    v_mfma_f32_16x16x32_bf16 v[136:139], a[152:155], a[200:203], v[136:139]
    v_mfma_f32_16x16x32_bf16 v[140:143], a[152:155], a[204:207], v[140:143]
    v_accvgpr_write_b32 a241, v26
    v_mfma_f32_16x16x32_bf16 v[144:147], a[156:159], a[192:195], v[144:147]
    v_accvgpr_write_b32 a242, v26
    v_mfma_f32_16x16x32_bf16 v[148:151], a[156:159], a[196:199], v[148:151]
    buffer_load_dwordx4 v17, s[20:23], s30 offen offset:3072 lds
    v_mfma_f32_16x16x32_bf16 v[152:155], a[156:159], a[200:203], v[152:155]
    s_add_u32 s30, s30, 131072
    v_accvgpr_write_b32 a243, v26
    v_mfma_f32_16x16x32_bf16 v[156:159], a[156:159], a[204:207], v[156:159]
    s_waitcnt lgkmcnt(0) vmcnt(16)
    v_mfma_f32_16x16x32_bf16 v[32:35], a[160:163], a[208:211], v[32:35]
    ds_read_b128 a[192:195], v2 offset:512
    s_add_u32 m0, s33, 12288
    v_mfma_f32_16x16x32_bf16 v[36:39], a[160:163], a[212:215], v[36:39]
    ds_read_b128 a[196:199], v2 offset:16896
    buffer_load_dwordx4 v14, s[20:23], s30 offen offset:0 lds
    v_mfma_f32_16x16x32_bf16 v[40:43], a[160:163], a[216:219], v[40:43]
    ds_read_b128 a[200:203], v2 offset:33280
    v_mfma_f32_16x16x32_bf16 v[44:47], a[160:163], a[220:223], v[44:47]
    ds_read_b128 a[204:207], v2 offset:49664
    v_mfma_f32_16x16x32_bf16 v[48:51], a[164:167], a[208:211], v[48:51]
    ds_read_b64_tr_b16 a[128:129], v6 offset:16384
    v_mfma_f32_16x16x32_bf16 v[52:55], a[164:167], a[212:215], v[52:55]
    ds_read_b64_tr_b16 a[132:133], v7 offset:16384
    buffer_load_dwordx4 v15, s[20:23], s30 offen offset:1024 lds
    v_mfma_f32_16x16x32_bf16 v[56:59], a[164:167], a[216:219], v[56:59]
    ds_read_b64_tr_b16 a[136:137], v8 offset:16384
    v_mfma_f32_16x16x32_bf16 v[60:63], a[164:167], a[220:223], v[60:63]
    ds_read_b64_tr_b16 a[140:141], v9 offset:16384
    v_mfma_f32_16x16x32_bf16 v[64:67], a[168:171], a[208:211], v[64:67]
    ds_read_b64_tr_b16 a[144:145], v10 offset:16384
    v_mfma_f32_16x16x32_bf16 v[68:71], a[168:171], a[212:215], v[68:71]
    ds_read_b64_tr_b16 a[148:149], v11 offset:16384
    buffer_load_dwordx4 v16, s[20:23], s30 offen offset:2048 lds
    v_mfma_f32_16x16x32_bf16 v[72:75], a[168:171], a[216:219], v[72:75]
    ds_read_b64_tr_b16 a[152:153], v12 offset:16384
    v_mfma_f32_16x16x32_bf16 v[76:79], a[168:171], a[220:223], v[76:79]
    ds_read_b64_tr_b16 a[156:157], v13 offset:16384
    v_mfma_f32_16x16x32_bf16 v[80:83], a[172:175], a[208:211], v[80:83]
    v_mfma_f32_16x16x32_bf16 v[84:87], a[172:175], a[212:215], v[84:87]
    buffer_load_dwordx4 v17, s[20:23], s30 offen offset:3072 lds
    v_mfma_f32_16x16x32_bf16 v[88:91], a[172:175], a[216:219], v[88:91]
    s_add_u32 s30, s30, 131072
    v_mfma_f32_16x16x32_bf16 v[92:95], a[172:175], a[220:223], v[92:95]
    s_waitcnt lgkmcnt(0) vmcnt(16)
    v_mfma_f32_16x16x32_bf16 v[96:99], a[176:179], a[208:211], v[96:99]
    ds_read_b64_tr_b16 a[130:131], v6 offset:20480
    s_add_u32 m0, s33, 16384
    v_mfma_f32_16x16x32_bf16 v[100:103], a[176:179], a[212:215], v[100:103]
    ds_read_b64_tr_b16 a[134:135], v7 offset:20480
    buffer_load_dwordx4 v14, s[20:23], s30 offen offset:0 lds
    v_mfma_f32_16x16x32_bf16 v[104:107], a[176:179], a[216:219], v[104:107]
    ds_read_b64_tr_b16 a[138:139], v8 offset:20480
    v_mfma_f32_16x16x32_bf16 v[108:111], a[176:179], a[220:223], v[108:111]
    ds_read_b64_tr_b16 a[142:143], v9 offset:20480
    v_mfma_f32_16x16x32_bf16 v[112:115], a[180:183], a[208:211], v[112:115]
    ds_read_b64_tr_b16 a[146:147], v10 offset:20480
    v_mfma_f32_16x16x32_bf16 v[116:119], a[180:183], a[212:215], v[116:119]
    ds_read_b64_tr_b16 a[150:151], v11 offset:20480
    buffer_load_dwordx4 v15, s[20:23], s30 offen offset:1024 lds
    v_mfma_f32_16x16x32_bf16 v[120:123], a[180:183], a[216:219], v[120:123]
    ds_read_b64_tr_b16 a[154:155], v12 offset:20480
    v_mfma_f32_16x16x32_bf16 v[124:127], a[180:183], a[220:223], v[124:127]
    ds_read_b64_tr_b16 a[158:159], v13 offset:20480
    v_mfma_f32_16x16x32_bf16 v[128:131], a[184:187], a[208:211], v[128:131]
    s_load_dwordx4 s[56:59], s[0:1], 48
    v_mfma_f32_16x16x32_bf16 v[132:135], a[184:187], a[212:215], v[132:135]
    buffer_load_dwordx4 v16, s[20:23], s30 offen offset:2048 lds
    s_load_dwordx2 s[60:61], s[0:1], 72
    v_mfma_f32_16x16x32_bf16 v[136:139], a[184:187], a[216:219], v[136:139]
    s_lshl_b32 s6, s2, 14
    v_mfma_f32_16x16x32_bf16 v[140:143], a[184:187], a[220:223], v[140:143]
    s_add_u32 s6, s6, s32
    v_mfma_f32_16x16x32_bf16 v[144:147], a[188:191], a[208:211], v[144:147]
    v_add_u32 v250, s6, v249
    v_mfma_f32_16x16x32_bf16 v[148:151], a[188:191], a[212:215], v[148:151]
    buffer_load_dwordx4 v17, s[20:23], s30 offen offset:3072 lds
    v_subrev_u32 v251, 524288, v250
    v_mfma_f32_16x16x32_bf16 v[152:155], a[188:191], a[216:219], v[152:155]
    s_add_u32 s30, s30, 131072
    v_subrev_u32 v252, 1048576, v250
    v_mfma_f32_16x16x32_bf16 v[156:159], a[188:191], a[220:223], v[156:159]
    s_load_dwordx2 s[62:63], s[0:1], 96
    s_waitcnt lgkmcnt(0) vmcnt(16)
    v_mfma_f32_16x16x32_bf16 v[32:35], a[128:131], a[192:195], v[32:35]
    ds_read_b128 a[208:211], v3 offset:512
    s_add_u32 m0, s33, 20480
    v_mfma_f32_16x16x32_bf16 v[36:39], a[128:131], a[196:199], v[36:39]
    ds_read_b128 a[212:215], v3 offset:16896
    buffer_load_dwordx4 v14, s[20:23], s30 offen offset:0 lds
    v_mfma_f32_16x16x32_bf16 v[40:43], a[128:131], a[200:203], v[40:43]
    ds_read_b128 a[216:219], v3 offset:33280
    v_mfma_f32_16x16x32_bf16 v[44:47], a[128:131], a[204:207], v[44:47]
    ds_read_b128 a[220:223], v3 offset:49664
    v_mfma_f32_16x16x32_bf16 v[48:51], a[132:135], a[192:195], v[48:51]
    ds_read_b64_tr_b16 a[160:161], v6 offset:0
    v_mfma_f32_16x16x32_bf16 v[52:55], a[132:135], a[196:199], v[52:55]
    ds_read_b64_tr_b16 a[164:165], v7 offset:0
    buffer_load_dwordx4 v15, s[20:23], s30 offen offset:1024 lds
    v_mfma_f32_16x16x32_bf16 v[56:59], a[132:135], a[200:203], v[56:59]
    ds_read_b64_tr_b16 a[168:169], v8 offset:0
    v_mfma_f32_16x16x32_bf16 v[60:63], a[132:135], a[204:207], v[60:63]
    ds_read_b64_tr_b16 a[172:173], v9 offset:0
    v_mfma_f32_16x16x32_bf16 v[64:67], a[136:139], a[192:195], v[64:67]
    ds_read_b64_tr_b16 a[176:177], v10 offset:0
    v_mfma_f32_16x16x32_bf16 v[68:71], a[136:139], a[196:199], v[68:71]
    ds_read_b64_tr_b16 a[180:181], v11 offset:0
    buffer_load_dwordx4 v16, s[20:23], s30 offen offset:2048 lds
    v_mfma_f32_16x16x32_bf16 v[72:75], a[136:139], a[200:203], v[72:75]
    ds_read_b64_tr_b16 a[184:185], v12 offset:0
    v_mfma_f32_16x16x32_bf16 v[76:79], a[136:139], a[204:207], v[76:79]
    ds_read_b64_tr_b16 a[188:189], v13 offset:0
    v_mfma_f32_16x16x32_bf16 v[80:83], a[140:143], a[192:195], v[80:83]
    v_mfma_f32_16x16x32_bf16 v[84:87], a[140:143], a[196:199], v[84:87]
    buffer_load_dwordx4 v17, s[20:23], s30 offen offset:3072 lds
    v_mfma_f32_16x16x32_bf16 v[88:91], a[140:143], a[200:203], v[88:91]
    s_add_u32 s30, s30, 131072
    v_mfma_f32_16x16x32_bf16 v[92:95], a[140:143], a[204:207], v[92:95]
    s_waitcnt lgkmcnt(0) vmcnt(16)
    v_mfma_f32_16x16x32_bf16 v[96:99], a[144:147], a[192:195], v[96:99]
    ds_read_b64_tr_b16 a[162:163], v6 offset:4096
    s_add_u32 m0, s33, 0
    v_mfma_f32_16x16x32_bf16 v[100:103], a[144:147], a[196:199], v[100:103]
    ds_read_b64_tr_b16 a[166:167], v7 offset:4096
    buffer_load_dwordx4 v14, s[20:23], s30 offen offset:0 lds
    v_mfma_f32_16x16x32_bf16 v[104:107], a[144:147], a[200:203], v[104:107]
    ds_read_b64_tr_b16 a[170:171], v8 offset:4096
    v_mfma_f32_16x16x32_bf16 v[108:111], a[144:147], a[204:207], v[108:111]
    ds_read_b64_tr_b16 a[174:175], v9 offset:4096
    v_mfma_f32_16x16x32_bf16 v[112:115], a[148:151], a[192:195], v[112:115]
    ds_read_b64_tr_b16 a[178:179], v10 offset:4096
    v_mfma_f32_16x16x32_bf16 v[116:119], a[148:151], a[196:199], v[116:119]
    ds_read_b64_tr_b16 a[182:183], v11 offset:4096
    buffer_load_dwordx4 v15, s[20:23], s30 offen offset:1024 lds
    v_mfma_f32_16x16x32_bf16 v[120:123], a[148:151], a[200:203], v[120:123]
    ds_read_b64_tr_b16 a[186:187], v12 offset:4096
    v_mfma_f32_16x16x32_bf16 v[124:127], a[148:151], a[204:207], v[124:127]
    ds_read_b64_tr_b16 a[190:191], v13 offset:4096
    v_mfma_f32_16x16x32_bf16 v[128:131], a[152:155], a[192:195], v[128:131]
    s_mov_b32 s44, s56
    s_mov_b32 s45, s57
    v_mfma_f32_16x16x32_bf16 v[132:135], a[152:155], a[196:199], v[132:135]
    buffer_load_dwordx4 v16, s[20:23], s30 offen offset:2048 lds
    s_mov_b32 s46, 524288
    v_mfma_f32_16x16x32_bf16 v[136:139], a[152:155], a[200:203], v[136:139]
    s_mov_b32 s47, 0x00020000
    s_mov_b32 s48, s58
    v_mfma_f32_16x16x32_bf16 v[140:143], a[152:155], a[204:207], v[140:143]
    s_mov_b32 s49, s59
    v_mfma_f32_16x16x32_bf16 v[144:147], a[156:159], a[192:195], v[144:147]
    s_mov_b32 s50, 524288
    s_mov_b32 s51, 0x00020000
    v_mfma_f32_16x16x32_bf16 v[148:151], a[156:159], a[196:199], v[148:151]
    buffer_load_dwordx4 v17, s[20:23], s30 offen offset:3072 lds
    s_mov_b32 s52, s60
    v_mfma_f32_16x16x32_bf16 v[152:155], a[156:159], a[200:203], v[152:155]
    s_add_u32 s30, s30, 131072
    s_mov_b32 s53, s61
    s_mov_b32 s54, 1835008
    v_mfma_f32_16x16x32_bf16 v[156:159], a[156:159], a[204:207], v[156:159]
    s_mov_b32 s55, 0x00020000
    s_waitcnt lgkmcnt(0) vmcnt(16)
    v_mfma_f32_16x16x32_bf16 v[32:35], a[160:163], a[208:211], v[32:35]
    ds_read_b128 a[192:195], v4 offset:512
    s_add_u32 m0, s33, 4096
    v_mfma_f32_16x16x32_bf16 v[36:39], a[160:163], a[212:215], v[36:39]
    ds_read_b128 a[196:199], v4 offset:16896
    buffer_load_dwordx4 v14, s[20:23], s30 offen offset:0 lds
    v_mfma_f32_16x16x32_bf16 v[40:43], a[160:163], a[216:219], v[40:43]
    ds_read_b128 a[200:203], v4 offset:33280
    v_mfma_f32_16x16x32_bf16 v[44:47], a[160:163], a[220:223], v[44:47]
    ds_read_b128 a[204:207], v4 offset:49664
    v_mfma_f32_16x16x32_bf16 v[48:51], a[164:167], a[208:211], v[48:51]
    ds_read_b64_tr_b16 a[128:129], v6 offset:8192
    v_mfma_f32_16x16x32_bf16 v[52:55], a[164:167], a[212:215], v[52:55]
    ds_read_b64_tr_b16 a[132:133], v7 offset:8192
    buffer_load_dwordx4 v15, s[20:23], s30 offen offset:1024 lds
    v_mfma_f32_16x16x32_bf16 v[56:59], a[164:167], a[216:219], v[56:59]
    ds_read_b64_tr_b16 a[136:137], v8 offset:8192
    v_mfma_f32_16x16x32_bf16 v[60:63], a[164:167], a[220:223], v[60:63]
    ds_read_b64_tr_b16 a[140:141], v9 offset:8192
    v_mfma_f32_16x16x32_bf16 v[64:67], a[168:171], a[208:211], v[64:67]
    ds_read_b64_tr_b16 a[144:145], v10 offset:8192
    v_mfma_f32_16x16x32_bf16 v[68:71], a[168:171], a[212:215], v[68:71]
    ds_read_b64_tr_b16 a[148:149], v11 offset:8192
    buffer_load_dwordx4 v16, s[20:23], s30 offen offset:2048 lds
    v_mfma_f32_16x16x32_bf16 v[72:75], a[168:171], a[216:219], v[72:75]
    ds_read_b64_tr_b16 a[152:153], v12 offset:8192
    v_mfma_f32_16x16x32_bf16 v[76:79], a[168:171], a[220:223], v[76:79]
    ds_read_b64_tr_b16 a[156:157], v13 offset:8192
    v_mfma_f32_16x16x32_bf16 v[80:83], a[172:175], a[208:211], v[80:83]
    v_mfma_f32_16x16x32_bf16 v[84:87], a[172:175], a[212:215], v[84:87]
    buffer_load_dwordx4 v17, s[20:23], s30 offen offset:3072 lds
    v_mfma_f32_16x16x32_bf16 v[88:91], a[172:175], a[216:219], v[88:91]
    s_add_u32 s30, s30, 131072
    v_mfma_f32_16x16x32_bf16 v[92:95], a[172:175], a[220:223], v[92:95]
    s_waitcnt lgkmcnt(0) vmcnt(16)
    v_mfma_f32_16x16x32_bf16 v[96:99], a[176:179], a[208:211], v[96:99]
    ds_read_b64_tr_b16 a[130:131], v6 offset:12288
    s_add_u32 m0, s33, 8192
    v_mfma_f32_16x16x32_bf16 v[100:103], a[176:179], a[212:215], v[100:103]
    ds_read_b64_tr_b16 a[134:135], v7 offset:12288
    buffer_load_dwordx4 v14, s[20:23], s30 offen offset:0 lds
    v_mfma_f32_16x16x32_bf16 v[104:107], a[176:179], a[216:219], v[104:107]
    ds_read_b64_tr_b16 a[138:139], v8 offset:12288
    v_mfma_f32_16x16x32_bf16 v[108:111], a[176:179], a[220:223], v[108:111]
    ds_read_b64_tr_b16 a[142:143], v9 offset:12288
    v_mfma_f32_16x16x32_bf16 v[112:115], a[180:183], a[208:211], v[112:115]
    ds_read_b64_tr_b16 a[146:147], v10 offset:12288
    v_mfma_f32_16x16x32_bf16 v[116:119], a[180:183], a[212:215], v[116:119]
    ds_read_b64_tr_b16 a[150:151], v11 offset:12288
    buffer_load_dwordx4 v15, s[20:23], s30 offen offset:1024 lds
    v_mfma_f32_16x16x32_bf16 v[120:123], a[180:183], a[216:219], v[120:123]
    ds_read_b64_tr_b16 a[154:155], v12 offset:12288
    v_mfma_f32_16x16x32_bf16 v[124:127], a[180:183], a[220:223], v[124:127]
    ds_read_b64_tr_b16 a[158:159], v13 offset:12288
    v_mfma_f32_16x16x32_bf16 v[128:131], a[184:187], a[208:211], v[128:131]
    s_mov_b32 s56, s62
    v_mfma_f32_16x16x32_bf16 v[132:135], a[184:187], a[212:215], v[132:135]
    buffer_load_dwordx4 v16, s[20:23], s30 offen offset:2048 lds
    s_mov_b32 s57, s63
    v_mfma_f32_16x16x32_bf16 v[136:139], a[184:187], a[216:219], v[136:139]
    v_mfma_f32_16x16x32_bf16 v[140:143], a[184:187], a[220:223], v[140:143]
    s_mov_b32 s58, 2097152
    v_mfma_f32_16x16x32_bf16 v[144:147], a[188:191], a[208:211], v[144:147]
    s_mov_b32 s59, 0x00020000
    v_mfma_f32_16x16x32_bf16 v[148:151], a[188:191], a[212:215], v[148:151]
    buffer_load_dwordx4 v17, s[20:23], s30 offen offset:3072 lds
    v_mfma_f32_16x16x32_bf16 v[152:155], a[188:191], a[216:219], v[152:155]
    s_add_u32 s30, s30, 131072
    s_mov_b32 s60, 3145728
    v_mfma_f32_16x16x32_bf16 v[156:159], a[188:191], a[220:223], v[156:159]
    s_waitcnt lgkmcnt(0) vmcnt(16)
    v_mfma_f32_16x16x32_bf16 v[32:35], a[128:131], a[192:195], v[32:35]
    ds_read_b128 a[208:211], v5 offset:512
    s_add_u32 m0, s33, 12288
    v_mfma_f32_16x16x32_bf16 v[36:39], a[128:131], a[196:199], v[36:39]
    ds_read_b128 a[212:215], v5 offset:16896
    buffer_load_dwordx4 v14, s[20:23], s30 offen offset:0 lds
    v_mfma_f32_16x16x32_bf16 v[40:43], a[128:131], a[200:203], v[40:43]
    ds_read_b128 a[216:219], v5 offset:33280
    v_mfma_f32_16x16x32_bf16 v[44:47], a[128:131], a[204:207], v[44:47]
    ds_read_b128 a[220:223], v5 offset:49664
    v_mfma_f32_16x16x32_bf16 v[48:51], a[132:135], a[192:195], v[48:51]
    ds_read_b64_tr_b16 a[160:161], v6 offset:16384
    v_mfma_f32_16x16x32_bf16 v[52:55], a[132:135], a[196:199], v[52:55]
    ds_read_b64_tr_b16 a[164:165], v7 offset:16384
    buffer_load_dwordx4 v15, s[20:23], s30 offen offset:1024 lds
    v_mfma_f32_16x16x32_bf16 v[56:59], a[132:135], a[200:203], v[56:59]
    ds_read_b64_tr_b16 a[168:169], v8 offset:16384
    v_mfma_f32_16x16x32_bf16 v[60:63], a[132:135], a[204:207], v[60:63]
    ds_read_b64_tr_b16 a[172:173], v9 offset:16384
    v_mfma_f32_16x16x32_bf16 v[64:67], a[136:139], a[192:195], v[64:67]
    ds_read_b64_tr_b16 a[176:177], v10 offset:16384
    v_mfma_f32_16x16x32_bf16 v[68:71], a[136:139], a[196:199], v[68:71]
    ds_read_b64_tr_b16 a[180:181], v11 offset:16384
    buffer_load_dwordx4 v16, s[20:23], s30 offen offset:2048 lds
    v_mfma_f32_16x16x32_bf16 v[72:75], a[136:139], a[200:203], v[72:75]
    ds_read_b64_tr_b16 a[184:185], v12 offset:16384
    v_mfma_f32_16x16x32_bf16 v[76:79], a[136:139], a[204:207], v[76:79]
    ds_read_b64_tr_b16 a[188:189], v13 offset:16384
    v_mfma_f32_16x16x32_bf16 v[80:83], a[140:143], a[192:195], v[80:83]
    v_mfma_f32_16x16x32_bf16 v[84:87], a[140:143], a[196:199], v[84:87]
    buffer_load_dwordx4 v17, s[20:23], s30 offen offset:3072 lds
    v_mfma_f32_16x16x32_bf16 v[88:91], a[140:143], a[200:203], v[88:91]
    s_add_u32 s30, s30, 131072
    v_mfma_f32_16x16x32_bf16 v[92:95], a[140:143], a[204:207], v[92:95]
    s_waitcnt lgkmcnt(0) vmcnt(16)
    v_mfma_f32_16x16x32_bf16 v[96:99], a[144:147], a[192:195], v[96:99]
    ds_read_b64_tr_b16 a[162:163], v6 offset:20480
    s_add_u32 m0, s33, 16384
    v_mfma_f32_16x16x32_bf16 v[100:103], a[144:147], a[196:199], v[100:103]
    ds_read_b64_tr_b16 a[166:167], v7 offset:20480
    buffer_load_dwordx4 v14, s[20:23], s30 offen offset:0 lds
    v_mfma_f32_16x16x32_bf16 v[104:107], a[144:147], a[200:203], v[104:107]
    ds_read_b64_tr_b16 a[170:171], v8 offset:20480
    v_mfma_f32_16x16x32_bf16 v[108:111], a[144:147], a[204:207], v[108:111]
    ds_read_b64_tr_b16 a[174:175], v9 offset:20480
    v_mfma_f32_16x16x32_bf16 v[112:115], a[148:151], a[192:195], v[112:115]
    ds_read_b64_tr_b16 a[178:179], v10 offset:20480
    v_mfma_f32_16x16x32_bf16 v[116:119], a[148:151], a[196:199], v[116:119]
    ds_read_b64_tr_b16 a[182:183], v11 offset:20480
    buffer_load_dwordx4 v15, s[20:23], s30 offen offset:1024 lds
    v_mfma_f32_16x16x32_bf16 v[120:123], a[148:151], a[200:203], v[120:123]
    ds_read_b64_tr_b16 a[186:187], v12 offset:20480
    v_mfma_f32_16x16x32_bf16 v[124:127], a[148:151], a[204:207], v[124:127]
    ds_read_b64_tr_b16 a[190:191], v13 offset:20480
    v_mfma_f32_16x16x32_bf16 v[128:131], a[152:155], a[192:195], v[128:131]
    s_lshl_b32 s6, s3, 21
    s_lshl_b32 s7, s4, 16
    v_mfma_f32_16x16x32_bf16 v[132:135], a[152:155], a[196:199], v[132:135]
    buffer_load_dwordx4 v16, s[20:23], s30 offen offset:2048 lds
    s_add_u32 s6, s6, s7
    s_add_u32 s6, s6, s32
    v_mfma_f32_16x16x32_bf16 v[136:139], a[152:155], a[200:203], v[136:139]
    s_add_u32 s60, s6, 13631488
    s_mov_b32 s61, 16384
    v_mfma_f32_16x16x32_bf16 v[140:143], a[152:155], a[204:207], v[140:143]
    s_lshl_b32 s6, s3, 18
    s_and_b32 s7, s4, 3
    v_mfma_f32_16x16x32_bf16 v[144:147], a[156:159], a[192:195], v[144:147]
    s_lshl_b32 s7, s7, 16
    s_add_u32 s6, s6, s7
    v_mfma_f32_16x16x32_bf16 v[148:151], a[156:159], a[196:199], v[148:151]
    buffer_load_dwordx4 v17, s[20:23], s30 offen offset:3072 lds
    s_lshr_b32 s7, s4, 2
    s_lshl_b32 s7, s7, 13
    v_mfma_f32_16x16x32_bf16 v[152:155], a[156:159], a[200:203], v[152:155]
    s_add_u32 s30, s30, 131072
    s_add_u32 s6, s6, s7
    s_and_b32 s7, s32, 4096
    v_mfma_f32_16x16x32_bf16 v[156:159], a[156:159], a[204:207], v[156:159]
    s_add_u32 s6, s6, s7
    s_add_u32 s62, s6, 3145728
    s_waitcnt lgkmcnt(0) vmcnt(16)
    v_mfma_f32_16x16x32_bf16 v[32:35], a[160:163], a[208:211], v[32:35]
    ds_read_b128 a[192:195], v2 offset:768
    s_add_u32 m0, s33, 20480
    v_mfma_f32_16x16x32_bf16 v[36:39], a[160:163], a[212:215], v[36:39]
    ds_read_b128 a[196:199], v2 offset:17152
    buffer_load_dwordx4 v14, s[20:23], s30 offen offset:0 lds
    v_mfma_f32_16x16x32_bf16 v[40:43], a[160:163], a[216:219], v[40:43]
    ds_read_b128 a[200:203], v2 offset:33536
    v_mfma_f32_16x16x32_bf16 v[44:47], a[160:163], a[220:223], v[44:47]
    ds_read_b128 a[204:207], v2 offset:49920
    v_mfma_f32_16x16x32_bf16 v[48:51], a[164:167], a[208:211], v[48:51]
    ds_read_b64_tr_b16 a[128:129], v6 offset:0
    v_mfma_f32_16x16x32_bf16 v[52:55], a[164:167], a[212:215], v[52:55]
    ds_read_b64_tr_b16 a[132:133], v7 offset:0
    buffer_load_dwordx4 v15, s[20:23], s30 offen offset:1024 lds
    v_mfma_f32_16x16x32_bf16 v[56:59], a[164:167], a[216:219], v[56:59]
    ds_read_b64_tr_b16 a[136:137], v8 offset:0
    v_mfma_f32_16x16x32_bf16 v[60:63], a[164:167], a[220:223], v[60:63]
    ds_read_b64_tr_b16 a[140:141], v9 offset:0
    v_mfma_f32_16x16x32_bf16 v[64:67], a[168:171], a[208:211], v[64:67]
    ds_read_b64_tr_b16 a[144:145], v10 offset:0
    v_mfma_f32_16x16x32_bf16 v[68:71], a[168:171], a[212:215], v[68:71]
    ds_read_b64_tr_b16 a[148:149], v11 offset:0
    buffer_load_dwordx4 v16, s[20:23], s30 offen offset:2048 lds
    v_mfma_f32_16x16x32_bf16 v[72:75], a[168:171], a[216:219], v[72:75]
    ds_read_b64_tr_b16 a[152:153], v12 offset:0
    v_mfma_f32_16x16x32_bf16 v[76:79], a[168:171], a[220:223], v[76:79]
    ds_read_b64_tr_b16 a[156:157], v13 offset:0
    v_mfma_f32_16x16x32_bf16 v[80:83], a[172:175], a[208:211], v[80:83]
    v_mfma_f32_16x16x32_bf16 v[84:87], a[172:175], a[212:215], v[84:87]
    buffer_load_dwordx4 v17, s[20:23], s30 offen offset:3072 lds
    v_mfma_f32_16x16x32_bf16 v[88:91], a[172:175], a[216:219], v[88:91]
    s_add_u32 s30, s30, 131072
    v_mfma_f32_16x16x32_bf16 v[92:95], a[172:175], a[220:223], v[92:95]
    s_waitcnt lgkmcnt(0) vmcnt(16)
    v_mfma_f32_16x16x32_bf16 v[96:99], a[176:179], a[208:211], v[96:99]
    ds_read_b64_tr_b16 a[130:131], v6 offset:4096
    s_add_u32 m0, s33, 0
    v_mfma_f32_16x16x32_bf16 v[100:103], a[176:179], a[212:215], v[100:103]
    ds_read_b64_tr_b16 a[134:135], v7 offset:4096
    buffer_load_dwordx4 v14, s[20:23], s30 offen offset:0 lds
    v_mfma_f32_16x16x32_bf16 v[104:107], a[176:179], a[216:219], v[104:107]
    ds_read_b64_tr_b16 a[138:139], v8 offset:4096
    v_mfma_f32_16x16x32_bf16 v[108:111], a[176:179], a[220:223], v[108:111]
    ds_read_b64_tr_b16 a[142:143], v9 offset:4096
    v_mfma_f32_16x16x32_bf16 v[112:115], a[180:183], a[208:211], v[112:115]
    ds_read_b64_tr_b16 a[146:147], v10 offset:4096
    v_mfma_f32_16x16x32_bf16 v[116:119], a[180:183], a[212:215], v[116:119]
    ds_read_b64_tr_b16 a[150:151], v11 offset:4096
    buffer_load_dwordx4 v15, s[20:23], s30 offen offset:1024 lds
    v_mfma_f32_16x16x32_bf16 v[120:123], a[180:183], a[216:219], v[120:123]
    ds_read_b64_tr_b16 a[154:155], v12 offset:4096
    v_mfma_f32_16x16x32_bf16 v[124:127], a[180:183], a[220:223], v[124:127]
    ds_read_b64_tr_b16 a[158:159], v13 offset:4096
    v_mfma_f32_16x16x32_bf16 v[128:131], a[184:187], a[208:211], v[128:131]
    v_mfma_f32_16x16x32_bf16 v[132:135], a[184:187], a[212:215], v[132:135]
    buffer_load_dwordx4 v16, s[20:23], s30 offen offset:2048 lds
    v_mfma_f32_16x16x32_bf16 v[136:139], a[184:187], a[216:219], v[136:139]
    v_mfma_f32_16x16x32_bf16 v[140:143], a[184:187], a[220:223], v[140:143]
    v_mfma_f32_16x16x32_bf16 v[144:147], a[188:191], a[208:211], v[144:147]
    v_mfma_f32_16x16x32_bf16 v[148:151], a[188:191], a[212:215], v[148:151]
    buffer_load_dwordx4 v17, s[20:23], s30 offen offset:3072 lds
    v_mfma_f32_16x16x32_bf16 v[152:155], a[188:191], a[216:219], v[152:155]
    s_add_u32 s30, s30, 131072
    v_mfma_f32_16x16x32_bf16 v[156:159], a[188:191], a[220:223], v[156:159]
    s_waitcnt lgkmcnt(0) vmcnt(16)
    v_mfma_f32_16x16x32_bf16 v[32:35], a[128:131], a[192:195], v[32:35]
    ds_read_b128 a[208:211], v3 offset:768
    s_add_u32 m0, s33, 4096
    v_mfma_f32_16x16x32_bf16 v[36:39], a[128:131], a[196:199], v[36:39]
    ds_read_b128 a[212:215], v3 offset:17152
    buffer_load_dwordx4 v14, s[20:23], s30 offen offset:0 lds
    v_mfma_f32_16x16x32_bf16 v[40:43], a[128:131], a[200:203], v[40:43]
    ds_read_b128 a[216:219], v3 offset:33536
    v_mfma_f32_16x16x32_bf16 v[44:47], a[128:131], a[204:207], v[44:47]
    ds_read_b128 a[220:223], v3 offset:49920
    v_mfma_f32_16x16x32_bf16 v[48:51], a[132:135], a[192:195], v[48:51]
    ds_read_b64_tr_b16 a[160:161], v6 offset:8192
    v_mfma_f32_16x16x32_bf16 v[52:55], a[132:135], a[196:199], v[52:55]
    ds_read_b64_tr_b16 a[164:165], v7 offset:8192
    buffer_load_dwordx4 v15, s[20:23], s30 offen offset:1024 lds
    v_mfma_f32_16x16x32_bf16 v[56:59], a[132:135], a[200:203], v[56:59]
    ds_read_b64_tr_b16 a[168:169], v8 offset:8192
    v_mfma_f32_16x16x32_bf16 v[60:63], a[132:135], a[204:207], v[60:63]
    ds_read_b64_tr_b16 a[172:173], v9 offset:8192
    v_mfma_f32_16x16x32_bf16 v[64:67], a[136:139], a[192:195], v[64:67]
    ds_read_b64_tr_b16 a[176:177], v10 offset:8192
    v_mfma_f32_16x16x32_bf16 v[68:71], a[136:139], a[196:199], v[68:71]
    ds_read_b64_tr_b16 a[180:181], v11 offset:8192
    buffer_load_dwordx4 v16, s[20:23], s30 offen offset:2048 lds
    v_mfma_f32_16x16x32_bf16 v[72:75], a[136:139], a[200:203], v[72:75]
    ds_read_b64_tr_b16 a[184:185], v12 offset:8192
    v_mfma_f32_16x16x32_bf16 v[76:79], a[136:139], a[204:207], v[76:79]
    ds_read_b64_tr_b16 a[188:189], v13 offset:8192
    v_mfma_f32_16x16x32_bf16 v[80:83], a[140:143], a[192:195], v[80:83]
    v_mfma_f32_16x16x32_bf16 v[84:87], a[140:143], a[196:199], v[84:87]
    buffer_load_dwordx4 v17, s[20:23], s30 offen offset:3072 lds
    v_mfma_f32_16x16x32_bf16 v[88:91], a[140:143], a[200:203], v[88:91]
    s_add_u32 s30, s30, 131072
    v_mfma_f32_16x16x32_bf16 v[92:95], a[140:143], a[204:207], v[92:95]
    s_waitcnt lgkmcnt(0) vmcnt(16)
    v_mfma_f32_16x16x32_bf16 v[96:99], a[144:147], a[192:195], v[96:99]
    ds_read_b64_tr_b16 a[162:163], v6 offset:12288
    s_add_u32 m0, s33, 8192
    v_mfma_f32_16x16x32_bf16 v[100:103], a[144:147], a[196:199], v[100:103]
    ds_read_b64_tr_b16 a[166:167], v7 offset:12288
    buffer_load_dwordx4 v18, s[12:15], s28 offen offset:0 lds
    v_mfma_f32_16x16x32_bf16 v[104:107], a[144:147], a[200:203], v[104:107]
    ds_read_b64_tr_b16 a[170:171], v8 offset:12288
    v_mfma_f32_16x16x32_bf16 v[108:111], a[144:147], a[204:207], v[108:111]
    ds_read_b64_tr_b16 a[174:175], v9 offset:12288
    v_mfma_f32_16x16x32_bf16 v[112:115], a[148:151], a[192:195], v[112:115]
    ds_read_b64_tr_b16 a[178:179], v10 offset:12288
    v_mfma_f32_16x16x32_bf16 v[116:119], a[148:151], a[196:199], v[116:119]
    ds_read_b64_tr_b16 a[182:183], v11 offset:12288
    buffer_load_dwordx4 v19, s[12:15], s28 offen offset:1024 lds
    v_mfma_f32_16x16x32_bf16 v[120:123], a[148:151], a[200:203], v[120:123]
    ds_read_b64_tr_b16 a[186:187], v12 offset:12288
    v_mfma_f32_16x16x32_bf16 v[124:127], a[148:151], a[204:207], v[124:127]
    ds_read_b64_tr_b16 a[190:191], v13 offset:12288
    v_mfma_f32_16x16x32_bf16 v[128:131], a[152:155], a[192:195], v[128:131]
    v_mfma_f32_16x16x32_bf16 v[132:135], a[152:155], a[196:199], v[132:135]
    buffer_load_dwordx4 v20, s[12:15], s28 offen offset:2048 lds
    v_mfma_f32_16x16x32_bf16 v[136:139], a[152:155], a[200:203], v[136:139]
    v_mfma_f32_16x16x32_bf16 v[140:143], a[152:155], a[204:207], v[140:143]
    v_mfma_f32_16x16x32_bf16 v[144:147], a[156:159], a[192:195], v[144:147]
    v_mfma_f32_16x16x32_bf16 v[148:151], a[156:159], a[196:199], v[148:151]
    buffer_load_dwordx4 v21, s[12:15], s28 offen offset:3072 lds
    v_mfma_f32_16x16x32_bf16 v[152:155], a[156:159], a[200:203], v[152:155]
    s_add_u32 s28, s28, 16384
    v_mfma_f32_16x16x32_bf16 v[156:159], a[156:159], a[204:207], v[156:159]
    s_waitcnt lgkmcnt(0) vmcnt(16)
    v_mfma_f32_16x16x32_bf16 v[32:35], a[160:163], a[208:211], v[32:35]
    ds_read_b128 a[192:195], v4 offset:768
    s_add_u32 m0, s33, 12288
    v_mfma_f32_16x16x32_bf16 v[36:39], a[160:163], a[212:215], v[36:39]
    ds_read_b128 a[196:199], v4 offset:17152
    buffer_load_dwordx4 v18, s[12:15], s28 offen offset:0 lds
    v_mfma_f32_16x16x32_bf16 v[40:43], a[160:163], a[216:219], v[40:43]
    ds_read_b128 a[200:203], v4 offset:33536
    v_mfma_f32_16x16x32_bf16 v[44:47], a[160:163], a[220:223], v[44:47]
    ds_read_b128 a[204:207], v4 offset:49920
    v_mfma_f32_16x16x32_bf16 v[48:51], a[164:167], a[208:211], v[48:51]
    ds_read_b64_tr_b16 a[128:129], v6 offset:16384
    v_mfma_f32_16x16x32_bf16 v[52:55], a[164:167], a[212:215], v[52:55]
    ds_read_b64_tr_b16 a[132:133], v7 offset:16384
    buffer_load_dwordx4 v19, s[12:15], s28 offen offset:1024 lds
    v_mfma_f32_16x16x32_bf16 v[56:59], a[164:167], a[216:219], v[56:59]
    ds_read_b64_tr_b16 a[136:137], v8 offset:16384
    v_mfma_f32_16x16x32_bf16 v[60:63], a[164:167], a[220:223], v[60:63]
    ds_read_b64_tr_b16 a[140:141], v9 offset:16384
    v_mfma_f32_16x16x32_bf16 v[64:67], a[168:171], a[208:211], v[64:67]
    ds_read_b64_tr_b16 a[144:145], v10 offset:16384
    v_mfma_f32_16x16x32_bf16 v[68:71], a[168:171], a[212:215], v[68:71]
    ds_read_b64_tr_b16 a[148:149], v11 offset:16384
    buffer_load_dwordx4 v20, s[12:15], s28 offen offset:2048 lds
    v_mfma_f32_16x16x32_bf16 v[72:75], a[168:171], a[216:219], v[72:75]
    ds_read_b64_tr_b16 a[152:153], v12 offset:16384
    v_mfma_f32_16x16x32_bf16 v[76:79], a[168:171], a[220:223], v[76:79]
    ds_read_b64_tr_b16 a[156:157], v13 offset:16384
    v_mfma_f32_16x16x32_bf16 v[80:83], a[172:175], a[208:211], v[80:83]
    v_mfma_f32_16x16x32_bf16 v[84:87], a[172:175], a[212:215], v[84:87]
    buffer_load_dwordx4 v21, s[12:15], s28 offen offset:3072 lds
    v_mfma_f32_16x16x32_bf16 v[88:91], a[172:175], a[216:219], v[88:91]
    s_add_u32 s28, s28, 16384
    v_mfma_f32_16x16x32_bf16 v[92:95], a[172:175], a[220:223], v[92:95]
    s_waitcnt lgkmcnt(0) vmcnt(16)
    v_mfma_f32_16x16x32_bf16 v[96:99], a[176:179], a[208:211], v[96:99]
    ds_read_b64_tr_b16 a[130:131], v6 offset:20480
    s_add_u32 m0, s33, 16384
    v_mfma_f32_16x16x32_bf16 v[100:103], a[176:179], a[212:215], v[100:103]
    ds_read_b64_tr_b16 a[134:135], v7 offset:20480
    buffer_load_dwordx4 v22, s[16:19], s29 offen offset:0 lds
    v_mfma_f32_16x16x32_bf16 v[104:107], a[176:179], a[216:219], v[104:107]
    ds_read_b64_tr_b16 a[138:139], v8 offset:20480
    v_mfma_f32_16x16x32_bf16 v[108:111], a[176:179], a[220:223], v[108:111]
    ds_read_b64_tr_b16 a[142:143], v9 offset:20480
    v_mfma_f32_16x16x32_bf16 v[112:115], a[180:183], a[208:211], v[112:115]
    ds_read_b64_tr_b16 a[146:147], v10 offset:20480
    v_mfma_f32_16x16x32_bf16 v[116:119], a[180:183], a[212:215], v[116:119]
    ds_read_b64_tr_b16 a[150:151], v11 offset:20480
    buffer_load_dwordx4 v23, s[16:19], s29 offen offset:1024 lds
    v_mfma_f32_16x16x32_bf16 v[120:123], a[180:183], a[216:219], v[120:123]
    ds_read_b64_tr_b16 a[154:155], v12 offset:20480
    v_mfma_f32_16x16x32_bf16 v[124:127], a[180:183], a[220:223], v[124:127]
    ds_read_b64_tr_b16 a[158:159], v13 offset:20480
    v_mfma_f32_16x16x32_bf16 v[128:131], a[184:187], a[208:211], v[128:131]
    v_lshl_add_u32 v14, v25, 10, v28
    v_mfma_f32_16x16x32_bf16 v[132:135], a[184:187], a[212:215], v[132:135]
    buffer_load_dwordx4 v22, s[16:19], s29 offen offset:2048 lds
    v_xor_b32 v15, 0x80, v14
    v_mfma_f32_16x16x32_bf16 v[136:139], a[184:187], a[216:219], v[136:139]
    v_add_u32 v16, 6144, v14
    v_mfma_f32_16x16x32_bf16 v[140:143], a[184:187], a[220:223], v[140:143]
    v_mfma_f32_16x16x32_bf16 v[144:147], a[188:191], a[208:211], v[144:147]
    v_add_u32 v17, 9216, v15
    v_mfma_f32_16x16x32_bf16 v[148:151], a[188:191], a[212:215], v[148:151]
    buffer_load_dwordx4 v23, s[16:19], s29 offen offset:3072 lds
    v_add_u32 v15, 3072, v15
    v_mfma_f32_16x16x32_bf16 v[152:155], a[188:191], a[216:219], v[152:155]
    s_add_u32 s29, s29, 16384
    s_mov_b32 s30, 0
    v_mfma_f32_16x16x32_bf16 v[156:159], a[188:191], a[220:223], v[156:159]
    s_waitcnt lgkmcnt(0) vmcnt(16)
    v_mfma_f32_16x16x32_bf16 v[32:35], a[128:131], a[192:195], v[32:35]
    ds_read_b128 a[208:211], v5 offset:768
    s_add_u32 m0, s33, 20480
    v_mfma_f32_16x16x32_bf16 v[36:39], a[128:131], a[196:199], v[36:39]
    ds_read_b128 a[212:215], v5 offset:17152
    buffer_load_dwordx4 v18, s[12:15], s28 offen offset:0 lds
    v_mfma_f32_16x16x32_bf16 v[40:43], a[128:131], a[200:203], v[40:43]
    ds_read_b128 a[216:219], v5 offset:33536
    v_mfma_f32_16x16x32_bf16 v[44:47], a[128:131], a[204:207], v[44:47]
    ds_read_b128 a[220:223], v5 offset:49920
    v_mfma_f32_16x16x32_bf16 v[48:51], a[132:135], a[192:195], v[48:51]
    ds_read_b64_tr_b16 a[160:161], v6 offset:0
    v_mfma_f32_16x16x32_bf16 v[52:55], a[132:135], a[196:199], v[52:55]
    ds_read_b64_tr_b16 a[164:165], v7 offset:0
    buffer_load_dwordx4 v19, s[12:15], s28 offen offset:1024 lds
    v_mfma_f32_16x16x32_bf16 v[56:59], a[132:135], a[200:203], v[56:59]
    ds_read_b64_tr_b16 a[168:169], v8 offset:0
    v_mfma_f32_16x16x32_bf16 v[60:63], a[132:135], a[204:207], v[60:63]
    ds_read_b64_tr_b16 a[172:173], v9 offset:0
    v_mfma_f32_16x16x32_bf16 v[64:67], a[136:139], a[192:195], v[64:67]
    ds_read_b64_tr_b16 a[176:177], v10 offset:0
    v_mfma_f32_16x16x32_bf16 v[68:71], a[136:139], a[196:199], v[68:71]
    ds_read_b64_tr_b16 a[180:181], v11 offset:0
    buffer_load_dwordx4 v20, s[12:15], s28 offen offset:2048 lds
    v_mfma_f32_16x16x32_bf16 v[72:75], a[136:139], a[200:203], v[72:75]
    ds_read_b64_tr_b16 a[184:185], v12 offset:0
    v_mfma_f32_16x16x32_bf16 v[76:79], a[136:139], a[204:207], v[76:79]
    ds_read_b64_tr_b16 a[188:189], v13 offset:0
    v_mfma_f32_16x16x32_bf16 v[80:83], a[140:143], a[192:195], v[80:83]
    v_mfma_f32_16x16x32_bf16 v[84:87], a[140:143], a[196:199], v[84:87]
    buffer_load_dwordx4 v21, s[12:15], s28 offen offset:3072 lds
    v_mfma_f32_16x16x32_bf16 v[88:91], a[140:143], a[200:203], v[88:91]
    s_add_u32 s28, s28, 16384
    v_mfma_f32_16x16x32_bf16 v[92:95], a[140:143], a[204:207], v[92:95]
    s_waitcnt lgkmcnt(0) vmcnt(16)
    v_mfma_f32_16x16x32_bf16 v[96:99], a[144:147], a[192:195], v[96:99]
    ds_read_b64_tr_b16 a[162:163], v6 offset:4096
    s_add_u32 m0, s33, 0
    v_mfma_f32_16x16x32_bf16 v[100:103], a[144:147], a[196:199], v[100:103]
    ds_read_b64_tr_b16 a[166:167], v7 offset:4096
    buffer_load_dwordx4 v22, s[16:19], s29 offen offset:0 lds
    v_mfma_f32_16x16x32_bf16 v[104:107], a[144:147], a[200:203], v[104:107]
    ds_read_b64_tr_b16 a[170:171], v8 offset:4096
    v_mfma_f32_16x16x32_bf16 v[108:111], a[144:147], a[204:207], v[108:111]
    ds_read_b64_tr_b16 a[174:175], v9 offset:4096
    v_mfma_f32_16x16x32_bf16 v[112:115], a[148:151], a[192:195], v[112:115]
    ds_read_b64_tr_b16 a[178:179], v10 offset:4096
    v_mfma_f32_16x16x32_bf16 v[116:119], a[148:151], a[196:199], v[116:119]
    ds_read_b64_tr_b16 a[182:183], v11 offset:4096
    buffer_load_dwordx4 v23, s[16:19], s29 offen offset:1024 lds
    v_mfma_f32_16x16x32_bf16 v[120:123], a[148:151], a[200:203], v[120:123]
    ds_read_b64_tr_b16 a[186:187], v12 offset:4096
    v_mfma_f32_16x16x32_bf16 v[124:127], a[148:151], a[204:207], v[124:127]
    ds_read_b64_tr_b16 a[190:191], v13 offset:4096
    v_mfma_f32_16x16x32_bf16 v[128:131], a[152:155], a[192:195], v[128:131]
    v_mfma_f32_16x16x32_bf16 v[132:135], a[152:155], a[196:199], v[132:135]
    buffer_load_dwordx4 v22, s[16:19], s29 offen offset:2048 lds
    v_mfma_f32_16x16x32_bf16 v[136:139], a[152:155], a[200:203], v[136:139]
    v_mfma_f32_16x16x32_bf16 v[140:143], a[152:155], a[204:207], v[140:143]
    v_mfma_f32_16x16x32_bf16 v[144:147], a[156:159], a[192:195], v[144:147]
    v_mfma_f32_16x16x32_bf16 v[148:151], a[156:159], a[196:199], v[148:151]
    buffer_load_dwordx4 v23, s[16:19], s29 offen offset:3072 lds
    v_mfma_f32_16x16x32_bf16 v[152:155], a[156:159], a[200:203], v[152:155]
    s_add_u32 s29, s29, 16384
    v_mfma_f32_16x16x32_bf16 v[156:159], a[156:159], a[204:207], v[156:159]
    s_waitcnt lgkmcnt(0) vmcnt(16)
    s_barrier
    v_mfma_f32_16x16x32_bf16 v[32:35], a[160:163], a[208:211], v[32:35]
    ds_read_b128 a[128:131], v224 offset:8192
    v_mfma_f32_16x16x32_bf16 v[36:39], a[160:163], a[212:215], v[36:39]
    ds_read_b128 a[132:135], v224 offset:32768
    v_mfma_f32_16x16x32_bf16 v[40:43], a[160:163], a[216:219], v[40:43]
    ds_read_b128 a[136:139], v225 offset:8192
    v_mfma_f32_16x16x32_bf16 v[44:47], a[160:163], a[220:223], v[44:47]
    ds_read_b128 a[140:143], v225 offset:32768
    v_mfma_f32_16x16x32_bf16 v[48:51], a[164:167], a[208:211], v[48:51]
    ds_read_b128 a[144:147], v226 offset:8192
    v_mfma_f32_16x16x32_bf16 v[52:55], a[164:167], a[212:215], v[52:55]
    ds_read_b128 a[148:151], v226 offset:32768
    v_mfma_f32_16x16x32_bf16 v[56:59], a[164:167], a[216:219], v[56:59]
    ds_read_b128 a[152:155], v227 offset:8192
    v_mfma_f32_16x16x32_bf16 v[60:63], a[164:167], a[220:223], v[60:63]
    ds_read_b128 a[156:159], v227 offset:32768
    v_mfma_f32_16x16x32_bf16 v[64:67], a[168:171], a[208:211], v[64:67]
    v_mfma_f32_16x16x32_bf16 v[68:71], a[168:171], a[212:215], v[68:71]
    v_cvt_pk_bf16_f32 v160, v32, v33
    v_cvt_pk_bf16_f32 v161, v34, v35
    v_mfma_f32_16x16x32_bf16 v[72:75], a[168:171], a[216:219], v[72:75]
    v_cvt_pk_bf16_f32 v162, v48, v49
    v_cvt_pk_bf16_f32 v163, v50, v51
    v_mfma_f32_16x16x32_bf16 v[76:79], a[168:171], a[220:223], v[76:79]
    v_cvt_pk_bf16_f32 v176, v36, v37
    v_cvt_pk_bf16_f32 v177, v38, v39
    v_mfma_f32_16x16x32_bf16 v[80:83], a[172:175], a[208:211], v[80:83]
    v_cvt_pk_bf16_f32 v178, v52, v53
    v_cvt_pk_bf16_f32 v179, v54, v55
    v_mfma_f32_16x16x32_bf16 v[84:87], a[172:175], a[212:215], v[84:87]
    v_cvt_pk_bf16_f32 v192, v40, v41
    v_cvt_pk_bf16_f32 v193, v42, v43
    v_mfma_f32_16x16x32_bf16 v[88:91], a[172:175], a[216:219], v[88:91]
    v_cvt_pk_bf16_f32 v194, v56, v57
    v_cvt_pk_bf16_f32 v195, v58, v59
    v_mfma_f32_16x16x32_bf16 v[92:95], a[172:175], a[220:223], v[92:95]
    v_cvt_pk_bf16_f32 v208, v44, v45
    v_cvt_pk_bf16_f32 v209, v46, v47
    v_mfma_f32_16x16x32_bf16 v[96:99], a[176:179], a[208:211], v[96:99]
    v_cvt_pk_bf16_f32 v210, v60, v61
    v_cvt_pk_bf16_f32 v211, v62, v63
    v_mfma_f32_16x16x32_bf16 v[100:103], a[176:179], a[212:215], v[100:103]
    v_permlane16_swap_b32 v160, v162
    v_permlane16_swap_b32 v161, v163
    v_mfma_f32_16x16x32_bf16 v[104:107], a[176:179], a[216:219], v[104:107]
    v_permlane16_swap_b32 v176, v178
    v_permlane16_swap_b32 v177, v179
    v_mfma_f32_16x16x32_bf16 v[108:111], a[176:179], a[220:223], v[108:111]
    v_permlane16_swap_b32 v192, v194
    v_permlane16_swap_b32 v193, v195
    v_mfma_f32_16x16x32_bf16 v[112:115], a[180:183], a[208:211], v[112:115]
    v_permlane16_swap_b32 v208, v210
    v_permlane16_swap_b32 v209, v211
    v_mfma_f32_16x16x32_bf16 v[116:119], a[180:183], a[212:215], v[116:119]
    v_cvt_pk_bf16_f32 v164, v64, v65
    v_cvt_pk_bf16_f32 v165, v66, v67
    v_mfma_f32_16x16x32_bf16 v[120:123], a[180:183], a[216:219], v[120:123]
    v_cvt_pk_bf16_f32 v166, v80, v81
    v_cvt_pk_bf16_f32 v167, v82, v83
    v_mfma_f32_16x16x32_bf16 v[124:127], a[180:183], a[220:223], v[124:127]
    v_cvt_pk_bf16_f32 v180, v68, v69
    v_cvt_pk_bf16_f32 v181, v70, v71
    v_mfma_f32_16x16x32_bf16 v[128:131], a[184:187], a[208:211], v[128:131]
    v_cvt_pk_bf16_f32 v182, v84, v85
    v_cvt_pk_bf16_f32 v183, v86, v87
    v_mfma_f32_16x16x32_bf16 v[132:135], a[184:187], a[212:215], v[132:135]
    v_cvt_pk_bf16_f32 v196, v72, v73
    v_cvt_pk_bf16_f32 v197, v74, v75
    v_mfma_f32_16x16x32_bf16 v[136:139], a[184:187], a[216:219], v[136:139]
    v_cvt_pk_bf16_f32 v198, v88, v89
    v_cvt_pk_bf16_f32 v199, v90, v91
    v_mfma_f32_16x16x32_bf16 v[140:143], a[184:187], a[220:223], v[140:143]
    v_cvt_pk_bf16_f32 v212, v76, v77
    v_cvt_pk_bf16_f32 v213, v78, v79
    v_mfma_f32_16x16x32_bf16 v[144:147], a[188:191], a[208:211], v[144:147]
    v_cvt_pk_bf16_f32 v214, v92, v93
    v_cvt_pk_bf16_f32 v215, v94, v95
    v_mfma_f32_16x16x32_bf16 v[148:151], a[188:191], a[212:215], v[148:151]
    v_permlane16_swap_b32 v164, v166
    v_permlane16_swap_b32 v165, v167
    v_mfma_f32_16x16x32_bf16 v[152:155], a[188:191], a[216:219], v[152:155]
    v_permlane16_swap_b32 v180, v182
    v_permlane16_swap_b32 v181, v183
    v_mfma_f32_16x16x32_bf16 v[156:159], a[188:191], a[220:223], v[156:159]
    v_permlane16_swap_b32 v196, v198
    v_permlane16_swap_b32 v197, v199
    v_permlane16_swap_b32 v212, v214
    v_permlane16_swap_b32 v213, v215
    v_cvt_pk_bf16_f32 v168, v96, v97
    v_cvt_pk_bf16_f32 v169, v98, v99
    v_cvt_pk_bf16_f32 v170, v112, v113
    v_cvt_pk_bf16_f32 v171, v114, v115
    v_cvt_pk_bf16_f32 v184, v100, v101
    v_cvt_pk_bf16_f32 v185, v102, v103
    v_cvt_pk_bf16_f32 v186, v116, v117
    v_cvt_pk_bf16_f32 v187, v118, v119
    v_cvt_pk_bf16_f32 v200, v104, v105
    v_cvt_pk_bf16_f32 v201, v106, v107
    v_cvt_pk_bf16_f32 v202, v120, v121
    v_cvt_pk_bf16_f32 v203, v122, v123
    v_cvt_pk_bf16_f32 v216, v108, v109
    v_cvt_pk_bf16_f32 v217, v110, v111
    v_cvt_pk_bf16_f32 v218, v124, v125
    v_cvt_pk_bf16_f32 v219, v126, v127
    v_permlane16_swap_b32 v168, v170
    v_permlane16_swap_b32 v169, v171
    v_permlane16_swap_b32 v184, v186
    v_permlane16_swap_b32 v185, v187
    v_permlane16_swap_b32 v200, v202
    v_permlane16_swap_b32 v201, v203
    v_permlane16_swap_b32 v216, v218
    v_permlane16_swap_b32 v217, v219
    v_cvt_pk_bf16_f32 v172, v128, v129
    v_cvt_pk_bf16_f32 v173, v130, v131
    v_cvt_pk_bf16_f32 v174, v144, v145
    v_cvt_pk_bf16_f32 v175, v146, v147
    v_cvt_pk_bf16_f32 v188, v132, v133
    v_cvt_pk_bf16_f32 v189, v134, v135
    v_cvt_pk_bf16_f32 v190, v148, v149
    v_cvt_pk_bf16_f32 v191, v150, v151
    v_cvt_pk_bf16_f32 v204, v136, v137
    v_cvt_pk_bf16_f32 v205, v138, v139
    v_cvt_pk_bf16_f32 v206, v152, v153
    v_cvt_pk_bf16_f32 v207, v154, v155
    v_cvt_pk_bf16_f32 v220, v140, v141
    v_cvt_pk_bf16_f32 v221, v142, v143
    v_cvt_pk_bf16_f32 v222, v156, v157
    v_cvt_pk_bf16_f32 v223, v158, v159
    v_permlane16_swap_b32 v172, v174
    v_permlane16_swap_b32 v173, v175
    v_permlane16_swap_b32 v188, v190
    v_permlane16_swap_b32 v189, v191
    v_permlane16_swap_b32 v204, v206
    v_permlane16_swap_b32 v205, v207
    v_permlane16_swap_b32 v220, v222
    v_permlane16_swap_b32 v221, v223
K1_PRE:
    s_waitcnt lgkmcnt(0)
    v_mfma_f32_16x16x32_bf16 v[32:35], a[128:131], v[160:163], 0
    v_mfma_f32_16x16x32_bf16 v[40:43], a[128:131], v[176:179], 0
    v_mfma_f32_16x16x32_bf16 v[48:51], a[128:131], v[192:195], 0
    v_mfma_f32_16x16x32_bf16 v[56:59], a[128:131], v[208:211], 0
    ds_read_b128 a[160:163], v228 offset:8192
    v_mfma_f32_16x16x32_bf16 v[36:39], a[132:135], v[160:163], 0
    v_mfma_f32_16x16x32_bf16 v[44:47], a[132:135], v[176:179], 0
    v_mfma_f32_16x16x32_bf16 v[52:55], a[132:135], v[192:195], 0
    v_mfma_f32_16x16x32_bf16 v[60:63], a[132:135], v[208:211], 0
    ds_read_b128 a[164:167], v228 offset:32768
    v_mfma_f32_16x16x32_bf16 v[32:35], a[136:139], v[164:167], v[32:35]
    v_mfma_f32_16x16x32_bf16 v[40:43], a[136:139], v[180:183], v[40:43]
    v_mfma_f32_16x16x32_bf16 v[48:51], a[136:139], v[196:199], v[48:51]
    v_mfma_f32_16x16x32_bf16 v[56:59], a[136:139], v[212:215], v[56:59]
    ds_read_b128 a[168:171], v229 offset:8192
    v_mfma_f32_16x16x32_bf16 v[36:39], a[140:143], v[164:167], v[36:39]
    v_mfma_f32_16x16x32_bf16 v[44:47], a[140:143], v[180:183], v[44:47]
    v_mfma_f32_16x16x32_bf16 v[52:55], a[140:143], v[196:199], v[52:55]
    v_mfma_f32_16x16x32_bf16 v[60:63], a[140:143], v[212:215], v[60:63]
    ds_read_b128 a[172:175], v229 offset:32768
    v_mfma_f32_16x16x32_bf16 v[32:35], a[144:147], v[168:171], v[32:35]
    v_mfma_f32_16x16x32_bf16 v[40:43], a[144:147], v[184:187], v[40:43]
    v_mfma_f32_16x16x32_bf16 v[48:51], a[144:147], v[200:203], v[48:51]
    v_mfma_f32_16x16x32_bf16 v[56:59], a[144:147], v[216:219], v[56:59]
    ds_read_b128 a[176:179], v230 offset:8192
    v_mfma_f32_16x16x32_bf16 v[36:39], a[148:151], v[168:171], v[36:39]
    v_mfma_f32_16x16x32_bf16 v[44:47], a[148:151], v[184:187], v[44:47]
    v_mfma_f32_16x16x32_bf16 v[52:55], a[148:151], v[200:203], v[52:55]
    v_mfma_f32_16x16x32_bf16 v[60:63], a[148:151], v[216:219], v[60:63]
    ds_read_b128 a[180:183], v230 offset:32768
    v_mfma_f32_16x16x32_bf16 v[32:35], a[152:155], v[172:175], v[32:35]
    v_mfma_f32_16x16x32_bf16 v[40:43], a[152:155], v[188:191], v[40:43]
    v_mfma_f32_16x16x32_bf16 v[48:51], a[152:155], v[204:207], v[48:51]
    v_mfma_f32_16x16x32_bf16 v[56:59], a[152:155], v[220:223], v[56:59]
    ds_read_b128 a[184:187], v231 offset:8192
    v_mfma_f32_16x16x32_bf16 v[36:39], a[156:159], v[172:175], v[36:39]
    v_mfma_f32_16x16x32_bf16 v[44:47], a[156:159], v[188:191], v[44:47]
    v_mfma_f32_16x16x32_bf16 v[52:55], a[156:159], v[204:207], v[52:55]
    v_mfma_f32_16x16x32_bf16 v[60:63], a[156:159], v[220:223], v[60:63]
    ds_read_b128 a[188:191], v231 offset:32768
    v_max3_f32 v24, v32, v33, v34
    v_max3_f32 v25, v40, v41, v42
    v_max3_f32 v26, v48, v49, v50
    v_max3_f32 v27, v56, v57, v58
    v_max3_f32 v24, v24, v35, v36
    v_max3_f32 v25, v25, v43, v44
    v_max3_f32 v26, v26, v51, v52
    v_max3_f32 v27, v27, v59, v60
    v_max3_f32 v24, v24, v37, v38
    v_max3_f32 v25, v25, v45, v46
    v_max3_f32 v26, v26, v53, v54
    v_max3_f32 v27, v27, v61, v62
    v_max_f32 v24, v24, v39
    v_max_f32 v25, v25, v47
    v_max_f32 v26, v26, v55
    v_max_f32 v27, v27, v63
    v_mov_b32 v28, v24
    v_mov_b32 v29, v25
    v_mov_b32 v30, v26
    v_mov_b32 v31, v27
    v_permlane16_swap_b32 v24, v28
    v_permlane16_swap_b32 v25, v29
    v_permlane16_swap_b32 v26, v30
    v_permlane16_swap_b32 v27, v31
    v_max_f32 v24, v24, v28
    v_max_f32 v25, v25, v29
    v_max_f32 v26, v26, v30
    v_max_f32 v27, v27, v31
    v_mov_b32 v28, v24
    v_mov_b32 v29, v25
    v_mov_b32 v30, v26
    v_mov_b32 v31, v27
    v_permlane32_swap_b32 v24, v28
    v_permlane32_swap_b32 v25, v29
    v_permlane32_swap_b32 v26, v30
    v_permlane32_swap_b32 v27, v31
    v_max_f32 v24, v24, v28
    v_max_f32 v25, v25, v29
    v_max_f32 v26, v26, v30
    v_max_f32 v27, v27, v31
    s_cmp_eq_u32 s34, 0
    s_cbranch_scc1 K1_M0
    v_mov_b32 v24, v144
    v_mov_b32 v25, v145
    v_mov_b32 v26, v146
    v_mov_b32 v27, v147
K1_M0:
    v_sub_f32 v128, 0, v24
    v_sub_f32 v129, 0, v24
    v_sub_f32 v130, 0, v24
    v_sub_f32 v131, 0, v24
    v_sub_f32 v132, 0, v25
    v_sub_f32 v133, 0, v25
    v_sub_f32 v134, 0, v25
    v_sub_f32 v135, 0, v25
    v_sub_f32 v136, 0, v26
    v_sub_f32 v137, 0, v26
    v_sub_f32 v138, 0, v26
    v_sub_f32 v139, 0, v26
    v_sub_f32 v140, 0, v27
    v_sub_f32 v141, 0, v27
    v_sub_f32 v142, 0, v27
    v_sub_f32 v143, 0, v27
    v_pk_add_f32 v[32:33], v[32:33], v[128:129]
    v_pk_add_f32 v[34:35], v[34:35], v[128:129]
    v_pk_add_f32 v[36:37], v[36:37], v[128:129]
    v_pk_add_f32 v[38:39], v[38:39], v[128:129]
    v_pk_add_f32 v[40:41], v[40:41], v[132:133]
    v_pk_add_f32 v[42:43], v[42:43], v[132:133]
    v_pk_add_f32 v[44:45], v[44:45], v[132:133]
    v_pk_add_f32 v[46:47], v[46:47], v[132:133]
    v_pk_add_f32 v[48:49], v[48:49], v[136:137]
    v_pk_add_f32 v[50:51], v[50:51], v[136:137]
    v_pk_add_f32 v[52:53], v[52:53], v[136:137]
    v_pk_add_f32 v[54:55], v[54:55], v[136:137]
    v_pk_add_f32 v[56:57], v[56:57], v[140:141]
    v_pk_add_f32 v[58:59], v[58:59], v[140:141]
    v_pk_add_f32 v[60:61], v[60:61], v[140:141]
    v_pk_add_f32 v[62:63], v[62:63], v[140:141]
    s_waitcnt vmcnt(8) lgkmcnt(0)
    s_barrier
    v_mfma_f32_16x16x32_bf16 v[64:67], a[160:163], v[160:163], v[128:131]
    v_exp_f32 v32, v32
    v_mfma_f32_16x16x32_bf16 v[72:75], a[160:163], v[176:179], v[132:135]
    v_exp_f32 v33, v33
    v_mfma_f32_16x16x32_bf16 v[80:83], a[160:163], v[192:195], v[136:139]
    s_add_u32 m0, s33, 8192
    v_cvt_pk_bf16_f32 v96, v32, v33
    v_mfma_f32_16x16x32_bf16 v[88:91], a[160:163], v[208:211], v[140:143]
    v_exp_f32 v34, v34
    v_mfma_f32_16x16x32_bf16 v[68:71], a[164:167], v[160:163], v[128:131]
    v_exp_f32 v35, v35
    v_mfma_f32_16x16x32_bf16 v[76:79], a[164:167], v[176:179], v[132:135]
    v_cvt_pk_bf16_f32 v97, v34, v35
    v_mfma_f32_16x16x32_bf16 v[84:87], a[164:167], v[192:195], v[136:139]
    v_exp_f32 v36, v36
    v_mfma_f32_16x16x32_bf16 v[92:95], a[164:167], v[208:211], v[140:143]
    v_exp_f32 v37, v37
    v_mfma_f32_16x16x32_bf16 v[64:67], a[168:171], v[164:167], v[64:67]
    v_cvt_pk_bf16_f32 v98, v36, v37
    v_mfma_f32_16x16x32_bf16 v[72:75], a[168:171], v[180:183], v[72:75]
    v_exp_f32 v38, v38
    v_mfma_f32_16x16x32_bf16 v[80:83], a[168:171], v[196:199], v[80:83]
    v_exp_f32 v39, v39
    v_mfma_f32_16x16x32_bf16 v[88:91], a[168:171], v[212:215], v[88:91]
    v_cvt_pk_bf16_f32 v99, v38, v39
    v_mfma_f32_16x16x32_bf16 v[68:71], a[172:175], v[164:167], v[68:71]
    buffer_load_dwordx4 v18, s[12:15], s28 offen offset:0 lds
    v_mfma_f32_16x16x32_bf16 v[76:79], a[172:175], v[180:183], v[76:79]
    v_exp_f32 v40, v40
    v_mfma_f32_16x16x32_bf16 v[84:87], a[172:175], v[196:199], v[84:87]
    v_exp_f32 v41, v41
    v_mfma_f32_16x16x32_bf16 v[92:95], a[172:175], v[212:215], v[92:95]
    v_cvt_pk_bf16_f32 v100, v40, v41
    v_mfma_f32_16x16x32_bf16 v[64:67], a[176:179], v[168:171], v[64:67]
    v_exp_f32 v42, v42
    v_mfma_f32_16x16x32_bf16 v[72:75], a[176:179], v[184:187], v[72:75]
    v_exp_f32 v43, v43
    v_mfma_f32_16x16x32_bf16 v[80:83], a[176:179], v[200:203], v[80:83]
    v_cvt_pk_bf16_f32 v101, v42, v43
    v_mfma_f32_16x16x32_bf16 v[88:91], a[176:179], v[216:219], v[88:91]
    v_exp_f32 v44, v44
    v_mfma_f32_16x16x32_bf16 v[68:71], a[180:183], v[168:171], v[68:71]
    v_exp_f32 v45, v45
    v_mfma_f32_16x16x32_bf16 v[76:79], a[180:183], v[184:187], v[76:79]
    v_cvt_pk_bf16_f32 v102, v44, v45
    v_mfma_f32_16x16x32_bf16 v[84:87], a[180:183], v[200:203], v[84:87]
    v_exp_f32 v46, v46
    v_mfma_f32_16x16x32_bf16 v[92:95], a[180:183], v[216:219], v[92:95]
    buffer_load_dwordx4 v19, s[12:15], s28 offen offset:1024 lds
    v_mfma_f32_16x16x32_bf16 v[64:67], a[184:187], v[172:175], v[64:67]
    v_exp_f32 v47, v47
    v_mfma_f32_16x16x32_bf16 v[72:75], a[184:187], v[188:191], v[72:75]
    v_cvt_pk_bf16_f32 v103, v46, v47
    v_mfma_f32_16x16x32_bf16 v[80:83], a[184:187], v[204:207], v[80:83]
    v_exp_f32 v48, v48
    v_mfma_f32_16x16x32_bf16 v[88:91], a[184:187], v[220:223], v[88:91]
    v_exp_f32 v49, v49
    v_mfma_f32_16x16x32_bf16 v[68:71], a[188:191], v[172:175], v[68:71]
    v_cvt_pk_bf16_f32 v104, v48, v49
    v_mfma_f32_16x16x32_bf16 v[76:79], a[188:191], v[188:191], v[76:79]
    v_exp_f32 v50, v50
    v_mfma_f32_16x16x32_bf16 v[84:87], a[188:191], v[204:207], v[84:87]
    v_exp_f32 v51, v51
    v_mfma_f32_16x16x32_bf16 v[92:95], a[188:191], v[220:223], v[92:95]
    v_cvt_pk_bf16_f32 v105, v50, v51
    ds_read_b128 a[128:131], v224 offset:12288
    v_exp_f32 v52, v52
    buffer_load_dwordx4 v20, s[12:15], s28 offen offset:2048 lds
    ds_read_b128 a[132:135], v224 offset:36864
    v_exp_f32 v53, v53
    s_nop 0
    v_cvt_pk_bf16_f32 v106, v52, v53
    ds_read_b128 a[136:139], v225 offset:12288
    v_exp_f32 v54, v54
    v_exp_f32 v55, v55
    s_nop 0
    v_cvt_pk_bf16_f32 v107, v54, v55
    ds_read_b128 a[140:143], v225 offset:36864
    v_exp_f32 v56, v56
    buffer_load_dwordx4 v21, s[12:15], s28 offen offset:3072 lds
    ds_read_b128 a[144:147], v226 offset:12288
    v_exp_f32 v57, v57
    s_nop 0
    v_cvt_pk_bf16_f32 v108, v56, v57
    ds_read_b128 a[148:151], v226 offset:36864
    v_exp_f32 v58, v58
    v_exp_f32 v59, v59
    s_nop 0
    v_cvt_pk_bf16_f32 v109, v58, v59
    ds_read_b128 a[152:155], v227 offset:12288
    v_exp_f32 v60, v60
    v_exp_f32 v61, v61
    s_add_u32 s28, s28, 16384
    ds_read_b128 a[156:159], v227 offset:36864
    v_cvt_pk_bf16_f32 v110, v60, v61
    v_exp_f32 v62, v62
    v_exp_f32 v63, v63
    s_nop 0
    v_cvt_pk_bf16_f32 v111, v62, v63
    s_waitcnt lgkmcnt(0)
    v_mfma_f32_16x16x32_bf16 v[32:35], a[128:131], v[160:163], v[128:131]
    v_exp_f32 v64, v64
    v_mfma_f32_16x16x32_bf16 v[40:43], a[128:131], v[176:179], v[132:135]
    ds_read_b64_tr_b16 a[160:161], v240 offset:16384
    ds_read_b64_tr_b16 a[162:163], v240 offset:40960
    v_mfma_f32_16x16x32_bf16 v[48:51], a[128:131], v[192:195], v[136:139]
    v_exp_f32 v65, v65
    v_mfma_f32_16x16x32_bf16 v[56:59], a[128:131], v[208:211], v[140:143]
    s_add_u32 m0, s33, 4096
    ds_read_b64_tr_b16 a[164:165], v241 offset:16384
    v_mfma_f32_16x16x32_bf16 v[36:39], a[132:135], v[160:163], v[128:131]
    v_exp_f32 v66, v66
    v_mfma_f32_16x16x32_bf16 v[44:47], a[132:135], v[176:179], v[132:135]
    ds_read_b64_tr_b16 a[166:167], v241 offset:40960
    v_cvt_pk_bf16_f32 v112, v64, v65
    v_mfma_f32_16x16x32_bf16 v[52:55], a[132:135], v[192:195], v[136:139]
    v_exp_f32 v67, v67
    v_mfma_f32_16x16x32_bf16 v[60:63], a[132:135], v[208:211], v[140:143]
    ds_read_b64_tr_b16 a[168:169], v242 offset:16384
    ds_read_b64_tr_b16 a[170:171], v242 offset:40960
    v_mfma_f32_16x16x32_bf16 v[32:35], a[136:139], v[164:167], v[32:35]
    v_exp_f32 v68, v68
    v_mfma_f32_16x16x32_bf16 v[40:43], a[136:139], v[180:183], v[40:43]
    ds_read_b64_tr_b16 a[172:173], v243 offset:16384
    v_cvt_pk_bf16_f32 v113, v66, v67
    v_mfma_f32_16x16x32_bf16 v[48:51], a[136:139], v[196:199], v[48:51]
    v_exp_f32 v69, v69
    v_mfma_f32_16x16x32_bf16 v[56:59], a[136:139], v[212:215], v[56:59]
    ds_read_b64_tr_b16 a[174:175], v243 offset:40960
    v_cvt_pk_bf16_f32 v114, v68, v69
    v_mfma_f32_16x16x32_bf16 v[36:39], a[140:143], v[164:167], v[36:39]
    v_exp_f32 v70, v70
    v_mfma_f32_16x16x32_bf16 v[44:47], a[140:143], v[180:183], v[44:47]
    ds_read_b64_tr_b16 a[176:177], v244 offset:16384
    buffer_load_dwordx4 v22, s[16:19], s29 offen offset:0 lds
    v_mfma_f32_16x16x32_bf16 v[52:55], a[140:143], v[196:199], v[52:55]
    v_exp_f32 v71, v71
    v_mfma_f32_16x16x32_bf16 v[60:63], a[140:143], v[212:215], v[60:63]
    ds_read_b64_tr_b16 a[178:179], v244 offset:40960
    ds_read_b64_tr_b16 a[180:181], v245 offset:16384
    v_mfma_f32_16x16x32_bf16 v[32:35], a[144:147], v[168:171], v[32:35]
    v_exp_f32 v72, v72
    v_mfma_f32_16x16x32_bf16 v[40:43], a[144:147], v[184:187], v[40:43]
    ds_read_b64_tr_b16 a[182:183], v245 offset:40960
    v_cvt_pk_bf16_f32 v115, v70, v71
    v_mfma_f32_16x16x32_bf16 v[48:51], a[144:147], v[200:203], v[48:51]
    ds_read_b64_tr_b16 a[184:185], v246 offset:16384
    v_mfma_f32_16x16x32_bf16 v[56:59], a[144:147], v[216:219], v[56:59]
    v_exp_f32 v73, v73
    v_mfma_f32_16x16x32_bf16 v[36:39], a[148:151], v[168:171], v[36:39]
    ds_read_b64_tr_b16 a[186:187], v246 offset:40960
    v_cvt_pk_bf16_f32 v116, v72, v73
    v_mfma_f32_16x16x32_bf16 v[44:47], a[148:151], v[184:187], v[44:47]
    v_exp_f32 v74, v74
    v_mfma_f32_16x16x32_bf16 v[52:55], a[148:151], v[200:203], v[52:55]
    ds_read_b64_tr_b16 a[188:189], v247 offset:16384
    ds_read_b64_tr_b16 a[190:191], v247 offset:40960
    v_mfma_f32_16x16x32_bf16 v[60:63], a[148:151], v[216:219], v[60:63]
    v_exp_f32 v75, v75
    v_mfma_f32_16x16x32_bf16 v[32:35], a[152:155], v[172:175], v[32:35]
    buffer_load_dwordx4 v23, s[16:19], s29 offen offset:1024 lds
    v_cvt_pk_bf16_f32 v117, v74, v75
    v_mfma_f32_16x16x32_bf16 v[40:43], a[152:155], v[188:191], v[40:43]
    v_exp_f32 v76, v76
    v_mfma_f32_16x16x32_bf16 v[48:51], a[152:155], v[204:207], v[48:51]
    v_exp_f32 v77, v77
    v_mfma_f32_16x16x32_bf16 v[56:59], a[152:155], v[220:223], v[56:59]
    v_cvt_pk_bf16_f32 v118, v76, v77
    v_mfma_f32_16x16x32_bf16 v[36:39], a[156:159], v[172:175], v[36:39]
    v_exp_f32 v78, v78
    v_mfma_f32_16x16x32_bf16 v[44:47], a[156:159], v[188:191], v[44:47]
    v_exp_f32 v79, v79
    v_mfma_f32_16x16x32_bf16 v[52:55], a[156:159], v[204:207], v[52:55]
    v_cvt_pk_bf16_f32 v119, v78, v79
    v_mfma_f32_16x16x32_bf16 v[60:63], a[156:159], v[220:223], v[60:63]
    v_exp_f32 v80, v80
    v_mfma_f32_16x16x32_bf16 a[224:227], a[240:243], v[96:99], 0
    ds_read_b128 a[128:131], v228 offset:12288
    v_mfma_f32_16x16x32_bf16 a[228:231], a[240:243], v[100:103], 0
    v_exp_f32 v81, v81
    v_mfma_f32_16x16x32_bf16 a[232:235], a[240:243], v[104:107], 0
    buffer_load_dwordx4 v22, s[16:19], s29 offen offset:2048 lds
    v_cvt_pk_bf16_f32 v120, v80, v81
    v_mfma_f32_16x16x32_bf16 a[236:239], a[240:243], v[108:111], 0
    ds_read_b128 a[132:135], v228 offset:36864
    s_waitcnt lgkmcnt(2)
    v_mfma_f32_16x16x32_bf16 a[0:3], a[160:163], v[96:99], 0
    v_exp_f32 v82, v82
    v_mfma_f32_16x16x32_bf16 a[4:7], a[160:163], v[100:103], 0
    v_exp_f32 v83, v83
    v_mfma_f32_16x16x32_bf16 a[8:11], a[160:163], v[104:107], 0
    ds_read_b128 a[136:139], v229 offset:12288
    v_cvt_pk_bf16_f32 v121, v82, v83
    v_mfma_f32_16x16x32_bf16 a[12:15], a[160:163], v[108:111], 0
    v_exp_f32 v84, v84
    v_mfma_f32_16x16x32_bf16 a[16:19], a[164:167], v[96:99], 0
    v_exp_f32 v85, v85
    v_mfma_f32_16x16x32_bf16 a[20:23], a[164:167], v[100:103], 0
    v_cvt_pk_bf16_f32 v122, v84, v85
    v_mfma_f32_16x16x32_bf16 a[24:27], a[164:167], v[104:107], 0
    ds_read_b128 a[140:143], v229 offset:36864
    v_mfma_f32_16x16x32_bf16 a[28:31], a[164:167], v[108:111], 0
    v_exp_f32 v86, v86
    v_mfma_f32_16x16x32_bf16 a[32:35], a[168:171], v[96:99], 0
    buffer_load_dwordx4 v23, s[16:19], s29 offen offset:3072 lds
    v_mfma_f32_16x16x32_bf16 a[36:39], a[168:171], v[100:103], 0
    ds_read_b128 a[144:147], v230 offset:12288
    v_mfma_f32_16x16x32_bf16 a[40:43], a[168:171], v[104:107], 0
    v_exp_f32 v87, v87
    v_mfma_f32_16x16x32_bf16 a[44:47], a[168:171], v[108:111], 0
    v_cvt_pk_bf16_f32 v123, v86, v87
    v_mfma_f32_16x16x32_bf16 a[48:51], a[172:175], v[96:99], 0
    ds_read_b128 a[148:151], v230 offset:36864
    v_mfma_f32_16x16x32_bf16 a[52:55], a[172:175], v[100:103], 0
    v_exp_f32 v88, v88
    v_mfma_f32_16x16x32_bf16 a[56:59], a[172:175], v[104:107], 0
    v_exp_f32 v89, v89
    v_mfma_f32_16x16x32_bf16 a[60:63], a[172:175], v[108:111], 0
    v_cvt_pk_bf16_f32 v124, v88, v89
    v_mfma_f32_16x16x32_bf16 a[64:67], a[176:179], v[96:99], 0
    ds_read_b128 a[152:155], v231 offset:12288
    v_mfma_f32_16x16x32_bf16 a[68:71], a[176:179], v[100:103], 0
    v_exp_f32 v90, v90
    v_mfma_f32_16x16x32_bf16 a[72:75], a[176:179], v[104:107], 0
    v_exp_f32 v91, v91
    v_mfma_f32_16x16x32_bf16 a[76:79], a[176:179], v[108:111], 0
    s_add_u32 s29, s29, 16384
    ds_read_b128 a[156:159], v231 offset:36864
    v_mfma_f32_16x16x32_bf16 a[80:83], a[180:183], v[96:99], 0
    v_cvt_pk_bf16_f32 v125, v90, v91
    v_mfma_f32_16x16x32_bf16 a[84:87], a[180:183], v[100:103], 0
    v_exp_f32 v92, v92
    v_mfma_f32_16x16x32_bf16 a[88:91], a[180:183], v[104:107], 0
    v_exp_f32 v93, v93
    v_mfma_f32_16x16x32_bf16 a[92:95], a[180:183], v[108:111], 0
    v_cvt_pk_bf16_f32 v126, v92, v93
    v_mfma_f32_16x16x32_bf16 a[96:99], a[184:187], v[96:99], 0
    v_exp_f32 v94, v94
    v_mfma_f32_16x16x32_bf16 a[100:103], a[184:187], v[100:103], 0
    v_exp_f32 v95, v95
    v_mfma_f32_16x16x32_bf16 a[104:107], a[184:187], v[104:107], 0
    v_cvt_pk_bf16_f32 v127, v94, v95
    v_mfma_f32_16x16x32_bf16 a[108:111], a[184:187], v[108:111], 0
    v_mfma_f32_16x16x32_bf16 a[112:115], a[188:191], v[96:99], 0
    v_mfma_f32_16x16x32_bf16 a[116:119], a[188:191], v[100:103], 0
    v_mfma_f32_16x16x32_bf16 a[120:123], a[188:191], v[104:107], 0
    v_mfma_f32_16x16x32_bf16 a[124:127], a[188:191], v[108:111], 0
    s_mov_b32 s31, 9
.p2align 6
K1_LOOP:
    s_waitcnt vmcnt(8) lgkmcnt(0)
    s_barrier
    v_mfma_f32_16x16x32_bf16 v[64:67], a[128:131], v[160:163], v[128:131]
    v_exp_f32 v32, v32
    v_mfma_f32_16x16x32_bf16 v[72:75], a[128:131], v[176:179], v[132:135]
    ds_read_b64_tr_b16 a[160:161], v232 offset:0
    ds_read_b64_tr_b16 a[162:163], v232 offset:24576
    v_mfma_f32_16x16x32_bf16 v[80:83], a[128:131], v[192:195], v[136:139]
    v_exp_f32 v33, v33
    v_mfma_f32_16x16x32_bf16 v[88:91], a[128:131], v[208:211], v[140:143]
    buffer_load_dword a252, v249, s[8:11], s60 offen sc1
    ds_read_b64_tr_b16 a[164:165], v233 offset:0
    v_mfma_f32_16x16x32_bf16 v[68:71], a[132:135], v[160:163], v[128:131]
    v_exp_f32 v34, v34
    v_mfma_f32_16x16x32_bf16 v[76:79], a[132:135], v[176:179], v[132:135]
    ds_read_b64_tr_b16 a[166:167], v233 offset:24576
    v_cvt_pk_bf16_f32 v96, v32, v33
    v_mfma_f32_16x16x32_bf16 v[84:87], a[132:135], v[192:195], v[136:139]
    v_exp_f32 v35, v35
    v_mfma_f32_16x16x32_bf16 v[92:95], a[132:135], v[208:211], v[140:143]
    ds_read_b64_tr_b16 a[168:169], v234 offset:0
    ds_read_b64_tr_b16 a[170:171], v234 offset:24576
    v_mfma_f32_16x16x32_bf16 v[64:67], a[136:139], v[164:167], v[64:67]
    v_exp_f32 v36, v36
    v_mfma_f32_16x16x32_bf16 v[72:75], a[136:139], v[180:183], v[72:75]
    ds_read_b64_tr_b16 a[172:173], v235 offset:0
    v_cvt_pk_bf16_f32 v97, v34, v35
    v_mfma_f32_16x16x32_bf16 v[80:83], a[136:139], v[196:199], v[80:83]
    v_exp_f32 v37, v37
    v_mfma_f32_16x16x32_bf16 v[88:91], a[136:139], v[212:215], v[88:91]
    s_add_u32 s60, s60, s61
    ds_read_b64_tr_b16 a[174:175], v235 offset:24576
    v_mfma_f32_16x16x32_bf16 v[68:71], a[140:143], v[164:167], v[68:71]
    v_exp_f32 v38, v38
    v_mfma_f32_16x16x32_bf16 v[76:79], a[140:143], v[180:183], v[76:79]
    ds_read_b64_tr_b16 a[176:177], v236 offset:0
    ds_read_b64_tr_b16 a[178:179], v236 offset:24576
    v_mfma_f32_16x16x32_bf16 v[84:87], a[140:143], v[196:199], v[84:87]
    v_exp_f32 v39, v39
    v_mfma_f32_16x16x32_bf16 v[92:95], a[140:143], v[212:215], v[92:95]
    ds_read_b64_tr_b16 a[180:181], v237 offset:0
    v_cvt_pk_bf16_f32 v98, v36, v37
    v_mfma_f32_16x16x32_bf16 v[64:67], a[144:147], v[168:171], v[64:67]
    v_exp_f32 v40, v40
    v_mfma_f32_16x16x32_bf16 v[72:75], a[144:147], v[184:187], v[72:75]
    ds_read_b64_tr_b16 a[182:183], v237 offset:24576
    v_cvt_pk_bf16_f32 v99, v38, v39
    v_mfma_f32_16x16x32_bf16 v[80:83], a[144:147], v[200:203], v[80:83]
    ds_read_b64_tr_b16 a[184:185], v238 offset:0
    s_add_u32 m0, s33, 12288
    v_mfma_f32_16x16x32_bf16 v[88:91], a[144:147], v[216:219], v[88:91]
    v_exp_f32 v41, v41
    v_mfma_f32_16x16x32_bf16 v[68:71], a[148:151], v[168:171], v[68:71]
    ds_read_b64_tr_b16 a[186:187], v238 offset:24576
    v_cvt_pk_bf16_f32 v100, v40, v41
    v_mfma_f32_16x16x32_bf16 v[76:79], a[148:151], v[184:187], v[76:79]
    v_exp_f32 v42, v42
    v_mfma_f32_16x16x32_bf16 v[84:87], a[148:151], v[200:203], v[84:87]
    ds_read_b64_tr_b16 a[188:189], v239 offset:0
    ds_read_b64_tr_b16 a[190:191], v239 offset:24576
    v_mfma_f32_16x16x32_bf16 v[92:95], a[148:151], v[216:219], v[92:95]
    v_exp_f32 v43, v43
    v_mfma_f32_16x16x32_bf16 v[64:67], a[152:155], v[172:175], v[64:67]
    v_cvt_pk_bf16_f32 v101, v42, v43
    v_mfma_f32_16x16x32_bf16 v[72:75], a[152:155], v[188:191], v[72:75]
    v_exp_f32 v44, v44
    v_mfma_f32_16x16x32_bf16 v[80:83], a[152:155], v[204:207], v[80:83]
    buffer_load_dwordx4 v18, s[12:15], s28 offen offset:0 lds
    v_mfma_f32_16x16x32_bf16 v[88:91], a[152:155], v[220:223], v[88:91]
    v_exp_f32 v45, v45
    v_mfma_f32_16x16x32_bf16 v[68:71], a[156:159], v[172:175], v[68:71]
    v_cvt_pk_bf16_f32 v102, v44, v45
    v_mfma_f32_16x16x32_bf16 v[76:79], a[156:159], v[188:191], v[76:79]
    v_exp_f32 v46, v46
    v_mfma_f32_16x16x32_bf16 v[84:87], a[156:159], v[204:207], v[84:87]
    v_exp_f32 v47, v47
    v_mfma_f32_16x16x32_bf16 v[92:95], a[156:159], v[220:223], v[92:95]
    v_cvt_pk_bf16_f32 v103, v46, v47
    v_mfma_f32_16x16x32_bf16 a[224:227], a[240:243], v[112:115], a[224:227]
    ds_read_b128 a[128:131], v224 offset:20480
    v_mfma_f32_16x16x32_bf16 a[228:231], a[240:243], v[116:119], a[228:231]
    v_exp_f32 v48, v48
    v_mfma_f32_16x16x32_bf16 a[232:235], a[240:243], v[120:123], a[232:235]
    buffer_load_dwordx4 v19, s[12:15], s28 offen offset:1024 lds
    v_mfma_f32_16x16x32_bf16 a[236:239], a[240:243], v[124:127], a[236:239]
    ds_read_b128 a[132:135], v224 offset:45056
    s_waitcnt lgkmcnt(2)
    v_mfma_f32_16x16x32_bf16 a[0:3], a[160:163], v[112:115], a[0:3]
    v_exp_f32 v49, v49
    v_mfma_f32_16x16x32_bf16 a[4:7], a[160:163], v[116:119], a[4:7]
    v_exp_f32 v50, v50
    v_mfma_f32_16x16x32_bf16 a[8:11], a[160:163], v[120:123], a[8:11]
    ds_read_b128 a[136:139], v225 offset:20480
    v_cvt_pk_bf16_f32 v104, v48, v49
    v_mfma_f32_16x16x32_bf16 a[12:15], a[160:163], v[124:127], a[12:15]
    v_exp_f32 v51, v51
    v_mfma_f32_16x16x32_bf16 a[16:19], a[164:167], v[112:115], a[16:19]
    v_cvt_pk_bf16_f32 v105, v50, v51
    v_mfma_f32_16x16x32_bf16 a[20:23], a[164:167], v[116:119], a[20:23]
    v_exp_f32 v52, v52
    v_mfma_f32_16x16x32_bf16 a[24:27], a[164:167], v[120:123], a[24:27]
    buffer_load_dwordx4 v20, s[12:15], s28 offen offset:2048 lds
    ds_read_b128 a[140:143], v225 offset:45056
    v_mfma_f32_16x16x32_bf16 a[28:31], a[164:167], v[124:127], a[28:31]
    v_exp_f32 v53, v53
    v_mfma_f32_16x16x32_bf16 a[32:35], a[168:171], v[112:115], a[32:35]
    v_cvt_pk_bf16_f32 v106, v52, v53
    v_mfma_f32_16x16x32_bf16 a[36:39], a[168:171], v[116:119], a[36:39]
    v_exp_f32 v54, v54
    v_mfma_f32_16x16x32_bf16 a[40:43], a[168:171], v[120:123], a[40:43]
    ds_read_b128 a[144:147], v226 offset:20480
    v_mfma_f32_16x16x32_bf16 a[44:47], a[168:171], v[124:127], a[44:47]
    v_exp_f32 v55, v55
    v_mfma_f32_16x16x32_bf16 a[48:51], a[172:175], v[112:115], a[48:51]
    ds_read_b128 a[148:151], v226 offset:45056
    v_cvt_pk_bf16_f32 v107, v54, v55
    v_mfma_f32_16x16x32_bf16 a[52:55], a[172:175], v[116:119], a[52:55]
    v_exp_f32 v56, v56
    v_mfma_f32_16x16x32_bf16 a[56:59], a[172:175], v[120:123], a[56:59]
    buffer_load_dwordx4 v21, s[12:15], s28 offen offset:3072 lds
    v_mfma_f32_16x16x32_bf16 a[60:63], a[172:175], v[124:127], a[60:63]
    v_exp_f32 v57, v57
    v_mfma_f32_16x16x32_bf16 a[64:67], a[176:179], v[112:115], a[64:67]
    ds_read_b128 a[152:155], v227 offset:20480
    v_cvt_pk_bf16_f32 v108, v56, v57
    v_mfma_f32_16x16x32_bf16 a[68:71], a[176:179], v[116:119], a[68:71]
    v_exp_f32 v58, v58
    v_mfma_f32_16x16x32_bf16 a[72:75], a[176:179], v[120:123], a[72:75]
    v_exp_f32 v59, v59
    v_mfma_f32_16x16x32_bf16 a[76:79], a[176:179], v[124:127], a[76:79]
    ds_read_b128 a[156:159], v227 offset:45056
    v_cvt_pk_bf16_f32 v109, v58, v59
    v_mfma_f32_16x16x32_bf16 a[80:83], a[180:183], v[112:115], a[80:83]
    v_exp_f32 v60, v60
    v_mfma_f32_16x16x32_bf16 a[84:87], a[180:183], v[116:119], a[84:87]
    v_exp_f32 v61, v61
    v_mfma_f32_16x16x32_bf16 a[88:91], a[180:183], v[120:123], a[88:91]
    s_add_u32 s28, s28, 16384
    v_cvt_pk_bf16_f32 v110, v60, v61
    v_mfma_f32_16x16x32_bf16 a[92:95], a[180:183], v[124:127], a[92:95]
    v_exp_f32 v62, v62
    v_mfma_f32_16x16x32_bf16 a[96:99], a[184:187], v[112:115], a[96:99]
    v_exp_f32 v63, v63
    v_mfma_f32_16x16x32_bf16 a[100:103], a[184:187], v[116:119], a[100:103]
    v_cvt_pk_bf16_f32 v111, v62, v63
    v_mfma_f32_16x16x32_bf16 a[104:107], a[184:187], v[120:123], a[104:107]
    v_mfma_f32_16x16x32_bf16 a[108:111], a[184:187], v[124:127], a[108:111]
    v_mfma_f32_16x16x32_bf16 a[112:115], a[188:191], v[112:115], a[112:115]
    v_mfma_f32_16x16x32_bf16 a[116:119], a[188:191], v[116:119], a[116:119]
    v_mfma_f32_16x16x32_bf16 a[120:123], a[188:191], v[120:123], a[120:123]
    v_mfma_f32_16x16x32_bf16 a[124:127], a[188:191], v[124:127], a[124:127]
    s_waitcnt lgkmcnt(0)
    v_mfma_f32_16x16x32_bf16 v[32:35], a[128:131], v[160:163], v[128:131]
    v_exp_f32 v64, v64
    v_mfma_f32_16x16x32_bf16 v[40:43], a[128:131], v[176:179], v[132:135]
    ds_read_b64_tr_b16 a[160:161], v240 offset:0
    ds_read_b64_tr_b16 a[162:163], v240 offset:24576
    v_mfma_f32_16x16x32_bf16 v[48:51], a[128:131], v[192:195], v[136:139]
    v_exp_f32 v65, v65
    v_mfma_f32_16x16x32_bf16 v[56:59], a[128:131], v[208:211], v[140:143]
    s_add_u32 m0, s33, 16384
    ds_read_b64_tr_b16 a[164:165], v241 offset:0
    v_mfma_f32_16x16x32_bf16 v[36:39], a[132:135], v[160:163], v[128:131]
    v_exp_f32 v66, v66
    v_mfma_f32_16x16x32_bf16 v[44:47], a[132:135], v[176:179], v[132:135]
    ds_read_b64_tr_b16 a[166:167], v241 offset:24576
    v_cvt_pk_bf16_f32 v112, v64, v65
    v_mfma_f32_16x16x32_bf16 v[52:55], a[132:135], v[192:195], v[136:139]
    v_exp_f32 v67, v67
    v_mfma_f32_16x16x32_bf16 v[60:63], a[132:135], v[208:211], v[140:143]
    ds_read_b64_tr_b16 a[168:169], v242 offset:0
    ds_read_b64_tr_b16 a[170:171], v242 offset:24576
    v_mfma_f32_16x16x32_bf16 v[32:35], a[136:139], v[164:167], v[32:35]
    v_exp_f32 v68, v68
    v_mfma_f32_16x16x32_bf16 v[40:43], a[136:139], v[180:183], v[40:43]
    ds_read_b64_tr_b16 a[172:173], v243 offset:0
    v_cvt_pk_bf16_f32 v113, v66, v67
    v_mfma_f32_16x16x32_bf16 v[48:51], a[136:139], v[196:199], v[48:51]
    v_exp_f32 v69, v69
    v_mfma_f32_16x16x32_bf16 v[56:59], a[136:139], v[212:215], v[56:59]
    ds_read_b64_tr_b16 a[174:175], v243 offset:24576
    v_cvt_pk_bf16_f32 v114, v68, v69
    v_mfma_f32_16x16x32_bf16 v[36:39], a[140:143], v[164:167], v[36:39]
    v_exp_f32 v70, v70
    v_mfma_f32_16x16x32_bf16 v[44:47], a[140:143], v[180:183], v[44:47]
    ds_read_b64_tr_b16 a[176:177], v244 offset:0
    buffer_load_dwordx4 v22, s[16:19], s29 offen offset:0 lds
    v_mfma_f32_16x16x32_bf16 v[52:55], a[140:143], v[196:199], v[52:55]
    v_exp_f32 v71, v71
    v_mfma_f32_16x16x32_bf16 v[60:63], a[140:143], v[212:215], v[60:63]
    ds_read_b64_tr_b16 a[178:179], v244 offset:24576
    ds_read_b64_tr_b16 a[180:181], v245 offset:0
    v_mfma_f32_16x16x32_bf16 v[32:35], a[144:147], v[168:171], v[32:35]
    v_exp_f32 v72, v72
    v_mfma_f32_16x16x32_bf16 v[40:43], a[144:147], v[184:187], v[40:43]
    ds_read_b64_tr_b16 a[182:183], v245 offset:24576
    v_cvt_pk_bf16_f32 v115, v70, v71
    v_mfma_f32_16x16x32_bf16 v[48:51], a[144:147], v[200:203], v[48:51]
    ds_read_b64_tr_b16 a[184:185], v246 offset:0
    v_mfma_f32_16x16x32_bf16 v[56:59], a[144:147], v[216:219], v[56:59]
    v_exp_f32 v73, v73
    v_mfma_f32_16x16x32_bf16 v[36:39], a[148:151], v[168:171], v[36:39]
    ds_read_b64_tr_b16 a[186:187], v246 offset:24576
    v_cvt_pk_bf16_f32 v116, v72, v73
    v_mfma_f32_16x16x32_bf16 v[44:47], a[148:151], v[184:187], v[44:47]
    v_exp_f32 v74, v74
    v_mfma_f32_16x16x32_bf16 v[52:55], a[148:151], v[200:203], v[52:55]
    ds_read_b64_tr_b16 a[188:189], v247 offset:0
    ds_read_b64_tr_b16 a[190:191], v247 offset:24576
    v_mfma_f32_16x16x32_bf16 v[60:63], a[148:151], v[216:219], v[60:63]
    v_exp_f32 v75, v75
    v_mfma_f32_16x16x32_bf16 v[32:35], a[152:155], v[172:175], v[32:35]
    buffer_load_dwordx4 v23, s[16:19], s29 offen offset:1024 lds
    v_cvt_pk_bf16_f32 v117, v74, v75
    v_mfma_f32_16x16x32_bf16 v[40:43], a[152:155], v[188:191], v[40:43]
    v_exp_f32 v76, v76
    v_mfma_f32_16x16x32_bf16 v[48:51], a[152:155], v[204:207], v[48:51]
    v_exp_f32 v77, v77
    v_mfma_f32_16x16x32_bf16 v[56:59], a[152:155], v[220:223], v[56:59]
    v_cvt_pk_bf16_f32 v118, v76, v77
    v_mfma_f32_16x16x32_bf16 v[36:39], a[156:159], v[172:175], v[36:39]
    v_exp_f32 v78, v78
    v_mfma_f32_16x16x32_bf16 v[44:47], a[156:159], v[188:191], v[44:47]
    v_exp_f32 v79, v79
    v_mfma_f32_16x16x32_bf16 v[52:55], a[156:159], v[204:207], v[52:55]
    v_cvt_pk_bf16_f32 v119, v78, v79
    v_mfma_f32_16x16x32_bf16 v[60:63], a[156:159], v[220:223], v[60:63]
    v_exp_f32 v80, v80
    v_mfma_f32_16x16x32_bf16 a[224:227], a[240:243], v[96:99], a[224:227]
    ds_read_b128 a[128:131], v228 offset:20480
    v_mfma_f32_16x16x32_bf16 a[228:231], a[240:243], v[100:103], a[228:231]
    v_exp_f32 v81, v81
    v_mfma_f32_16x16x32_bf16 a[232:235], a[240:243], v[104:107], a[232:235]
    buffer_load_dwordx4 v22, s[16:19], s29 offen offset:2048 lds
    v_cvt_pk_bf16_f32 v120, v80, v81
    v_mfma_f32_16x16x32_bf16 a[236:239], a[240:243], v[108:111], a[236:239]
    ds_read_b128 a[132:135], v228 offset:45056
    s_waitcnt lgkmcnt(2)
    v_mfma_f32_16x16x32_bf16 a[0:3], a[160:163], v[96:99], a[0:3]
    v_exp_f32 v82, v82
    v_mfma_f32_16x16x32_bf16 a[4:7], a[160:163], v[100:103], a[4:7]
    v_exp_f32 v83, v83
    v_mfma_f32_16x16x32_bf16 a[8:11], a[160:163], v[104:107], a[8:11]
    ds_read_b128 a[136:139], v229 offset:20480
    v_cvt_pk_bf16_f32 v121, v82, v83
    v_mfma_f32_16x16x32_bf16 a[12:15], a[160:163], v[108:111], a[12:15]
    v_exp_f32 v84, v84
    v_mfma_f32_16x16x32_bf16 a[16:19], a[164:167], v[96:99], a[16:19]
    v_exp_f32 v85, v85
    v_mfma_f32_16x16x32_bf16 a[20:23], a[164:167], v[100:103], a[20:23]
    v_cvt_pk_bf16_f32 v122, v84, v85
    v_mfma_f32_16x16x32_bf16 a[24:27], a[164:167], v[104:107], a[24:27]
    ds_read_b128 a[140:143], v229 offset:45056
    v_mfma_f32_16x16x32_bf16 a[28:31], a[164:167], v[108:111], a[28:31]
    v_exp_f32 v86, v86
    v_mfma_f32_16x16x32_bf16 a[32:35], a[168:171], v[96:99], a[32:35]
    buffer_load_dwordx4 v23, s[16:19], s29 offen offset:3072 lds
    v_mfma_f32_16x16x32_bf16 a[36:39], a[168:171], v[100:103], a[36:39]
    ds_read_b128 a[144:147], v230 offset:20480
    v_mfma_f32_16x16x32_bf16 a[40:43], a[168:171], v[104:107], a[40:43]
    v_exp_f32 v87, v87
    v_mfma_f32_16x16x32_bf16 a[44:47], a[168:171], v[108:111], a[44:47]
    v_cvt_pk_bf16_f32 v123, v86, v87
    v_mfma_f32_16x16x32_bf16 a[48:51], a[172:175], v[96:99], a[48:51]
    ds_read_b128 a[148:151], v230 offset:45056
    v_mfma_f32_16x16x32_bf16 a[52:55], a[172:175], v[100:103], a[52:55]
    v_exp_f32 v88, v88
    v_mfma_f32_16x16x32_bf16 a[56:59], a[172:175], v[104:107], a[56:59]
    v_exp_f32 v89, v89
    v_mfma_f32_16x16x32_bf16 a[60:63], a[172:175], v[108:111], a[60:63]
    v_cvt_pk_bf16_f32 v124, v88, v89
    v_mfma_f32_16x16x32_bf16 a[64:67], a[176:179], v[96:99], a[64:67]
    ds_read_b128 a[152:155], v231 offset:20480
    v_mfma_f32_16x16x32_bf16 a[68:71], a[176:179], v[100:103], a[68:71]
    v_exp_f32 v90, v90
    v_mfma_f32_16x16x32_bf16 a[72:75], a[176:179], v[104:107], a[72:75]
    v_exp_f32 v91, v91
    v_mfma_f32_16x16x32_bf16 a[76:79], a[176:179], v[108:111], a[76:79]
    s_add_u32 s29, s29, 16384
    ds_read_b128 a[156:159], v231 offset:45056
    v_mfma_f32_16x16x32_bf16 a[80:83], a[180:183], v[96:99], a[80:83]
    v_cvt_pk_bf16_f32 v125, v90, v91
    v_mfma_f32_16x16x32_bf16 a[84:87], a[180:183], v[100:103], a[84:87]
    v_exp_f32 v92, v92
    v_mfma_f32_16x16x32_bf16 a[88:91], a[180:183], v[104:107], a[88:91]
    v_exp_f32 v93, v93
    v_mfma_f32_16x16x32_bf16 a[92:95], a[180:183], v[108:111], a[92:95]
    v_cvt_pk_bf16_f32 v126, v92, v93
    v_mfma_f32_16x16x32_bf16 a[96:99], a[184:187], v[96:99], a[96:99]
    v_exp_f32 v94, v94
    v_mfma_f32_16x16x32_bf16 a[100:103], a[184:187], v[100:103], a[100:103]
    v_exp_f32 v95, v95
    v_mfma_f32_16x16x32_bf16 a[104:107], a[184:187], v[104:107], a[104:107]
    v_cvt_pk_bf16_f32 v127, v94, v95
    v_mfma_f32_16x16x32_bf16 a[108:111], a[184:187], v[108:111], a[108:111]
    v_mfma_f32_16x16x32_bf16 a[112:115], a[188:191], v[96:99], a[112:115]
    v_mfma_f32_16x16x32_bf16 a[116:119], a[188:191], v[100:103], a[116:119]
    v_mfma_f32_16x16x32_bf16 a[120:123], a[188:191], v[104:107], a[120:123]
    v_mfma_f32_16x16x32_bf16 a[124:127], a[188:191], v[108:111], a[124:127]
    s_waitcnt vmcnt(9) lgkmcnt(0)
    s_barrier
    v_mfma_f32_16x16x32_bf16 v[64:67], a[128:131], v[160:163], v[128:131]
    v_exp_f32 v32, v32
    v_mfma_f32_16x16x32_bf16 v[72:75], a[128:131], v[176:179], v[132:135]
    ds_read_b64_tr_b16 a[160:161], v232 offset:4096
    ds_read_b64_tr_b16 a[162:163], v232 offset:28672
    v_mfma_f32_16x16x32_bf16 v[80:83], a[128:131], v[192:195], v[136:139]
    v_exp_f32 v33, v33
    v_mfma_f32_16x16x32_bf16 v[88:91], a[128:131], v[208:211], v[140:143]
    s_add_u32 m0, s33, 20480
    ds_read_b64_tr_b16 a[164:165], v233 offset:4096
    v_mfma_f32_16x16x32_bf16 v[68:71], a[132:135], v[160:163], v[128:131]
    v_exp_f32 v34, v34
    v_mfma_f32_16x16x32_bf16 v[76:79], a[132:135], v[176:179], v[132:135]
    ds_read_b64_tr_b16 a[166:167], v233 offset:28672
    v_cvt_pk_bf16_f32 v96, v32, v33
    v_mfma_f32_16x16x32_bf16 v[84:87], a[132:135], v[192:195], v[136:139]
    v_exp_f32 v35, v35
    v_mfma_f32_16x16x32_bf16 v[92:95], a[132:135], v[208:211], v[140:143]
    ds_read_b64_tr_b16 a[168:169], v234 offset:4096
    ds_read_b64_tr_b16 a[170:171], v234 offset:28672
    v_mfma_f32_16x16x32_bf16 v[64:67], a[136:139], v[164:167], v[64:67]
    v_exp_f32 v36, v36
    v_mfma_f32_16x16x32_bf16 v[72:75], a[136:139], v[180:183], v[72:75]
    ds_read_b64_tr_b16 a[172:173], v235 offset:4096
    v_cvt_pk_bf16_f32 v97, v34, v35
    v_mfma_f32_16x16x32_bf16 v[80:83], a[136:139], v[196:199], v[80:83]
    v_exp_f32 v37, v37
    v_mfma_f32_16x16x32_bf16 v[88:91], a[136:139], v[212:215], v[88:91]
    ds_read_b64_tr_b16 a[174:175], v235 offset:28672
    v_cvt_pk_bf16_f32 v98, v36, v37
    v_mfma_f32_16x16x32_bf16 v[68:71], a[140:143], v[164:167], v[68:71]
    v_exp_f32 v38, v38
    v_mfma_f32_16x16x32_bf16 v[76:79], a[140:143], v[180:183], v[76:79]
    ds_read_b64_tr_b16 a[176:177], v236 offset:4096
    buffer_load_dwordx4 v18, s[12:15], s28 offen offset:0 lds
    v_mfma_f32_16x16x32_bf16 v[84:87], a[140:143], v[196:199], v[84:87]
    v_exp_f32 v39, v39
    v_mfma_f32_16x16x32_bf16 v[92:95], a[140:143], v[212:215], v[92:95]
    ds_read_b64_tr_b16 a[178:179], v236 offset:28672
    ds_read_b64_tr_b16 a[180:181], v237 offset:4096
    v_mfma_f32_16x16x32_bf16 v[64:67], a[144:147], v[168:171], v[64:67]
    v_exp_f32 v40, v40
    v_mfma_f32_16x16x32_bf16 v[72:75], a[144:147], v[184:187], v[72:75]
    ds_read_b64_tr_b16 a[182:183], v237 offset:28672
    v_cvt_pk_bf16_f32 v99, v38, v39
    v_mfma_f32_16x16x32_bf16 v[80:83], a[144:147], v[200:203], v[80:83]
    ds_read_b64_tr_b16 a[184:185], v238 offset:4096
    v_mfma_f32_16x16x32_bf16 v[88:91], a[144:147], v[216:219], v[88:91]
    v_exp_f32 v41, v41
    v_mfma_f32_16x16x32_bf16 v[68:71], a[148:151], v[168:171], v[68:71]
    ds_read_b64_tr_b16 a[186:187], v238 offset:28672
    v_cvt_pk_bf16_f32 v100, v40, v41
    v_mfma_f32_16x16x32_bf16 v[76:79], a[148:151], v[184:187], v[76:79]
    v_exp_f32 v42, v42
    v_mfma_f32_16x16x32_bf16 v[84:87], a[148:151], v[200:203], v[84:87]
    ds_read_b64_tr_b16 a[188:189], v239 offset:4096
    ds_read_b64_tr_b16 a[190:191], v239 offset:28672
    v_mfma_f32_16x16x32_bf16 v[92:95], a[148:151], v[216:219], v[92:95]
    v_exp_f32 v43, v43
    v_mfma_f32_16x16x32_bf16 v[64:67], a[152:155], v[172:175], v[64:67]
    buffer_load_dwordx4 v19, s[12:15], s28 offen offset:1024 lds
    v_cvt_pk_bf16_f32 v101, v42, v43
    v_mfma_f32_16x16x32_bf16 v[72:75], a[152:155], v[188:191], v[72:75]
    v_exp_f32 v44, v44
    v_mfma_f32_16x16x32_bf16 v[80:83], a[152:155], v[204:207], v[80:83]
    v_exp_f32 v45, v45
    v_mfma_f32_16x16x32_bf16 v[88:91], a[152:155], v[220:223], v[88:91]
    v_cvt_pk_bf16_f32 v102, v44, v45
    v_mfma_f32_16x16x32_bf16 v[68:71], a[156:159], v[172:175], v[68:71]
    v_exp_f32 v46, v46
    v_mfma_f32_16x16x32_bf16 v[76:79], a[156:159], v[188:191], v[76:79]
    v_exp_f32 v47, v47
    v_mfma_f32_16x16x32_bf16 v[84:87], a[156:159], v[204:207], v[84:87]
    v_cvt_pk_bf16_f32 v103, v46, v47
    v_mfma_f32_16x16x32_bf16 v[92:95], a[156:159], v[220:223], v[92:95]
    v_exp_f32 v48, v48
    v_mfma_f32_16x16x32_bf16 a[224:227], a[240:243], v[112:115], a[224:227]
    ds_read_b128 a[128:131], v224 offset:8192
    v_mfma_f32_16x16x32_bf16 a[228:231], a[240:243], v[116:119], a[228:231]
    v_exp_f32 v49, v49
    v_mfma_f32_16x16x32_bf16 a[232:235], a[240:243], v[120:123], a[232:235]
    buffer_load_dwordx4 v20, s[12:15], s28 offen offset:2048 lds
    v_cvt_pk_bf16_f32 v104, v48, v49
    v_mfma_f32_16x16x32_bf16 a[236:239], a[240:243], v[124:127], a[236:239]
    ds_read_b128 a[132:135], v224 offset:32768
    s_waitcnt lgkmcnt(2)
    v_mfma_f32_16x16x32_bf16 a[0:3], a[160:163], v[112:115], a[0:3]
    v_exp_f32 v50, v50
    v_mfma_f32_16x16x32_bf16 a[4:7], a[160:163], v[116:119], a[4:7]
    v_exp_f32 v51, v51
    v_mfma_f32_16x16x32_bf16 a[8:11], a[160:163], v[120:123], a[8:11]
    ds_read_b128 a[136:139], v225 offset:8192
    v_cvt_pk_bf16_f32 v105, v50, v51
    v_mfma_f32_16x16x32_bf16 a[12:15], a[160:163], v[124:127], a[12:15]
    v_exp_f32 v52, v52
    v_mfma_f32_16x16x32_bf16 a[16:19], a[164:167], v[112:115], a[16:19]
    v_exp_f32 v53, v53
    v_mfma_f32_16x16x32_bf16 a[20:23], a[164:167], v[116:119], a[20:23]
    v_cvt_pk_bf16_f32 v106, v52, v53
    v_mfma_f32_16x16x32_bf16 a[24:27], a[164:167], v[120:123], a[24:27]
    ds_read_b128 a[140:143], v225 offset:32768
    v_mfma_f32_16x16x32_bf16 a[28:31], a[164:167], v[124:127], a[28:31]
    v_exp_f32 v54, v54
    v_mfma_f32_16x16x32_bf16 a[32:35], a[168:171], v[112:115], a[32:35]
    buffer_load_dwordx4 v21, s[12:15], s28 offen offset:3072 lds
    v_mfma_f32_16x16x32_bf16 a[36:39], a[168:171], v[116:119], a[36:39]
    ds_read_b128 a[144:147], v226 offset:8192
    v_mfma_f32_16x16x32_bf16 a[40:43], a[168:171], v[120:123], a[40:43]
    v_exp_f32 v55, v55
    v_mfma_f32_16x16x32_bf16 a[44:47], a[168:171], v[124:127], a[44:47]
    v_cvt_pk_bf16_f32 v107, v54, v55
    v_mfma_f32_16x16x32_bf16 a[48:51], a[172:175], v[112:115], a[48:51]
    ds_read_b128 a[148:151], v226 offset:32768
    v_mfma_f32_16x16x32_bf16 a[52:55], a[172:175], v[116:119], a[52:55]
    v_exp_f32 v56, v56
    v_mfma_f32_16x16x32_bf16 a[56:59], a[172:175], v[120:123], a[56:59]
    v_exp_f32 v57, v57
    v_mfma_f32_16x16x32_bf16 a[60:63], a[172:175], v[124:127], a[60:63]
    v_cvt_pk_bf16_f32 v108, v56, v57
    v_mfma_f32_16x16x32_bf16 a[64:67], a[176:179], v[112:115], a[64:67]
    ds_read_b128 a[152:155], v227 offset:8192
    v_mfma_f32_16x16x32_bf16 a[68:71], a[176:179], v[116:119], a[68:71]
    v_exp_f32 v58, v58
    v_mfma_f32_16x16x32_bf16 a[72:75], a[176:179], v[120:123], a[72:75]
    v_exp_f32 v59, v59
    v_mfma_f32_16x16x32_bf16 a[76:79], a[176:179], v[124:127], a[76:79]
    s_add_u32 s28, s28, 16384
    ds_read_b128 a[156:159], v227 offset:32768
    v_mfma_f32_16x16x32_bf16 a[80:83], a[180:183], v[112:115], a[80:83]
    v_cvt_pk_bf16_f32 v109, v58, v59
    v_mfma_f32_16x16x32_bf16 a[84:87], a[180:183], v[116:119], a[84:87]
    v_exp_f32 v60, v60
    v_mfma_f32_16x16x32_bf16 a[88:91], a[180:183], v[120:123], a[88:91]
    v_exp_f32 v61, v61
    v_mfma_f32_16x16x32_bf16 a[92:95], a[180:183], v[124:127], a[92:95]
    v_cvt_pk_bf16_f32 v110, v60, v61
    v_mfma_f32_16x16x32_bf16 a[96:99], a[184:187], v[112:115], a[96:99]
    v_exp_f32 v62, v62
    v_mfma_f32_16x16x32_bf16 a[100:103], a[184:187], v[116:119], a[100:103]
    v_exp_f32 v63, v63
    v_mfma_f32_16x16x32_bf16 a[104:107], a[184:187], v[120:123], a[104:107]
    v_cvt_pk_bf16_f32 v111, v62, v63
    v_mfma_f32_16x16x32_bf16 a[108:111], a[184:187], v[124:127], a[108:111]
    v_mfma_f32_16x16x32_bf16 a[112:115], a[188:191], v[112:115], a[112:115]
    v_mfma_f32_16x16x32_bf16 a[116:119], a[188:191], v[116:119], a[116:119]
    v_mfma_f32_16x16x32_bf16 a[120:123], a[188:191], v[120:123], a[120:123]
    v_mfma_f32_16x16x32_bf16 a[124:127], a[188:191], v[124:127], a[124:127]
    s_waitcnt lgkmcnt(0)
    v_mfma_f32_16x16x32_bf16 v[32:35], a[128:131], v[160:163], v[128:131]
    v_exp_f32 v64, v64
    v_mfma_f32_16x16x32_bf16 v[40:43], a[128:131], v[176:179], v[132:135]
    ds_read_b64_tr_b16 a[160:161], v240 offset:4096
    ds_read_b64_tr_b16 a[162:163], v240 offset:28672
    v_mfma_f32_16x16x32_bf16 v[48:51], a[128:131], v[192:195], v[136:139]
    v_exp_f32 v65, v65
    v_mfma_f32_16x16x32_bf16 v[56:59], a[128:131], v[208:211], v[140:143]
    s_add_u32 m0, s33, 0
    ds_read_b64_tr_b16 a[164:165], v241 offset:4096
    v_mfma_f32_16x16x32_bf16 v[36:39], a[132:135], v[160:163], v[128:131]
    v_exp_f32 v66, v66
    v_mfma_f32_16x16x32_bf16 v[44:47], a[132:135], v[176:179], v[132:135]
    ds_read_b64_tr_b16 a[166:167], v241 offset:28672
    v_cvt_pk_bf16_f32 v112, v64, v65
    v_mfma_f32_16x16x32_bf16 v[52:55], a[132:135], v[192:195], v[136:139]
    v_exp_f32 v67, v67
    v_mfma_f32_16x16x32_bf16 v[60:63], a[132:135], v[208:211], v[140:143]
    ds_read_b64_tr_b16 a[168:169], v242 offset:4096
    ds_read_b64_tr_b16 a[170:171], v242 offset:28672
    v_mfma_f32_16x16x32_bf16 v[32:35], a[136:139], v[164:167], v[32:35]
    v_exp_f32 v68, v68
    v_mfma_f32_16x16x32_bf16 v[40:43], a[136:139], v[180:183], v[40:43]
    ds_read_b64_tr_b16 a[172:173], v243 offset:4096
    v_cvt_pk_bf16_f32 v113, v66, v67
    v_mfma_f32_16x16x32_bf16 v[48:51], a[136:139], v[196:199], v[48:51]
    v_exp_f32 v69, v69
    v_mfma_f32_16x16x32_bf16 v[56:59], a[136:139], v[212:215], v[56:59]
    ds_read_b64_tr_b16 a[174:175], v243 offset:28672
    v_cvt_pk_bf16_f32 v114, v68, v69
    v_mfma_f32_16x16x32_bf16 v[36:39], a[140:143], v[164:167], v[36:39]
    v_exp_f32 v70, v70
    v_mfma_f32_16x16x32_bf16 v[44:47], a[140:143], v[180:183], v[44:47]
    ds_read_b64_tr_b16 a[176:177], v244 offset:4096
    buffer_load_dwordx4 v22, s[16:19], s29 offen offset:0 lds
    v_mfma_f32_16x16x32_bf16 v[52:55], a[140:143], v[196:199], v[52:55]
    v_exp_f32 v71, v71
    v_mfma_f32_16x16x32_bf16 v[60:63], a[140:143], v[212:215], v[60:63]
    ds_read_b64_tr_b16 a[178:179], v244 offset:28672
    ds_read_b64_tr_b16 a[180:181], v245 offset:4096
    v_mfma_f32_16x16x32_bf16 v[32:35], a[144:147], v[168:171], v[32:35]
    v_exp_f32 v72, v72
    v_mfma_f32_16x16x32_bf16 v[40:43], a[144:147], v[184:187], v[40:43]
    ds_read_b64_tr_b16 a[182:183], v245 offset:28672
    v_cvt_pk_bf16_f32 v115, v70, v71
    v_mfma_f32_16x16x32_bf16 v[48:51], a[144:147], v[200:203], v[48:51]
    ds_read_b64_tr_b16 a[184:185], v246 offset:4096
    v_mfma_f32_16x16x32_bf16 v[56:59], a[144:147], v[216:219], v[56:59]
    v_exp_f32 v73, v73
    v_mfma_f32_16x16x32_bf16 v[36:39], a[148:151], v[168:171], v[36:39]
    ds_read_b64_tr_b16 a[186:187], v246 offset:28672
    v_cvt_pk_bf16_f32 v116, v72, v73
    v_mfma_f32_16x16x32_bf16 v[44:47], a[148:151], v[184:187], v[44:47]
    v_exp_f32 v74, v74
    v_mfma_f32_16x16x32_bf16 v[52:55], a[148:151], v[200:203], v[52:55]
    ds_read_b64_tr_b16 a[188:189], v247 offset:4096
    ds_read_b64_tr_b16 a[190:191], v247 offset:28672
    v_mfma_f32_16x16x32_bf16 v[60:63], a[148:151], v[216:219], v[60:63]
    v_exp_f32 v75, v75
    v_mfma_f32_16x16x32_bf16 v[32:35], a[152:155], v[172:175], v[32:35]
    buffer_load_dwordx4 v23, s[16:19], s29 offen offset:1024 lds
    v_cvt_pk_bf16_f32 v117, v74, v75
    v_mfma_f32_16x16x32_bf16 v[40:43], a[152:155], v[188:191], v[40:43]
    v_exp_f32 v76, v76
    v_mfma_f32_16x16x32_bf16 v[48:51], a[152:155], v[204:207], v[48:51]
    v_exp_f32 v77, v77
    v_mfma_f32_16x16x32_bf16 v[56:59], a[152:155], v[220:223], v[56:59]
    v_cvt_pk_bf16_f32 v118, v76, v77
    v_mfma_f32_16x16x32_bf16 v[36:39], a[156:159], v[172:175], v[36:39]
    v_exp_f32 v78, v78
    v_mfma_f32_16x16x32_bf16 v[44:47], a[156:159], v[188:191], v[44:47]
    v_exp_f32 v79, v79
    v_mfma_f32_16x16x32_bf16 v[52:55], a[156:159], v[204:207], v[52:55]
    v_cvt_pk_bf16_f32 v119, v78, v79
    v_mfma_f32_16x16x32_bf16 v[60:63], a[156:159], v[220:223], v[60:63]
    v_exp_f32 v80, v80
    v_mfma_f32_16x16x32_bf16 a[224:227], a[240:243], v[96:99], a[224:227]
    ds_read_b128 a[128:131], v228 offset:8192
    v_mfma_f32_16x16x32_bf16 a[228:231], a[240:243], v[100:103], a[228:231]
    v_exp_f32 v81, v81
    v_mfma_f32_16x16x32_bf16 a[232:235], a[240:243], v[104:107], a[232:235]
    buffer_load_dwordx4 v22, s[16:19], s29 offen offset:2048 lds
    v_cvt_pk_bf16_f32 v120, v80, v81
    v_mfma_f32_16x16x32_bf16 a[236:239], a[240:243], v[108:111], a[236:239]
    ds_read_b128 a[132:135], v228 offset:32768
    s_waitcnt lgkmcnt(2)
    v_mfma_f32_16x16x32_bf16 a[0:3], a[160:163], v[96:99], a[0:3]
    v_exp_f32 v82, v82
    v_mfma_f32_16x16x32_bf16 a[4:7], a[160:163], v[100:103], a[4:7]
    v_exp_f32 v83, v83
    v_mfma_f32_16x16x32_bf16 a[8:11], a[160:163], v[104:107], a[8:11]
    ds_read_b128 a[136:139], v229 offset:8192
    v_cvt_pk_bf16_f32 v121, v82, v83
    v_mfma_f32_16x16x32_bf16 a[12:15], a[160:163], v[108:111], a[12:15]
    v_exp_f32 v84, v84
    v_mfma_f32_16x16x32_bf16 a[16:19], a[164:167], v[96:99], a[16:19]
    v_exp_f32 v85, v85
    v_mfma_f32_16x16x32_bf16 a[20:23], a[164:167], v[100:103], a[20:23]
    v_cvt_pk_bf16_f32 v122, v84, v85
    v_mfma_f32_16x16x32_bf16 a[24:27], a[164:167], v[104:107], a[24:27]
    ds_read_b128 a[140:143], v229 offset:32768
    v_mfma_f32_16x16x32_bf16 a[28:31], a[164:167], v[108:111], a[28:31]
    v_exp_f32 v86, v86
    v_mfma_f32_16x16x32_bf16 a[32:35], a[168:171], v[96:99], a[32:35]
    buffer_load_dwordx4 v23, s[16:19], s29 offen offset:3072 lds
    v_mfma_f32_16x16x32_bf16 a[36:39], a[168:171], v[100:103], a[36:39]
    ds_read_b128 a[144:147], v230 offset:8192
    v_mfma_f32_16x16x32_bf16 a[40:43], a[168:171], v[104:107], a[40:43]
    v_exp_f32 v87, v87
    v_mfma_f32_16x16x32_bf16 a[44:47], a[168:171], v[108:111], a[44:47]
    v_cvt_pk_bf16_f32 v123, v86, v87
    v_mfma_f32_16x16x32_bf16 a[48:51], a[172:175], v[96:99], a[48:51]
    ds_read_b128 a[148:151], v230 offset:32768
    v_mfma_f32_16x16x32_bf16 a[52:55], a[172:175], v[100:103], a[52:55]
    v_exp_f32 v88, v88
    v_mfma_f32_16x16x32_bf16 a[56:59], a[172:175], v[104:107], a[56:59]
    v_exp_f32 v89, v89
    v_mfma_f32_16x16x32_bf16 a[60:63], a[172:175], v[108:111], a[60:63]
    v_cvt_pk_bf16_f32 v124, v88, v89
    v_mfma_f32_16x16x32_bf16 a[64:67], a[176:179], v[96:99], a[64:67]
    ds_read_b128 a[152:155], v231 offset:8192
    v_mfma_f32_16x16x32_bf16 a[68:71], a[176:179], v[100:103], a[68:71]
    v_exp_f32 v90, v90
    v_mfma_f32_16x16x32_bf16 a[72:75], a[176:179], v[104:107], a[72:75]
    v_exp_f32 v91, v91
    v_mfma_f32_16x16x32_bf16 a[76:79], a[176:179], v[108:111], a[76:79]
    s_add_u32 s29, s29, 16384
    ds_read_b128 a[156:159], v231 offset:32768
    v_mfma_f32_16x16x32_bf16 a[80:83], a[180:183], v[96:99], a[80:83]
    v_cvt_pk_bf16_f32 v125, v90, v91
    v_mfma_f32_16x16x32_bf16 a[84:87], a[180:183], v[100:103], a[84:87]
    v_exp_f32 v92, v92
    v_mfma_f32_16x16x32_bf16 a[88:91], a[180:183], v[104:107], a[88:91]
    v_exp_f32 v93, v93
    v_mfma_f32_16x16x32_bf16 a[92:95], a[180:183], v[108:111], a[92:95]
    v_cvt_pk_bf16_f32 v126, v92, v93
    v_mfma_f32_16x16x32_bf16 a[96:99], a[184:187], v[96:99], a[96:99]
    v_exp_f32 v94, v94
    v_mfma_f32_16x16x32_bf16 a[100:103], a[184:187], v[100:103], a[100:103]
    v_exp_f32 v95, v95
    v_mfma_f32_16x16x32_bf16 a[104:107], a[184:187], v[104:107], a[104:107]
    v_cvt_pk_bf16_f32 v127, v94, v95
    v_mfma_f32_16x16x32_bf16 a[108:111], a[184:187], v[108:111], a[108:111]
    v_mfma_f32_16x16x32_bf16 a[112:115], a[188:191], v[96:99], a[112:115]
    v_mfma_f32_16x16x32_bf16 a[116:119], a[188:191], v[100:103], a[116:119]
    v_mfma_f32_16x16x32_bf16 a[120:123], a[188:191], v[104:107], a[120:123]
    v_mfma_f32_16x16x32_bf16 a[124:127], a[188:191], v[108:111], a[124:127]
    s_waitcnt vmcnt(8) lgkmcnt(0)
    s_barrier
    v_mfma_f32_16x16x32_bf16 v[64:67], a[128:131], v[160:163], v[128:131]
    v_exp_f32 v32, v32
    v_mfma_f32_16x16x32_bf16 v[72:75], a[128:131], v[176:179], v[132:135]
    ds_read_b64_tr_b16 a[160:161], v232 offset:16384
    ds_read_b64_tr_b16 a[162:163], v232 offset:40960
    v_mfma_f32_16x16x32_bf16 v[80:83], a[128:131], v[192:195], v[136:139]
    v_exp_f32 v33, v33
    v_mfma_f32_16x16x32_bf16 v[88:91], a[128:131], v[208:211], v[140:143]
    s_add_u32 m0, s33, 8192
    ds_read_b64_tr_b16 a[164:165], v233 offset:16384
    v_mfma_f32_16x16x32_bf16 v[68:71], a[132:135], v[160:163], v[128:131]
    v_exp_f32 v34, v34
    v_mfma_f32_16x16x32_bf16 v[76:79], a[132:135], v[176:179], v[132:135]
    ds_read_b64_tr_b16 a[166:167], v233 offset:40960
    v_cvt_pk_bf16_f32 v96, v32, v33
    v_mfma_f32_16x16x32_bf16 v[84:87], a[132:135], v[192:195], v[136:139]
    v_exp_f32 v35, v35
    v_mfma_f32_16x16x32_bf16 v[92:95], a[132:135], v[208:211], v[140:143]
    ds_read_b64_tr_b16 a[168:169], v234 offset:16384
    ds_read_b64_tr_b16 a[170:171], v234 offset:40960
    v_mfma_f32_16x16x32_bf16 v[64:67], a[136:139], v[164:167], v[64:67]
    v_exp_f32 v36, v36
    v_mfma_f32_16x16x32_bf16 v[72:75], a[136:139], v[180:183], v[72:75]
    ds_read_b64_tr_b16 a[172:173], v235 offset:16384
    v_cvt_pk_bf16_f32 v97, v34, v35
    v_mfma_f32_16x16x32_bf16 v[80:83], a[136:139], v[196:199], v[80:83]
    v_exp_f32 v37, v37
    v_mfma_f32_16x16x32_bf16 v[88:91], a[136:139], v[212:215], v[88:91]
    ds_read_b64_tr_b16 a[174:175], v235 offset:40960
    v_cvt_pk_bf16_f32 v98, v36, v37
    v_mfma_f32_16x16x32_bf16 v[68:71], a[140:143], v[164:167], v[68:71]
    v_exp_f32 v38, v38
    v_mfma_f32_16x16x32_bf16 v[76:79], a[140:143], v[180:183], v[76:79]
    ds_read_b64_tr_b16 a[176:177], v236 offset:16384
    buffer_load_dwordx4 v18, s[12:15], s28 offen offset:0 lds
    v_mfma_f32_16x16x32_bf16 v[84:87], a[140:143], v[196:199], v[84:87]
    v_exp_f32 v39, v39
    v_mfma_f32_16x16x32_bf16 v[92:95], a[140:143], v[212:215], v[92:95]
    ds_read_b64_tr_b16 a[178:179], v236 offset:40960
    ds_read_b64_tr_b16 a[180:181], v237 offset:16384
    v_mfma_f32_16x16x32_bf16 v[64:67], a[144:147], v[168:171], v[64:67]
    v_exp_f32 v40, v40
    v_mfma_f32_16x16x32_bf16 v[72:75], a[144:147], v[184:187], v[72:75]
    ds_read_b64_tr_b16 a[182:183], v237 offset:40960
    v_cvt_pk_bf16_f32 v99, v38, v39
    v_mfma_f32_16x16x32_bf16 v[80:83], a[144:147], v[200:203], v[80:83]
    ds_read_b64_tr_b16 a[184:185], v238 offset:16384
    v_mfma_f32_16x16x32_bf16 v[88:91], a[144:147], v[216:219], v[88:91]
    v_exp_f32 v41, v41
    v_mfma_f32_16x16x32_bf16 v[68:71], a[148:151], v[168:171], v[68:71]
    ds_read_b64_tr_b16 a[186:187], v238 offset:40960
    v_cvt_pk_bf16_f32 v100, v40, v41
    v_mfma_f32_16x16x32_bf16 v[76:79], a[148:151], v[184:187], v[76:79]
    v_exp_f32 v42, v42
    v_mfma_f32_16x16x32_bf16 v[84:87], a[148:151], v[200:203], v[84:87]
    ds_read_b64_tr_b16 a[188:189], v239 offset:16384
    ds_read_b64_tr_b16 a[190:191], v239 offset:40960
    v_mfma_f32_16x16x32_bf16 v[92:95], a[148:151], v[216:219], v[92:95]
    v_exp_f32 v43, v43
    v_mfma_f32_16x16x32_bf16 v[64:67], a[152:155], v[172:175], v[64:67]
    buffer_load_dwordx4 v19, s[12:15], s28 offen offset:1024 lds
    v_cvt_pk_bf16_f32 v101, v42, v43
    v_mfma_f32_16x16x32_bf16 v[72:75], a[152:155], v[188:191], v[72:75]
    v_exp_f32 v44, v44
    v_mfma_f32_16x16x32_bf16 v[80:83], a[152:155], v[204:207], v[80:83]
    v_exp_f32 v45, v45
    v_mfma_f32_16x16x32_bf16 v[88:91], a[152:155], v[220:223], v[88:91]
    v_cvt_pk_bf16_f32 v102, v44, v45
    v_mfma_f32_16x16x32_bf16 v[68:71], a[156:159], v[172:175], v[68:71]
    v_exp_f32 v46, v46
    v_mfma_f32_16x16x32_bf16 v[76:79], a[156:159], v[188:191], v[76:79]
    v_exp_f32 v47, v47
    v_mfma_f32_16x16x32_bf16 v[84:87], a[156:159], v[204:207], v[84:87]
    v_cvt_pk_bf16_f32 v103, v46, v47
    v_mfma_f32_16x16x32_bf16 v[92:95], a[156:159], v[220:223], v[92:95]
    v_exp_f32 v48, v48
    v_mfma_f32_16x16x32_bf16 a[224:227], a[240:243], v[112:115], a[224:227]
    ds_read_b128 a[128:131], v224 offset:12288
    v_mfma_f32_16x16x32_bf16 a[228:231], a[240:243], v[116:119], a[228:231]
    v_exp_f32 v49, v49
    v_mfma_f32_16x16x32_bf16 a[232:235], a[240:243], v[120:123], a[232:235]
    buffer_load_dwordx4 v20, s[12:15], s28 offen offset:2048 lds
    v_cvt_pk_bf16_f32 v104, v48, v49
    v_mfma_f32_16x16x32_bf16 a[236:239], a[240:243], v[124:127], a[236:239]
    ds_read_b128 a[132:135], v224 offset:36864
    s_waitcnt lgkmcnt(2)
    v_mfma_f32_16x16x32_bf16 a[0:3], a[160:163], v[112:115], a[0:3]
    v_exp_f32 v50, v50
    v_mfma_f32_16x16x32_bf16 a[4:7], a[160:163], v[116:119], a[4:7]
    v_exp_f32 v51, v51
    v_mfma_f32_16x16x32_bf16 a[8:11], a[160:163], v[120:123], a[8:11]
    ds_read_b128 a[136:139], v225 offset:12288
    v_cvt_pk_bf16_f32 v105, v50, v51
    v_mfma_f32_16x16x32_bf16 a[12:15], a[160:163], v[124:127], a[12:15]
    v_exp_f32 v52, v52
    v_mfma_f32_16x16x32_bf16 a[16:19], a[164:167], v[112:115], a[16:19]
    v_exp_f32 v53, v53
    v_mfma_f32_16x16x32_bf16 a[20:23], a[164:167], v[116:119], a[20:23]
    v_cvt_pk_bf16_f32 v106, v52, v53
    v_mfma_f32_16x16x32_bf16 a[24:27], a[164:167], v[120:123], a[24:27]
    ds_read_b128 a[140:143], v225 offset:36864
    v_mfma_f32_16x16x32_bf16 a[28:31], a[164:167], v[124:127], a[28:31]
    v_exp_f32 v54, v54
    v_mfma_f32_16x16x32_bf16 a[32:35], a[168:171], v[112:115], a[32:35]
    buffer_load_dwordx4 v21, s[12:15], s28 offen offset:3072 lds
    v_mfma_f32_16x16x32_bf16 a[36:39], a[168:171], v[116:119], a[36:39]
    ds_read_b128 a[144:147], v226 offset:12288
    v_mfma_f32_16x16x32_bf16 a[40:43], a[168:171], v[120:123], a[40:43]
    v_exp_f32 v55, v55
    v_mfma_f32_16x16x32_bf16 a[44:47], a[168:171], v[124:127], a[44:47]
    v_cvt_pk_bf16_f32 v107, v54, v55
    v_mfma_f32_16x16x32_bf16 a[48:51], a[172:175], v[112:115], a[48:51]
    ds_read_b128 a[148:151], v226 offset:36864
    v_mfma_f32_16x16x32_bf16 a[52:55], a[172:175], v[116:119], a[52:55]
    v_exp_f32 v56, v56
    v_mfma_f32_16x16x32_bf16 a[56:59], a[172:175], v[120:123], a[56:59]
    v_exp_f32 v57, v57
    v_mfma_f32_16x16x32_bf16 a[60:63], a[172:175], v[124:127], a[60:63]
    v_cvt_pk_bf16_f32 v108, v56, v57
    v_mfma_f32_16x16x32_bf16 a[64:67], a[176:179], v[112:115], a[64:67]
    ds_read_b128 a[152:155], v227 offset:12288
    v_mfma_f32_16x16x32_bf16 a[68:71], a[176:179], v[116:119], a[68:71]
    v_exp_f32 v58, v58
    v_mfma_f32_16x16x32_bf16 a[72:75], a[176:179], v[120:123], a[72:75]
    v_exp_f32 v59, v59
    v_mfma_f32_16x16x32_bf16 a[76:79], a[176:179], v[124:127], a[76:79]
    s_add_u32 s28, s28, 16384
    ds_read_b128 a[156:159], v227 offset:36864
    v_mfma_f32_16x16x32_bf16 a[80:83], a[180:183], v[112:115], a[80:83]
    v_cvt_pk_bf16_f32 v109, v58, v59
    v_mfma_f32_16x16x32_bf16 a[84:87], a[180:183], v[116:119], a[84:87]
    v_exp_f32 v60, v60
    v_mfma_f32_16x16x32_bf16 a[88:91], a[180:183], v[120:123], a[88:91]
    v_exp_f32 v61, v61
    v_mfma_f32_16x16x32_bf16 a[92:95], a[180:183], v[124:127], a[92:95]
    v_cvt_pk_bf16_f32 v110, v60, v61
    v_mfma_f32_16x16x32_bf16 a[96:99], a[184:187], v[112:115], a[96:99]
    v_exp_f32 v62, v62
    v_mfma_f32_16x16x32_bf16 a[100:103], a[184:187], v[116:119], a[100:103]
    v_exp_f32 v63, v63
    v_mfma_f32_16x16x32_bf16 a[104:107], a[184:187], v[120:123], a[104:107]
    v_cvt_pk_bf16_f32 v111, v62, v63
    v_mfma_f32_16x16x32_bf16 a[108:111], a[184:187], v[124:127], a[108:111]
    v_mfma_f32_16x16x32_bf16 a[112:115], a[188:191], v[112:115], a[112:115]
    v_mfma_f32_16x16x32_bf16 a[116:119], a[188:191], v[116:119], a[116:119]
    v_mfma_f32_16x16x32_bf16 a[120:123], a[188:191], v[120:123], a[120:123]
    v_mfma_f32_16x16x32_bf16 a[124:127], a[188:191], v[124:127], a[124:127]
    s_waitcnt lgkmcnt(0)
    v_mfma_f32_16x16x32_bf16 v[32:35], a[128:131], v[160:163], v[128:131]
    v_exp_f32 v64, v64
    v_mfma_f32_16x16x32_bf16 v[40:43], a[128:131], v[176:179], v[132:135]
    ds_read_b64_tr_b16 a[160:161], v240 offset:16384
    ds_read_b64_tr_b16 a[162:163], v240 offset:40960
    v_mfma_f32_16x16x32_bf16 v[48:51], a[128:131], v[192:195], v[136:139]
    v_exp_f32 v65, v65
    v_mfma_f32_16x16x32_bf16 v[56:59], a[128:131], v[208:211], v[140:143]
    s_add_u32 m0, s33, 4096
    ds_read_b64_tr_b16 a[164:165], v241 offset:16384
    v_mfma_f32_16x16x32_bf16 v[36:39], a[132:135], v[160:163], v[128:131]
    v_exp_f32 v66, v66
    v_mfma_f32_16x16x32_bf16 v[44:47], a[132:135], v[176:179], v[132:135]
    ds_read_b64_tr_b16 a[166:167], v241 offset:40960
    v_cvt_pk_bf16_f32 v112, v64, v65
    v_mfma_f32_16x16x32_bf16 v[52:55], a[132:135], v[192:195], v[136:139]
    v_exp_f32 v67, v67
    v_mfma_f32_16x16x32_bf16 v[60:63], a[132:135], v[208:211], v[140:143]
    ds_read_b64_tr_b16 a[168:169], v242 offset:16384
    ds_read_b64_tr_b16 a[170:171], v242 offset:40960
    v_mfma_f32_16x16x32_bf16 v[32:35], a[136:139], v[164:167], v[32:35]
    v_exp_f32 v68, v68
    v_mfma_f32_16x16x32_bf16 v[40:43], a[136:139], v[180:183], v[40:43]
    ds_read_b64_tr_b16 a[172:173], v243 offset:16384
    v_cvt_pk_bf16_f32 v113, v66, v67
    v_mfma_f32_16x16x32_bf16 v[48:51], a[136:139], v[196:199], v[48:51]
    v_exp_f32 v69, v69
    v_mfma_f32_16x16x32_bf16 v[56:59], a[136:139], v[212:215], v[56:59]
    ds_read_b64_tr_b16 a[174:175], v243 offset:40960
    v_cvt_pk_bf16_f32 v114, v68, v69
    v_mfma_f32_16x16x32_bf16 v[36:39], a[140:143], v[164:167], v[36:39]
    v_exp_f32 v70, v70
    v_mfma_f32_16x16x32_bf16 v[44:47], a[140:143], v[180:183], v[44:47]
    ds_read_b64_tr_b16 a[176:177], v244 offset:16384
    buffer_load_dwordx4 v22, s[16:19], s29 offen offset:0 lds
    v_mfma_f32_16x16x32_bf16 v[52:55], a[140:143], v[196:199], v[52:55]
    v_exp_f32 v71, v71
    v_mfma_f32_16x16x32_bf16 v[60:63], a[140:143], v[212:215], v[60:63]
    ds_read_b64_tr_b16 a[178:179], v244 offset:40960
    ds_read_b64_tr_b16 a[180:181], v245 offset:16384
    v_mfma_f32_16x16x32_bf16 v[32:35], a[144:147], v[168:171], v[32:35]
    v_exp_f32 v72, v72
    v_mfma_f32_16x16x32_bf16 v[40:43], a[144:147], v[184:187], v[40:43]
    ds_read_b64_tr_b16 a[182:183], v245 offset:40960
    v_cvt_pk_bf16_f32 v115, v70, v71
    v_mfma_f32_16x16x32_bf16 v[48:51], a[144:147], v[200:203], v[48:51]
    ds_read_b64_tr_b16 a[184:185], v246 offset:16384
    v_mfma_f32_16x16x32_bf16 v[56:59], a[144:147], v[216:219], v[56:59]
    v_exp_f32 v73, v73
    v_mfma_f32_16x16x32_bf16 v[36:39], a[148:151], v[168:171], v[36:39]
    ds_read_b64_tr_b16 a[186:187], v246 offset:40960
    v_cvt_pk_bf16_f32 v116, v72, v73
    v_mfma_f32_16x16x32_bf16 v[44:47], a[148:151], v[184:187], v[44:47]
    v_exp_f32 v74, v74
    v_mfma_f32_16x16x32_bf16 v[52:55], a[148:151], v[200:203], v[52:55]
    ds_read_b64_tr_b16 a[188:189], v247 offset:16384
    ds_read_b64_tr_b16 a[190:191], v247 offset:40960
    v_mfma_f32_16x16x32_bf16 v[60:63], a[148:151], v[216:219], v[60:63]
    v_exp_f32 v75, v75
    v_mfma_f32_16x16x32_bf16 v[32:35], a[152:155], v[172:175], v[32:35]
    buffer_load_dwordx4 v23, s[16:19], s29 offen offset:1024 lds
    v_cvt_pk_bf16_f32 v117, v74, v75
    v_mfma_f32_16x16x32_bf16 v[40:43], a[152:155], v[188:191], v[40:43]
    v_exp_f32 v76, v76
    v_mfma_f32_16x16x32_bf16 v[48:51], a[152:155], v[204:207], v[48:51]
    v_exp_f32 v77, v77
    v_mfma_f32_16x16x32_bf16 v[56:59], a[152:155], v[220:223], v[56:59]
    v_cvt_pk_bf16_f32 v118, v76, v77
    v_mfma_f32_16x16x32_bf16 v[36:39], a[156:159], v[172:175], v[36:39]
    v_exp_f32 v78, v78
    v_mfma_f32_16x16x32_bf16 v[44:47], a[156:159], v[188:191], v[44:47]
    v_exp_f32 v79, v79
    v_mfma_f32_16x16x32_bf16 v[52:55], a[156:159], v[204:207], v[52:55]
    v_cvt_pk_bf16_f32 v119, v78, v79
    v_mfma_f32_16x16x32_bf16 v[60:63], a[156:159], v[220:223], v[60:63]
    v_exp_f32 v80, v80
    v_mfma_f32_16x16x32_bf16 a[224:227], a[240:243], v[96:99], a[224:227]
    ds_read_b128 a[128:131], v228 offset:12288
    v_mfma_f32_16x16x32_bf16 a[228:231], a[240:243], v[100:103], a[228:231]
    v_exp_f32 v81, v81
    v_mfma_f32_16x16x32_bf16 a[232:235], a[240:243], v[104:107], a[232:235]
    buffer_load_dwordx4 v22, s[16:19], s29 offen offset:2048 lds
    v_cvt_pk_bf16_f32 v120, v80, v81
    v_mfma_f32_16x16x32_bf16 a[236:239], a[240:243], v[108:111], a[236:239]
    ds_read_b128 a[132:135], v228 offset:36864
    s_waitcnt lgkmcnt(2)
    v_mfma_f32_16x16x32_bf16 a[0:3], a[160:163], v[96:99], a[0:3]
    v_exp_f32 v82, v82
    v_mfma_f32_16x16x32_bf16 a[4:7], a[160:163], v[100:103], a[4:7]
    v_exp_f32 v83, v83
    v_mfma_f32_16x16x32_bf16 a[8:11], a[160:163], v[104:107], a[8:11]
    ds_read_b128 a[136:139], v229 offset:12288
    v_cvt_pk_bf16_f32 v121, v82, v83
    v_mfma_f32_16x16x32_bf16 a[12:15], a[160:163], v[108:111], a[12:15]
    v_exp_f32 v84, v84
    v_mfma_f32_16x16x32_bf16 a[16:19], a[164:167], v[96:99], a[16:19]
    v_exp_f32 v85, v85
    v_mfma_f32_16x16x32_bf16 a[20:23], a[164:167], v[100:103], a[20:23]
    v_cvt_pk_bf16_f32 v122, v84, v85
    v_mfma_f32_16x16x32_bf16 a[24:27], a[164:167], v[104:107], a[24:27]
    ds_read_b128 a[140:143], v229 offset:36864
    v_mfma_f32_16x16x32_bf16 a[28:31], a[164:167], v[108:111], a[28:31]
    v_exp_f32 v86, v86
    v_mfma_f32_16x16x32_bf16 a[32:35], a[168:171], v[96:99], a[32:35]
    buffer_load_dwordx4 v23, s[16:19], s29 offen offset:3072 lds
    v_mfma_f32_16x16x32_bf16 a[36:39], a[168:171], v[100:103], a[36:39]
    ds_read_b128 a[144:147], v230 offset:12288
    v_mfma_f32_16x16x32_bf16 a[40:43], a[168:171], v[104:107], a[40:43]
    v_exp_f32 v87, v87
    v_mfma_f32_16x16x32_bf16 a[44:47], a[168:171], v[108:111], a[44:47]
    v_cvt_pk_bf16_f32 v123, v86, v87
    v_mfma_f32_16x16x32_bf16 a[48:51], a[172:175], v[96:99], a[48:51]
    ds_read_b128 a[148:151], v230 offset:36864
    v_mfma_f32_16x16x32_bf16 a[52:55], a[172:175], v[100:103], a[52:55]
    v_exp_f32 v88, v88
    v_mfma_f32_16x16x32_bf16 a[56:59], a[172:175], v[104:107], a[56:59]
    v_exp_f32 v89, v89
    v_mfma_f32_16x16x32_bf16 a[60:63], a[172:175], v[108:111], a[60:63]
    v_cvt_pk_bf16_f32 v124, v88, v89
    v_mfma_f32_16x16x32_bf16 a[64:67], a[176:179], v[96:99], a[64:67]
    ds_read_b128 a[152:155], v231 offset:12288
    v_mfma_f32_16x16x32_bf16 a[68:71], a[176:179], v[100:103], a[68:71]
    v_exp_f32 v90, v90
    v_mfma_f32_16x16x32_bf16 a[72:75], a[176:179], v[104:107], a[72:75]
    v_exp_f32 v91, v91
    v_mfma_f32_16x16x32_bf16 a[76:79], a[176:179], v[108:111], a[76:79]
    s_add_u32 s29, s29, 16384
    ds_read_b128 a[156:159], v231 offset:36864
    v_mfma_f32_16x16x32_bf16 a[80:83], a[180:183], v[96:99], a[80:83]
    v_cvt_pk_bf16_f32 v125, v90, v91
    v_mfma_f32_16x16x32_bf16 a[84:87], a[180:183], v[100:103], a[84:87]
    v_exp_f32 v92, v92
    v_mfma_f32_16x16x32_bf16 a[88:91], a[180:183], v[104:107], a[88:91]
    v_exp_f32 v93, v93
    v_mfma_f32_16x16x32_bf16 a[92:95], a[180:183], v[108:111], a[92:95]
    v_cvt_pk_bf16_f32 v126, v92, v93
    v_mfma_f32_16x16x32_bf16 a[96:99], a[184:187], v[96:99], a[96:99]
    v_exp_f32 v94, v94
    v_mfma_f32_16x16x32_bf16 a[100:103], a[184:187], v[100:103], a[100:103]
    v_exp_f32 v95, v95
    v_mfma_f32_16x16x32_bf16 a[104:107], a[184:187], v[104:107], a[104:107]
    v_cvt_pk_bf16_f32 v127, v94, v95
    v_mfma_f32_16x16x32_bf16 a[108:111], a[184:187], v[108:111], a[108:111]
    v_mfma_f32_16x16x32_bf16 a[112:115], a[188:191], v[96:99], a[112:115]
    v_mfma_f32_16x16x32_bf16 a[116:119], a[188:191], v[100:103], a[116:119]
    v_mfma_f32_16x16x32_bf16 a[120:123], a[188:191], v[104:107], a[120:123]
    v_mfma_f32_16x16x32_bf16 a[124:127], a[188:191], v[108:111], a[124:127]
    s_cmp_eq_u32 s31, 6
    s_cselect_b32 s60, s62, s60
    s_cselect_b32 s61, 2097152, s61
    s_sub_u32 s31, s31, 1
    s_cmp_lg_u32 s31, 0
    s_cbranch_scc1 K1_LOOP
    s_waitcnt vmcnt(8) lgkmcnt(0)
    s_barrier
    v_mfma_f32_16x16x32_bf16 v[64:67], a[128:131], v[160:163], v[128:131]
    v_exp_f32 v32, v32
    v_mfma_f32_16x16x32_bf16 v[72:75], a[128:131], v[176:179], v[132:135]
    ds_read_b64_tr_b16 a[160:161], v232 offset:0
    ds_read_b64_tr_b16 a[162:163], v232 offset:24576
    v_mfma_f32_16x16x32_bf16 v[80:83], a[128:131], v[192:195], v[136:139]
    v_exp_f32 v33, v33
    v_mfma_f32_16x16x32_bf16 v[88:91], a[128:131], v[208:211], v[140:143]
    buffer_load_dword a248, v249, s[24:27], s35 offen
    ds_read_b64_tr_b16 a[164:165], v233 offset:0
    v_mfma_f32_16x16x32_bf16 v[68:71], a[132:135], v[160:163], v[128:131]
    v_exp_f32 v34, v34
    v_mfma_f32_16x16x32_bf16 v[76:79], a[132:135], v[176:179], v[132:135]
    ds_read_b64_tr_b16 a[166:167], v233 offset:24576
    v_cvt_pk_bf16_f32 v96, v32, v33
    v_mfma_f32_16x16x32_bf16 v[84:87], a[132:135], v[192:195], v[136:139]
    v_exp_f32 v35, v35
    v_mfma_f32_16x16x32_bf16 v[92:95], a[132:135], v[208:211], v[140:143]
    ds_read_b64_tr_b16 a[168:169], v234 offset:0
    buffer_load_dword a249, v250, s[44:47], 0 offen
    v_mfma_f32_16x16x32_bf16 v[64:67], a[136:139], v[164:167], v[64:67]
    v_exp_f32 v36, v36
    v_mfma_f32_16x16x32_bf16 v[72:75], a[136:139], v[180:183], v[72:75]
    ds_read_b64_tr_b16 a[170:171], v234 offset:24576
    ds_read_b64_tr_b16 a[172:173], v235 offset:0
    v_mfma_f32_16x16x32_bf16 v[80:83], a[136:139], v[196:199], v[80:83]
    v_exp_f32 v37, v37
    v_mfma_f32_16x16x32_bf16 v[88:91], a[136:139], v[212:215], v[88:91]
    ds_read_b64_tr_b16 a[174:175], v235 offset:24576
    v_cvt_pk_bf16_f32 v97, v34, v35
    v_mfma_f32_16x16x32_bf16 v[68:71], a[140:143], v[164:167], v[68:71]
    v_exp_f32 v38, v38
    v_mfma_f32_16x16x32_bf16 v[76:79], a[140:143], v[180:183], v[76:79]
    ds_read_b64_tr_b16 a[176:177], v236 offset:0
    buffer_load_dword a250, v251, s[48:51], 0 offen
    v_mfma_f32_16x16x32_bf16 v[84:87], a[140:143], v[196:199], v[84:87]
    v_exp_f32 v39, v39
    v_mfma_f32_16x16x32_bf16 v[92:95], a[140:143], v[212:215], v[92:95]
    ds_read_b64_tr_b16 a[178:179], v236 offset:24576
    ds_read_b64_tr_b16 a[180:181], v237 offset:0
    v_mfma_f32_16x16x32_bf16 v[64:67], a[144:147], v[168:171], v[64:67]
    v_exp_f32 v40, v40
    v_mfma_f32_16x16x32_bf16 v[72:75], a[144:147], v[184:187], v[72:75]
    ds_read_b64_tr_b16 a[182:183], v237 offset:24576
    v_cvt_pk_bf16_f32 v98, v36, v37
    v_mfma_f32_16x16x32_bf16 v[80:83], a[144:147], v[200:203], v[80:83]
    ds_read_b64_tr_b16 a[184:185], v238 offset:0
    buffer_load_dword a251, v252, s[52:55], 0 offen
    v_mfma_f32_16x16x32_bf16 v[88:91], a[144:147], v[216:219], v[88:91]
    v_exp_f32 v41, v41
    v_mfma_f32_16x16x32_bf16 v[68:71], a[148:151], v[168:171], v[68:71]
    ds_read_b64_tr_b16 a[186:187], v238 offset:24576
    v_cvt_pk_bf16_f32 v99, v38, v39
    v_mfma_f32_16x16x32_bf16 v[76:79], a[148:151], v[184:187], v[76:79]
    v_exp_f32 v42, v42
    v_mfma_f32_16x16x32_bf16 v[84:87], a[148:151], v[200:203], v[84:87]
    ds_read_b64_tr_b16 a[188:189], v239 offset:0
    ds_read_b64_tr_b16 a[190:191], v239 offset:24576
    v_mfma_f32_16x16x32_bf16 v[92:95], a[148:151], v[216:219], v[92:95]
    v_exp_f32 v43, v43
    v_mfma_f32_16x16x32_bf16 v[64:67], a[152:155], v[172:175], v[64:67]
    buffer_load_dword a253, v250, s[56:59], 0 offen
    v_cvt_pk_bf16_f32 v100, v40, v41
    v_mfma_f32_16x16x32_bf16 v[72:75], a[152:155], v[188:191], v[72:75]
    v_exp_f32 v44, v44
    v_mfma_f32_16x16x32_bf16 v[80:83], a[152:155], v[204:207], v[80:83]
    v_cvt_pk_bf16_f32 v101, v42, v43
    v_mfma_f32_16x16x32_bf16 v[88:91], a[152:155], v[220:223], v[88:91]
    v_exp_f32 v45, v45
    v_mfma_f32_16x16x32_bf16 v[68:71], a[156:159], v[172:175], v[68:71]
    buffer_load_dword v253, off, s[40:43], 0 offset:128 sc1
    v_cvt_pk_bf16_f32 v102, v44, v45
    v_mfma_f32_16x16x32_bf16 v[76:79], a[156:159], v[188:191], v[76:79]
    v_exp_f32 v46, v46
    v_mfma_f32_16x16x32_bf16 v[84:87], a[156:159], v[204:207], v[84:87]
    v_exp_f32 v47, v47
    v_mfma_f32_16x16x32_bf16 v[92:95], a[156:159], v[220:223], v[92:95]
    v_cvt_pk_bf16_f32 v103, v46, v47
    v_mfma_f32_16x16x32_bf16 a[224:227], a[240:243], v[112:115], a[224:227]
    ds_read_b128 a[128:131], v224 offset:20480
    v_mfma_f32_16x16x32_bf16 a[228:231], a[240:243], v[116:119], a[228:231]
    v_exp_f32 v48, v48
    v_mfma_f32_16x16x32_bf16 a[232:235], a[240:243], v[120:123], a[232:235]
    s_add_u32 m0, s33, 12288
    v_mfma_f32_16x16x32_bf16 a[236:239], a[240:243], v[124:127], a[236:239]
    ds_read_b128 a[132:135], v224 offset:45056
    s_waitcnt lgkmcnt(2)
    v_mfma_f32_16x16x32_bf16 a[0:3], a[160:163], v[112:115], a[0:3]
    v_exp_f32 v49, v49
    v_mfma_f32_16x16x32_bf16 a[4:7], a[160:163], v[116:119], a[4:7]
    v_exp_f32 v50, v50
    v_mfma_f32_16x16x32_bf16 a[8:11], a[160:163], v[120:123], a[8:11]
    ds_read_b128 a[136:139], v225 offset:20480
    v_cvt_pk_bf16_f32 v104, v48, v49
    v_mfma_f32_16x16x32_bf16 a[12:15], a[160:163], v[124:127], a[12:15]
    v_exp_f32 v51, v51
    v_mfma_f32_16x16x32_bf16 a[16:19], a[164:167], v[112:115], a[16:19]
    buffer_load_dwordx4 v18, s[12:15], s28 offen offset:0 lds
    v_cvt_pk_bf16_f32 v105, v50, v51
    v_mfma_f32_16x16x32_bf16 a[20:23], a[164:167], v[116:119], a[20:23]
    v_exp_f32 v52, v52
    v_mfma_f32_16x16x32_bf16 a[24:27], a[164:167], v[120:123], a[24:27]
    ds_read_b128 a[140:143], v225 offset:45056
    v_mfma_f32_16x16x32_bf16 a[28:31], a[164:167], v[124:127], a[28:31]
    v_exp_f32 v53, v53
    v_mfma_f32_16x16x32_bf16 a[32:35], a[168:171], v[112:115], a[32:35]
    buffer_load_dwordx4 v19, s[12:15], s28 offen offset:1024 lds
    v_cvt_pk_bf16_f32 v106, v52, v53
    v_mfma_f32_16x16x32_bf16 a[36:39], a[168:171], v[116:119], a[36:39]
    v_exp_f32 v54, v54
    v_mfma_f32_16x16x32_bf16 a[40:43], a[168:171], v[120:123], a[40:43]
    ds_read_b128 a[144:147], v226 offset:20480
    v_mfma_f32_16x16x32_bf16 a[44:47], a[168:171], v[124:127], a[44:47]
    v_exp_f32 v55, v55
    v_mfma_f32_16x16x32_bf16 a[48:51], a[172:175], v[112:115], a[48:51]
    ds_read_b128 a[148:151], v226 offset:45056
    v_cvt_pk_bf16_f32 v107, v54, v55
    v_mfma_f32_16x16x32_bf16 a[52:55], a[172:175], v[116:119], a[52:55]
    v_exp_f32 v56, v56
    v_mfma_f32_16x16x32_bf16 a[56:59], a[172:175], v[120:123], a[56:59]
    buffer_load_dwordx4 v20, s[12:15], s28 offen offset:2048 lds
    v_mfma_f32_16x16x32_bf16 a[60:63], a[172:175], v[124:127], a[60:63]
    v_exp_f32 v57, v57
    v_mfma_f32_16x16x32_bf16 a[64:67], a[176:179], v[112:115], a[64:67]
    ds_read_b128 a[152:155], v227 offset:20480
    v_cvt_pk_bf16_f32 v108, v56, v57
    v_mfma_f32_16x16x32_bf16 a[68:71], a[176:179], v[116:119], a[68:71]
    v_exp_f32 v58, v58
    v_mfma_f32_16x16x32_bf16 a[72:75], a[176:179], v[120:123], a[72:75]
    v_exp_f32 v59, v59
    v_mfma_f32_16x16x32_bf16 a[76:79], a[176:179], v[124:127], a[76:79]
    buffer_load_dwordx4 v21, s[12:15], s28 offen offset:3072 lds
    ds_read_b128 a[156:159], v227 offset:45056
    v_mfma_f32_16x16x32_bf16 a[80:83], a[180:183], v[112:115], a[80:83]
    v_cvt_pk_bf16_f32 v109, v58, v59
    v_mfma_f32_16x16x32_bf16 a[84:87], a[180:183], v[116:119], a[84:87]
    v_exp_f32 v60, v60
    v_mfma_f32_16x16x32_bf16 a[88:91], a[180:183], v[120:123], a[88:91]
    v_exp_f32 v61, v61
    v_mfma_f32_16x16x32_bf16 a[92:95], a[180:183], v[124:127], a[92:95]
    v_cvt_pk_bf16_f32 v110, v60, v61
    v_mfma_f32_16x16x32_bf16 a[96:99], a[184:187], v[112:115], a[96:99]
    s_add_u32 s28, s28, 16384
    v_mfma_f32_16x16x32_bf16 a[100:103], a[184:187], v[116:119], a[100:103]
    v_exp_f32 v62, v62
    v_mfma_f32_16x16x32_bf16 a[104:107], a[184:187], v[120:123], a[104:107]
    v_exp_f32 v63, v63
    v_mfma_f32_16x16x32_bf16 a[108:111], a[184:187], v[124:127], a[108:111]
    v_cvt_pk_bf16_f32 v111, v62, v63
    v_mfma_f32_16x16x32_bf16 a[112:115], a[188:191], v[112:115], a[112:115]
    v_mfma_f32_16x16x32_bf16 a[116:119], a[188:191], v[116:119], a[116:119]
    v_mfma_f32_16x16x32_bf16 a[120:123], a[188:191], v[120:123], a[120:123]
    v_mfma_f32_16x16x32_bf16 a[124:127], a[188:191], v[124:127], a[124:127]
    s_waitcnt lgkmcnt(0)
    v_mfma_f32_16x16x32_bf16 v[32:35], a[128:131], v[160:163], v[128:131]
    v_exp_f32 v64, v64
    v_mfma_f32_16x16x32_bf16 v[40:43], a[128:131], v[176:179], v[132:135]
    ds_read_b64_tr_b16 a[160:161], v240 offset:0
    ds_read_b64_tr_b16 a[162:163], v240 offset:24576
    v_mfma_f32_16x16x32_bf16 v[48:51], a[128:131], v[192:195], v[136:139]
    v_exp_f32 v65, v65
    v_mfma_f32_16x16x32_bf16 v[56:59], a[128:131], v[208:211], v[140:143]
    s_add_u32 m0, s33, 16384
    ds_read_b64_tr_b16 a[164:165], v241 offset:0
    v_mfma_f32_16x16x32_bf16 v[36:39], a[132:135], v[160:163], v[128:131]
    v_exp_f32 v66, v66
    v_mfma_f32_16x16x32_bf16 v[44:47], a[132:135], v[176:179], v[132:135]
    ds_read_b64_tr_b16 a[166:167], v241 offset:24576
    v_cvt_pk_bf16_f32 v112, v64, v65
    v_mfma_f32_16x16x32_bf16 v[52:55], a[132:135], v[192:195], v[136:139]
    v_exp_f32 v67, v67
    v_mfma_f32_16x16x32_bf16 v[60:63], a[132:135], v[208:211], v[140:143]
    ds_read_b64_tr_b16 a[168:169], v242 offset:0
    ds_read_b64_tr_b16 a[170:171], v242 offset:24576
    v_mfma_f32_16x16x32_bf16 v[32:35], a[136:139], v[164:167], v[32:35]
    v_exp_f32 v68, v68
    v_mfma_f32_16x16x32_bf16 v[40:43], a[136:139], v[180:183], v[40:43]
    ds_read_b64_tr_b16 a[172:173], v243 offset:0
    v_cvt_pk_bf16_f32 v113, v66, v67
    v_mfma_f32_16x16x32_bf16 v[48:51], a[136:139], v[196:199], v[48:51]
    v_exp_f32 v69, v69
    v_mfma_f32_16x16x32_bf16 v[56:59], a[136:139], v[212:215], v[56:59]
    ds_read_b64_tr_b16 a[174:175], v243 offset:24576
    v_cvt_pk_bf16_f32 v114, v68, v69
    v_mfma_f32_16x16x32_bf16 v[36:39], a[140:143], v[164:167], v[36:39]
    v_exp_f32 v70, v70
    v_mfma_f32_16x16x32_bf16 v[44:47], a[140:143], v[180:183], v[44:47]
    ds_read_b64_tr_b16 a[176:177], v244 offset:0
    buffer_load_dwordx4 v22, s[16:19], s29 offen offset:0 lds
    v_mfma_f32_16x16x32_bf16 v[52:55], a[140:143], v[196:199], v[52:55]
    v_exp_f32 v71, v71
    v_mfma_f32_16x16x32_bf16 v[60:63], a[140:143], v[212:215], v[60:63]
    ds_read_b64_tr_b16 a[178:179], v244 offset:24576
    ds_read_b64_tr_b16 a[180:181], v245 offset:0
    v_mfma_f32_16x16x32_bf16 v[32:35], a[144:147], v[168:171], v[32:35]
    v_exp_f32 v72, v72
    v_mfma_f32_16x16x32_bf16 v[40:43], a[144:147], v[184:187], v[40:43]
    ds_read_b64_tr_b16 a[182:183], v245 offset:24576
    v_cvt_pk_bf16_f32 v115, v70, v71
    v_mfma_f32_16x16x32_bf16 v[48:51], a[144:147], v[200:203], v[48:51]
    ds_read_b64_tr_b16 a[184:185], v246 offset:0
    v_mfma_f32_16x16x32_bf16 v[56:59], a[144:147], v[216:219], v[56:59]
    v_exp_f32 v73, v73
    v_mfma_f32_16x16x32_bf16 v[36:39], a[148:151], v[168:171], v[36:39]
    ds_read_b64_tr_b16 a[186:187], v246 offset:24576
    v_cvt_pk_bf16_f32 v116, v72, v73
    v_mfma_f32_16x16x32_bf16 v[44:47], a[148:151], v[184:187], v[44:47]
    v_exp_f32 v74, v74
    v_mfma_f32_16x16x32_bf16 v[52:55], a[148:151], v[200:203], v[52:55]
    ds_read_b64_tr_b16 a[188:189], v247 offset:0
    ds_read_b64_tr_b16 a[190:191], v247 offset:24576
    v_mfma_f32_16x16x32_bf16 v[60:63], a[148:151], v[216:219], v[60:63]
    v_exp_f32 v75, v75
    v_mfma_f32_16x16x32_bf16 v[32:35], a[152:155], v[172:175], v[32:35]
    buffer_load_dwordx4 v23, s[16:19], s29 offen offset:1024 lds
    v_cvt_pk_bf16_f32 v117, v74, v75
    v_mfma_f32_16x16x32_bf16 v[40:43], a[152:155], v[188:191], v[40:43]
    v_exp_f32 v76, v76
    v_mfma_f32_16x16x32_bf16 v[48:51], a[152:155], v[204:207], v[48:51]
    v_exp_f32 v77, v77
    v_mfma_f32_16x16x32_bf16 v[56:59], a[152:155], v[220:223], v[56:59]
    v_cvt_pk_bf16_f32 v118, v76, v77
    v_mfma_f32_16x16x32_bf16 v[36:39], a[156:159], v[172:175], v[36:39]
    v_exp_f32 v78, v78
    v_mfma_f32_16x16x32_bf16 v[44:47], a[156:159], v[188:191], v[44:47]
    v_exp_f32 v79, v79
    v_mfma_f32_16x16x32_bf16 v[52:55], a[156:159], v[204:207], v[52:55]
    v_cvt_pk_bf16_f32 v119, v78, v79
    v_mfma_f32_16x16x32_bf16 v[60:63], a[156:159], v[220:223], v[60:63]
    v_exp_f32 v80, v80
    v_mfma_f32_16x16x32_bf16 a[224:227], a[240:243], v[96:99], a[224:227]
    ds_read_b128 a[128:131], v228 offset:20480
    v_mfma_f32_16x16x32_bf16 a[228:231], a[240:243], v[100:103], a[228:231]
    v_exp_f32 v81, v81
    v_mfma_f32_16x16x32_bf16 a[232:235], a[240:243], v[104:107], a[232:235]
    buffer_load_dwordx4 v22, s[16:19], s29 offen offset:2048 lds
    v_cvt_pk_bf16_f32 v120, v80, v81
    v_mfma_f32_16x16x32_bf16 a[236:239], a[240:243], v[108:111], a[236:239]
    ds_read_b128 a[132:135], v228 offset:45056
    s_waitcnt lgkmcnt(2)
    v_mfma_f32_16x16x32_bf16 a[0:3], a[160:163], v[96:99], a[0:3]
    v_exp_f32 v82, v82
    v_mfma_f32_16x16x32_bf16 a[4:7], a[160:163], v[100:103], a[4:7]
    v_exp_f32 v83, v83
    v_mfma_f32_16x16x32_bf16 a[8:11], a[160:163], v[104:107], a[8:11]
    ds_read_b128 a[136:139], v229 offset:20480
    v_cvt_pk_bf16_f32 v121, v82, v83
    v_mfma_f32_16x16x32_bf16 a[12:15], a[160:163], v[108:111], a[12:15]
    v_exp_f32 v84, v84
    v_mfma_f32_16x16x32_bf16 a[16:19], a[164:167], v[96:99], a[16:19]
    v_exp_f32 v85, v85
    v_mfma_f32_16x16x32_bf16 a[20:23], a[164:167], v[100:103], a[20:23]
    v_cvt_pk_bf16_f32 v122, v84, v85
    v_mfma_f32_16x16x32_bf16 a[24:27], a[164:167], v[104:107], a[24:27]
    ds_read_b128 a[140:143], v229 offset:45056
    v_mfma_f32_16x16x32_bf16 a[28:31], a[164:167], v[108:111], a[28:31]
    v_exp_f32 v86, v86
    v_mfma_f32_16x16x32_bf16 a[32:35], a[168:171], v[96:99], a[32:35]
    buffer_load_dwordx4 v23, s[16:19], s29 offen offset:3072 lds
    v_mfma_f32_16x16x32_bf16 a[36:39], a[168:171], v[100:103], a[36:39]
    ds_read_b128 a[144:147], v230 offset:20480
    v_mfma_f32_16x16x32_bf16 a[40:43], a[168:171], v[104:107], a[40:43]
    v_exp_f32 v87, v87
    v_mfma_f32_16x16x32_bf16 a[44:47], a[168:171], v[108:111], a[44:47]
    v_cvt_pk_bf16_f32 v123, v86, v87
    v_mfma_f32_16x16x32_bf16 a[48:51], a[172:175], v[96:99], a[48:51]
    ds_read_b128 a[148:151], v230 offset:45056
    v_mfma_f32_16x16x32_bf16 a[52:55], a[172:175], v[100:103], a[52:55]
    v_exp_f32 v88, v88
    v_mfma_f32_16x16x32_bf16 a[56:59], a[172:175], v[104:107], a[56:59]
    v_exp_f32 v89, v89
    v_mfma_f32_16x16x32_bf16 a[60:63], a[172:175], v[108:111], a[60:63]
    v_cvt_pk_bf16_f32 v124, v88, v89
    v_mfma_f32_16x16x32_bf16 a[64:67], a[176:179], v[96:99], a[64:67]
    ds_read_b128 a[152:155], v231 offset:20480
    v_mfma_f32_16x16x32_bf16 a[68:71], a[176:179], v[100:103], a[68:71]
    v_exp_f32 v90, v90
    v_mfma_f32_16x16x32_bf16 a[72:75], a[176:179], v[104:107], a[72:75]
    v_exp_f32 v91, v91
    v_mfma_f32_16x16x32_bf16 a[76:79], a[176:179], v[108:111], a[76:79]
    s_add_u32 s29, s29, 16384
    ds_read_b128 a[156:159], v231 offset:45056
    v_mfma_f32_16x16x32_bf16 a[80:83], a[180:183], v[96:99], a[80:83]
    v_cvt_pk_bf16_f32 v125, v90, v91
    v_mfma_f32_16x16x32_bf16 a[84:87], a[180:183], v[100:103], a[84:87]
    v_exp_f32 v92, v92
    v_mfma_f32_16x16x32_bf16 a[88:91], a[180:183], v[104:107], a[88:91]
    v_exp_f32 v93, v93
    v_mfma_f32_16x16x32_bf16 a[92:95], a[180:183], v[108:111], a[92:95]
    v_cvt_pk_bf16_f32 v126, v92, v93
    v_mfma_f32_16x16x32_bf16 a[96:99], a[184:187], v[96:99], a[96:99]
    v_exp_f32 v94, v94
    v_mfma_f32_16x16x32_bf16 a[100:103], a[184:187], v[100:103], a[100:103]
    v_exp_f32 v95, v95
    v_mfma_f32_16x16x32_bf16 a[104:107], a[184:187], v[104:107], a[104:107]
    v_cvt_pk_bf16_f32 v127, v94, v95
    v_mfma_f32_16x16x32_bf16 a[108:111], a[184:187], v[108:111], a[108:111]
    v_mfma_f32_16x16x32_bf16 a[112:115], a[188:191], v[96:99], a[112:115]
    v_mfma_f32_16x16x32_bf16 a[116:119], a[188:191], v[100:103], a[116:119]
    v_mfma_f32_16x16x32_bf16 a[120:123], a[188:191], v[104:107], a[120:123]
    v_mfma_f32_16x16x32_bf16 a[124:127], a[188:191], v[108:111], a[124:127]
    s_waitcnt vmcnt(14) lgkmcnt(0)
    s_barrier
    v_mfma_f32_16x16x32_bf16 v[64:67], a[128:131], v[160:163], v[128:131]
    v_exp_f32 v32, v32
    v_mfma_f32_16x16x32_bf16 v[72:75], a[128:131], v[176:179], v[132:135]
    ds_read_b64_tr_b16 a[160:161], v232 offset:4096
    ds_read_b64_tr_b16 a[162:163], v232 offset:28672
    v_mfma_f32_16x16x32_bf16 v[80:83], a[128:131], v[192:195], v[136:139]
    v_exp_f32 v33, v33
    v_mfma_f32_16x16x32_bf16 v[88:91], a[128:131], v[208:211], v[140:143]
    s_add_u32 m0, s33, 20480
    ds_read_b64_tr_b16 a[164:165], v233 offset:4096
    v_mfma_f32_16x16x32_bf16 v[68:71], a[132:135], v[160:163], v[128:131]
    v_exp_f32 v34, v34
    v_mfma_f32_16x16x32_bf16 v[76:79], a[132:135], v[176:179], v[132:135]
    ds_read_b64_tr_b16 a[166:167], v233 offset:28672
    v_cvt_pk_bf16_f32 v96, v32, v33
    v_mfma_f32_16x16x32_bf16 v[84:87], a[132:135], v[192:195], v[136:139]
    v_exp_f32 v35, v35
    v_mfma_f32_16x16x32_bf16 v[92:95], a[132:135], v[208:211], v[140:143]
    ds_read_b64_tr_b16 a[168:169], v234 offset:4096
    ds_read_b64_tr_b16 a[170:171], v234 offset:28672
    v_mfma_f32_16x16x32_bf16 v[64:67], a[136:139], v[164:167], v[64:67]
    v_exp_f32 v36, v36
    v_mfma_f32_16x16x32_bf16 v[72:75], a[136:139], v[180:183], v[72:75]
    ds_read_b64_tr_b16 a[172:173], v235 offset:4096
    v_cvt_pk_bf16_f32 v97, v34, v35
    v_mfma_f32_16x16x32_bf16 v[80:83], a[136:139], v[196:199], v[80:83]
    v_exp_f32 v37, v37
    v_mfma_f32_16x16x32_bf16 v[88:91], a[136:139], v[212:215], v[88:91]
    ds_read_b64_tr_b16 a[174:175], v235 offset:28672
    v_cvt_pk_bf16_f32 v98, v36, v37
    v_mfma_f32_16x16x32_bf16 v[68:71], a[140:143], v[164:167], v[68:71]
    v_exp_f32 v38, v38
    v_mfma_f32_16x16x32_bf16 v[76:79], a[140:143], v[180:183], v[76:79]
    ds_read_b64_tr_b16 a[176:177], v236 offset:4096
    buffer_load_dwordx4 v14, s[24:27], s30 offen offset:0 lds
    v_mfma_f32_16x16x32_bf16 v[84:87], a[140:143], v[196:199], v[84:87]
    v_exp_f32 v39, v39
    v_mfma_f32_16x16x32_bf16 v[92:95], a[140:143], v[212:215], v[92:95]
    ds_read_b64_tr_b16 a[178:179], v236 offset:28672
    ds_read_b64_tr_b16 a[180:181], v237 offset:4096
    v_mfma_f32_16x16x32_bf16 v[64:67], a[144:147], v[168:171], v[64:67]
    v_exp_f32 v40, v40
    v_mfma_f32_16x16x32_bf16 v[72:75], a[144:147], v[184:187], v[72:75]
    ds_read_b64_tr_b16 a[182:183], v237 offset:28672
    v_cvt_pk_bf16_f32 v99, v38, v39
    v_mfma_f32_16x16x32_bf16 v[80:83], a[144:147], v[200:203], v[80:83]
    ds_read_b64_tr_b16 a[184:185], v238 offset:4096
    v_mfma_f32_16x16x32_bf16 v[88:91], a[144:147], v[216:219], v[88:91]
    v_exp_f32 v41, v41
    v_mfma_f32_16x16x32_bf16 v[68:71], a[148:151], v[168:171], v[68:71]
    ds_read_b64_tr_b16 a[186:187], v238 offset:28672
    v_cvt_pk_bf16_f32 v100, v40, v41
    v_mfma_f32_16x16x32_bf16 v[76:79], a[148:151], v[184:187], v[76:79]
    v_exp_f32 v42, v42
    v_mfma_f32_16x16x32_bf16 v[84:87], a[148:151], v[200:203], v[84:87]
    ds_read_b64_tr_b16 a[188:189], v239 offset:4096
    ds_read_b64_tr_b16 a[190:191], v239 offset:28672
    v_mfma_f32_16x16x32_bf16 v[92:95], a[148:151], v[216:219], v[92:95]
    v_exp_f32 v43, v43
    v_mfma_f32_16x16x32_bf16 v[64:67], a[152:155], v[172:175], v[64:67]
    buffer_load_dwordx4 v15, s[24:27], s30 offen offset:1024 lds
    v_cvt_pk_bf16_f32 v101, v42, v43
    v_mfma_f32_16x16x32_bf16 v[72:75], a[152:155], v[188:191], v[72:75]
    v_exp_f32 v44, v44
    v_mfma_f32_16x16x32_bf16 v[80:83], a[152:155], v[204:207], v[80:83]
    v_exp_f32 v45, v45
    v_mfma_f32_16x16x32_bf16 v[88:91], a[152:155], v[220:223], v[88:91]
    v_cvt_pk_bf16_f32 v102, v44, v45
    v_mfma_f32_16x16x32_bf16 v[68:71], a[156:159], v[172:175], v[68:71]
    v_exp_f32 v46, v46
    v_mfma_f32_16x16x32_bf16 v[76:79], a[156:159], v[188:191], v[76:79]
    v_exp_f32 v47, v47
    v_mfma_f32_16x16x32_bf16 v[84:87], a[156:159], v[204:207], v[84:87]
    v_cvt_pk_bf16_f32 v103, v46, v47
    v_mfma_f32_16x16x32_bf16 v[92:95], a[156:159], v[220:223], v[92:95]
    v_exp_f32 v48, v48
    v_mfma_f32_16x16x32_bf16 a[224:227], a[240:243], v[112:115], a[224:227]
    ds_read_b128 a[128:131], v224 offset:8192
    v_mfma_f32_16x16x32_bf16 a[228:231], a[240:243], v[116:119], a[228:231]
    v_exp_f32 v49, v49
    v_mfma_f32_16x16x32_bf16 a[232:235], a[240:243], v[120:123], a[232:235]
    buffer_load_dwordx4 v16, s[24:27], s30 offen offset:2048 lds
    v_cvt_pk_bf16_f32 v104, v48, v49
    v_mfma_f32_16x16x32_bf16 a[236:239], a[240:243], v[124:127], a[236:239]
    ds_read_b128 a[132:135], v224 offset:32768
    s_waitcnt lgkmcnt(2)
    v_mfma_f32_16x16x32_bf16 a[0:3], a[160:163], v[112:115], a[0:3]
    v_exp_f32 v50, v50
    v_mfma_f32_16x16x32_bf16 a[4:7], a[160:163], v[116:119], a[4:7]
    v_exp_f32 v51, v51
    v_mfma_f32_16x16x32_bf16 a[8:11], a[160:163], v[120:123], a[8:11]
    ds_read_b128 a[136:139], v225 offset:8192
    v_cvt_pk_bf16_f32 v105, v50, v51
    v_mfma_f32_16x16x32_bf16 a[12:15], a[160:163], v[124:127], a[12:15]
    v_exp_f32 v52, v52
    v_mfma_f32_16x16x32_bf16 a[16:19], a[164:167], v[112:115], a[16:19]
    v_exp_f32 v53, v53
    v_mfma_f32_16x16x32_bf16 a[20:23], a[164:167], v[116:119], a[20:23]
    v_cvt_pk_bf16_f32 v106, v52, v53
    v_mfma_f32_16x16x32_bf16 a[24:27], a[164:167], v[120:123], a[24:27]
    ds_read_b128 a[140:143], v225 offset:32768
    v_mfma_f32_16x16x32_bf16 a[28:31], a[164:167], v[124:127], a[28:31]
    v_exp_f32 v54, v54
    v_mfma_f32_16x16x32_bf16 a[32:35], a[168:171], v[112:115], a[32:35]
    buffer_load_dwordx4 v17, s[24:27], s30 offen offset:3072 lds
    v_mfma_f32_16x16x32_bf16 a[36:39], a[168:171], v[116:119], a[36:39]
    ds_read_b128 a[144:147], v226 offset:8192
    v_mfma_f32_16x16x32_bf16 a[40:43], a[168:171], v[120:123], a[40:43]
    v_exp_f32 v55, v55
    v_mfma_f32_16x16x32_bf16 a[44:47], a[168:171], v[124:127], a[44:47]
    v_cvt_pk_bf16_f32 v107, v54, v55
    v_mfma_f32_16x16x32_bf16 a[48:51], a[172:175], v[112:115], a[48:51]
    ds_read_b128 a[148:151], v226 offset:32768
    v_mfma_f32_16x16x32_bf16 a[52:55], a[172:175], v[116:119], a[52:55]
    v_exp_f32 v56, v56
    v_mfma_f32_16x16x32_bf16 a[56:59], a[172:175], v[120:123], a[56:59]
    v_exp_f32 v57, v57
    v_mfma_f32_16x16x32_bf16 a[60:63], a[172:175], v[124:127], a[60:63]
    v_cvt_pk_bf16_f32 v108, v56, v57
    v_mfma_f32_16x16x32_bf16 a[64:67], a[176:179], v[112:115], a[64:67]
    ds_read_b128 a[152:155], v227 offset:8192
    v_mfma_f32_16x16x32_bf16 a[68:71], a[176:179], v[116:119], a[68:71]
    v_exp_f32 v58, v58
    v_mfma_f32_16x16x32_bf16 a[72:75], a[176:179], v[120:123], a[72:75]
    v_exp_f32 v59, v59
    v_mfma_f32_16x16x32_bf16 a[76:79], a[176:179], v[124:127], a[76:79]
    s_add_u32 s30, s30, 16384
    ds_read_b128 a[156:159], v227 offset:32768
    v_mfma_f32_16x16x32_bf16 a[80:83], a[180:183], v[112:115], a[80:83]
    v_cvt_pk_bf16_f32 v109, v58, v59
    v_mfma_f32_16x16x32_bf16 a[84:87], a[180:183], v[116:119], a[84:87]
    v_exp_f32 v60, v60
    v_mfma_f32_16x16x32_bf16 a[88:91], a[180:183], v[120:123], a[88:91]
    v_exp_f32 v61, v61
    v_mfma_f32_16x16x32_bf16 a[92:95], a[180:183], v[124:127], a[92:95]
    v_cvt_pk_bf16_f32 v110, v60, v61
    v_mfma_f32_16x16x32_bf16 a[96:99], a[184:187], v[112:115], a[96:99]
    v_exp_f32 v62, v62
    v_mfma_f32_16x16x32_bf16 a[100:103], a[184:187], v[116:119], a[100:103]
    v_exp_f32 v63, v63
    v_mfma_f32_16x16x32_bf16 a[104:107], a[184:187], v[120:123], a[104:107]
    v_cvt_pk_bf16_f32 v111, v62, v63
    v_mfma_f32_16x16x32_bf16 a[108:111], a[184:187], v[124:127], a[108:111]
    v_mfma_f32_16x16x32_bf16 a[112:115], a[188:191], v[112:115], a[112:115]
    v_mfma_f32_16x16x32_bf16 a[116:119], a[188:191], v[116:119], a[116:119]
    v_mfma_f32_16x16x32_bf16 a[120:123], a[188:191], v[120:123], a[120:123]
    v_mfma_f32_16x16x32_bf16 a[124:127], a[188:191], v[124:127], a[124:127]
    s_waitcnt lgkmcnt(0)
    v_mfma_f32_16x16x32_bf16 v[32:35], a[128:131], v[160:163], v[128:131]
    v_exp_f32 v64, v64
    v_mfma_f32_16x16x32_bf16 v[40:43], a[128:131], v[176:179], v[132:135]
    ds_read_b64_tr_b16 a[160:161], v240 offset:4096
    ds_read_b64_tr_b16 a[162:163], v240 offset:28672
    v_mfma_f32_16x16x32_bf16 v[48:51], a[128:131], v[192:195], v[136:139]
    v_exp_f32 v65, v65
    v_mfma_f32_16x16x32_bf16 v[56:59], a[128:131], v[208:211], v[140:143]
    s_add_u32 m0, s33, 0
    ds_read_b64_tr_b16 a[164:165], v241 offset:4096
    v_mfma_f32_16x16x32_bf16 v[36:39], a[132:135], v[160:163], v[128:131]
    v_exp_f32 v66, v66
    v_mfma_f32_16x16x32_bf16 v[44:47], a[132:135], v[176:179], v[132:135]
    ds_read_b64_tr_b16 a[166:167], v241 offset:28672
    v_cvt_pk_bf16_f32 v112, v64, v65
    v_mfma_f32_16x16x32_bf16 v[52:55], a[132:135], v[192:195], v[136:139]
    v_exp_f32 v67, v67
    v_mfma_f32_16x16x32_bf16 v[60:63], a[132:135], v[208:211], v[140:143]
    ds_read_b64_tr_b16 a[168:169], v242 offset:4096
    ds_read_b64_tr_b16 a[170:171], v242 offset:28672
    v_mfma_f32_16x16x32_bf16 v[32:35], a[136:139], v[164:167], v[32:35]
    v_exp_f32 v68, v68
    v_mfma_f32_16x16x32_bf16 v[40:43], a[136:139], v[180:183], v[40:43]
    ds_read_b64_tr_b16 a[172:173], v243 offset:4096
    v_cvt_pk_bf16_f32 v113, v66, v67
    v_mfma_f32_16x16x32_bf16 v[48:51], a[136:139], v[196:199], v[48:51]
    v_exp_f32 v69, v69
    v_mfma_f32_16x16x32_bf16 v[56:59], a[136:139], v[212:215], v[56:59]
    ds_read_b64_tr_b16 a[174:175], v243 offset:28672
    v_cvt_pk_bf16_f32 v114, v68, v69
    v_mfma_f32_16x16x32_bf16 v[36:39], a[140:143], v[164:167], v[36:39]
    v_exp_f32 v70, v70
    v_mfma_f32_16x16x32_bf16 v[44:47], a[140:143], v[180:183], v[44:47]
    ds_read_b64_tr_b16 a[176:177], v244 offset:4096
    buffer_load_dwordx4 v22, s[16:19], s29 offen offset:0 lds
    v_mfma_f32_16x16x32_bf16 v[52:55], a[140:143], v[196:199], v[52:55]
    v_exp_f32 v71, v71
    v_mfma_f32_16x16x32_bf16 v[60:63], a[140:143], v[212:215], v[60:63]
    ds_read_b64_tr_b16 a[178:179], v244 offset:28672
    ds_read_b64_tr_b16 a[180:181], v245 offset:4096
    v_mfma_f32_16x16x32_bf16 v[32:35], a[144:147], v[168:171], v[32:35]
    v_exp_f32 v72, v72
    v_mfma_f32_16x16x32_bf16 v[40:43], a[144:147], v[184:187], v[40:43]
    ds_read_b64_tr_b16 a[182:183], v245 offset:28672
    v_cvt_pk_bf16_f32 v115, v70, v71
    v_mfma_f32_16x16x32_bf16 v[48:51], a[144:147], v[200:203], v[48:51]
    ds_read_b64_tr_b16 a[184:185], v246 offset:4096
    v_mfma_f32_16x16x32_bf16 v[56:59], a[144:147], v[216:219], v[56:59]
    v_exp_f32 v73, v73
    v_mfma_f32_16x16x32_bf16 v[36:39], a[148:151], v[168:171], v[36:39]
    ds_read_b64_tr_b16 a[186:187], v246 offset:28672
    v_cvt_pk_bf16_f32 v116, v72, v73
    v_mfma_f32_16x16x32_bf16 v[44:47], a[148:151], v[184:187], v[44:47]
    v_exp_f32 v74, v74
    v_mfma_f32_16x16x32_bf16 v[52:55], a[148:151], v[200:203], v[52:55]
    ds_read_b64_tr_b16 a[188:189], v247 offset:4096
    ds_read_b64_tr_b16 a[190:191], v247 offset:28672
    v_mfma_f32_16x16x32_bf16 v[60:63], a[148:151], v[216:219], v[60:63]
    v_exp_f32 v75, v75
    v_mfma_f32_16x16x32_bf16 v[32:35], a[152:155], v[172:175], v[32:35]
    buffer_load_dwordx4 v23, s[16:19], s29 offen offset:1024 lds
    v_cvt_pk_bf16_f32 v117, v74, v75
    v_mfma_f32_16x16x32_bf16 v[40:43], a[152:155], v[188:191], v[40:43]
    v_exp_f32 v76, v76
    v_mfma_f32_16x16x32_bf16 v[48:51], a[152:155], v[204:207], v[48:51]
    v_exp_f32 v77, v77
    v_mfma_f32_16x16x32_bf16 v[56:59], a[152:155], v[220:223], v[56:59]
    v_cvt_pk_bf16_f32 v118, v76, v77
    v_mfma_f32_16x16x32_bf16 v[36:39], a[156:159], v[172:175], v[36:39]
    v_exp_f32 v78, v78
    v_mfma_f32_16x16x32_bf16 v[44:47], a[156:159], v[188:191], v[44:47]
    v_exp_f32 v79, v79
    v_mfma_f32_16x16x32_bf16 v[52:55], a[156:159], v[204:207], v[52:55]
    v_cvt_pk_bf16_f32 v119, v78, v79
    v_mfma_f32_16x16x32_bf16 v[60:63], a[156:159], v[220:223], v[60:63]
    v_exp_f32 v80, v80
    v_mfma_f32_16x16x32_bf16 a[224:227], a[240:243], v[96:99], a[224:227]
    ds_read_b128 a[128:131], v228 offset:8192
    v_mfma_f32_16x16x32_bf16 a[228:231], a[240:243], v[100:103], a[228:231]
    v_exp_f32 v81, v81
    v_mfma_f32_16x16x32_bf16 a[232:235], a[240:243], v[104:107], a[232:235]
    buffer_load_dwordx4 v22, s[16:19], s29 offen offset:2048 lds
    v_cvt_pk_bf16_f32 v120, v80, v81
    v_mfma_f32_16x16x32_bf16 a[236:239], a[240:243], v[108:111], a[236:239]
    ds_read_b128 a[132:135], v228 offset:32768
    s_waitcnt lgkmcnt(2)
    v_mfma_f32_16x16x32_bf16 a[0:3], a[160:163], v[96:99], a[0:3]
    v_exp_f32 v82, v82
    v_mfma_f32_16x16x32_bf16 a[4:7], a[160:163], v[100:103], a[4:7]
    v_exp_f32 v83, v83
    v_mfma_f32_16x16x32_bf16 a[8:11], a[160:163], v[104:107], a[8:11]
    ds_read_b128 a[136:139], v229 offset:8192
    v_cvt_pk_bf16_f32 v121, v82, v83
    v_mfma_f32_16x16x32_bf16 a[12:15], a[160:163], v[108:111], a[12:15]
    v_exp_f32 v84, v84
    v_mfma_f32_16x16x32_bf16 a[16:19], a[164:167], v[96:99], a[16:19]
    v_exp_f32 v85, v85
    v_mfma_f32_16x16x32_bf16 a[20:23], a[164:167], v[100:103], a[20:23]
    v_cvt_pk_bf16_f32 v122, v84, v85
    v_mfma_f32_16x16x32_bf16 a[24:27], a[164:167], v[104:107], a[24:27]
    ds_read_b128 a[140:143], v229 offset:32768
    v_mfma_f32_16x16x32_bf16 a[28:31], a[164:167], v[108:111], a[28:31]
    v_exp_f32 v86, v86
    v_mfma_f32_16x16x32_bf16 a[32:35], a[168:171], v[96:99], a[32:35]
    buffer_load_dwordx4 v23, s[16:19], s29 offen offset:3072 lds
    v_mfma_f32_16x16x32_bf16 a[36:39], a[168:171], v[100:103], a[36:39]
    ds_read_b128 a[144:147], v230 offset:8192
    v_mfma_f32_16x16x32_bf16 a[40:43], a[168:171], v[104:107], a[40:43]
    v_exp_f32 v87, v87
    v_mfma_f32_16x16x32_bf16 a[44:47], a[168:171], v[108:111], a[44:47]
    v_cvt_pk_bf16_f32 v123, v86, v87
    v_mfma_f32_16x16x32_bf16 a[48:51], a[172:175], v[96:99], a[48:51]
    ds_read_b128 a[148:151], v230 offset:32768
    v_mfma_f32_16x16x32_bf16 a[52:55], a[172:175], v[100:103], a[52:55]
    v_exp_f32 v88, v88
    v_mfma_f32_16x16x32_bf16 a[56:59], a[172:175], v[104:107], a[56:59]
    v_exp_f32 v89, v89
    v_mfma_f32_16x16x32_bf16 a[60:63], a[172:175], v[108:111], a[60:63]
    v_cvt_pk_bf16_f32 v124, v88, v89
    v_mfma_f32_16x16x32_bf16 a[64:67], a[176:179], v[96:99], a[64:67]
    ds_read_b128 a[152:155], v231 offset:8192
    v_mfma_f32_16x16x32_bf16 a[68:71], a[176:179], v[100:103], a[68:71]
    v_exp_f32 v90, v90
    v_mfma_f32_16x16x32_bf16 a[72:75], a[176:179], v[104:107], a[72:75]
    v_exp_f32 v91, v91
    v_mfma_f32_16x16x32_bf16 a[76:79], a[176:179], v[108:111], a[76:79]
    s_add_u32 s29, s29, 16384
    ds_read_b128 a[156:159], v231 offset:32768
    v_mfma_f32_16x16x32_bf16 a[80:83], a[180:183], v[96:99], a[80:83]
    v_cvt_pk_bf16_f32 v125, v90, v91
    v_mfma_f32_16x16x32_bf16 a[84:87], a[180:183], v[100:103], a[84:87]
    v_exp_f32 v92, v92
    v_mfma_f32_16x16x32_bf16 a[88:91], a[180:183], v[104:107], a[88:91]
    v_exp_f32 v93, v93
    v_mfma_f32_16x16x32_bf16 a[92:95], a[180:183], v[108:111], a[92:95]
    v_cvt_pk_bf16_f32 v126, v92, v93
    v_mfma_f32_16x16x32_bf16 a[96:99], a[184:187], v[96:99], a[96:99]
    v_exp_f32 v94, v94
    v_mfma_f32_16x16x32_bf16 a[100:103], a[184:187], v[100:103], a[100:103]
    v_exp_f32 v95, v95
    v_mfma_f32_16x16x32_bf16 a[104:107], a[184:187], v[104:107], a[104:107]
    v_cvt_pk_bf16_f32 v127, v94, v95
    v_mfma_f32_16x16x32_bf16 a[108:111], a[184:187], v[108:111], a[108:111]
    v_mfma_f32_16x16x32_bf16 a[112:115], a[188:191], v[96:99], a[112:115]
    v_mfma_f32_16x16x32_bf16 a[116:119], a[188:191], v[100:103], a[116:119]
    v_mfma_f32_16x16x32_bf16 a[120:123], a[188:191], v[104:107], a[120:123]
    v_mfma_f32_16x16x32_bf16 a[124:127], a[188:191], v[108:111], a[124:127]
    s_waitcnt vmcnt(8) lgkmcnt(0)
    s_barrier
    v_mfma_f32_16x16x32_bf16 v[64:67], a[128:131], v[160:163], v[128:131]
    v_exp_f32 v32, v32
    v_mfma_f32_16x16x32_bf16 v[72:75], a[128:131], v[176:179], v[132:135]
    ds_read_b64_tr_b16 a[160:161], v232 offset:16384
    ds_read_b64_tr_b16 a[162:163], v232 offset:40960
    v_mfma_f32_16x16x32_bf16 v[80:83], a[128:131], v[192:195], v[136:139]
    v_exp_f32 v33, v33
    v_mfma_f32_16x16x32_bf16 v[88:91], a[128:131], v[208:211], v[140:143]
    s_add_u32 m0, s33, 8192
    ds_read_b64_tr_b16 a[164:165], v233 offset:16384
    v_mfma_f32_16x16x32_bf16 v[68:71], a[132:135], v[160:163], v[128:131]
    v_exp_f32 v34, v34
    v_mfma_f32_16x16x32_bf16 v[76:79], a[132:135], v[176:179], v[132:135]
    ds_read_b64_tr_b16 a[166:167], v233 offset:40960
    v_cvt_pk_bf16_f32 v96, v32, v33
    v_mfma_f32_16x16x32_bf16 v[84:87], a[132:135], v[192:195], v[136:139]
    v_exp_f32 v35, v35
    v_mfma_f32_16x16x32_bf16 v[92:95], a[132:135], v[208:211], v[140:143]
    ds_read_b64_tr_b16 a[168:169], v234 offset:16384
    ds_read_b64_tr_b16 a[170:171], v234 offset:40960
    v_mfma_f32_16x16x32_bf16 v[64:67], a[136:139], v[164:167], v[64:67]
    v_exp_f32 v36, v36
    v_mfma_f32_16x16x32_bf16 v[72:75], a[136:139], v[180:183], v[72:75]
    ds_read_b64_tr_b16 a[172:173], v235 offset:16384
    v_cvt_pk_bf16_f32 v97, v34, v35
    v_mfma_f32_16x16x32_bf16 v[80:83], a[136:139], v[196:199], v[80:83]
    v_exp_f32 v37, v37
    v_mfma_f32_16x16x32_bf16 v[88:91], a[136:139], v[212:215], v[88:91]
    ds_read_b64_tr_b16 a[174:175], v235 offset:40960
    v_cvt_pk_bf16_f32 v98, v36, v37
    v_mfma_f32_16x16x32_bf16 v[68:71], a[140:143], v[164:167], v[68:71]
    v_exp_f32 v38, v38
    v_mfma_f32_16x16x32_bf16 v[76:79], a[140:143], v[180:183], v[76:79]
    ds_read_b64_tr_b16 a[176:177], v236 offset:16384
    buffer_load_dwordx4 v14, s[24:27], s30 offen offset:0 lds
    v_mfma_f32_16x16x32_bf16 v[84:87], a[140:143], v[196:199], v[84:87]
    v_exp_f32 v39, v39
    v_mfma_f32_16x16x32_bf16 v[92:95], a[140:143], v[212:215], v[92:95]
    ds_read_b64_tr_b16 a[178:179], v236 offset:40960
    ds_read_b64_tr_b16 a[180:181], v237 offset:16384
    v_mfma_f32_16x16x32_bf16 v[64:67], a[144:147], v[168:171], v[64:67]
    v_exp_f32 v40, v40
    v_mfma_f32_16x16x32_bf16 v[72:75], a[144:147], v[184:187], v[72:75]
    ds_read_b64_tr_b16 a[182:183], v237 offset:40960
    v_cvt_pk_bf16_f32 v99, v38, v39
    v_mfma_f32_16x16x32_bf16 v[80:83], a[144:147], v[200:203], v[80:83]
    ds_read_b64_tr_b16 a[184:185], v238 offset:16384
    v_mfma_f32_16x16x32_bf16 v[88:91], a[144:147], v[216:219], v[88:91]
    v_exp_f32 v41, v41
    v_mfma_f32_16x16x32_bf16 v[68:71], a[148:151], v[168:171], v[68:71]
    ds_read_b64_tr_b16 a[186:187], v238 offset:40960
    v_cvt_pk_bf16_f32 v100, v40, v41
    v_mfma_f32_16x16x32_bf16 v[76:79], a[148:151], v[184:187], v[76:79]
    v_exp_f32 v42, v42
    v_mfma_f32_16x16x32_bf16 v[84:87], a[148:151], v[200:203], v[84:87]
    ds_read_b64_tr_b16 a[188:189], v239 offset:16384
    ds_read_b64_tr_b16 a[190:191], v239 offset:40960
    v_mfma_f32_16x16x32_bf16 v[92:95], a[148:151], v[216:219], v[92:95]
    v_exp_f32 v43, v43
    v_mfma_f32_16x16x32_bf16 v[64:67], a[152:155], v[172:175], v[64:67]
    buffer_load_dwordx4 v15, s[24:27], s30 offen offset:1024 lds
    v_cvt_pk_bf16_f32 v101, v42, v43
    v_mfma_f32_16x16x32_bf16 v[72:75], a[152:155], v[188:191], v[72:75]
    v_exp_f32 v44, v44
    v_mfma_f32_16x16x32_bf16 v[80:83], a[152:155], v[204:207], v[80:83]
    v_exp_f32 v45, v45
    v_mfma_f32_16x16x32_bf16 v[88:91], a[152:155], v[220:223], v[88:91]
    v_cvt_pk_bf16_f32 v102, v44, v45
    v_mfma_f32_16x16x32_bf16 v[68:71], a[156:159], v[172:175], v[68:71]
    v_exp_f32 v46, v46
    v_mfma_f32_16x16x32_bf16 v[76:79], a[156:159], v[188:191], v[76:79]
    v_exp_f32 v47, v47
    v_mfma_f32_16x16x32_bf16 v[84:87], a[156:159], v[204:207], v[84:87]
    v_cvt_pk_bf16_f32 v103, v46, v47
    v_mfma_f32_16x16x32_bf16 v[92:95], a[156:159], v[220:223], v[92:95]
    v_exp_f32 v48, v48
    v_mfma_f32_16x16x32_bf16 a[224:227], a[240:243], v[112:115], a[224:227]
    ds_read_b128 a[128:131], v224 offset:12288
    v_mfma_f32_16x16x32_bf16 a[228:231], a[240:243], v[116:119], a[228:231]
    v_exp_f32 v49, v49
    v_mfma_f32_16x16x32_bf16 a[232:235], a[240:243], v[120:123], a[232:235]
    buffer_load_dwordx4 v16, s[24:27], s30 offen offset:2048 lds
    v_cvt_pk_bf16_f32 v104, v48, v49
    v_mfma_f32_16x16x32_bf16 a[236:239], a[240:243], v[124:127], a[236:239]
    ds_read_b128 a[132:135], v224 offset:36864
    s_waitcnt lgkmcnt(2)
    v_mfma_f32_16x16x32_bf16 a[0:3], a[160:163], v[112:115], a[0:3]
    v_exp_f32 v50, v50
    v_mfma_f32_16x16x32_bf16 a[4:7], a[160:163], v[116:119], a[4:7]
    v_exp_f32 v51, v51
    v_mfma_f32_16x16x32_bf16 a[8:11], a[160:163], v[120:123], a[8:11]
    ds_read_b128 a[136:139], v225 offset:12288
    v_cvt_pk_bf16_f32 v105, v50, v51
    v_mfma_f32_16x16x32_bf16 a[12:15], a[160:163], v[124:127], a[12:15]
    v_exp_f32 v52, v52
    v_mfma_f32_16x16x32_bf16 a[16:19], a[164:167], v[112:115], a[16:19]
    v_exp_f32 v53, v53
    v_mfma_f32_16x16x32_bf16 a[20:23], a[164:167], v[116:119], a[20:23]
    v_cvt_pk_bf16_f32 v106, v52, v53
    v_mfma_f32_16x16x32_bf16 a[24:27], a[164:167], v[120:123], a[24:27]
    ds_read_b128 a[140:143], v225 offset:36864
    v_mfma_f32_16x16x32_bf16 a[28:31], a[164:167], v[124:127], a[28:31]
    v_exp_f32 v54, v54
    v_mfma_f32_16x16x32_bf16 a[32:35], a[168:171], v[112:115], a[32:35]
    buffer_load_dwordx4 v17, s[24:27], s30 offen offset:3072 lds
    v_mfma_f32_16x16x32_bf16 a[36:39], a[168:171], v[116:119], a[36:39]
    ds_read_b128 a[144:147], v226 offset:12288
    v_mfma_f32_16x16x32_bf16 a[40:43], a[168:171], v[120:123], a[40:43]
    v_exp_f32 v55, v55
    v_mfma_f32_16x16x32_bf16 a[44:47], a[168:171], v[124:127], a[44:47]
    v_cvt_pk_bf16_f32 v107, v54, v55
    v_mfma_f32_16x16x32_bf16 a[48:51], a[172:175], v[112:115], a[48:51]
    ds_read_b128 a[148:151], v226 offset:36864
    v_mfma_f32_16x16x32_bf16 a[52:55], a[172:175], v[116:119], a[52:55]
    v_exp_f32 v56, v56
    v_mfma_f32_16x16x32_bf16 a[56:59], a[172:175], v[120:123], a[56:59]
    v_exp_f32 v57, v57
    v_mfma_f32_16x16x32_bf16 a[60:63], a[172:175], v[124:127], a[60:63]
    v_cvt_pk_bf16_f32 v108, v56, v57
    v_mfma_f32_16x16x32_bf16 a[64:67], a[176:179], v[112:115], a[64:67]
    ds_read_b128 a[152:155], v227 offset:12288
    v_mfma_f32_16x16x32_bf16 a[68:71], a[176:179], v[116:119], a[68:71]
    v_exp_f32 v58, v58
    v_mfma_f32_16x16x32_bf16 a[72:75], a[176:179], v[120:123], a[72:75]
    v_exp_f32 v59, v59
    v_mfma_f32_16x16x32_bf16 a[76:79], a[176:179], v[124:127], a[76:79]
    s_add_u32 s30, s30, 16384
    ds_read_b128 a[156:159], v227 offset:36864
    v_mfma_f32_16x16x32_bf16 a[80:83], a[180:183], v[112:115], a[80:83]
    v_cvt_pk_bf16_f32 v109, v58, v59
    v_mfma_f32_16x16x32_bf16 a[84:87], a[180:183], v[116:119], a[84:87]
    v_exp_f32 v60, v60
    v_mfma_f32_16x16x32_bf16 a[88:91], a[180:183], v[120:123], a[88:91]
    v_exp_f32 v61, v61
    v_mfma_f32_16x16x32_bf16 a[92:95], a[180:183], v[124:127], a[92:95]
    v_cvt_pk_bf16_f32 v110, v60, v61
    v_mfma_f32_16x16x32_bf16 a[96:99], a[184:187], v[112:115], a[96:99]
    v_exp_f32 v62, v62
    v_mfma_f32_16x16x32_bf16 a[100:103], a[184:187], v[116:119], a[100:103]
    v_exp_f32 v63, v63
    v_mfma_f32_16x16x32_bf16 a[104:107], a[184:187], v[120:123], a[104:107]
    v_cvt_pk_bf16_f32 v111, v62, v63
    v_mfma_f32_16x16x32_bf16 a[108:111], a[184:187], v[124:127], a[108:111]
    v_mfma_f32_16x16x32_bf16 a[112:115], a[188:191], v[112:115], a[112:115]
    v_mfma_f32_16x16x32_bf16 a[116:119], a[188:191], v[116:119], a[116:119]
    v_mfma_f32_16x16x32_bf16 a[120:123], a[188:191], v[120:123], a[120:123]
    v_mfma_f32_16x16x32_bf16 a[124:127], a[188:191], v[124:127], a[124:127]
    s_waitcnt lgkmcnt(0)
    v_mfma_f32_16x16x32_bf16 v[32:35], a[128:131], v[160:163], v[128:131]
    v_exp_f32 v64, v64
    v_mfma_f32_16x16x32_bf16 v[40:43], a[128:131], v[176:179], v[132:135]
    ds_read_b64_tr_b16 a[160:161], v240 offset:16384
    ds_read_b64_tr_b16 a[162:163], v240 offset:40960
    v_mfma_f32_16x16x32_bf16 v[48:51], a[128:131], v[192:195], v[136:139]
    v_exp_f32 v65, v65
    v_mfma_f32_16x16x32_bf16 v[56:59], a[128:131], v[208:211], v[140:143]
    s_add_u32 m0, s33, 4096
    ds_read_b64_tr_b16 a[164:165], v241 offset:16384
    v_mfma_f32_16x16x32_bf16 v[36:39], a[132:135], v[160:163], v[128:131]
    v_exp_f32 v66, v66
    v_mfma_f32_16x16x32_bf16 v[44:47], a[132:135], v[176:179], v[132:135]
    ds_read_b64_tr_b16 a[166:167], v241 offset:40960
    v_cvt_pk_bf16_f32 v112, v64, v65
    v_mfma_f32_16x16x32_bf16 v[52:55], a[132:135], v[192:195], v[136:139]
    v_exp_f32 v67, v67
    v_mfma_f32_16x16x32_bf16 v[60:63], a[132:135], v[208:211], v[140:143]
    ds_read_b64_tr_b16 a[168:169], v242 offset:16384
    ds_read_b64_tr_b16 a[170:171], v242 offset:40960
    v_mfma_f32_16x16x32_bf16 v[32:35], a[136:139], v[164:167], v[32:35]
    v_exp_f32 v68, v68
    v_mfma_f32_16x16x32_bf16 v[40:43], a[136:139], v[180:183], v[40:43]
    ds_read_b64_tr_b16 a[172:173], v243 offset:16384
    v_cvt_pk_bf16_f32 v113, v66, v67
    v_mfma_f32_16x16x32_bf16 v[48:51], a[136:139], v[196:199], v[48:51]
    v_exp_f32 v69, v69
    v_mfma_f32_16x16x32_bf16 v[56:59], a[136:139], v[212:215], v[56:59]
    ds_read_b64_tr_b16 a[174:175], v243 offset:40960
    v_cvt_pk_bf16_f32 v114, v68, v69
    v_mfma_f32_16x16x32_bf16 v[36:39], a[140:143], v[164:167], v[36:39]
    v_exp_f32 v70, v70
    v_mfma_f32_16x16x32_bf16 v[44:47], a[140:143], v[180:183], v[44:47]
    ds_read_b64_tr_b16 a[176:177], v244 offset:16384
    buffer_load_dwordx4 v22, s[16:19], s29 offen offset:0 lds
    v_mfma_f32_16x16x32_bf16 v[52:55], a[140:143], v[196:199], v[52:55]
    v_exp_f32 v71, v71
    v_mfma_f32_16x16x32_bf16 v[60:63], a[140:143], v[212:215], v[60:63]
    ds_read_b64_tr_b16 a[178:179], v244 offset:40960
    ds_read_b64_tr_b16 a[180:181], v245 offset:16384
    v_mfma_f32_16x16x32_bf16 v[32:35], a[144:147], v[168:171], v[32:35]
    v_exp_f32 v72, v72
    v_mfma_f32_16x16x32_bf16 v[40:43], a[144:147], v[184:187], v[40:43]
    ds_read_b64_tr_b16 a[182:183], v245 offset:40960
    v_cvt_pk_bf16_f32 v115, v70, v71
    v_mfma_f32_16x16x32_bf16 v[48:51], a[144:147], v[200:203], v[48:51]
    ds_read_b64_tr_b16 a[184:185], v246 offset:16384
    v_mfma_f32_16x16x32_bf16 v[56:59], a[144:147], v[216:219], v[56:59]
    v_exp_f32 v73, v73
    v_mfma_f32_16x16x32_bf16 v[36:39], a[148:151], v[168:171], v[36:39]
    ds_read_b64_tr_b16 a[186:187], v246 offset:40960
    v_cvt_pk_bf16_f32 v116, v72, v73
    v_mfma_f32_16x16x32_bf16 v[44:47], a[148:151], v[184:187], v[44:47]
    v_exp_f32 v74, v74
    v_mfma_f32_16x16x32_bf16 v[52:55], a[148:151], v[200:203], v[52:55]
    ds_read_b64_tr_b16 a[188:189], v247 offset:16384
    ds_read_b64_tr_b16 a[190:191], v247 offset:40960
    v_mfma_f32_16x16x32_bf16 v[60:63], a[148:151], v[216:219], v[60:63]
    v_exp_f32 v75, v75
    v_mfma_f32_16x16x32_bf16 v[32:35], a[152:155], v[172:175], v[32:35]
    buffer_load_dwordx4 v23, s[16:19], s29 offen offset:1024 lds
    v_cvt_pk_bf16_f32 v117, v74, v75
    v_mfma_f32_16x16x32_bf16 v[40:43], a[152:155], v[188:191], v[40:43]
    v_exp_f32 v76, v76
    v_mfma_f32_16x16x32_bf16 v[48:51], a[152:155], v[204:207], v[48:51]
    v_exp_f32 v77, v77
    v_mfma_f32_16x16x32_bf16 v[56:59], a[152:155], v[220:223], v[56:59]
    v_cvt_pk_bf16_f32 v118, v76, v77
    v_mfma_f32_16x16x32_bf16 v[36:39], a[156:159], v[172:175], v[36:39]
    v_exp_f32 v78, v78
    v_mfma_f32_16x16x32_bf16 v[44:47], a[156:159], v[188:191], v[44:47]
    v_exp_f32 v79, v79
    v_mfma_f32_16x16x32_bf16 v[52:55], a[156:159], v[204:207], v[52:55]
    v_cvt_pk_bf16_f32 v119, v78, v79
    v_mfma_f32_16x16x32_bf16 v[60:63], a[156:159], v[220:223], v[60:63]
    v_exp_f32 v80, v80
    v_mfma_f32_16x16x32_bf16 a[224:227], a[240:243], v[96:99], a[224:227]
    ds_read_b128 a[128:131], v228 offset:12288
    v_mfma_f32_16x16x32_bf16 a[228:231], a[240:243], v[100:103], a[228:231]
    v_exp_f32 v81, v81
    v_mfma_f32_16x16x32_bf16 a[232:235], a[240:243], v[104:107], a[232:235]
    buffer_load_dwordx4 v22, s[16:19], s29 offen offset:2048 lds
    v_cvt_pk_bf16_f32 v120, v80, v81
    v_mfma_f32_16x16x32_bf16 a[236:239], a[240:243], v[108:111], a[236:239]
    ds_read_b128 a[132:135], v228 offset:36864
    s_waitcnt lgkmcnt(2)
    v_mfma_f32_16x16x32_bf16 a[0:3], a[160:163], v[96:99], a[0:3]
    v_exp_f32 v82, v82
    v_mfma_f32_16x16x32_bf16 a[4:7], a[160:163], v[100:103], a[4:7]
    v_exp_f32 v83, v83
    v_mfma_f32_16x16x32_bf16 a[8:11], a[160:163], v[104:107], a[8:11]
    ds_read_b128 a[136:139], v229 offset:12288
    v_cvt_pk_bf16_f32 v121, v82, v83
    v_mfma_f32_16x16x32_bf16 a[12:15], a[160:163], v[108:111], a[12:15]
    v_exp_f32 v84, v84
    v_mfma_f32_16x16x32_bf16 a[16:19], a[164:167], v[96:99], a[16:19]
    v_exp_f32 v85, v85
    v_mfma_f32_16x16x32_bf16 a[20:23], a[164:167], v[100:103], a[20:23]
    v_cvt_pk_bf16_f32 v122, v84, v85
    v_mfma_f32_16x16x32_bf16 a[24:27], a[164:167], v[104:107], a[24:27]
    ds_read_b128 a[140:143], v229 offset:36864
    v_mfma_f32_16x16x32_bf16 a[28:31], a[164:167], v[108:111], a[28:31]
    v_exp_f32 v86, v86
    v_mfma_f32_16x16x32_bf16 a[32:35], a[168:171], v[96:99], a[32:35]
    buffer_load_dwordx4 v23, s[16:19], s29 offen offset:3072 lds
    v_mfma_f32_16x16x32_bf16 a[36:39], a[168:171], v[100:103], a[36:39]
    ds_read_b128 a[144:147], v230 offset:12288
    v_mfma_f32_16x16x32_bf16 a[40:43], a[168:171], v[104:107], a[40:43]
    v_exp_f32 v87, v87
    v_mfma_f32_16x16x32_bf16 a[44:47], a[168:171], v[108:111], a[44:47]
    v_cvt_pk_bf16_f32 v123, v86, v87
    v_mfma_f32_16x16x32_bf16 a[48:51], a[172:175], v[96:99], a[48:51]
    ds_read_b128 a[148:151], v230 offset:36864
    v_mfma_f32_16x16x32_bf16 a[52:55], a[172:175], v[100:103], a[52:55]
    v_exp_f32 v88, v88
    v_mfma_f32_16x16x32_bf16 a[56:59], a[172:175], v[104:107], a[56:59]
    v_exp_f32 v89, v89
    v_mfma_f32_16x16x32_bf16 a[60:63], a[172:175], v[108:111], a[60:63]
    v_cvt_pk_bf16_f32 v124, v88, v89
    v_mfma_f32_16x16x32_bf16 a[64:67], a[176:179], v[96:99], a[64:67]
    ds_read_b128 a[152:155], v231 offset:12288
    v_mfma_f32_16x16x32_bf16 a[68:71], a[176:179], v[100:103], a[68:71]
    v_exp_f32 v90, v90
    v_mfma_f32_16x16x32_bf16 a[72:75], a[176:179], v[104:107], a[72:75]
    v_exp_f32 v91, v91
    v_mfma_f32_16x16x32_bf16 a[76:79], a[176:179], v[108:111], a[76:79]
    s_add_u32 s29, s29, 16384
    ds_read_b128 a[156:159], v231 offset:36864
    v_mfma_f32_16x16x32_bf16 a[80:83], a[180:183], v[96:99], a[80:83]
    v_cvt_pk_bf16_f32 v125, v90, v91
    v_mfma_f32_16x16x32_bf16 a[84:87], a[180:183], v[100:103], a[84:87]
    v_exp_f32 v92, v92
    v_mfma_f32_16x16x32_bf16 a[88:91], a[180:183], v[104:107], a[88:91]
    v_exp_f32 v93, v93
    v_mfma_f32_16x16x32_bf16 a[92:95], a[180:183], v[108:111], a[92:95]
    v_cvt_pk_bf16_f32 v126, v92, v93
    v_mfma_f32_16x16x32_bf16 a[96:99], a[184:187], v[96:99], a[96:99]
    v_exp_f32 v94, v94
    v_mfma_f32_16x16x32_bf16 a[100:103], a[184:187], v[100:103], a[100:103]
    v_exp_f32 v95, v95
    v_mfma_f32_16x16x32_bf16 a[104:107], a[184:187], v[104:107], a[104:107]
    v_cvt_pk_bf16_f32 v127, v94, v95
    v_mfma_f32_16x16x32_bf16 a[108:111], a[184:187], v[108:111], a[108:111]
    v_mfma_f32_16x16x32_bf16 a[112:115], a[188:191], v[96:99], a[112:115]
    v_mfma_f32_16x16x32_bf16 a[116:119], a[188:191], v[100:103], a[116:119]
    v_mfma_f32_16x16x32_bf16 a[120:123], a[188:191], v[104:107], a[120:123]
    v_mfma_f32_16x16x32_bf16 a[124:127], a[188:191], v[108:111], a[124:127]
    s_waitcnt vmcnt(8) lgkmcnt(0)
    s_barrier
    v_mfma_f32_16x16x32_bf16 v[64:67], a[128:131], v[160:163], v[128:131]
    v_exp_f32 v32, v32
    v_mfma_f32_16x16x32_bf16 v[72:75], a[128:131], v[176:179], v[132:135]
    ds_read_b64_tr_b16 a[160:161], v232 offset:0
    ds_read_b64_tr_b16 a[162:163], v232 offset:24576
    v_mfma_f32_16x16x32_bf16 v[80:83], a[128:131], v[192:195], v[136:139]
    v_exp_f32 v33, v33
    v_mfma_f32_16x16x32_bf16 v[88:91], a[128:131], v[208:211], v[140:143]
    s_add_u32 m0, s33, 12288
    ds_read_b64_tr_b16 a[164:165], v233 offset:0
    v_mfma_f32_16x16x32_bf16 v[68:71], a[132:135], v[160:163], v[128:131]
    v_exp_f32 v34, v34
    v_mfma_f32_16x16x32_bf16 v[76:79], a[132:135], v[176:179], v[132:135]
    ds_read_b64_tr_b16 a[166:167], v233 offset:24576
    v_cvt_pk_bf16_f32 v96, v32, v33
    v_mfma_f32_16x16x32_bf16 v[84:87], a[132:135], v[192:195], v[136:139]
    v_exp_f32 v35, v35
    v_mfma_f32_16x16x32_bf16 v[92:95], a[132:135], v[208:211], v[140:143]
    ds_read_b64_tr_b16 a[168:169], v234 offset:0
    ds_read_b64_tr_b16 a[170:171], v234 offset:24576
    v_mfma_f32_16x16x32_bf16 v[64:67], a[136:139], v[164:167], v[64:67]
    v_exp_f32 v36, v36
    v_mfma_f32_16x16x32_bf16 v[72:75], a[136:139], v[180:183], v[72:75]
    ds_read_b64_tr_b16 a[172:173], v235 offset:0
    v_cvt_pk_bf16_f32 v97, v34, v35
    v_mfma_f32_16x16x32_bf16 v[80:83], a[136:139], v[196:199], v[80:83]
    v_exp_f32 v37, v37
    v_mfma_f32_16x16x32_bf16 v[88:91], a[136:139], v[212:215], v[88:91]
    ds_read_b64_tr_b16 a[174:175], v235 offset:24576
    v_cvt_pk_bf16_f32 v98, v36, v37
    v_mfma_f32_16x16x32_bf16 v[68:71], a[140:143], v[164:167], v[68:71]
    v_exp_f32 v38, v38
    v_mfma_f32_16x16x32_bf16 v[76:79], a[140:143], v[180:183], v[76:79]
    ds_read_b64_tr_b16 a[176:177], v236 offset:0
    buffer_load_dwordx4 v14, s[24:27], s30 offen offset:0 lds
    v_mfma_f32_16x16x32_bf16 v[84:87], a[140:143], v[196:199], v[84:87]
    v_exp_f32 v39, v39
    v_mfma_f32_16x16x32_bf16 v[92:95], a[140:143], v[212:215], v[92:95]
    ds_read_b64_tr_b16 a[178:179], v236 offset:24576
    ds_read_b64_tr_b16 a[180:181], v237 offset:0
    v_mfma_f32_16x16x32_bf16 v[64:67], a[144:147], v[168:171], v[64:67]
    v_exp_f32 v40, v40
    v_mfma_f32_16x16x32_bf16 v[72:75], a[144:147], v[184:187], v[72:75]
    ds_read_b64_tr_b16 a[182:183], v237 offset:24576
    v_cvt_pk_bf16_f32 v99, v38, v39
    v_mfma_f32_16x16x32_bf16 v[80:83], a[144:147], v[200:203], v[80:83]
    ds_read_b64_tr_b16 a[184:185], v238 offset:0
    v_mfma_f32_16x16x32_bf16 v[88:91], a[144:147], v[216:219], v[88:91]
    v_exp_f32 v41, v41
    v_mfma_f32_16x16x32_bf16 v[68:71], a[148:151], v[168:171], v[68:71]
    ds_read_b64_tr_b16 a[186:187], v238 offset:24576
    v_cvt_pk_bf16_f32 v100, v40, v41
    v_mfma_f32_16x16x32_bf16 v[76:79], a[148:151], v[184:187], v[76:79]
    v_exp_f32 v42, v42
    v_mfma_f32_16x16x32_bf16 v[84:87], a[148:151], v[200:203], v[84:87]
    ds_read_b64_tr_b16 a[188:189], v239 offset:0
    ds_read_b64_tr_b16 a[190:191], v239 offset:24576
    v_mfma_f32_16x16x32_bf16 v[92:95], a[148:151], v[216:219], v[92:95]
    v_exp_f32 v43, v43
    v_mfma_f32_16x16x32_bf16 v[64:67], a[152:155], v[172:175], v[64:67]
    buffer_load_dwordx4 v15, s[24:27], s30 offen offset:1024 lds
    v_cvt_pk_bf16_f32 v101, v42, v43
    v_mfma_f32_16x16x32_bf16 v[72:75], a[152:155], v[188:191], v[72:75]
    v_exp_f32 v44, v44
    v_mfma_f32_16x16x32_bf16 v[80:83], a[152:155], v[204:207], v[80:83]
    v_exp_f32 v45, v45
    v_mfma_f32_16x16x32_bf16 v[88:91], a[152:155], v[220:223], v[88:91]
    v_cvt_pk_bf16_f32 v102, v44, v45
    v_mfma_f32_16x16x32_bf16 v[68:71], a[156:159], v[172:175], v[68:71]
    v_exp_f32 v46, v46
    v_mfma_f32_16x16x32_bf16 v[76:79], a[156:159], v[188:191], v[76:79]
    v_exp_f32 v47, v47
    v_mfma_f32_16x16x32_bf16 v[84:87], a[156:159], v[204:207], v[84:87]
    v_cvt_pk_bf16_f32 v103, v46, v47
    v_mfma_f32_16x16x32_bf16 v[92:95], a[156:159], v[220:223], v[92:95]
    v_exp_f32 v48, v48
    v_mfma_f32_16x16x32_bf16 a[224:227], a[240:243], v[112:115], a[224:227]
    v_exp_f32 v49, v49
    v_mfma_f32_16x16x32_bf16 a[228:231], a[240:243], v[116:119], a[228:231]
    v_cvt_pk_bf16_f32 v104, v48, v49
    v_mfma_f32_16x16x32_bf16 a[232:235], a[240:243], v[120:123], a[232:235]
    buffer_load_dwordx4 v16, s[24:27], s30 offen offset:2048 lds
    v_mfma_f32_16x16x32_bf16 a[236:239], a[240:243], v[124:127], a[236:239]
    s_waitcnt lgkmcnt(0)
    v_mfma_f32_16x16x32_bf16 a[0:3], a[160:163], v[112:115], a[0:3]
    v_exp_f32 v50, v50
    v_mfma_f32_16x16x32_bf16 a[4:7], a[160:163], v[116:119], a[4:7]
    v_exp_f32 v51, v51
    v_mfma_f32_16x16x32_bf16 a[8:11], a[160:163], v[120:123], a[8:11]
    v_cvt_pk_bf16_f32 v105, v50, v51
    v_mfma_f32_16x16x32_bf16 a[12:15], a[160:163], v[124:127], a[12:15]
    v_exp_f32 v52, v52
    v_mfma_f32_16x16x32_bf16 a[16:19], a[164:167], v[112:115], a[16:19]
    v_exp_f32 v53, v53
    v_mfma_f32_16x16x32_bf16 a[20:23], a[164:167], v[116:119], a[20:23]
    v_cvt_pk_bf16_f32 v106, v52, v53
    v_mfma_f32_16x16x32_bf16 a[24:27], a[164:167], v[120:123], a[24:27]
    v_exp_f32 v54, v54
    v_mfma_f32_16x16x32_bf16 a[28:31], a[164:167], v[124:127], a[28:31]
    v_exp_f32 v55, v55
    v_mfma_f32_16x16x32_bf16 a[32:35], a[168:171], v[112:115], a[32:35]
    buffer_load_dwordx4 v17, s[24:27], s30 offen offset:3072 lds
    v_cvt_pk_bf16_f32 v107, v54, v55
    v_mfma_f32_16x16x32_bf16 a[36:39], a[168:171], v[116:119], a[36:39]
    v_exp_f32 v56, v56
    v_mfma_f32_16x16x32_bf16 a[40:43], a[168:171], v[120:123], a[40:43]
    v_exp_f32 v57, v57
    v_mfma_f32_16x16x32_bf16 a[44:47], a[168:171], v[124:127], a[44:47]
    v_cvt_pk_bf16_f32 v108, v56, v57
    v_mfma_f32_16x16x32_bf16 a[48:51], a[172:175], v[112:115], a[48:51]
    v_exp_f32 v58, v58
    v_mfma_f32_16x16x32_bf16 a[52:55], a[172:175], v[116:119], a[52:55]
    v_exp_f32 v59, v59
    v_mfma_f32_16x16x32_bf16 a[56:59], a[172:175], v[120:123], a[56:59]
    v_cvt_pk_bf16_f32 v109, v58, v59
    v_mfma_f32_16x16x32_bf16 a[60:63], a[172:175], v[124:127], a[60:63]
    v_exp_f32 v60, v60
    v_mfma_f32_16x16x32_bf16 a[64:67], a[176:179], v[112:115], a[64:67]
    v_exp_f32 v61, v61
    v_mfma_f32_16x16x32_bf16 a[68:71], a[176:179], v[116:119], a[68:71]
    v_cvt_pk_bf16_f32 v110, v60, v61
    v_mfma_f32_16x16x32_bf16 a[72:75], a[176:179], v[120:123], a[72:75]
    v_exp_f32 v62, v62
    v_mfma_f32_16x16x32_bf16 a[76:79], a[176:179], v[124:127], a[76:79]
    s_add_u32 s30, s30, 16384
    v_mfma_f32_16x16x32_bf16 a[80:83], a[180:183], v[112:115], a[80:83]
    v_exp_f32 v63, v63
    v_mfma_f32_16x16x32_bf16 a[84:87], a[180:183], v[116:119], a[84:87]
    v_cvt_pk_bf16_f32 v111, v62, v63
    v_mfma_f32_16x16x32_bf16 a[88:91], a[180:183], v[120:123], a[88:91]
    v_mfma_f32_16x16x32_bf16 a[92:95], a[180:183], v[124:127], a[92:95]
    v_mfma_f32_16x16x32_bf16 a[96:99], a[184:187], v[112:115], a[96:99]
    v_mfma_f32_16x16x32_bf16 a[100:103], a[184:187], v[116:119], a[100:103]
    v_mfma_f32_16x16x32_bf16 a[104:107], a[184:187], v[120:123], a[104:107]
    v_mfma_f32_16x16x32_bf16 a[108:111], a[184:187], v[124:127], a[108:111]
    v_mfma_f32_16x16x32_bf16 a[112:115], a[188:191], v[112:115], a[112:115]
    v_mfma_f32_16x16x32_bf16 a[116:119], a[188:191], v[116:119], a[116:119]
    v_mfma_f32_16x16x32_bf16 a[120:123], a[188:191], v[120:123], a[120:123]
    v_mfma_f32_16x16x32_bf16 a[124:127], a[188:191], v[124:127], a[124:127]
    s_waitcnt lgkmcnt(0)
    v_exp_f32 v64, v64
    ds_read_b64_tr_b16 a[160:161], v240 offset:0
    ds_read_b64_tr_b16 a[162:163], v240 offset:24576
    v_exp_f32 v65, v65
    s_add_u32 m0, s33, 16384
    ds_read_b64_tr_b16 a[164:165], v241 offset:0
    v_exp_f32 v66, v66
    ds_read_b64_tr_b16 a[166:167], v241 offset:24576
    v_cvt_pk_bf16_f32 v112, v64, v65
    v_exp_f32 v67, v67
    ds_read_b64_tr_b16 a[168:169], v242 offset:0
    ds_read_b64_tr_b16 a[170:171], v242 offset:24576
    v_exp_f32 v68, v68
    ds_read_b64_tr_b16 a[172:173], v243 offset:0
    v_cvt_pk_bf16_f32 v113, v66, v67
    v_exp_f32 v69, v69
    ds_read_b64_tr_b16 a[174:175], v243 offset:24576
    v_cvt_pk_bf16_f32 v114, v68, v69
    v_exp_f32 v70, v70
    ds_read_b64_tr_b16 a[176:177], v244 offset:0
    buffer_load_dwordx4 v14, s[24:27], s30 offen offset:0 lds
    v_exp_f32 v71, v71
    ds_read_b64_tr_b16 a[178:179], v244 offset:24576
    ds_read_b64_tr_b16 a[180:181], v245 offset:0
    v_exp_f32 v72, v72
    ds_read_b64_tr_b16 a[182:183], v245 offset:24576
    v_cvt_pk_bf16_f32 v115, v70, v71
    ds_read_b64_tr_b16 a[184:185], v246 offset:0
    v_exp_f32 v73, v73
    ds_read_b64_tr_b16 a[186:187], v246 offset:24576
    v_cvt_pk_bf16_f32 v116, v72, v73
    v_exp_f32 v74, v74
    ds_read_b64_tr_b16 a[188:189], v247 offset:0
    ds_read_b64_tr_b16 a[190:191], v247 offset:24576
    v_exp_f32 v75, v75
    buffer_load_dwordx4 v15, s[24:27], s30 offen offset:1024 lds
    v_cvt_pk_bf16_f32 v117, v74, v75
    v_exp_f32 v76, v76
    v_exp_f32 v77, v77
    s_nop 0
    v_cvt_pk_bf16_f32 v118, v76, v77
    v_exp_f32 v78, v78
    v_exp_f32 v79, v79
    s_nop 0
    v_cvt_pk_bf16_f32 v119, v78, v79
    v_exp_f32 v80, v80
    v_mfma_f32_16x16x32_bf16 a[224:227], a[240:243], v[96:99], a[224:227]
    v_exp_f32 v81, v81
    v_mfma_f32_16x16x32_bf16 a[228:231], a[240:243], v[100:103], a[228:231]
    v_cvt_pk_bf16_f32 v120, v80, v81
    v_mfma_f32_16x16x32_bf16 a[232:235], a[240:243], v[104:107], a[232:235]
    buffer_load_dwordx4 v16, s[24:27], s30 offen offset:2048 lds
    v_mfma_f32_16x16x32_bf16 a[236:239], a[240:243], v[108:111], a[236:239]
    s_waitcnt lgkmcnt(0)
    v_mfma_f32_16x16x32_bf16 a[0:3], a[160:163], v[96:99], a[0:3]
    v_exp_f32 v82, v82
    v_mfma_f32_16x16x32_bf16 a[4:7], a[160:163], v[100:103], a[4:7]
    v_exp_f32 v83, v83
    v_mfma_f32_16x16x32_bf16 a[8:11], a[160:163], v[104:107], a[8:11]
    v_cvt_pk_bf16_f32 v121, v82, v83
    v_mfma_f32_16x16x32_bf16 a[12:15], a[160:163], v[108:111], a[12:15]
    v_exp_f32 v84, v84
    v_mfma_f32_16x16x32_bf16 a[16:19], a[164:167], v[96:99], a[16:19]
    v_exp_f32 v85, v85
    v_mfma_f32_16x16x32_bf16 a[20:23], a[164:167], v[100:103], a[20:23]
    v_cvt_pk_bf16_f32 v122, v84, v85
    v_mfma_f32_16x16x32_bf16 a[24:27], a[164:167], v[104:107], a[24:27]
    v_exp_f32 v86, v86
    v_mfma_f32_16x16x32_bf16 a[28:31], a[164:167], v[108:111], a[28:31]
    v_exp_f32 v87, v87
    v_mfma_f32_16x16x32_bf16 a[32:35], a[168:171], v[96:99], a[32:35]
    buffer_load_dwordx4 v17, s[24:27], s30 offen offset:3072 lds
    v_cvt_pk_bf16_f32 v123, v86, v87
    v_mfma_f32_16x16x32_bf16 a[36:39], a[168:171], v[100:103], a[36:39]
    v_exp_f32 v88, v88
    v_mfma_f32_16x16x32_bf16 a[40:43], a[168:171], v[104:107], a[40:43]
    v_exp_f32 v89, v89
    v_mfma_f32_16x16x32_bf16 a[44:47], a[168:171], v[108:111], a[44:47]
    v_cvt_pk_bf16_f32 v124, v88, v89
    v_mfma_f32_16x16x32_bf16 a[48:51], a[172:175], v[96:99], a[48:51]
    v_exp_f32 v90, v90
    v_mfma_f32_16x16x32_bf16 a[52:55], a[172:175], v[100:103], a[52:55]
    v_exp_f32 v91, v91
    v_mfma_f32_16x16x32_bf16 a[56:59], a[172:175], v[104:107], a[56:59]
    v_cvt_pk_bf16_f32 v125, v90, v91
    v_mfma_f32_16x16x32_bf16 a[60:63], a[172:175], v[108:111], a[60:63]
    v_exp_f32 v92, v92
    v_mfma_f32_16x16x32_bf16 a[64:67], a[176:179], v[96:99], a[64:67]
    v_exp_f32 v93, v93
    v_mfma_f32_16x16x32_bf16 a[68:71], a[176:179], v[100:103], a[68:71]
    v_cvt_pk_bf16_f32 v126, v92, v93
    v_mfma_f32_16x16x32_bf16 a[72:75], a[176:179], v[104:107], a[72:75]
    v_exp_f32 v94, v94
    v_mfma_f32_16x16x32_bf16 a[76:79], a[176:179], v[108:111], a[76:79]
    s_add_u32 s30, s30, 16384
    v_mfma_f32_16x16x32_bf16 a[80:83], a[180:183], v[96:99], a[80:83]
    v_exp_f32 v95, v95
    v_mfma_f32_16x16x32_bf16 a[84:87], a[180:183], v[100:103], a[84:87]
    v_cvt_pk_bf16_f32 v127, v94, v95
    v_mfma_f32_16x16x32_bf16 a[88:91], a[180:183], v[104:107], a[88:91]
    v_mfma_f32_16x16x32_bf16 a[92:95], a[180:183], v[108:111], a[92:95]
    v_mfma_f32_16x16x32_bf16 a[96:99], a[184:187], v[96:99], a[96:99]
    v_mfma_f32_16x16x32_bf16 a[100:103], a[184:187], v[100:103], a[100:103]
    v_mfma_f32_16x16x32_bf16 a[104:107], a[184:187], v[104:107], a[104:107]
    v_mfma_f32_16x16x32_bf16 a[108:111], a[184:187], v[108:111], a[108:111]
    v_mfma_f32_16x16x32_bf16 a[112:115], a[188:191], v[96:99], a[112:115]
    v_mfma_f32_16x16x32_bf16 a[116:119], a[188:191], v[100:103], a[116:119]
    v_mfma_f32_16x16x32_bf16 a[120:123], a[188:191], v[104:107], a[120:123]
    v_mfma_f32_16x16x32_bf16 a[124:127], a[188:191], v[108:111], a[124:127]
    s_waitcnt vmcnt(8) lgkmcnt(0)
    s_barrier
    ds_read_b64_tr_b16 a[160:161], v232 offset:4096
    ds_read_b64_tr_b16 a[162:163], v232 offset:28672
    s_add_u32 m0, s33, 0
    ds_read_b64_tr_b16 a[164:165], v233 offset:4096
    ds_read_b64_tr_b16 a[166:167], v233 offset:28672
    ds_read_b64_tr_b16 a[168:169], v234 offset:4096
    ds_read_b64_tr_b16 a[170:171], v234 offset:28672
    ds_read_b64_tr_b16 a[172:173], v235 offset:4096
    ds_read_b64_tr_b16 a[174:175], v235 offset:28672
    ds_read_b64_tr_b16 a[176:177], v236 offset:4096
    buffer_load_dwordx4 v14, s[24:27], s30 offen offset:0 lds
    ds_read_b64_tr_b16 a[178:179], v236 offset:28672
    ds_read_b64_tr_b16 a[180:181], v237 offset:4096
    ds_read_b64_tr_b16 a[182:183], v237 offset:28672
    ds_read_b64_tr_b16 a[184:185], v238 offset:4096
    ds_read_b64_tr_b16 a[186:187], v238 offset:28672
    ds_read_b64_tr_b16 a[188:189], v239 offset:4096
    ds_read_b64_tr_b16 a[190:191], v239 offset:28672
    buffer_load_dwordx4 v15, s[24:27], s30 offen offset:1024 lds
    v_mfma_f32_16x16x32_bf16 a[224:227], a[240:243], v[112:115], a[224:227]
    v_mfma_f32_16x16x32_bf16 a[228:231], a[240:243], v[116:119], a[228:231]
    v_mfma_f32_16x16x32_bf16 a[232:235], a[240:243], v[120:123], a[232:235]
    buffer_load_dwordx4 v16, s[24:27], s30 offen offset:2048 lds
    v_mfma_f32_16x16x32_bf16 a[236:239], a[240:243], v[124:127], a[236:239]
    s_waitcnt lgkmcnt(0)
    v_mfma_f32_16x16x32_bf16 a[0:3], a[160:163], v[112:115], a[0:3]
    v_mfma_f32_16x16x32_bf16 a[4:7], a[160:163], v[116:119], a[4:7]
    v_mfma_f32_16x16x32_bf16 a[8:11], a[160:163], v[120:123], a[8:11]
    v_mfma_f32_16x16x32_bf16 a[12:15], a[160:163], v[124:127], a[12:15]
    v_mfma_f32_16x16x32_bf16 a[16:19], a[164:167], v[112:115], a[16:19]
    v_mfma_f32_16x16x32_bf16 a[20:23], a[164:167], v[116:119], a[20:23]
    v_mfma_f32_16x16x32_bf16 a[24:27], a[164:167], v[120:123], a[24:27]
    v_mfma_f32_16x16x32_bf16 a[28:31], a[164:167], v[124:127], a[28:31]
    v_mfma_f32_16x16x32_bf16 a[32:35], a[168:171], v[112:115], a[32:35]
    buffer_load_dwordx4 v17, s[24:27], s30 offen offset:3072 lds
    v_mfma_f32_16x16x32_bf16 a[36:39], a[168:171], v[116:119], a[36:39]
    v_mfma_f32_16x16x32_bf16 a[40:43], a[168:171], v[120:123], a[40:43]
    v_mfma_f32_16x16x32_bf16 a[44:47], a[168:171], v[124:127], a[44:47]
    v_mfma_f32_16x16x32_bf16 a[48:51], a[172:175], v[112:115], a[48:51]
    v_mfma_f32_16x16x32_bf16 a[52:55], a[172:175], v[116:119], a[52:55]
    v_mfma_f32_16x16x32_bf16 a[56:59], a[172:175], v[120:123], a[56:59]
    v_mfma_f32_16x16x32_bf16 a[60:63], a[172:175], v[124:127], a[60:63]
    v_mfma_f32_16x16x32_bf16 a[64:67], a[176:179], v[112:115], a[64:67]
    v_mfma_f32_16x16x32_bf16 a[68:71], a[176:179], v[116:119], a[68:71]
    v_mfma_f32_16x16x32_bf16 a[72:75], a[176:179], v[120:123], a[72:75]
    v_mfma_f32_16x16x32_bf16 a[76:79], a[176:179], v[124:127], a[76:79]
    s_add_u32 s30, s30, 16384
    v_mfma_f32_16x16x32_bf16 a[80:83], a[180:183], v[112:115], a[80:83]
    v_mfma_f32_16x16x32_bf16 a[84:87], a[180:183], v[116:119], a[84:87]
    v_mfma_f32_16x16x32_bf16 a[88:91], a[180:183], v[120:123], a[88:91]
    v_mfma_f32_16x16x32_bf16 a[92:95], a[180:183], v[124:127], a[92:95]
    v_mfma_f32_16x16x32_bf16 a[96:99], a[184:187], v[112:115], a[96:99]
    v_mfma_f32_16x16x32_bf16 a[100:103], a[184:187], v[116:119], a[100:103]
    v_mfma_f32_16x16x32_bf16 a[104:107], a[184:187], v[120:123], a[104:107]
    v_mfma_f32_16x16x32_bf16 a[108:111], a[184:187], v[124:127], a[108:111]
    v_mfma_f32_16x16x32_bf16 a[112:115], a[188:191], v[112:115], a[112:115]
    v_mfma_f32_16x16x32_bf16 a[116:119], a[188:191], v[116:119], a[116:119]
    v_mfma_f32_16x16x32_bf16 a[120:123], a[188:191], v[120:123], a[120:123]
    v_mfma_f32_16x16x32_bf16 a[124:127], a[188:191], v[124:127], a[124:127]
    s_mov_b32 s6, 30000
    s_nop 0
K1_LT0:
    v_cmp_gt_u32 vcc, 85, v253
    s_sub_u32 s6, s6, 1
    s_cbranch_vccz K1_LT1
    s_cmp_eq_u32 s6, 0
    s_cbranch_scc1 K1_LT1
    buffer_load_dword v253, off, s[40:43], 0 offset:128 sc1
    s_waitcnt vmcnt(0)
    s_branch K1_LT0
K1_LT1:
    ds_read_b64_tr_b16 a[128:129], v6 offset:20480
    ds_read_b64_tr_b16 a[132:133], v7 offset:20480
    ds_read_b64_tr_b16 a[136:137], v8 offset:20480
    ds_read_b64_tr_b16 a[140:141], v9 offset:20480
    ds_read_b64_tr_b16 a[144:145], v10 offset:20480
    ds_read_b64_tr_b16 a[148:149], v11 offset:20480
    ds_read_b64_tr_b16 a[152:153], v12 offset:20480
    ds_read_b64_tr_b16 a[156:157], v13 offset:20480
    ds_read_b64_tr_b16 a[130:131], v6 offset:8192
    ds_read_b64_tr_b16 a[134:135], v7 offset:8192
    ds_read_b64_tr_b16 a[138:139], v8 offset:8192
    ds_read_b64_tr_b16 a[142:143], v9 offset:8192
    ds_read_b64_tr_b16 a[146:147], v10 offset:8192
    ds_read_b64_tr_b16 a[150:151], v11 offset:8192
    ds_read_b64_tr_b16 a[154:155], v12 offset:8192
    ds_read_b64_tr_b16 a[158:159], v13 offset:8192
    v_accvgpr_read_b32 v24, a224
    v_accvgpr_read_b32 v25, a228
    v_accvgpr_read_b32 v26, a232
    v_accvgpr_read_b32 v27, a236
    s_mov_b32 s6, 0x53800000
    v_cmp_nle_f32 s[36:37], v24, s6
    v_cmp_nle_f32 s[38:39], v25, s6
    s_or_b64 s[36:37], s[36:37], s[38:39]
    v_cmp_nle_f32 s[38:39], v26, s6
    s_or_b64 s[36:37], s[36:37], s[38:39]
    v_cmp_nle_f32 s[38:39], v27, s6
    s_or_b64 s[36:37], s[36:37], s[38:39]
    v_rcp_f32 v148, v24
    v_rcp_f32 v150, v25
    v_rcp_f32 v152, v26
    v_rcp_f32 v154, v27
    s_or_b32 s36, s36, s37
    s_lshl_b32 s7, s5, 2
    s_add_u32 s7, s7, 118784
    v_mov_b32 v24, s7
    v_mov_b32 v25, s36
    ds_write_b32 v24, v25
    s_lshl_b32 s7, s5, 8
    v_add_u32 v28, s7, v2
    v_add_u32 v29, s7, v3
    v_add_u32 v30, s7, v4
    v_add_u32 v31, s7, v5
    v_accvgpr_read_b32 v32, a0
    v_accvgpr_read_b32 v33, a1
    v_accvgpr_read_b32 v34, a2
    v_accvgpr_read_b32 v35, a3
    v_accvgpr_read_b32 v36, a16
    v_accvgpr_read_b32 v37, a17
    v_accvgpr_read_b32 v38, a18
    v_accvgpr_read_b32 v39, a19
    v_pk_mul_f32 v[32:33], v[32:33], v[148:149] op_sel_hi:[1,0]
    v_pk_mul_f32 v[34:35], v[34:35], v[148:149] op_sel_hi:[1,0]
    v_pk_mul_f32 v[36:37], v[36:37], v[148:149] op_sel_hi:[1,0]
    v_pk_mul_f32 v[38:39], v[38:39], v[148:149] op_sel_hi:[1,0]
    v_cvt_pk_bf16_f32 v32, v32, v33
    v_cvt_pk_bf16_f32 v33, v34, v35
    v_cvt_pk_bf16_f32 v34, v36, v37
    v_cvt_pk_bf16_f32 v35, v38, v39
    ds_write_b128 v28, v[32:35] offset:0
    v_accvgpr_read_b32 v40, a4
    v_accvgpr_read_b32 v41, a5
    v_accvgpr_read_b32 v42, a6
    v_accvgpr_read_b32 v43, a7
    v_accvgpr_read_b32 v44, a20
    v_accvgpr_read_b32 v45, a21
    v_accvgpr_read_b32 v46, a22
    v_accvgpr_read_b32 v47, a23
    v_pk_mul_f32 v[40:41], v[40:41], v[150:151] op_sel_hi:[1,0]
    v_pk_mul_f32 v[42:43], v[42:43], v[150:151] op_sel_hi:[1,0]
    v_pk_mul_f32 v[44:45], v[44:45], v[150:151] op_sel_hi:[1,0]
    v_pk_mul_f32 v[46:47], v[46:47], v[150:151] op_sel_hi:[1,0]
    v_cvt_pk_bf16_f32 v40, v40, v41
    v_cvt_pk_bf16_f32 v41, v42, v43
    v_cvt_pk_bf16_f32 v42, v44, v45
    v_cvt_pk_bf16_f32 v43, v46, v47
    ds_write_b128 v28, v[40:43] offset:16384
    v_accvgpr_read_b32 v48, a8
    v_accvgpr_read_b32 v49, a9
    v_accvgpr_read_b32 v50, a10
    v_accvgpr_read_b32 v51, a11
    v_accvgpr_read_b32 v52, a24
    v_accvgpr_read_b32 v53, a25
    v_accvgpr_read_b32 v54, a26
    v_accvgpr_read_b32 v55, a27
    v_pk_mul_f32 v[48:49], v[48:49], v[152:153] op_sel_hi:[1,0]
    v_pk_mul_f32 v[50:51], v[50:51], v[152:153] op_sel_hi:[1,0]
    v_pk_mul_f32 v[52:53], v[52:53], v[152:153] op_sel_hi:[1,0]
    v_pk_mul_f32 v[54:55], v[54:55], v[152:153] op_sel_hi:[1,0]
    v_cvt_pk_bf16_f32 v48, v48, v49
    v_cvt_pk_bf16_f32 v49, v50, v51
    v_cvt_pk_bf16_f32 v50, v52, v53
    v_cvt_pk_bf16_f32 v51, v54, v55
    ds_write_b128 v28, v[48:51] offset:32768
    v_accvgpr_read_b32 v56, a12
    v_accvgpr_read_b32 v57, a13
    v_accvgpr_read_b32 v58, a14
    v_accvgpr_read_b32 v59, a15
    v_accvgpr_read_b32 v60, a28
    v_accvgpr_read_b32 v61, a29
    v_accvgpr_read_b32 v62, a30
    v_accvgpr_read_b32 v63, a31
    v_pk_mul_f32 v[56:57], v[56:57], v[154:155] op_sel_hi:[1,0]
    v_pk_mul_f32 v[58:59], v[58:59], v[154:155] op_sel_hi:[1,0]
    v_pk_mul_f32 v[60:61], v[60:61], v[154:155] op_sel_hi:[1,0]
    v_pk_mul_f32 v[62:63], v[62:63], v[154:155] op_sel_hi:[1,0]
    v_cvt_pk_bf16_f32 v56, v56, v57
    v_cvt_pk_bf16_f32 v57, v58, v59
    v_cvt_pk_bf16_f32 v58, v60, v61
    v_cvt_pk_bf16_f32 v59, v62, v63
    ds_write_b128 v28, v[56:59] offset:49152
    v_accvgpr_read_b32 v64, a32
    v_accvgpr_read_b32 v65, a33
    v_accvgpr_read_b32 v66, a34
    v_accvgpr_read_b32 v67, a35
    v_accvgpr_read_b32 v68, a48
    v_accvgpr_read_b32 v69, a49
    v_accvgpr_read_b32 v70, a50
    v_accvgpr_read_b32 v71, a51
    v_pk_mul_f32 v[64:65], v[64:65], v[148:149] op_sel_hi:[1,0]
    v_pk_mul_f32 v[66:67], v[66:67], v[148:149] op_sel_hi:[1,0]
    v_pk_mul_f32 v[68:69], v[68:69], v[148:149] op_sel_hi:[1,0]
    v_pk_mul_f32 v[70:71], v[70:71], v[148:149] op_sel_hi:[1,0]
    v_cvt_pk_bf16_f32 v64, v64, v65
    v_cvt_pk_bf16_f32 v65, v66, v67
    v_cvt_pk_bf16_f32 v66, v68, v69
    v_cvt_pk_bf16_f32 v67, v70, v71
    ds_write_b128 v29, v[64:67] offset:0
    v_accvgpr_read_b32 v72, a36
    v_accvgpr_read_b32 v73, a37
    v_accvgpr_read_b32 v74, a38
    v_accvgpr_read_b32 v75, a39
    v_accvgpr_read_b32 v76, a52
    v_accvgpr_read_b32 v77, a53
    v_accvgpr_read_b32 v78, a54
    v_accvgpr_read_b32 v79, a55
    v_pk_mul_f32 v[72:73], v[72:73], v[150:151] op_sel_hi:[1,0]
    v_pk_mul_f32 v[74:75], v[74:75], v[150:151] op_sel_hi:[1,0]
    v_pk_mul_f32 v[76:77], v[76:77], v[150:151] op_sel_hi:[1,0]
    v_pk_mul_f32 v[78:79], v[78:79], v[150:151] op_sel_hi:[1,0]
    v_cvt_pk_bf16_f32 v72, v72, v73
    v_cvt_pk_bf16_f32 v73, v74, v75
    v_cvt_pk_bf16_f32 v74, v76, v77
    v_cvt_pk_bf16_f32 v75, v78, v79
    ds_write_b128 v29, v[72:75] offset:16384
    v_accvgpr_read_b32 v80, a40
    v_accvgpr_read_b32 v81, a41
    v_accvgpr_read_b32 v82, a42
    v_accvgpr_read_b32 v83, a43
    v_accvgpr_read_b32 v84, a56
    v_accvgpr_read_b32 v85, a57
    v_accvgpr_read_b32 v86, a58
    v_accvgpr_read_b32 v87, a59
    v_pk_mul_f32 v[80:81], v[80:81], v[152:153] op_sel_hi:[1,0]
    v_pk_mul_f32 v[82:83], v[82:83], v[152:153] op_sel_hi:[1,0]
    v_pk_mul_f32 v[84:85], v[84:85], v[152:153] op_sel_hi:[1,0]
    v_pk_mul_f32 v[86:87], v[86:87], v[152:153] op_sel_hi:[1,0]
    v_cvt_pk_bf16_f32 v80, v80, v81
    v_cvt_pk_bf16_f32 v81, v82, v83
    v_cvt_pk_bf16_f32 v82, v84, v85
    v_cvt_pk_bf16_f32 v83, v86, v87
    ds_write_b128 v29, v[80:83] offset:32768
    v_accvgpr_read_b32 v88, a44
    v_accvgpr_read_b32 v89, a45
    v_accvgpr_read_b32 v90, a46
    v_accvgpr_read_b32 v91, a47
    v_accvgpr_read_b32 v92, a60
    v_accvgpr_read_b32 v93, a61
    v_accvgpr_read_b32 v94, a62
    v_accvgpr_read_b32 v95, a63
    v_pk_mul_f32 v[88:89], v[88:89], v[154:155] op_sel_hi:[1,0]
    v_pk_mul_f32 v[90:91], v[90:91], v[154:155] op_sel_hi:[1,0]
    v_pk_mul_f32 v[92:93], v[92:93], v[154:155] op_sel_hi:[1,0]
    v_pk_mul_f32 v[94:95], v[94:95], v[154:155] op_sel_hi:[1,0]
    v_cvt_pk_bf16_f32 v88, v88, v89
    v_cvt_pk_bf16_f32 v89, v90, v91
    v_cvt_pk_bf16_f32 v90, v92, v93
    v_cvt_pk_bf16_f32 v91, v94, v95
    ds_write_b128 v29, v[88:91] offset:49152
    v_accvgpr_read_b32 v32, a64
    v_accvgpr_read_b32 v33, a65
    v_accvgpr_read_b32 v34, a66
    v_accvgpr_read_b32 v35, a67
    v_accvgpr_read_b32 v36, a80
    v_accvgpr_read_b32 v37, a81
    v_accvgpr_read_b32 v38, a82
    v_accvgpr_read_b32 v39, a83
    v_pk_mul_f32 v[32:33], v[32:33], v[148:149] op_sel_hi:[1,0]
    v_pk_mul_f32 v[34:35], v[34:35], v[148:149] op_sel_hi:[1,0]
    v_pk_mul_f32 v[36:37], v[36:37], v[148:149] op_sel_hi:[1,0]
    v_pk_mul_f32 v[38:39], v[38:39], v[148:149] op_sel_hi:[1,0]
    v_cvt_pk_bf16_f32 v32, v32, v33
    v_cvt_pk_bf16_f32 v33, v34, v35
    v_cvt_pk_bf16_f32 v34, v36, v37
    v_cvt_pk_bf16_f32 v35, v38, v39
    ds_write_b128 v30, v[32:35] offset:0
    v_accvgpr_read_b32 v40, a68
    v_accvgpr_read_b32 v41, a69
    v_accvgpr_read_b32 v42, a70
    v_accvgpr_read_b32 v43, a71
    v_accvgpr_read_b32 v44, a84
    v_accvgpr_read_b32 v45, a85
    v_accvgpr_read_b32 v46, a86
    v_accvgpr_read_b32 v47, a87
    v_pk_mul_f32 v[40:41], v[40:41], v[150:151] op_sel_hi:[1,0]
    v_pk_mul_f32 v[42:43], v[42:43], v[150:151] op_sel_hi:[1,0]
    v_pk_mul_f32 v[44:45], v[44:45], v[150:151] op_sel_hi:[1,0]
    v_pk_mul_f32 v[46:47], v[46:47], v[150:151] op_sel_hi:[1,0]
    v_cvt_pk_bf16_f32 v40, v40, v41
    v_cvt_pk_bf16_f32 v41, v42, v43
    v_cvt_pk_bf16_f32 v42, v44, v45
    v_cvt_pk_bf16_f32 v43, v46, v47
    ds_write_b128 v30, v[40:43] offset:16384
    v_accvgpr_read_b32 v48, a72
    v_accvgpr_read_b32 v49, a73
    v_accvgpr_read_b32 v50, a74
    v_accvgpr_read_b32 v51, a75
    v_accvgpr_read_b32 v52, a88
    v_accvgpr_read_b32 v53, a89
    v_accvgpr_read_b32 v54, a90
    v_accvgpr_read_b32 v55, a91
    v_pk_mul_f32 v[48:49], v[48:49], v[152:153] op_sel_hi:[1,0]
    v_pk_mul_f32 v[50:51], v[50:51], v[152:153] op_sel_hi:[1,0]
    v_pk_mul_f32 v[52:53], v[52:53], v[152:153] op_sel_hi:[1,0]
    v_pk_mul_f32 v[54:55], v[54:55], v[152:153] op_sel_hi:[1,0]
    v_cvt_pk_bf16_f32 v48, v48, v49
    v_cvt_pk_bf16_f32 v49, v50, v51
    v_cvt_pk_bf16_f32 v50, v52, v53
    v_cvt_pk_bf16_f32 v51, v54, v55
    ds_write_b128 v30, v[48:51] offset:32768
    v_accvgpr_read_b32 v56, a76
    v_accvgpr_read_b32 v57, a77
    v_accvgpr_read_b32 v58, a78
    v_accvgpr_read_b32 v59, a79
    v_accvgpr_read_b32 v60, a92
    v_accvgpr_read_b32 v61, a93
    v_accvgpr_read_b32 v62, a94
    v_accvgpr_read_b32 v63, a95
    v_pk_mul_f32 v[56:57], v[56:57], v[154:155] op_sel_hi:[1,0]
    v_pk_mul_f32 v[58:59], v[58:59], v[154:155] op_sel_hi:[1,0]
    v_pk_mul_f32 v[60:61], v[60:61], v[154:155] op_sel_hi:[1,0]
    v_pk_mul_f32 v[62:63], v[62:63], v[154:155] op_sel_hi:[1,0]
    v_cvt_pk_bf16_f32 v56, v56, v57
    v_cvt_pk_bf16_f32 v57, v58, v59
    v_cvt_pk_bf16_f32 v58, v60, v61
    v_cvt_pk_bf16_f32 v59, v62, v63
    ds_write_b128 v30, v[56:59] offset:49152
    v_accvgpr_read_b32 v64, a96
    v_accvgpr_read_b32 v65, a97
    v_accvgpr_read_b32 v66, a98
    v_accvgpr_read_b32 v67, a99
    v_accvgpr_read_b32 v68, a112
    v_accvgpr_read_b32 v69, a113
    v_accvgpr_read_b32 v70, a114
    v_accvgpr_read_b32 v71, a115
    v_pk_mul_f32 v[64:65], v[64:65], v[148:149] op_sel_hi:[1,0]
    v_pk_mul_f32 v[66:67], v[66:67], v[148:149] op_sel_hi:[1,0]
    v_pk_mul_f32 v[68:69], v[68:69], v[148:149] op_sel_hi:[1,0]
    v_pk_mul_f32 v[70:71], v[70:71], v[148:149] op_sel_hi:[1,0]
    v_cvt_pk_bf16_f32 v64, v64, v65
    v_cvt_pk_bf16_f32 v65, v66, v67
    v_cvt_pk_bf16_f32 v66, v68, v69
    v_cvt_pk_bf16_f32 v67, v70, v71
    ds_write_b128 v31, v[64:67] offset:0
    v_accvgpr_read_b32 v72, a100
    v_accvgpr_read_b32 v73, a101
    v_accvgpr_read_b32 v74, a102
    v_accvgpr_read_b32 v75, a103
    v_accvgpr_read_b32 v76, a116
    v_accvgpr_read_b32 v77, a117
    v_accvgpr_read_b32 v78, a118
    v_accvgpr_read_b32 v79, a119
    v_pk_mul_f32 v[72:73], v[72:73], v[150:151] op_sel_hi:[1,0]
    v_pk_mul_f32 v[74:75], v[74:75], v[150:151] op_sel_hi:[1,0]
    v_pk_mul_f32 v[76:77], v[76:77], v[150:151] op_sel_hi:[1,0]
    v_pk_mul_f32 v[78:79], v[78:79], v[150:151] op_sel_hi:[1,0]
    v_cvt_pk_bf16_f32 v72, v72, v73
    v_cvt_pk_bf16_f32 v73, v74, v75
    v_cvt_pk_bf16_f32 v74, v76, v77
    v_cvt_pk_bf16_f32 v75, v78, v79
    ds_write_b128 v31, v[72:75] offset:16384
    v_accvgpr_read_b32 v80, a104
    v_accvgpr_read_b32 v81, a105
    v_accvgpr_read_b32 v82, a106
    v_accvgpr_read_b32 v83, a107
    v_accvgpr_read_b32 v84, a120
    v_accvgpr_read_b32 v85, a121
    v_accvgpr_read_b32 v86, a122
    v_accvgpr_read_b32 v87, a123
    v_pk_mul_f32 v[80:81], v[80:81], v[152:153] op_sel_hi:[1,0]
    v_pk_mul_f32 v[82:83], v[82:83], v[152:153] op_sel_hi:[1,0]
    v_pk_mul_f32 v[84:85], v[84:85], v[152:153] op_sel_hi:[1,0]
    v_pk_mul_f32 v[86:87], v[86:87], v[152:153] op_sel_hi:[1,0]
    v_cvt_pk_bf16_f32 v80, v80, v81
    v_cvt_pk_bf16_f32 v81, v82, v83
    v_cvt_pk_bf16_f32 v82, v84, v85
    v_cvt_pk_bf16_f32 v83, v86, v87
    ds_write_b128 v31, v[80:83] offset:32768
    v_accvgpr_read_b32 v88, a108
    v_accvgpr_read_b32 v89, a109
    v_accvgpr_read_b32 v90, a110
    v_accvgpr_read_b32 v91, a111
    v_accvgpr_read_b32 v92, a124
    v_accvgpr_read_b32 v93, a125
    v_accvgpr_read_b32 v94, a126
    v_accvgpr_read_b32 v95, a127
    v_pk_mul_f32 v[88:89], v[88:89], v[154:155] op_sel_hi:[1,0]
    v_pk_mul_f32 v[90:91], v[90:91], v[154:155] op_sel_hi:[1,0]
    v_pk_mul_f32 v[92:93], v[92:93], v[154:155] op_sel_hi:[1,0]
    v_pk_mul_f32 v[94:95], v[94:95], v[154:155] op_sel_hi:[1,0]
    v_cvt_pk_bf16_f32 v88, v88, v89
    v_cvt_pk_bf16_f32 v89, v90, v91
    v_cvt_pk_bf16_f32 v90, v92, v93
    v_cvt_pk_bf16_f32 v91, v94, v95
    ds_write_b128 v31, v[88:91] offset:49152
    v_mov_b32 v24, 118784
    s_waitcnt lgkmcnt(0)
    s_barrier
    ds_read_b128 v[28:31], v24
    ds_read_b128 a[192:195], v2 offset:0
    ds_read_b128 a[196:199], v2 offset:16384
    ds_read_b128 a[200:203], v2 offset:32768
    ds_read_b128 a[204:207], v2 offset:49152
    s_waitcnt lgkmcnt(4)
    s_barrier
    v_or3_b32 v28, v28, v29, v30
    v_or_b32 v28, v28, v31
    s_nop 0
    v_readfirstlane_b32 s6, v28
    s_cmp_eq_u32 s6, 0
    s_cbranch_scc1 K1_OPROJ
    s_cmp_eq_u32 s34, 0
    s_cbranch_scc1 K1_FALLBACK
K1_OPROJ:
    s_add_u32 m0, s33, 4096
    s_nop 0
    buffer_load_dwordx4 v14, s[24:27], s30 offen offset:0 lds
    buffer_load_dwordx4 v15, s[24:27], s30 offen offset:1024 lds
    buffer_load_dwordx4 v16, s[24:27], s30 offen offset:2048 lds
    buffer_load_dwordx4 v17, s[24:27], s30 offen offset:3072 lds
    s_add_u32 s30, s30, 16384
    s_add_u32 m0, s33, 20480
    s_nop 0
    buffer_load_dwordx4 v14, s[24:27], s30 offen offset:0 lds
    buffer_load_dwordx4 v15, s[24:27], s30 offen offset:1024 lds
    buffer_load_dwordx4 v16, s[24:27], s30 offen offset:2048 lds
    buffer_load_dwordx4 v17, s[24:27], s30 offen offset:3072 lds
    s_add_u32 s30, s30, 16384
    s_waitcnt lgkmcnt(0) vmcnt(16)
    v_mfma_f32_16x16x32_bf16 v[32:35], a[128:131], a[192:195], 0
    ds_read_b128 a[208:211], v3 offset:0
    s_add_u32 m0, s33, 8192
    v_mfma_f32_16x16x32_bf16 v[36:39], a[128:131], a[196:199], 0
    ds_read_b128 a[212:215], v3 offset:16384
    buffer_load_dwordx4 v14, s[24:27], s30 offen offset:0 lds
    v_mfma_f32_16x16x32_bf16 v[40:43], a[128:131], a[200:203], 0
    ds_read_b128 a[216:219], v3 offset:32768
    v_mfma_f32_16x16x32_bf16 v[44:47], a[128:131], a[204:207], 0
    ds_read_b128 a[220:223], v3 offset:49152
    v_mfma_f32_16x16x32_bf16 v[48:51], a[132:135], a[192:195], 0
    ds_read_b64_tr_b16 a[160:161], v6 offset:12288
    v_mfma_f32_16x16x32_bf16 v[52:55], a[132:135], a[196:199], 0
    ds_read_b64_tr_b16 a[164:165], v7 offset:12288
    buffer_load_dwordx4 v15, s[24:27], s30 offen offset:1024 lds
    v_mfma_f32_16x16x32_bf16 v[56:59], a[132:135], a[200:203], 0
    ds_read_b64_tr_b16 a[168:169], v8 offset:12288
    v_mfma_f32_16x16x32_bf16 v[60:63], a[132:135], a[204:207], 0
    ds_read_b64_tr_b16 a[172:173], v9 offset:12288
    v_mfma_f32_16x16x32_bf16 v[64:67], a[136:139], a[192:195], 0
    ds_read_b64_tr_b16 a[176:177], v10 offset:12288
    v_mfma_f32_16x16x32_bf16 v[68:71], a[136:139], a[196:199], 0
    ds_read_b64_tr_b16 a[180:181], v11 offset:12288
    buffer_load_dwordx4 v16, s[24:27], s30 offen offset:2048 lds
    v_mfma_f32_16x16x32_bf16 v[72:75], a[136:139], a[200:203], 0
    ds_read_b64_tr_b16 a[184:185], v12 offset:12288
    v_mfma_f32_16x16x32_bf16 v[76:79], a[136:139], a[204:207], 0
    ds_read_b64_tr_b16 a[188:189], v13 offset:12288
    v_mfma_f32_16x16x32_bf16 v[80:83], a[140:143], a[192:195], 0
    v_mfma_f32_16x16x32_bf16 v[84:87], a[140:143], a[196:199], 0
    buffer_load_dwordx4 v17, s[24:27], s30 offen offset:3072 lds
    v_mfma_f32_16x16x32_bf16 v[88:91], a[140:143], a[200:203], 0
    s_add_u32 s30, s30, 16384
    v_mfma_f32_16x16x32_bf16 v[92:95], a[140:143], a[204:207], 0
    s_waitcnt lgkmcnt(0) vmcnt(16)
    v_mfma_f32_16x16x32_bf16 v[96:99], a[144:147], a[192:195], 0
    ds_read_b64_tr_b16 a[162:163], v6 offset:16384
    s_add_u32 m0, s33, 12288
    v_mfma_f32_16x16x32_bf16 v[100:103], a[144:147], a[196:199], 0
    ds_read_b64_tr_b16 a[166:167], v7 offset:16384
    buffer_load_dwordx4 v14, s[24:27], s30 offen offset:0 lds
    v_mfma_f32_16x16x32_bf16 v[104:107], a[144:147], a[200:203], 0
    ds_read_b64_tr_b16 a[170:171], v8 offset:16384
    v_mfma_f32_16x16x32_bf16 v[108:111], a[144:147], a[204:207], 0
    ds_read_b64_tr_b16 a[174:175], v9 offset:16384
    v_mfma_f32_16x16x32_bf16 v[112:115], a[148:151], a[192:195], 0
    ds_read_b64_tr_b16 a[178:179], v10 offset:16384
    v_mfma_f32_16x16x32_bf16 v[116:119], a[148:151], a[196:199], 0
    ds_read_b64_tr_b16 a[182:183], v11 offset:16384
    buffer_load_dwordx4 v15, s[24:27], s30 offen offset:1024 lds
    v_mfma_f32_16x16x32_bf16 v[120:123], a[148:151], a[200:203], 0
    ds_read_b64_tr_b16 a[186:187], v12 offset:16384
    v_mfma_f32_16x16x32_bf16 v[124:127], a[148:151], a[204:207], 0
    ds_read_b64_tr_b16 a[190:191], v13 offset:16384
    v_mfma_f32_16x16x32_bf16 v[128:131], a[152:155], a[192:195], 0
    s_lshl_b32 s6, s3, 21
    s_lshl_b32 s7, s4, 16
    v_mfma_f32_16x16x32_bf16 v[132:135], a[152:155], a[196:199], 0
    buffer_load_dwordx4 v16, s[24:27], s30 offen offset:2048 lds
    s_add_u32 s6, s6, s7
    v_mfma_f32_16x16x32_bf16 v[136:139], a[152:155], a[200:203], 0
    s_lshl_b32 s7, s5, 9
    v_mfma_f32_16x16x32_bf16 v[140:143], a[152:155], a[204:207], 0
    s_add_u32 s6, s6, s7
    v_mfma_f32_16x16x32_bf16 v[144:147], a[156:159], a[192:195], 0
    s_add_u32 s36, s6, 13631488
    v_mfma_f32_16x16x32_bf16 v[148:151], a[156:159], a[196:199], 0
    buffer_load_dwordx4 v17, s[24:27], s30 offen offset:3072 lds
    s_add_u32 s37, s6, 13647872
    v_mfma_f32_16x16x32_bf16 v[152:155], a[156:159], a[200:203], 0
    s_add_u32 s30, s30, 16384
    s_add_u32 s38, s6, 13664256
    v_mfma_f32_16x16x32_bf16 v[156:159], a[156:159], a[204:207], 0
    s_add_u32 s39, s6, 13680640
    s_waitcnt lgkmcnt(0) vmcnt(16)
    v_mfma_f32_16x16x32_bf16 v[32:35], a[160:163], a[208:211], v[32:35]
    ds_read_b128 a[192:195], v4 offset:0
    s_add_u32 m0, s33, 16384
    v_mfma_f32_16x16x32_bf16 v[36:39], a[160:163], a[212:215], v[36:39]
    ds_read_b128 a[196:199], v4 offset:16384
    buffer_load_dwordx4 v14, s[24:27], s30 offen offset:0 lds
    v_mfma_f32_16x16x32_bf16 v[40:43], a[160:163], a[216:219], v[40:43]
    ds_read_b128 a[200:203], v4 offset:32768
    v_mfma_f32_16x16x32_bf16 v[44:47], a[160:163], a[220:223], v[44:47]
    ds_read_b128 a[204:207], v4 offset:49152
    v_mfma_f32_16x16x32_bf16 v[48:51], a[164:167], a[208:211], v[48:51]
    ds_read_b64_tr_b16 a[128:129], v6 offset:0
    v_mfma_f32_16x16x32_bf16 v[52:55], a[164:167], a[212:215], v[52:55]
    ds_read_b64_tr_b16 a[132:133], v7 offset:0
    buffer_load_dwordx4 v15, s[24:27], s30 offen offset:1024 lds
    v_mfma_f32_16x16x32_bf16 v[56:59], a[164:167], a[216:219], v[56:59]
    ds_read_b64_tr_b16 a[136:137], v8 offset:0
    v_mfma_f32_16x16x32_bf16 v[60:63], a[164:167], a[220:223], v[60:63]
    ds_read_b64_tr_b16 a[140:141], v9 offset:0
    v_mfma_f32_16x16x32_bf16 v[64:67], a[168:171], a[208:211], v[64:67]
    ds_read_b64_tr_b16 a[144:145], v10 offset:0
    v_mfma_f32_16x16x32_bf16 v[68:71], a[168:171], a[212:215], v[68:71]
    ds_read_b64_tr_b16 a[148:149], v11 offset:0
    buffer_load_dwordx4 v16, s[24:27], s30 offen offset:2048 lds
    v_mfma_f32_16x16x32_bf16 v[72:75], a[168:171], a[216:219], v[72:75]
    ds_read_b64_tr_b16 a[152:153], v12 offset:0
    v_mfma_f32_16x16x32_bf16 v[76:79], a[168:171], a[220:223], v[76:79]
    ds_read_b64_tr_b16 a[156:157], v13 offset:0
    v_mfma_f32_16x16x32_bf16 v[80:83], a[172:175], a[208:211], v[80:83]
    v_mfma_f32_16x16x32_bf16 v[84:87], a[172:175], a[212:215], v[84:87]
    buffer_load_dwordx4 v17, s[24:27], s30 offen offset:3072 lds
    v_mfma_f32_16x16x32_bf16 v[88:91], a[172:175], a[216:219], v[88:91]
    s_add_u32 s30, s30, 16384
    v_mfma_f32_16x16x32_bf16 v[92:95], a[172:175], a[220:223], v[92:95]
    s_waitcnt lgkmcnt(0) vmcnt(16)
    v_mfma_f32_16x16x32_bf16 v[96:99], a[176:179], a[208:211], v[96:99]
    ds_read_b64_tr_b16 a[130:131], v6 offset:4096
    s_add_u32 m0, s33, 0
    v_mfma_f32_16x16x32_bf16 v[100:103], a[176:179], a[212:215], v[100:103]
    ds_read_b64_tr_b16 a[134:135], v7 offset:4096
    buffer_load_dwordx4 v14, s[24:27], s30 offen offset:0 lds
    v_mfma_f32_16x16x32_bf16 v[104:107], a[176:179], a[216:219], v[104:107]
    ds_read_b64_tr_b16 a[138:139], v8 offset:4096
    v_mfma_f32_16x16x32_bf16 v[108:111], a[176:179], a[220:223], v[108:111]
    ds_read_b64_tr_b16 a[142:143], v9 offset:4096
    v_mfma_f32_16x16x32_bf16 v[112:115], a[180:183], a[208:211], v[112:115]
    ds_read_b64_tr_b16 a[146:147], v10 offset:4096
    v_mfma_f32_16x16x32_bf16 v[116:119], a[180:183], a[212:215], v[116:119]
    ds_read_b64_tr_b16 a[150:151], v11 offset:4096
    buffer_load_dwordx4 v15, s[24:27], s30 offen offset:1024 lds
    v_mfma_f32_16x16x32_bf16 v[120:123], a[180:183], a[216:219], v[120:123]
    ds_read_b64_tr_b16 a[154:155], v12 offset:4096
    v_mfma_f32_16x16x32_bf16 v[124:127], a[180:183], a[220:223], v[124:127]
    ds_read_b64_tr_b16 a[158:159], v13 offset:4096
    v_mfma_f32_16x16x32_bf16 v[128:131], a[184:187], a[208:211], v[128:131]
    v_mfma_f32_16x16x32_bf16 v[132:135], a[184:187], a[212:215], v[132:135]
    buffer_load_dwordx4 v16, s[24:27], s30 offen offset:2048 lds
    v_mfma_f32_16x16x32_bf16 v[136:139], a[184:187], a[216:219], v[136:139]
    v_mfma_f32_16x16x32_bf16 v[140:143], a[184:187], a[220:223], v[140:143]
    v_mfma_f32_16x16x32_bf16 v[144:147], a[188:191], a[208:211], v[144:147]
    v_mfma_f32_16x16x32_bf16 v[148:151], a[188:191], a[212:215], v[148:151]
    buffer_load_dwordx4 v17, s[24:27], s30 offen offset:3072 lds
    v_mfma_f32_16x16x32_bf16 v[152:155], a[188:191], a[216:219], v[152:155]
    s_add_u32 s30, s30, 16384
    v_mfma_f32_16x16x32_bf16 v[156:159], a[188:191], a[220:223], v[156:159]
    s_waitcnt lgkmcnt(0) vmcnt(16)
    v_mfma_f32_16x16x32_bf16 v[32:35], a[128:131], a[192:195], v[32:35]
    ds_read_b128 a[208:211], v5 offset:0
    s_add_u32 m0, s33, 4096
    v_mfma_f32_16x16x32_bf16 v[36:39], a[128:131], a[196:199], v[36:39]
    ds_read_b128 a[212:215], v5 offset:16384
    buffer_load_dwordx4 v14, s[24:27], s30 offen offset:0 lds
    v_mfma_f32_16x16x32_bf16 v[40:43], a[128:131], a[200:203], v[40:43]
    ds_read_b128 a[216:219], v5 offset:32768
    v_mfma_f32_16x16x32_bf16 v[44:47], a[128:131], a[204:207], v[44:47]
    ds_read_b128 a[220:223], v5 offset:49152
    v_mfma_f32_16x16x32_bf16 v[48:51], a[132:135], a[192:195], v[48:51]
    ds_read_b64_tr_b16 a[160:161], v6 offset:20480
    v_mfma_f32_16x16x32_bf16 v[52:55], a[132:135], a[196:199], v[52:55]
    ds_read_b64_tr_b16 a[164:165], v7 offset:20480
    buffer_load_dwordx4 v15, s[24:27], s30 offen offset:1024 lds
    v_mfma_f32_16x16x32_bf16 v[56:59], a[132:135], a[200:203], v[56:59]
    ds_read_b64_tr_b16 a[168:169], v8 offset:20480
    v_mfma_f32_16x16x32_bf16 v[60:63], a[132:135], a[204:207], v[60:63]
    ds_read_b64_tr_b16 a[172:173], v9 offset:20480
    v_mfma_f32_16x16x32_bf16 v[64:67], a[136:139], a[192:195], v[64:67]
    ds_read_b64_tr_b16 a[176:177], v10 offset:20480
    v_mfma_f32_16x16x32_bf16 v[68:71], a[136:139], a[196:199], v[68:71]
    ds_read_b64_tr_b16 a[180:181], v11 offset:20480
    buffer_load_dwordx4 v16, s[24:27], s30 offen offset:2048 lds
    v_mfma_f32_16x16x32_bf16 v[72:75], a[136:139], a[200:203], v[72:75]
    ds_read_b64_tr_b16 a[184:185], v12 offset:20480
    v_mfma_f32_16x16x32_bf16 v[76:79], a[136:139], a[204:207], v[76:79]
    ds_read_b64_tr_b16 a[188:189], v13 offset:20480
    v_mfma_f32_16x16x32_bf16 v[80:83], a[140:143], a[192:195], v[80:83]
    v_mfma_f32_16x16x32_bf16 v[84:87], a[140:143], a[196:199], v[84:87]
    buffer_load_dwordx4 v17, s[24:27], s30 offen offset:3072 lds
    v_mfma_f32_16x16x32_bf16 v[88:91], a[140:143], a[200:203], v[88:91]
    s_add_u32 s30, s30, 16384
    v_mfma_f32_16x16x32_bf16 v[92:95], a[140:143], a[204:207], v[92:95]
    s_waitcnt lgkmcnt(0) vmcnt(16)
    v_mfma_f32_16x16x32_bf16 v[96:99], a[144:147], a[192:195], v[96:99]
    ds_read_b64_tr_b16 a[162:163], v6 offset:8192
    s_add_u32 m0, s33, 20480
    v_mfma_f32_16x16x32_bf16 v[100:103], a[144:147], a[196:199], v[100:103]
    ds_read_b64_tr_b16 a[166:167], v7 offset:8192
    buffer_load_dwordx4 v14, s[24:27], s30 offen offset:0 lds
    v_mfma_f32_16x16x32_bf16 v[104:107], a[144:147], a[200:203], v[104:107]
    ds_read_b64_tr_b16 a[170:171], v8 offset:8192
    v_mfma_f32_16x16x32_bf16 v[108:111], a[144:147], a[204:207], v[108:111]
    ds_read_b64_tr_b16 a[174:175], v9 offset:8192
    v_mfma_f32_16x16x32_bf16 v[112:115], a[148:151], a[192:195], v[112:115]
    ds_read_b64_tr_b16 a[178:179], v10 offset:8192
    v_mfma_f32_16x16x32_bf16 v[116:119], a[148:151], a[196:199], v[116:119]
    ds_read_b64_tr_b16 a[182:183], v11 offset:8192
    buffer_load_dwordx4 v15, s[24:27], s30 offen offset:1024 lds
    v_mfma_f32_16x16x32_bf16 v[120:123], a[148:151], a[200:203], v[120:123]
    ds_read_b64_tr_b16 a[186:187], v12 offset:8192
    v_mfma_f32_16x16x32_bf16 v[124:127], a[148:151], a[204:207], v[124:127]
    ds_read_b64_tr_b16 a[190:191], v13 offset:8192
    v_mfma_f32_16x16x32_bf16 v[128:131], a[152:155], a[192:195], v[128:131]
    v_mfma_f32_16x16x32_bf16 v[132:135], a[152:155], a[196:199], v[132:135]
    buffer_load_dwordx4 v16, s[24:27], s30 offen offset:2048 lds
    v_mfma_f32_16x16x32_bf16 v[136:139], a[152:155], a[200:203], v[136:139]
    v_mfma_f32_16x16x32_bf16 v[140:143], a[152:155], a[204:207], v[140:143]
    v_mfma_f32_16x16x32_bf16 v[144:147], a[156:159], a[192:195], v[144:147]
    v_mfma_f32_16x16x32_bf16 v[148:151], a[156:159], a[196:199], v[148:151]
    buffer_load_dwordx4 v17, s[24:27], s30 offen offset:3072 lds
    v_mfma_f32_16x16x32_bf16 v[152:155], a[156:159], a[200:203], v[152:155]
    s_add_u32 s30, s30, 16384
    v_mfma_f32_16x16x32_bf16 v[156:159], a[156:159], a[204:207], v[156:159]
    s_waitcnt lgkmcnt(0) vmcnt(16)
    v_mfma_f32_16x16x32_bf16 v[32:35], a[160:163], a[208:211], v[32:35]
    ds_read_b128 a[192:195], v2 offset:256
    s_add_u32 m0, s33, 8192
    v_mfma_f32_16x16x32_bf16 v[36:39], a[160:163], a[212:215], v[36:39]
    ds_read_b128 a[196:199], v2 offset:16640
    buffer_load_dwordx4 v14, s[24:27], s30 offen offset:0 lds
    v_mfma_f32_16x16x32_bf16 v[40:43], a[160:163], a[216:219], v[40:43]
    ds_read_b128 a[200:203], v2 offset:33024
    v_mfma_f32_16x16x32_bf16 v[44:47], a[160:163], a[220:223], v[44:47]
    ds_read_b128 a[204:207], v2 offset:49408
    v_mfma_f32_16x16x32_bf16 v[48:51], a[164:167], a[208:211], v[48:51]
    ds_read_b64_tr_b16 a[128:129], v6 offset:12288
    v_mfma_f32_16x16x32_bf16 v[52:55], a[164:167], a[212:215], v[52:55]
    ds_read_b64_tr_b16 a[132:133], v7 offset:12288
    buffer_load_dwordx4 v15, s[24:27], s30 offen offset:1024 lds
    v_mfma_f32_16x16x32_bf16 v[56:59], a[164:167], a[216:219], v[56:59]
    ds_read_b64_tr_b16 a[136:137], v8 offset:12288
    v_mfma_f32_16x16x32_bf16 v[60:63], a[164:167], a[220:223], v[60:63]
    ds_read_b64_tr_b16 a[140:141], v9 offset:12288
    v_mfma_f32_16x16x32_bf16 v[64:67], a[168:171], a[208:211], v[64:67]
    ds_read_b64_tr_b16 a[144:145], v10 offset:12288
    v_mfma_f32_16x16x32_bf16 v[68:71], a[168:171], a[212:215], v[68:71]
    ds_read_b64_tr_b16 a[148:149], v11 offset:12288
    buffer_load_dwordx4 v16, s[24:27], s30 offen offset:2048 lds
    v_mfma_f32_16x16x32_bf16 v[72:75], a[168:171], a[216:219], v[72:75]
    ds_read_b64_tr_b16 a[152:153], v12 offset:12288
    v_mfma_f32_16x16x32_bf16 v[76:79], a[168:171], a[220:223], v[76:79]
    ds_read_b64_tr_b16 a[156:157], v13 offset:12288
    v_mfma_f32_16x16x32_bf16 v[80:83], a[172:175], a[208:211], v[80:83]
    v_mfma_f32_16x16x32_bf16 v[84:87], a[172:175], a[212:215], v[84:87]
    buffer_load_dwordx4 v17, s[24:27], s30 offen offset:3072 lds
    v_mfma_f32_16x16x32_bf16 v[88:91], a[172:175], a[216:219], v[88:91]
    s_add_u32 s30, s30, 16384
    v_mfma_f32_16x16x32_bf16 v[92:95], a[172:175], a[220:223], v[92:95]
    s_waitcnt lgkmcnt(0) vmcnt(16)
    v_mfma_f32_16x16x32_bf16 v[96:99], a[176:179], a[208:211], v[96:99]
    ds_read_b64_tr_b16 a[130:131], v6 offset:16384
    s_add_u32 m0, s33, 12288
    v_mfma_f32_16x16x32_bf16 v[100:103], a[176:179], a[212:215], v[100:103]
    ds_read_b64_tr_b16 a[134:135], v7 offset:16384
    buffer_load_dwordx4 v14, s[24:27], s30 offen offset:0 lds
    v_mfma_f32_16x16x32_bf16 v[104:107], a[176:179], a[216:219], v[104:107]
    ds_read_b64_tr_b16 a[138:139], v8 offset:16384
    v_mfma_f32_16x16x32_bf16 v[108:111], a[176:179], a[220:223], v[108:111]
    ds_read_b64_tr_b16 a[142:143], v9 offset:16384
    v_mfma_f32_16x16x32_bf16 v[112:115], a[180:183], a[208:211], v[112:115]
    ds_read_b64_tr_b16 a[146:147], v10 offset:16384
    v_mfma_f32_16x16x32_bf16 v[116:119], a[180:183], a[212:215], v[116:119]
    ds_read_b64_tr_b16 a[150:151], v11 offset:16384
    buffer_load_dwordx4 v15, s[24:27], s30 offen offset:1024 lds
    v_mfma_f32_16x16x32_bf16 v[120:123], a[180:183], a[216:219], v[120:123]
    ds_read_b64_tr_b16 a[154:155], v12 offset:16384
    v_mfma_f32_16x16x32_bf16 v[124:127], a[180:183], a[220:223], v[124:127]
    ds_read_b64_tr_b16 a[158:159], v13 offset:16384
    v_mfma_f32_16x16x32_bf16 v[128:131], a[184:187], a[208:211], v[128:131]
    v_mfma_f32_16x16x32_bf16 v[132:135], a[184:187], a[212:215], v[132:135]
    buffer_load_dwordx4 v16, s[24:27], s30 offen offset:2048 lds
    v_mfma_f32_16x16x32_bf16 v[136:139], a[184:187], a[216:219], v[136:139]
    v_mfma_f32_16x16x32_bf16 v[140:143], a[184:187], a[220:223], v[140:143]
    v_mfma_f32_16x16x32_bf16 v[144:147], a[188:191], a[208:211], v[144:147]
    v_mfma_f32_16x16x32_bf16 v[148:151], a[188:191], a[212:215], v[148:151]
    buffer_load_dwordx4 v17, s[24:27], s30 offen offset:3072 lds
    v_mfma_f32_16x16x32_bf16 v[152:155], a[188:191], a[216:219], v[152:155]
    s_add_u32 s30, s30, 16384
    v_mfma_f32_16x16x32_bf16 v[156:159], a[188:191], a[220:223], v[156:159]
    s_waitcnt lgkmcnt(0) vmcnt(16)
    v_mfma_f32_16x16x32_bf16 v[32:35], a[128:131], a[192:195], v[32:35]
    ds_read_b128 a[208:211], v3 offset:256
    s_add_u32 m0, s33, 16384
    v_mfma_f32_16x16x32_bf16 v[36:39], a[128:131], a[196:199], v[36:39]
    ds_read_b128 a[212:215], v3 offset:16640
    buffer_load_dwordx4 v14, s[24:27], s30 offen offset:0 lds
    v_mfma_f32_16x16x32_bf16 v[40:43], a[128:131], a[200:203], v[40:43]
    ds_read_b128 a[216:219], v3 offset:33024
    v_mfma_f32_16x16x32_bf16 v[44:47], a[128:131], a[204:207], v[44:47]
    ds_read_b128 a[220:223], v3 offset:49408
    v_mfma_f32_16x16x32_bf16 v[48:51], a[132:135], a[192:195], v[48:51]
    ds_read_b64_tr_b16 a[160:161], v6 offset:0
    v_mfma_f32_16x16x32_bf16 v[52:55], a[132:135], a[196:199], v[52:55]
    ds_read_b64_tr_b16 a[164:165], v7 offset:0
    buffer_load_dwordx4 v15, s[24:27], s30 offen offset:1024 lds
    v_mfma_f32_16x16x32_bf16 v[56:59], a[132:135], a[200:203], v[56:59]
    ds_read_b64_tr_b16 a[168:169], v8 offset:0
    v_mfma_f32_16x16x32_bf16 v[60:63], a[132:135], a[204:207], v[60:63]
    ds_read_b64_tr_b16 a[172:173], v9 offset:0
    v_mfma_f32_16x16x32_bf16 v[64:67], a[136:139], a[192:195], v[64:67]
    ds_read_b64_tr_b16 a[176:177], v10 offset:0
    v_mfma_f32_16x16x32_bf16 v[68:71], a[136:139], a[196:199], v[68:71]
    ds_read_b64_tr_b16 a[180:181], v11 offset:0
    buffer_load_dwordx4 v16, s[24:27], s30 offen offset:2048 lds
    v_mfma_f32_16x16x32_bf16 v[72:75], a[136:139], a[200:203], v[72:75]
    ds_read_b64_tr_b16 a[184:185], v12 offset:0
    v_mfma_f32_16x16x32_bf16 v[76:79], a[136:139], a[204:207], v[76:79]
    ds_read_b64_tr_b16 a[188:189], v13 offset:0
    v_mfma_f32_16x16x32_bf16 v[80:83], a[140:143], a[192:195], v[80:83]
    v_mfma_f32_16x16x32_bf16 v[84:87], a[140:143], a[196:199], v[84:87]
    buffer_load_dwordx4 v17, s[24:27], s30 offen offset:3072 lds
    v_mfma_f32_16x16x32_bf16 v[88:91], a[140:143], a[200:203], v[88:91]
    s_add_u32 s30, s30, 16384
    v_mfma_f32_16x16x32_bf16 v[92:95], a[140:143], a[204:207], v[92:95]
    s_waitcnt lgkmcnt(0) vmcnt(16)
    v_mfma_f32_16x16x32_bf16 v[96:99], a[144:147], a[192:195], v[96:99]
    ds_read_b64_tr_b16 a[162:163], v6 offset:4096
    s_add_u32 m0, s33, 0
    v_mfma_f32_16x16x32_bf16 v[100:103], a[144:147], a[196:199], v[100:103]
    ds_read_b64_tr_b16 a[166:167], v7 offset:4096
    buffer_load_dwordx4 v14, s[24:27], s30 offen offset:0 lds
    v_mfma_f32_16x16x32_bf16 v[104:107], a[144:147], a[200:203], v[104:107]
    ds_read_b64_tr_b16 a[170:171], v8 offset:4096
    v_mfma_f32_16x16x32_bf16 v[108:111], a[144:147], a[204:207], v[108:111]
    ds_read_b64_tr_b16 a[174:175], v9 offset:4096
    v_mfma_f32_16x16x32_bf16 v[112:115], a[148:151], a[192:195], v[112:115]
    ds_read_b64_tr_b16 a[178:179], v10 offset:4096
    v_mfma_f32_16x16x32_bf16 v[116:119], a[148:151], a[196:199], v[116:119]
    ds_read_b64_tr_b16 a[182:183], v11 offset:4096
    buffer_load_dwordx4 v15, s[24:27], s30 offen offset:1024 lds
    v_mfma_f32_16x16x32_bf16 v[120:123], a[148:151], a[200:203], v[120:123]
    ds_read_b64_tr_b16 a[186:187], v12 offset:4096
    v_mfma_f32_16x16x32_bf16 v[124:127], a[148:151], a[204:207], v[124:127]
    ds_read_b64_tr_b16 a[190:191], v13 offset:4096
    v_mfma_f32_16x16x32_bf16 v[128:131], a[152:155], a[192:195], v[128:131]
    v_mfma_f32_16x16x32_bf16 v[132:135], a[152:155], a[196:199], v[132:135]
    buffer_load_dwordx4 v16, s[24:27], s30 offen offset:2048 lds
    v_mfma_f32_16x16x32_bf16 v[136:139], a[152:155], a[200:203], v[136:139]
    v_mfma_f32_16x16x32_bf16 v[140:143], a[152:155], a[204:207], v[140:143]
    v_mfma_f32_16x16x32_bf16 v[144:147], a[156:159], a[192:195], v[144:147]
    v_mfma_f32_16x16x32_bf16 v[148:151], a[156:159], a[196:199], v[148:151]
    buffer_load_dwordx4 v17, s[24:27], s30 offen offset:3072 lds
    v_mfma_f32_16x16x32_bf16 v[152:155], a[156:159], a[200:203], v[152:155]
    s_add_u32 s30, s30, 16384
    v_mfma_f32_16x16x32_bf16 v[156:159], a[156:159], a[204:207], v[156:159]
    s_waitcnt lgkmcnt(0) vmcnt(16)
    v_mfma_f32_16x16x32_bf16 v[32:35], a[160:163], a[208:211], v[32:35]
    ds_read_b128 a[192:195], v4 offset:256
    s_add_u32 m0, s33, 4096
    v_mfma_f32_16x16x32_bf16 v[36:39], a[160:163], a[212:215], v[36:39]
    ds_read_b128 a[196:199], v4 offset:16640
    buffer_load_dwordx4 v14, s[24:27], s30 offen offset:0 lds
    v_mfma_f32_16x16x32_bf16 v[40:43], a[160:163], a[216:219], v[40:43]
    ds_read_b128 a[200:203], v4 offset:33024
    v_mfma_f32_16x16x32_bf16 v[44:47], a[160:163], a[220:223], v[44:47]
    ds_read_b128 a[204:207], v4 offset:49408
    v_mfma_f32_16x16x32_bf16 v[48:51], a[164:167], a[208:211], v[48:51]
    ds_read_b64_tr_b16 a[128:129], v6 offset:20480
    v_mfma_f32_16x16x32_bf16 v[52:55], a[164:167], a[212:215], v[52:55]
    ds_read_b64_tr_b16 a[132:133], v7 offset:20480
    buffer_load_dwordx4 v15, s[24:27], s30 offen offset:1024 lds
    v_mfma_f32_16x16x32_bf16 v[56:59], a[164:167], a[216:219], v[56:59]
    ds_read_b64_tr_b16 a[136:137], v8 offset:20480
    v_mfma_f32_16x16x32_bf16 v[60:63], a[164:167], a[220:223], v[60:63]
    ds_read_b64_tr_b16 a[140:141], v9 offset:20480
    v_mfma_f32_16x16x32_bf16 v[64:67], a[168:171], a[208:211], v[64:67]
    ds_read_b64_tr_b16 a[144:145], v10 offset:20480
    v_mfma_f32_16x16x32_bf16 v[68:71], a[168:171], a[212:215], v[68:71]
    ds_read_b64_tr_b16 a[148:149], v11 offset:20480
    buffer_load_dwordx4 v16, s[24:27], s30 offen offset:2048 lds
    v_mfma_f32_16x16x32_bf16 v[72:75], a[168:171], a[216:219], v[72:75]
    ds_read_b64_tr_b16 a[152:153], v12 offset:20480
    v_mfma_f32_16x16x32_bf16 v[76:79], a[168:171], a[220:223], v[76:79]
    ds_read_b64_tr_b16 a[156:157], v13 offset:20480
    v_mfma_f32_16x16x32_bf16 v[80:83], a[172:175], a[208:211], v[80:83]
    v_mfma_f32_16x16x32_bf16 v[84:87], a[172:175], a[212:215], v[84:87]
    buffer_load_dwordx4 v17, s[24:27], s30 offen offset:3072 lds
    v_mfma_f32_16x16x32_bf16 v[88:91], a[172:175], a[216:219], v[88:91]
    s_add_u32 s30, s30, 16384
    v_mfma_f32_16x16x32_bf16 v[92:95], a[172:175], a[220:223], v[92:95]
    s_waitcnt lgkmcnt(0) vmcnt(16)
    v_mfma_f32_16x16x32_bf16 v[96:99], a[176:179], a[208:211], v[96:99]
    ds_read_b64_tr_b16 a[130:131], v6 offset:8192
    s_add_u32 m0, s33, 20480
    v_mfma_f32_16x16x32_bf16 v[100:103], a[176:179], a[212:215], v[100:103]
    ds_read_b64_tr_b16 a[134:135], v7 offset:8192
    buffer_load_dwordx4 v14, s[24:27], s30 offen offset:0 lds
    v_mfma_f32_16x16x32_bf16 v[104:107], a[176:179], a[216:219], v[104:107]
    ds_read_b64_tr_b16 a[138:139], v8 offset:8192
    v_mfma_f32_16x16x32_bf16 v[108:111], a[176:179], a[220:223], v[108:111]
    ds_read_b64_tr_b16 a[142:143], v9 offset:8192
    v_mfma_f32_16x16x32_bf16 v[112:115], a[180:183], a[208:211], v[112:115]
    ds_read_b64_tr_b16 a[146:147], v10 offset:8192
    v_mfma_f32_16x16x32_bf16 v[116:119], a[180:183], a[212:215], v[116:119]
    ds_read_b64_tr_b16 a[150:151], v11 offset:8192
    buffer_load_dwordx4 v15, s[24:27], s30 offen offset:1024 lds
    v_mfma_f32_16x16x32_bf16 v[120:123], a[180:183], a[216:219], v[120:123]
    ds_read_b64_tr_b16 a[154:155], v12 offset:8192
    v_mfma_f32_16x16x32_bf16 v[124:127], a[180:183], a[220:223], v[124:127]
    ds_read_b64_tr_b16 a[158:159], v13 offset:8192
    v_mfma_f32_16x16x32_bf16 v[128:131], a[184:187], a[208:211], v[128:131]
    v_mfma_f32_16x16x32_bf16 v[132:135], a[184:187], a[212:215], v[132:135]
    buffer_load_dwordx4 v16, s[24:27], s30 offen offset:2048 lds
    v_mfma_f32_16x16x32_bf16 v[136:139], a[184:187], a[216:219], v[136:139]
    v_mfma_f32_16x16x32_bf16 v[140:143], a[184:187], a[220:223], v[140:143]
    v_mfma_f32_16x16x32_bf16 v[144:147], a[188:191], a[208:211], v[144:147]
    v_mfma_f32_16x16x32_bf16 v[148:151], a[188:191], a[212:215], v[148:151]
    buffer_load_dwordx4 v17, s[24:27], s30 offen offset:3072 lds
    v_mfma_f32_16x16x32_bf16 v[152:155], a[188:191], a[216:219], v[152:155]
    s_add_u32 s30, s30, 16384
    v_mfma_f32_16x16x32_bf16 v[156:159], a[188:191], a[220:223], v[156:159]
    s_waitcnt lgkmcnt(0) vmcnt(16)
    v_mfma_f32_16x16x32_bf16 v[32:35], a[128:131], a[192:195], v[32:35]
    ds_read_b128 a[208:211], v5 offset:256
    s_add_u32 m0, s33, 8192
    v_mfma_f32_16x16x32_bf16 v[36:39], a[128:131], a[196:199], v[36:39]
    ds_read_b128 a[212:215], v5 offset:16640
    buffer_load_dwordx4 v14, s[24:27], s30 offen offset:0 lds
    v_mfma_f32_16x16x32_bf16 v[40:43], a[128:131], a[200:203], v[40:43]
    ds_read_b128 a[216:219], v5 offset:33024
    v_mfma_f32_16x16x32_bf16 v[44:47], a[128:131], a[204:207], v[44:47]
    ds_read_b128 a[220:223], v5 offset:49408
    v_mfma_f32_16x16x32_bf16 v[48:51], a[132:135], a[192:195], v[48:51]
    ds_read_b64_tr_b16 a[160:161], v6 offset:12288
    v_mfma_f32_16x16x32_bf16 v[52:55], a[132:135], a[196:199], v[52:55]
    ds_read_b64_tr_b16 a[164:165], v7 offset:12288
    buffer_load_dwordx4 v15, s[24:27], s30 offen offset:1024 lds
    v_mfma_f32_16x16x32_bf16 v[56:59], a[132:135], a[200:203], v[56:59]
    ds_read_b64_tr_b16 a[168:169], v8 offset:12288
    v_mfma_f32_16x16x32_bf16 v[60:63], a[132:135], a[204:207], v[60:63]
    ds_read_b64_tr_b16 a[172:173], v9 offset:12288
    v_mfma_f32_16x16x32_bf16 v[64:67], a[136:139], a[192:195], v[64:67]
    ds_read_b64_tr_b16 a[176:177], v10 offset:12288
    v_mfma_f32_16x16x32_bf16 v[68:71], a[136:139], a[196:199], v[68:71]
    ds_read_b64_tr_b16 a[180:181], v11 offset:12288
    buffer_load_dwordx4 v16, s[24:27], s30 offen offset:2048 lds
    v_mfma_f32_16x16x32_bf16 v[72:75], a[136:139], a[200:203], v[72:75]
    ds_read_b64_tr_b16 a[184:185], v12 offset:12288
    v_mfma_f32_16x16x32_bf16 v[76:79], a[136:139], a[204:207], v[76:79]
    ds_read_b64_tr_b16 a[188:189], v13 offset:12288
    v_mfma_f32_16x16x32_bf16 v[80:83], a[140:143], a[192:195], v[80:83]
    v_mfma_f32_16x16x32_bf16 v[84:87], a[140:143], a[196:199], v[84:87]
    buffer_load_dwordx4 v17, s[24:27], s30 offen offset:3072 lds
    v_mfma_f32_16x16x32_bf16 v[88:91], a[140:143], a[200:203], v[88:91]
    s_add_u32 s30, s30, 16384
    v_mfma_f32_16x16x32_bf16 v[92:95], a[140:143], a[204:207], v[92:95]
    s_waitcnt lgkmcnt(0) vmcnt(16)
    v_mfma_f32_16x16x32_bf16 v[96:99], a[144:147], a[192:195], v[96:99]
    ds_read_b64_tr_b16 a[162:163], v6 offset:16384
    s_add_u32 m0, s33, 12288
    v_mfma_f32_16x16x32_bf16 v[100:103], a[144:147], a[196:199], v[100:103]
    ds_read_b64_tr_b16 a[166:167], v7 offset:16384
    buffer_load_dwordx4 v14, s[24:27], s30 offen offset:0 lds
    v_mfma_f32_16x16x32_bf16 v[104:107], a[144:147], a[200:203], v[104:107]
    ds_read_b64_tr_b16 a[170:171], v8 offset:16384
    v_mfma_f32_16x16x32_bf16 v[108:111], a[144:147], a[204:207], v[108:111]
    ds_read_b64_tr_b16 a[174:175], v9 offset:16384
    v_mfma_f32_16x16x32_bf16 v[112:115], a[148:151], a[192:195], v[112:115]
    ds_read_b64_tr_b16 a[178:179], v10 offset:16384
    v_mfma_f32_16x16x32_bf16 v[116:119], a[148:151], a[196:199], v[116:119]
    ds_read_b64_tr_b16 a[182:183], v11 offset:16384
    buffer_load_dwordx4 v15, s[24:27], s30 offen offset:1024 lds
    v_mfma_f32_16x16x32_bf16 v[120:123], a[148:151], a[200:203], v[120:123]
    ds_read_b64_tr_b16 a[186:187], v12 offset:16384
    v_mfma_f32_16x16x32_bf16 v[124:127], a[148:151], a[204:207], v[124:127]
    ds_read_b64_tr_b16 a[190:191], v13 offset:16384
    v_mfma_f32_16x16x32_bf16 v[128:131], a[152:155], a[192:195], v[128:131]
    v_mfma_f32_16x16x32_bf16 v[132:135], a[152:155], a[196:199], v[132:135]
    buffer_load_dwordx4 v16, s[24:27], s30 offen offset:2048 lds
    v_mfma_f32_16x16x32_bf16 v[136:139], a[152:155], a[200:203], v[136:139]
    v_mfma_f32_16x16x32_bf16 v[140:143], a[152:155], a[204:207], v[140:143]
    v_mfma_f32_16x16x32_bf16 v[144:147], a[156:159], a[192:195], v[144:147]
    v_mfma_f32_16x16x32_bf16 v[148:151], a[156:159], a[196:199], v[148:151]
    buffer_load_dwordx4 v17, s[24:27], s30 offen offset:3072 lds
    v_mfma_f32_16x16x32_bf16 v[152:155], a[156:159], a[200:203], v[152:155]
    s_add_u32 s30, s30, 16384
    v_mfma_f32_16x16x32_bf16 v[156:159], a[156:159], a[204:207], v[156:159]
    s_waitcnt lgkmcnt(0) vmcnt(16)
    v_mfma_f32_16x16x32_bf16 v[32:35], a[160:163], a[208:211], v[32:35]
    ds_read_b128 a[192:195], v2 offset:512
    s_add_u32 m0, s33, 16384
    v_mfma_f32_16x16x32_bf16 v[36:39], a[160:163], a[212:215], v[36:39]
    ds_read_b128 a[196:199], v2 offset:16896
    buffer_load_dwordx4 v14, s[24:27], s30 offen offset:0 lds
    v_mfma_f32_16x16x32_bf16 v[40:43], a[160:163], a[216:219], v[40:43]
    ds_read_b128 a[200:203], v2 offset:33280
    v_mfma_f32_16x16x32_bf16 v[44:47], a[160:163], a[220:223], v[44:47]
    ds_read_b128 a[204:207], v2 offset:49664
    v_mfma_f32_16x16x32_bf16 v[48:51], a[164:167], a[208:211], v[48:51]
    ds_read_b64_tr_b16 a[128:129], v6 offset:0
    v_mfma_f32_16x16x32_bf16 v[52:55], a[164:167], a[212:215], v[52:55]
    ds_read_b64_tr_b16 a[132:133], v7 offset:0
    buffer_load_dwordx4 v15, s[24:27], s30 offen offset:1024 lds
    v_mfma_f32_16x16x32_bf16 v[56:59], a[164:167], a[216:219], v[56:59]
    ds_read_b64_tr_b16 a[136:137], v8 offset:0
    v_mfma_f32_16x16x32_bf16 v[60:63], a[164:167], a[220:223], v[60:63]
    ds_read_b64_tr_b16 a[140:141], v9 offset:0
    v_mfma_f32_16x16x32_bf16 v[64:67], a[168:171], a[208:211], v[64:67]
    ds_read_b64_tr_b16 a[144:145], v10 offset:0
    v_mfma_f32_16x16x32_bf16 v[68:71], a[168:171], a[212:215], v[68:71]
    ds_read_b64_tr_b16 a[148:149], v11 offset:0
    buffer_load_dwordx4 v16, s[24:27], s30 offen offset:2048 lds
    v_mfma_f32_16x16x32_bf16 v[72:75], a[168:171], a[216:219], v[72:75]
    ds_read_b64_tr_b16 a[152:153], v12 offset:0
    v_mfma_f32_16x16x32_bf16 v[76:79], a[168:171], a[220:223], v[76:79]
    ds_read_b64_tr_b16 a[156:157], v13 offset:0
    v_mfma_f32_16x16x32_bf16 v[80:83], a[172:175], a[208:211], v[80:83]
    v_mfma_f32_16x16x32_bf16 v[84:87], a[172:175], a[212:215], v[84:87]
    buffer_load_dwordx4 v17, s[24:27], s30 offen offset:3072 lds
    v_mfma_f32_16x16x32_bf16 v[88:91], a[172:175], a[216:219], v[88:91]
    s_add_u32 s30, s30, 16384
    v_mfma_f32_16x16x32_bf16 v[92:95], a[172:175], a[220:223], v[92:95]
    s_waitcnt lgkmcnt(0) vmcnt(16)
    v_mfma_f32_16x16x32_bf16 v[96:99], a[176:179], a[208:211], v[96:99]
    ds_read_b64_tr_b16 a[130:131], v6 offset:4096
    s_add_u32 m0, s33, 0
    v_mfma_f32_16x16x32_bf16 v[100:103], a[176:179], a[212:215], v[100:103]
    ds_read_b64_tr_b16 a[134:135], v7 offset:4096
    buffer_load_dwordx4 v14, s[24:27], s30 offen offset:0 lds
    v_mfma_f32_16x16x32_bf16 v[104:107], a[176:179], a[216:219], v[104:107]
    ds_read_b64_tr_b16 a[138:139], v8 offset:4096
    v_mfma_f32_16x16x32_bf16 v[108:111], a[176:179], a[220:223], v[108:111]
    ds_read_b64_tr_b16 a[142:143], v9 offset:4096
    v_mfma_f32_16x16x32_bf16 v[112:115], a[180:183], a[208:211], v[112:115]
    ds_read_b64_tr_b16 a[146:147], v10 offset:4096
    v_mfma_f32_16x16x32_bf16 v[116:119], a[180:183], a[212:215], v[116:119]
    ds_read_b64_tr_b16 a[150:151], v11 offset:4096
    buffer_load_dwordx4 v15, s[24:27], s30 offen offset:1024 lds
    v_mfma_f32_16x16x32_bf16 v[120:123], a[180:183], a[216:219], v[120:123]
    ds_read_b64_tr_b16 a[154:155], v12 offset:4096
    v_mfma_f32_16x16x32_bf16 v[124:127], a[180:183], a[220:223], v[124:127]
    ds_read_b64_tr_b16 a[158:159], v13 offset:4096
    v_mfma_f32_16x16x32_bf16 v[128:131], a[184:187], a[208:211], v[128:131]
    v_mfma_f32_16x16x32_bf16 v[132:135], a[184:187], a[212:215], v[132:135]
    buffer_load_dwordx4 v16, s[24:27], s30 offen offset:2048 lds
    v_mfma_f32_16x16x32_bf16 v[136:139], a[184:187], a[216:219], v[136:139]
    v_mfma_f32_16x16x32_bf16 v[140:143], a[184:187], a[220:223], v[140:143]
    v_mfma_f32_16x16x32_bf16 v[144:147], a[188:191], a[208:211], v[144:147]
    v_mfma_f32_16x16x32_bf16 v[148:151], a[188:191], a[212:215], v[148:151]
    buffer_load_dwordx4 v17, s[24:27], s30 offen offset:3072 lds
    v_mfma_f32_16x16x32_bf16 v[152:155], a[188:191], a[216:219], v[152:155]
    s_add_u32 s30, s30, 16384
    v_mfma_f32_16x16x32_bf16 v[156:159], a[188:191], a[220:223], v[156:159]
    s_waitcnt lgkmcnt(0) vmcnt(16)
    v_mfma_f32_16x16x32_bf16 v[32:35], a[128:131], a[192:195], v[32:35]
    ds_read_b128 a[208:211], v3 offset:512
    s_add_u32 m0, s33, 4096
    v_mfma_f32_16x16x32_bf16 v[36:39], a[128:131], a[196:199], v[36:39]
    ds_read_b128 a[212:215], v3 offset:16896
    buffer_load_dwordx4 v14, s[24:27], s30 offen offset:0 lds
    v_mfma_f32_16x16x32_bf16 v[40:43], a[128:131], a[200:203], v[40:43]
    ds_read_b128 a[216:219], v3 offset:33280
    v_mfma_f32_16x16x32_bf16 v[44:47], a[128:131], a[204:207], v[44:47]
    ds_read_b128 a[220:223], v3 offset:49664
    v_mfma_f32_16x16x32_bf16 v[48:51], a[132:135], a[192:195], v[48:51]
    ds_read_b64_tr_b16 a[160:161], v6 offset:20480
    v_mfma_f32_16x16x32_bf16 v[52:55], a[132:135], a[196:199], v[52:55]
    ds_read_b64_tr_b16 a[164:165], v7 offset:20480
    buffer_load_dwordx4 v15, s[24:27], s30 offen offset:1024 lds
    v_mfma_f32_16x16x32_bf16 v[56:59], a[132:135], a[200:203], v[56:59]
    ds_read_b64_tr_b16 a[168:169], v8 offset:20480
    v_mfma_f32_16x16x32_bf16 v[60:63], a[132:135], a[204:207], v[60:63]
    ds_read_b64_tr_b16 a[172:173], v9 offset:20480
    v_mfma_f32_16x16x32_bf16 v[64:67], a[136:139], a[192:195], v[64:67]
    ds_read_b64_tr_b16 a[176:177], v10 offset:20480
    v_mfma_f32_16x16x32_bf16 v[68:71], a[136:139], a[196:199], v[68:71]
    ds_read_b64_tr_b16 a[180:181], v11 offset:20480
    buffer_load_dwordx4 v16, s[24:27], s30 offen offset:2048 lds
    v_mfma_f32_16x16x32_bf16 v[72:75], a[136:139], a[200:203], v[72:75]
    ds_read_b64_tr_b16 a[184:185], v12 offset:20480
    v_mfma_f32_16x16x32_bf16 v[76:79], a[136:139], a[204:207], v[76:79]
    ds_read_b64_tr_b16 a[188:189], v13 offset:20480
    v_mfma_f32_16x16x32_bf16 v[80:83], a[140:143], a[192:195], v[80:83]
    v_mfma_f32_16x16x32_bf16 v[84:87], a[140:143], a[196:199], v[84:87]
    buffer_load_dwordx4 v17, s[24:27], s30 offen offset:3072 lds
    v_mfma_f32_16x16x32_bf16 v[88:91], a[140:143], a[200:203], v[88:91]
    s_add_u32 s30, s30, 16384
    v_mfma_f32_16x16x32_bf16 v[92:95], a[140:143], a[204:207], v[92:95]
    s_waitcnt lgkmcnt(0) vmcnt(16)
    v_mfma_f32_16x16x32_bf16 v[96:99], a[144:147], a[192:195], v[96:99]
    ds_read_b64_tr_b16 a[162:163], v6 offset:8192
    s_add_u32 m0, s33, 20480
    v_mfma_f32_16x16x32_bf16 v[100:103], a[144:147], a[196:199], v[100:103]
    ds_read_b64_tr_b16 a[166:167], v7 offset:8192
    buffer_load_dwordx4 v14, s[24:27], s30 offen offset:0 lds
    v_mfma_f32_16x16x32_bf16 v[104:107], a[144:147], a[200:203], v[104:107]
    ds_read_b64_tr_b16 a[170:171], v8 offset:8192
    v_mfma_f32_16x16x32_bf16 v[108:111], a[144:147], a[204:207], v[108:111]
    ds_read_b64_tr_b16 a[174:175], v9 offset:8192
    v_mfma_f32_16x16x32_bf16 v[112:115], a[148:151], a[192:195], v[112:115]
    ds_read_b64_tr_b16 a[178:179], v10 offset:8192
    v_mfma_f32_16x16x32_bf16 v[116:119], a[148:151], a[196:199], v[116:119]
    ds_read_b64_tr_b16 a[182:183], v11 offset:8192
    buffer_load_dwordx4 v15, s[24:27], s30 offen offset:1024 lds
    v_mfma_f32_16x16x32_bf16 v[120:123], a[148:151], a[200:203], v[120:123]
    ds_read_b64_tr_b16 a[186:187], v12 offset:8192
    v_mfma_f32_16x16x32_bf16 v[124:127], a[148:151], a[204:207], v[124:127]
    ds_read_b64_tr_b16 a[190:191], v13 offset:8192
    v_mfma_f32_16x16x32_bf16 v[128:131], a[152:155], a[192:195], v[128:131]
    v_mfma_f32_16x16x32_bf16 v[132:135], a[152:155], a[196:199], v[132:135]
    buffer_load_dwordx4 v16, s[24:27], s30 offen offset:2048 lds
    v_mfma_f32_16x16x32_bf16 v[136:139], a[152:155], a[200:203], v[136:139]
    v_mfma_f32_16x16x32_bf16 v[140:143], a[152:155], a[204:207], v[140:143]
    v_mfma_f32_16x16x32_bf16 v[144:147], a[156:159], a[192:195], v[144:147]
    v_mfma_f32_16x16x32_bf16 v[148:151], a[156:159], a[196:199], v[148:151]
    buffer_load_dwordx4 v17, s[24:27], s30 offen offset:3072 lds
    v_mfma_f32_16x16x32_bf16 v[152:155], a[156:159], a[200:203], v[152:155]
    s_add_u32 s30, s30, 16384
    v_mfma_f32_16x16x32_bf16 v[156:159], a[156:159], a[204:207], v[156:159]
    s_waitcnt lgkmcnt(0) vmcnt(16)
    v_mfma_f32_16x16x32_bf16 v[32:35], a[160:163], a[208:211], v[32:35]
    ds_read_b128 a[192:195], v4 offset:512
    s_add_u32 m0, s33, 8192
    v_mfma_f32_16x16x32_bf16 v[36:39], a[160:163], a[212:215], v[36:39]
    ds_read_b128 a[196:199], v4 offset:16896
    buffer_load_dwordx4 v14, s[24:27], s30 offen offset:0 lds
    v_mfma_f32_16x16x32_bf16 v[40:43], a[160:163], a[216:219], v[40:43]
    ds_read_b128 a[200:203], v4 offset:33280
    v_mfma_f32_16x16x32_bf16 v[44:47], a[160:163], a[220:223], v[44:47]
    ds_read_b128 a[204:207], v4 offset:49664
    v_mfma_f32_16x16x32_bf16 v[48:51], a[164:167], a[208:211], v[48:51]
    ds_read_b64_tr_b16 a[128:129], v6 offset:12288
    v_mfma_f32_16x16x32_bf16 v[52:55], a[164:167], a[212:215], v[52:55]
    ds_read_b64_tr_b16 a[132:133], v7 offset:12288
    buffer_load_dwordx4 v15, s[24:27], s30 offen offset:1024 lds
    v_mfma_f32_16x16x32_bf16 v[56:59], a[164:167], a[216:219], v[56:59]
    ds_read_b64_tr_b16 a[136:137], v8 offset:12288
    v_mfma_f32_16x16x32_bf16 v[60:63], a[164:167], a[220:223], v[60:63]
    ds_read_b64_tr_b16 a[140:141], v9 offset:12288
    v_mfma_f32_16x16x32_bf16 v[64:67], a[168:171], a[208:211], v[64:67]
    ds_read_b64_tr_b16 a[144:145], v10 offset:12288
    v_mfma_f32_16x16x32_bf16 v[68:71], a[168:171], a[212:215], v[68:71]
    ds_read_b64_tr_b16 a[148:149], v11 offset:12288
    buffer_load_dwordx4 v16, s[24:27], s30 offen offset:2048 lds
    v_mfma_f32_16x16x32_bf16 v[72:75], a[168:171], a[216:219], v[72:75]
    ds_read_b64_tr_b16 a[152:153], v12 offset:12288
    v_mfma_f32_16x16x32_bf16 v[76:79], a[168:171], a[220:223], v[76:79]
    ds_read_b64_tr_b16 a[156:157], v13 offset:12288
    v_mfma_f32_16x16x32_bf16 v[80:83], a[172:175], a[208:211], v[80:83]
    v_mfma_f32_16x16x32_bf16 v[84:87], a[172:175], a[212:215], v[84:87]
    buffer_load_dwordx4 v17, s[24:27], s30 offen offset:3072 lds
    v_mfma_f32_16x16x32_bf16 v[88:91], a[172:175], a[216:219], v[88:91]
    s_add_u32 s30, s30, 16384
    v_mfma_f32_16x16x32_bf16 v[92:95], a[172:175], a[220:223], v[92:95]
    s_waitcnt lgkmcnt(0) vmcnt(16)
    v_mfma_f32_16x16x32_bf16 v[96:99], a[176:179], a[208:211], v[96:99]
    ds_read_b64_tr_b16 a[130:131], v6 offset:16384
    s_add_u32 m0, s33, 12288
    v_mfma_f32_16x16x32_bf16 v[100:103], a[176:179], a[212:215], v[100:103]
    ds_read_b64_tr_b16 a[134:135], v7 offset:16384
    buffer_load_dwordx4 v14, s[24:27], s30 offen offset:0 lds
    v_mfma_f32_16x16x32_bf16 v[104:107], a[176:179], a[216:219], v[104:107]
    ds_read_b64_tr_b16 a[138:139], v8 offset:16384
    v_mfma_f32_16x16x32_bf16 v[108:111], a[176:179], a[220:223], v[108:111]
    ds_read_b64_tr_b16 a[142:143], v9 offset:16384
    v_mfma_f32_16x16x32_bf16 v[112:115], a[180:183], a[208:211], v[112:115]
    ds_read_b64_tr_b16 a[146:147], v10 offset:16384
    v_mfma_f32_16x16x32_bf16 v[116:119], a[180:183], a[212:215], v[116:119]
    ds_read_b64_tr_b16 a[150:151], v11 offset:16384
    buffer_load_dwordx4 v15, s[24:27], s30 offen offset:1024 lds
    v_mfma_f32_16x16x32_bf16 v[120:123], a[180:183], a[216:219], v[120:123]
    ds_read_b64_tr_b16 a[154:155], v12 offset:16384
    v_mfma_f32_16x16x32_bf16 v[124:127], a[180:183], a[220:223], v[124:127]
    ds_read_b64_tr_b16 a[158:159], v13 offset:16384
    v_mfma_f32_16x16x32_bf16 v[128:131], a[184:187], a[208:211], v[128:131]
    v_mfma_f32_16x16x32_bf16 v[132:135], a[184:187], a[212:215], v[132:135]
    buffer_load_dwordx4 v16, s[24:27], s30 offen offset:2048 lds
    v_mfma_f32_16x16x32_bf16 v[136:139], a[184:187], a[216:219], v[136:139]
    v_mfma_f32_16x16x32_bf16 v[140:143], a[184:187], a[220:223], v[140:143]
    v_mfma_f32_16x16x32_bf16 v[144:147], a[188:191], a[208:211], v[144:147]
    v_mfma_f32_16x16x32_bf16 v[148:151], a[188:191], a[212:215], v[148:151]
    buffer_load_dwordx4 v17, s[24:27], s30 offen offset:3072 lds
    v_mfma_f32_16x16x32_bf16 v[152:155], a[188:191], a[216:219], v[152:155]
    s_add_u32 s30, s30, 16384
    v_mfma_f32_16x16x32_bf16 v[156:159], a[188:191], a[220:223], v[156:159]
    s_waitcnt lgkmcnt(0) vmcnt(16)
    v_mfma_f32_16x16x32_bf16 v[32:35], a[128:131], a[192:195], v[32:35]
    ds_read_b128 a[208:211], v5 offset:512
    s_add_u32 m0, s33, 16384
    v_mfma_f32_16x16x32_bf16 v[36:39], a[128:131], a[196:199], v[36:39]
    ds_read_b128 a[212:215], v5 offset:16896
    buffer_load_dwordx4 v14, s[24:27], s30 offen offset:0 lds
    v_mfma_f32_16x16x32_bf16 v[40:43], a[128:131], a[200:203], v[40:43]
    ds_read_b128 a[216:219], v5 offset:33280
    v_mfma_f32_16x16x32_bf16 v[44:47], a[128:131], a[204:207], v[44:47]
    ds_read_b128 a[220:223], v5 offset:49664
    v_mfma_f32_16x16x32_bf16 v[48:51], a[132:135], a[192:195], v[48:51]
    ds_read_b64_tr_b16 a[160:161], v6 offset:0
    v_mfma_f32_16x16x32_bf16 v[52:55], a[132:135], a[196:199], v[52:55]
    ds_read_b64_tr_b16 a[164:165], v7 offset:0
    buffer_load_dwordx4 v15, s[24:27], s30 offen offset:1024 lds
    v_mfma_f32_16x16x32_bf16 v[56:59], a[132:135], a[200:203], v[56:59]
    ds_read_b64_tr_b16 a[168:169], v8 offset:0
    v_mfma_f32_16x16x32_bf16 v[60:63], a[132:135], a[204:207], v[60:63]
    ds_read_b64_tr_b16 a[172:173], v9 offset:0
    v_mfma_f32_16x16x32_bf16 v[64:67], a[136:139], a[192:195], v[64:67]
    ds_read_b64_tr_b16 a[176:177], v10 offset:0
    v_mfma_f32_16x16x32_bf16 v[68:71], a[136:139], a[196:199], v[68:71]
    ds_read_b64_tr_b16 a[180:181], v11 offset:0
    buffer_load_dwordx4 v16, s[24:27], s30 offen offset:2048 lds
    v_mfma_f32_16x16x32_bf16 v[72:75], a[136:139], a[200:203], v[72:75]
    ds_read_b64_tr_b16 a[184:185], v12 offset:0
    v_mfma_f32_16x16x32_bf16 v[76:79], a[136:139], a[204:207], v[76:79]
    ds_read_b64_tr_b16 a[188:189], v13 offset:0
    v_mfma_f32_16x16x32_bf16 v[80:83], a[140:143], a[192:195], v[80:83]
    v_mfma_f32_16x16x32_bf16 v[84:87], a[140:143], a[196:199], v[84:87]
    buffer_load_dwordx4 v17, s[24:27], s30 offen offset:3072 lds
    v_mfma_f32_16x16x32_bf16 v[88:91], a[140:143], a[200:203], v[88:91]
    s_add_u32 s30, s30, 16384
    v_mfma_f32_16x16x32_bf16 v[92:95], a[140:143], a[204:207], v[92:95]
    s_waitcnt lgkmcnt(0) vmcnt(16)
    v_mfma_f32_16x16x32_bf16 v[96:99], a[144:147], a[192:195], v[96:99]
    ds_read_b64_tr_b16 a[162:163], v6 offset:4096
    s_add_u32 m0, s33, 0
    v_mfma_f32_16x16x32_bf16 v[100:103], a[144:147], a[196:199], v[100:103]
    ds_read_b64_tr_b16 a[166:167], v7 offset:4096
    buffer_load_dwordx4 v14, s[24:27], s30 offen offset:0 lds
    v_mfma_f32_16x16x32_bf16 v[104:107], a[144:147], a[200:203], v[104:107]
    ds_read_b64_tr_b16 a[170:171], v8 offset:4096
    v_mfma_f32_16x16x32_bf16 v[108:111], a[144:147], a[204:207], v[108:111]
    ds_read_b64_tr_b16 a[174:175], v9 offset:4096
    v_mfma_f32_16x16x32_bf16 v[112:115], a[148:151], a[192:195], v[112:115]
    ds_read_b64_tr_b16 a[178:179], v10 offset:4096
    v_mfma_f32_16x16x32_bf16 v[116:119], a[148:151], a[196:199], v[116:119]
    ds_read_b64_tr_b16 a[182:183], v11 offset:4096
    buffer_load_dwordx4 v15, s[24:27], s30 offen offset:1024 lds
    v_mfma_f32_16x16x32_bf16 v[120:123], a[148:151], a[200:203], v[120:123]
    ds_read_b64_tr_b16 a[186:187], v12 offset:4096
    v_mfma_f32_16x16x32_bf16 v[124:127], a[148:151], a[204:207], v[124:127]
    ds_read_b64_tr_b16 a[190:191], v13 offset:4096
    v_mfma_f32_16x16x32_bf16 v[128:131], a[152:155], a[192:195], v[128:131]
    v_mfma_f32_16x16x32_bf16 v[132:135], a[152:155], a[196:199], v[132:135]
    buffer_load_dwordx4 v16, s[24:27], s30 offen offset:2048 lds
    v_mfma_f32_16x16x32_bf16 v[136:139], a[152:155], a[200:203], v[136:139]
    v_mfma_f32_16x16x32_bf16 v[140:143], a[152:155], a[204:207], v[140:143]
    v_mfma_f32_16x16x32_bf16 v[144:147], a[156:159], a[192:195], v[144:147]
    v_mfma_f32_16x16x32_bf16 v[148:151], a[156:159], a[196:199], v[148:151]
    buffer_load_dwordx4 v17, s[24:27], s30 offen offset:3072 lds
    v_mfma_f32_16x16x32_bf16 v[152:155], a[156:159], a[200:203], v[152:155]
    s_add_u32 s30, s30, 16384
    v_mfma_f32_16x16x32_bf16 v[156:159], a[156:159], a[204:207], v[156:159]
    s_waitcnt lgkmcnt(0) vmcnt(16)
    v_mfma_f32_16x16x32_bf16 v[32:35], a[160:163], a[208:211], v[32:35]
    ds_read_b128 a[192:195], v2 offset:768
    s_add_u32 m0, s33, 4096
    v_mfma_f32_16x16x32_bf16 v[36:39], a[160:163], a[212:215], v[36:39]
    ds_read_b128 a[196:199], v2 offset:17152
    buffer_load_dwordx4 v14, s[24:27], s30 offen offset:0 lds
    v_mfma_f32_16x16x32_bf16 v[40:43], a[160:163], a[216:219], v[40:43]
    ds_read_b128 a[200:203], v2 offset:33536
    v_mfma_f32_16x16x32_bf16 v[44:47], a[160:163], a[220:223], v[44:47]
    ds_read_b128 a[204:207], v2 offset:49920
    v_mfma_f32_16x16x32_bf16 v[48:51], a[164:167], a[208:211], v[48:51]
    ds_read_b64_tr_b16 a[128:129], v6 offset:20480
    v_mfma_f32_16x16x32_bf16 v[52:55], a[164:167], a[212:215], v[52:55]
    ds_read_b64_tr_b16 a[132:133], v7 offset:20480
    buffer_load_dwordx4 v15, s[24:27], s30 offen offset:1024 lds
    v_mfma_f32_16x16x32_bf16 v[56:59], a[164:167], a[216:219], v[56:59]
    ds_read_b64_tr_b16 a[136:137], v8 offset:20480
    v_mfma_f32_16x16x32_bf16 v[60:63], a[164:167], a[220:223], v[60:63]
    ds_read_b64_tr_b16 a[140:141], v9 offset:20480
    v_mfma_f32_16x16x32_bf16 v[64:67], a[168:171], a[208:211], v[64:67]
    ds_read_b64_tr_b16 a[144:145], v10 offset:20480
    v_mfma_f32_16x16x32_bf16 v[68:71], a[168:171], a[212:215], v[68:71]
    ds_read_b64_tr_b16 a[148:149], v11 offset:20480
    buffer_load_dwordx4 v16, s[24:27], s30 offen offset:2048 lds
    v_mfma_f32_16x16x32_bf16 v[72:75], a[168:171], a[216:219], v[72:75]
    ds_read_b64_tr_b16 a[152:153], v12 offset:20480
    v_mfma_f32_16x16x32_bf16 v[76:79], a[168:171], a[220:223], v[76:79]
    ds_read_b64_tr_b16 a[156:157], v13 offset:20480
    v_mfma_f32_16x16x32_bf16 v[80:83], a[172:175], a[208:211], v[80:83]
    v_mfma_f32_16x16x32_bf16 v[84:87], a[172:175], a[212:215], v[84:87]
    buffer_load_dwordx4 v17, s[24:27], s30 offen offset:3072 lds
    v_mfma_f32_16x16x32_bf16 v[88:91], a[172:175], a[216:219], v[88:91]
    s_add_u32 s30, s30, 16384
    v_mfma_f32_16x16x32_bf16 v[92:95], a[172:175], a[220:223], v[92:95]
    s_waitcnt lgkmcnt(0) vmcnt(16)
    v_mfma_f32_16x16x32_bf16 v[96:99], a[176:179], a[208:211], v[96:99]
    ds_read_b64_tr_b16 a[130:131], v6 offset:8192
    s_add_u32 m0, s33, 20480
    v_mfma_f32_16x16x32_bf16 v[100:103], a[176:179], a[212:215], v[100:103]
    ds_read_b64_tr_b16 a[134:135], v7 offset:8192
    buffer_load_dwordx4 v14, s[24:27], s30 offen offset:0 lds
    v_mfma_f32_16x16x32_bf16 v[104:107], a[176:179], a[216:219], v[104:107]
    ds_read_b64_tr_b16 a[138:139], v8 offset:8192
    v_mfma_f32_16x16x32_bf16 v[108:111], a[176:179], a[220:223], v[108:111]
    ds_read_b64_tr_b16 a[142:143], v9 offset:8192
    v_mfma_f32_16x16x32_bf16 v[112:115], a[180:183], a[208:211], v[112:115]
    ds_read_b64_tr_b16 a[146:147], v10 offset:8192
    v_mfma_f32_16x16x32_bf16 v[116:119], a[180:183], a[212:215], v[116:119]
    ds_read_b64_tr_b16 a[150:151], v11 offset:8192
    buffer_load_dwordx4 v15, s[24:27], s30 offen offset:1024 lds
    v_mfma_f32_16x16x32_bf16 v[120:123], a[180:183], a[216:219], v[120:123]
    ds_read_b64_tr_b16 a[154:155], v12 offset:8192
    v_mfma_f32_16x16x32_bf16 v[124:127], a[180:183], a[220:223], v[124:127]
    ds_read_b64_tr_b16 a[158:159], v13 offset:8192
    v_mfma_f32_16x16x32_bf16 v[128:131], a[184:187], a[208:211], v[128:131]
    v_mfma_f32_16x16x32_bf16 v[132:135], a[184:187], a[212:215], v[132:135]
    buffer_load_dwordx4 v16, s[24:27], s30 offen offset:2048 lds
    v_mfma_f32_16x16x32_bf16 v[136:139], a[184:187], a[216:219], v[136:139]
    v_mfma_f32_16x16x32_bf16 v[140:143], a[184:187], a[220:223], v[140:143]
    v_mfma_f32_16x16x32_bf16 v[144:147], a[188:191], a[208:211], v[144:147]
    v_mfma_f32_16x16x32_bf16 v[148:151], a[188:191], a[212:215], v[148:151]
    buffer_load_dwordx4 v17, s[24:27], s30 offen offset:3072 lds
    v_mfma_f32_16x16x32_bf16 v[152:155], a[188:191], a[216:219], v[152:155]
    s_add_u32 s30, s30, 16384
    v_mfma_f32_16x16x32_bf16 v[156:159], a[188:191], a[220:223], v[156:159]
    s_waitcnt lgkmcnt(0) vmcnt(16)
    v_mfma_f32_16x16x32_bf16 v[32:35], a[128:131], a[192:195], v[32:35]
    ds_read_b128 a[208:211], v3 offset:768
    s_add_u32 m0, s33, 8192
    v_mfma_f32_16x16x32_bf16 v[36:39], a[128:131], a[196:199], v[36:39]
    ds_read_b128 a[212:215], v3 offset:17152
    buffer_load_dwordx4 v14, s[24:27], s30 offen offset:0 lds
    v_mfma_f32_16x16x32_bf16 v[40:43], a[128:131], a[200:203], v[40:43]
    ds_read_b128 a[216:219], v3 offset:33536
    v_mfma_f32_16x16x32_bf16 v[44:47], a[128:131], a[204:207], v[44:47]
    ds_read_b128 a[220:223], v3 offset:49920
    v_mfma_f32_16x16x32_bf16 v[48:51], a[132:135], a[192:195], v[48:51]
    ds_read_b64_tr_b16 a[160:161], v6 offset:12288
    v_mfma_f32_16x16x32_bf16 v[52:55], a[132:135], a[196:199], v[52:55]
    ds_read_b64_tr_b16 a[164:165], v7 offset:12288
    buffer_load_dwordx4 v15, s[24:27], s30 offen offset:1024 lds
    v_mfma_f32_16x16x32_bf16 v[56:59], a[132:135], a[200:203], v[56:59]
    ds_read_b64_tr_b16 a[168:169], v8 offset:12288
    v_mfma_f32_16x16x32_bf16 v[60:63], a[132:135], a[204:207], v[60:63]
    ds_read_b64_tr_b16 a[172:173], v9 offset:12288
    v_mfma_f32_16x16x32_bf16 v[64:67], a[136:139], a[192:195], v[64:67]
    ds_read_b64_tr_b16 a[176:177], v10 offset:12288
    v_mfma_f32_16x16x32_bf16 v[68:71], a[136:139], a[196:199], v[68:71]
    ds_read_b64_tr_b16 a[180:181], v11 offset:12288
    buffer_load_dwordx4 v16, s[24:27], s30 offen offset:2048 lds
    v_mfma_f32_16x16x32_bf16 v[72:75], a[136:139], a[200:203], v[72:75]
    ds_read_b64_tr_b16 a[184:185], v12 offset:12288
    v_mfma_f32_16x16x32_bf16 v[76:79], a[136:139], a[204:207], v[76:79]
    ds_read_b64_tr_b16 a[188:189], v13 offset:12288
    v_mfma_f32_16x16x32_bf16 v[80:83], a[140:143], a[192:195], v[80:83]
    v_mfma_f32_16x16x32_bf16 v[84:87], a[140:143], a[196:199], v[84:87]
    buffer_load_dwordx4 v17, s[24:27], s30 offen offset:3072 lds
    v_mfma_f32_16x16x32_bf16 v[88:91], a[140:143], a[200:203], v[88:91]
    s_add_u32 s30, s30, 16384
    v_mfma_f32_16x16x32_bf16 v[92:95], a[140:143], a[204:207], v[92:95]
    s_waitcnt lgkmcnt(0) vmcnt(16)
    v_mfma_f32_16x16x32_bf16 v[96:99], a[144:147], a[192:195], v[96:99]
    ds_read_b64_tr_b16 a[162:163], v6 offset:16384
    v_mfma_f32_16x16x32_bf16 v[100:103], a[144:147], a[196:199], v[100:103]
    ds_read_b64_tr_b16 a[166:167], v7 offset:16384
    v_mfma_f32_16x16x32_bf16 v[104:107], a[144:147], a[200:203], v[104:107]
    ds_read_b64_tr_b16 a[170:171], v8 offset:16384
    v_mfma_f32_16x16x32_bf16 v[108:111], a[144:147], a[204:207], v[108:111]
    ds_read_b64_tr_b16 a[174:175], v9 offset:16384
    v_mfma_f32_16x16x32_bf16 v[112:115], a[148:151], a[192:195], v[112:115]
    ds_read_b64_tr_b16 a[178:179], v10 offset:16384
    v_mfma_f32_16x16x32_bf16 v[116:119], a[148:151], a[196:199], v[116:119]
    ds_read_b64_tr_b16 a[182:183], v11 offset:16384
    v_mfma_f32_16x16x32_bf16 v[120:123], a[148:151], a[200:203], v[120:123]
    ds_read_b64_tr_b16 a[186:187], v12 offset:16384
    v_mfma_f32_16x16x32_bf16 v[124:127], a[148:151], a[204:207], v[124:127]
    ds_read_b64_tr_b16 a[190:191], v13 offset:16384
    v_mfma_f32_16x16x32_bf16 v[128:131], a[152:155], a[192:195], v[128:131]
    v_mfma_f32_16x16x32_bf16 v[132:135], a[152:155], a[196:199], v[132:135]
    v_mfma_f32_16x16x32_bf16 v[136:139], a[152:155], a[200:203], v[136:139]
    v_mfma_f32_16x16x32_bf16 v[140:143], a[152:155], a[204:207], v[140:143]
    v_mfma_f32_16x16x32_bf16 v[144:147], a[156:159], a[192:195], v[144:147]
    v_mfma_f32_16x16x32_bf16 v[148:151], a[156:159], a[196:199], v[148:151]
    v_mfma_f32_16x16x32_bf16 v[152:155], a[156:159], a[200:203], v[152:155]
    v_mfma_f32_16x16x32_bf16 v[156:159], a[156:159], a[204:207], v[156:159]
    s_waitcnt lgkmcnt(0) vmcnt(12)
    v_mfma_f32_16x16x32_bf16 v[32:35], a[160:163], a[208:211], v[32:35]
    ds_read_b128 a[192:195], v4 offset:768
    v_mfma_f32_16x16x32_bf16 v[36:39], a[160:163], a[212:215], v[36:39]
    ds_read_b128 a[196:199], v4 offset:17152
    v_mfma_f32_16x16x32_bf16 v[40:43], a[160:163], a[216:219], v[40:43]
    ds_read_b128 a[200:203], v4 offset:33536
    v_mfma_f32_16x16x32_bf16 v[44:47], a[160:163], a[220:223], v[44:47]
    ds_read_b128 a[204:207], v4 offset:49920
    v_mfma_f32_16x16x32_bf16 v[48:51], a[164:167], a[208:211], v[48:51]
    ds_read_b64_tr_b16 a[128:129], v6 offset:0
    v_mfma_f32_16x16x32_bf16 v[52:55], a[164:167], a[212:215], v[52:55]
    ds_read_b64_tr_b16 a[132:133], v7 offset:0
    v_mfma_f32_16x16x32_bf16 v[56:59], a[164:167], a[216:219], v[56:59]
    ds_read_b64_tr_b16 a[136:137], v8 offset:0
    v_mfma_f32_16x16x32_bf16 v[60:63], a[164:167], a[220:223], v[60:63]
    ds_read_b64_tr_b16 a[140:141], v9 offset:0
    v_mfma_f32_16x16x32_bf16 v[64:67], a[168:171], a[208:211], v[64:67]
    ds_read_b64_tr_b16 a[144:145], v10 offset:0
    v_mfma_f32_16x16x32_bf16 v[68:71], a[168:171], a[212:215], v[68:71]
    ds_read_b64_tr_b16 a[148:149], v11 offset:0
    v_mfma_f32_16x16x32_bf16 v[72:75], a[168:171], a[216:219], v[72:75]
    ds_read_b64_tr_b16 a[152:153], v12 offset:0
    v_mfma_f32_16x16x32_bf16 v[76:79], a[168:171], a[220:223], v[76:79]
    ds_read_b64_tr_b16 a[156:157], v13 offset:0
    v_mfma_f32_16x16x32_bf16 v[80:83], a[172:175], a[208:211], v[80:83]
    v_mfma_f32_16x16x32_bf16 v[84:87], a[172:175], a[212:215], v[84:87]
    v_mfma_f32_16x16x32_bf16 v[88:91], a[172:175], a[216:219], v[88:91]
    v_mfma_f32_16x16x32_bf16 v[92:95], a[172:175], a[220:223], v[92:95]
    s_waitcnt lgkmcnt(0) vmcnt(8)
    v_mfma_f32_16x16x32_bf16 v[96:99], a[176:179], a[208:211], v[96:99]
    ds_read_b64_tr_b16 a[130:131], v6 offset:4096
    v_mfma_f32_16x16x32_bf16 v[100:103], a[176:179], a[212:215], v[100:103]
    ds_read_b64_tr_b16 a[134:135], v7 offset:4096
    v_mfma_f32_16x16x32_bf16 v[104:107], a[176:179], a[216:219], v[104:107]
    ds_read_b64_tr_b16 a[138:139], v8 offset:4096
    v_mfma_f32_16x16x32_bf16 v[108:111], a[176:179], a[220:223], v[108:111]
    ds_read_b64_tr_b16 a[142:143], v9 offset:4096
    v_mfma_f32_16x16x32_bf16 v[112:115], a[180:183], a[208:211], v[112:115]
    ds_read_b64_tr_b16 a[146:147], v10 offset:4096
    v_mfma_f32_16x16x32_bf16 v[116:119], a[180:183], a[212:215], v[116:119]
    ds_read_b64_tr_b16 a[150:151], v11 offset:4096
    v_mfma_f32_16x16x32_bf16 v[120:123], a[180:183], a[216:219], v[120:123]
    ds_read_b64_tr_b16 a[154:155], v12 offset:4096
    v_mfma_f32_16x16x32_bf16 v[124:127], a[180:183], a[220:223], v[124:127]
    ds_read_b64_tr_b16 a[158:159], v13 offset:4096
    v_mfma_f32_16x16x32_bf16 v[128:131], a[184:187], a[208:211], v[128:131]
    v_mfma_f32_16x16x32_bf16 v[132:135], a[184:187], a[212:215], v[132:135]
    v_mfma_f32_16x16x32_bf16 v[136:139], a[184:187], a[216:219], v[136:139]
    v_mfma_f32_16x16x32_bf16 v[140:143], a[184:187], a[220:223], v[140:143]
    v_mfma_f32_16x16x32_bf16 v[144:147], a[188:191], a[208:211], v[144:147]
    v_mfma_f32_16x16x32_bf16 v[148:151], a[188:191], a[212:215], v[148:151]
    v_mfma_f32_16x16x32_bf16 v[152:155], a[188:191], a[216:219], v[152:155]
    v_mfma_f32_16x16x32_bf16 v[156:159], a[188:191], a[220:223], v[156:159]
    s_waitcnt lgkmcnt(0) vmcnt(4)
    v_mfma_f32_16x16x32_bf16 v[32:35], a[128:131], a[192:195], v[32:35]
    ds_read_b128 a[208:211], v5 offset:768
    v_mfma_f32_16x16x32_bf16 v[36:39], a[128:131], a[196:199], v[36:39]
    ds_read_b128 a[212:215], v5 offset:17152
    v_mfma_f32_16x16x32_bf16 v[40:43], a[128:131], a[200:203], v[40:43]
    ds_read_b128 a[216:219], v5 offset:33536
    v_mfma_f32_16x16x32_bf16 v[44:47], a[128:131], a[204:207], v[44:47]
    ds_read_b128 a[220:223], v5 offset:49920
    v_mfma_f32_16x16x32_bf16 v[48:51], a[132:135], a[192:195], v[48:51]
    ds_read_b64_tr_b16 a[160:161], v6 offset:20480
    v_mfma_f32_16x16x32_bf16 v[52:55], a[132:135], a[196:199], v[52:55]
    ds_read_b64_tr_b16 a[164:165], v7 offset:20480
    v_mfma_f32_16x16x32_bf16 v[56:59], a[132:135], a[200:203], v[56:59]
    ds_read_b64_tr_b16 a[168:169], v8 offset:20480
    v_mfma_f32_16x16x32_bf16 v[60:63], a[132:135], a[204:207], v[60:63]
    ds_read_b64_tr_b16 a[172:173], v9 offset:20480
    v_mfma_f32_16x16x32_bf16 v[64:67], a[136:139], a[192:195], v[64:67]
    ds_read_b64_tr_b16 a[176:177], v10 offset:20480
    v_mfma_f32_16x16x32_bf16 v[68:71], a[136:139], a[196:199], v[68:71]
    ds_read_b64_tr_b16 a[180:181], v11 offset:20480
    v_mfma_f32_16x16x32_bf16 v[72:75], a[136:139], a[200:203], v[72:75]
    ds_read_b64_tr_b16 a[184:185], v12 offset:20480
    v_mfma_f32_16x16x32_bf16 v[76:79], a[136:139], a[204:207], v[76:79]
    ds_read_b64_tr_b16 a[188:189], v13 offset:20480
    v_mfma_f32_16x16x32_bf16 v[80:83], a[140:143], a[192:195], v[80:83]
    v_mfma_f32_16x16x32_bf16 v[84:87], a[140:143], a[196:199], v[84:87]
    v_mfma_f32_16x16x32_bf16 v[88:91], a[140:143], a[200:203], v[88:91]
    v_mfma_f32_16x16x32_bf16 v[92:95], a[140:143], a[204:207], v[92:95]
    s_waitcnt lgkmcnt(0) vmcnt(0)
    v_mfma_f32_16x16x32_bf16 v[96:99], a[144:147], a[192:195], v[96:99]
    ds_read_b64_tr_b16 a[162:163], v6 offset:8192
    v_mfma_f32_16x16x32_bf16 v[100:103], a[144:147], a[196:199], v[100:103]
    ds_read_b64_tr_b16 a[166:167], v7 offset:8192
    v_mfma_f32_16x16x32_bf16 v[104:107], a[144:147], a[200:203], v[104:107]
    ds_read_b64_tr_b16 a[170:171], v8 offset:8192
    v_mfma_f32_16x16x32_bf16 v[108:111], a[144:147], a[204:207], v[108:111]
    ds_read_b64_tr_b16 a[174:175], v9 offset:8192
    v_mfma_f32_16x16x32_bf16 v[112:115], a[148:151], a[192:195], v[112:115]
    ds_read_b64_tr_b16 a[178:179], v10 offset:8192
    v_mfma_f32_16x16x32_bf16 v[116:119], a[148:151], a[196:199], v[116:119]
    ds_read_b64_tr_b16 a[182:183], v11 offset:8192
    v_mfma_f32_16x16x32_bf16 v[120:123], a[148:151], a[200:203], v[120:123]
    ds_read_b64_tr_b16 a[186:187], v12 offset:8192
    v_mfma_f32_16x16x32_bf16 v[124:127], a[148:151], a[204:207], v[124:127]
    ds_read_b64_tr_b16 a[190:191], v13 offset:8192
    v_mfma_f32_16x16x32_bf16 v[128:131], a[152:155], a[192:195], v[128:131]
    v_mfma_f32_16x16x32_bf16 v[132:135], a[152:155], a[196:199], v[132:135]
    v_mfma_f32_16x16x32_bf16 v[136:139], a[152:155], a[200:203], v[136:139]
    v_mfma_f32_16x16x32_bf16 v[140:143], a[152:155], a[204:207], v[140:143]
    v_mfma_f32_16x16x32_bf16 v[144:147], a[156:159], a[192:195], v[144:147]
    v_mfma_f32_16x16x32_bf16 v[148:151], a[156:159], a[196:199], v[148:151]
    v_mfma_f32_16x16x32_bf16 v[152:155], a[156:159], a[200:203], v[152:155]
    v_mfma_f32_16x16x32_bf16 v[156:159], a[156:159], a[204:207], v[156:159]
    s_waitcnt lgkmcnt(0)
    v_mfma_f32_16x16x32_bf16 v[32:35], a[160:163], a[208:211], v[32:35]
    v_mfma_f32_16x16x32_bf16 v[36:39], a[160:163], a[212:215], v[36:39]
    v_mfma_f32_16x16x32_bf16 v[40:43], a[160:163], a[216:219], v[40:43]
    v_mfma_f32_16x16x32_bf16 v[44:47], a[160:163], a[220:223], v[44:47]
    v_mfma_f32_16x16x32_bf16 v[48:51], a[164:167], a[208:211], v[48:51]
    v_mfma_f32_16x16x32_bf16 v[52:55], a[164:167], a[212:215], v[52:55]
    v_mfma_f32_16x16x32_bf16 v[56:59], a[164:167], a[216:219], v[56:59]
    v_mfma_f32_16x16x32_bf16 v[60:63], a[164:167], a[220:223], v[60:63]
    v_mfma_f32_16x16x32_bf16 v[64:67], a[168:171], a[208:211], v[64:67]
    v_mfma_f32_16x16x32_bf16 v[68:71], a[168:171], a[212:215], v[68:71]
    v_cvt_pk_bf16_f32 v160, v32, v33
    v_cvt_pk_bf16_f32 v161, v34, v35
    v_mfma_f32_16x16x32_bf16 v[72:75], a[168:171], a[216:219], v[72:75]
    v_cvt_pk_bf16_f32 v162, v48, v49
    v_cvt_pk_bf16_f32 v163, v50, v51
    v_mfma_f32_16x16x32_bf16 v[76:79], a[168:171], a[220:223], v[76:79]
    v_cvt_pk_bf16_f32 v176, v36, v37
    v_cvt_pk_bf16_f32 v177, v38, v39
    v_mfma_f32_16x16x32_bf16 v[80:83], a[172:175], a[208:211], v[80:83]
    v_cvt_pk_bf16_f32 v178, v52, v53
    v_cvt_pk_bf16_f32 v179, v54, v55
    v_mfma_f32_16x16x32_bf16 v[84:87], a[172:175], a[212:215], v[84:87]
    v_cvt_pk_bf16_f32 v192, v40, v41
    v_cvt_pk_bf16_f32 v193, v42, v43
    v_mfma_f32_16x16x32_bf16 v[88:91], a[172:175], a[216:219], v[88:91]
    v_cvt_pk_bf16_f32 v194, v56, v57
    v_cvt_pk_bf16_f32 v195, v58, v59
    v_mfma_f32_16x16x32_bf16 v[92:95], a[172:175], a[220:223], v[92:95]
    v_cvt_pk_bf16_f32 v208, v44, v45
    v_cvt_pk_bf16_f32 v209, v46, v47
    v_mfma_f32_16x16x32_bf16 v[96:99], a[176:179], a[208:211], v[96:99]
    v_cvt_pk_bf16_f32 v210, v60, v61
    v_cvt_pk_bf16_f32 v211, v62, v63
    v_mfma_f32_16x16x32_bf16 v[100:103], a[176:179], a[212:215], v[100:103]
    v_permlane16_swap_b32 v160, v162
    v_permlane16_swap_b32 v161, v163
    v_mfma_f32_16x16x32_bf16 v[104:107], a[176:179], a[216:219], v[104:107]
    v_permlane16_swap_b32 v176, v178
    v_permlane16_swap_b32 v177, v179
    v_mfma_f32_16x16x32_bf16 v[108:111], a[176:179], a[220:223], v[108:111]
    v_permlane16_swap_b32 v192, v194
    v_permlane16_swap_b32 v193, v195
    v_mfma_f32_16x16x32_bf16 v[112:115], a[180:183], a[208:211], v[112:115]
    v_permlane16_swap_b32 v208, v210
    v_permlane16_swap_b32 v209, v211
    v_mfma_f32_16x16x32_bf16 v[116:119], a[180:183], a[212:215], v[116:119]
    buffer_store_dwordx4 v[160:163], v248, s[8:11], s36 offen offset:0 sc1
    buffer_store_dwordx4 v[176:179], v248, s[8:11], s37 offen offset:0 sc1
    v_mfma_f32_16x16x32_bf16 v[120:123], a[180:183], a[216:219], v[120:123]
    buffer_store_dwordx4 v[192:195], v248, s[8:11], s38 offen offset:0 sc1
    buffer_store_dwordx4 v[208:211], v248, s[8:11], s39 offen offset:0 sc1
    v_mfma_f32_16x16x32_bf16 v[124:127], a[180:183], a[220:223], v[124:127]
    v_cvt_pk_bf16_f32 v164, v64, v65
    v_cvt_pk_bf16_f32 v165, v66, v67
    v_mfma_f32_16x16x32_bf16 v[128:131], a[184:187], a[208:211], v[128:131]
    v_cvt_pk_bf16_f32 v166, v80, v81
    v_cvt_pk_bf16_f32 v167, v82, v83
    v_mfma_f32_16x16x32_bf16 v[132:135], a[184:187], a[212:215], v[132:135]
    v_cvt_pk_bf16_f32 v180, v68, v69
    v_cvt_pk_bf16_f32 v181, v70, v71
    v_mfma_f32_16x16x32_bf16 v[136:139], a[184:187], a[216:219], v[136:139]
    v_cvt_pk_bf16_f32 v182, v84, v85
    v_cvt_pk_bf16_f32 v183, v86, v87
    v_mfma_f32_16x16x32_bf16 v[140:143], a[184:187], a[220:223], v[140:143]
    v_cvt_pk_bf16_f32 v196, v72, v73
    v_cvt_pk_bf16_f32 v197, v74, v75
    v_mfma_f32_16x16x32_bf16 v[144:147], a[188:191], a[208:211], v[144:147]
    v_cvt_pk_bf16_f32 v198, v88, v89
    v_cvt_pk_bf16_f32 v199, v90, v91
    v_mfma_f32_16x16x32_bf16 v[148:151], a[188:191], a[212:215], v[148:151]
    v_cvt_pk_bf16_f32 v212, v76, v77
    v_cvt_pk_bf16_f32 v213, v78, v79
    v_mfma_f32_16x16x32_bf16 v[152:155], a[188:191], a[216:219], v[152:155]
    v_cvt_pk_bf16_f32 v214, v92, v93
    v_cvt_pk_bf16_f32 v215, v94, v95
    v_mfma_f32_16x16x32_bf16 v[156:159], a[188:191], a[220:223], v[156:159]
    v_permlane16_swap_b32 v164, v166
    v_permlane16_swap_b32 v165, v167
    v_permlane16_swap_b32 v180, v182
    v_permlane16_swap_b32 v181, v183
    v_permlane16_swap_b32 v196, v198
    v_permlane16_swap_b32 v197, v199
    v_permlane16_swap_b32 v212, v214
    v_permlane16_swap_b32 v213, v215
    buffer_store_dwordx4 v[164:167], v248, s[8:11], s36 offen offset:128 sc1
    buffer_store_dwordx4 v[180:183], v248, s[8:11], s37 offen offset:128 sc1
    buffer_store_dwordx4 v[196:199], v248, s[8:11], s38 offen offset:128 sc1
    buffer_store_dwordx4 v[212:215], v248, s[8:11], s39 offen offset:128 sc1
    v_cvt_pk_bf16_f32 v168, v96, v97
    v_cvt_pk_bf16_f32 v169, v98, v99
    v_cvt_pk_bf16_f32 v170, v112, v113
    v_cvt_pk_bf16_f32 v171, v114, v115
    v_cvt_pk_bf16_f32 v184, v100, v101
    v_cvt_pk_bf16_f32 v185, v102, v103
    v_cvt_pk_bf16_f32 v186, v116, v117
    v_cvt_pk_bf16_f32 v187, v118, v119
    v_cvt_pk_bf16_f32 v200, v104, v105
    v_cvt_pk_bf16_f32 v201, v106, v107
    v_cvt_pk_bf16_f32 v202, v120, v121
    v_cvt_pk_bf16_f32 v203, v122, v123
    v_cvt_pk_bf16_f32 v216, v108, v109
    v_cvt_pk_bf16_f32 v217, v110, v111
    v_cvt_pk_bf16_f32 v218, v124, v125
    v_cvt_pk_bf16_f32 v219, v126, v127
    v_permlane16_swap_b32 v168, v170
    v_permlane16_swap_b32 v169, v171
    v_permlane16_swap_b32 v184, v186
    v_permlane16_swap_b32 v185, v187
    v_permlane16_swap_b32 v200, v202
    v_permlane16_swap_b32 v201, v203
    v_permlane16_swap_b32 v216, v218
    v_permlane16_swap_b32 v217, v219
    buffer_store_dwordx4 v[168:171], v248, s[8:11], s36 offen offset:256 sc1
    buffer_store_dwordx4 v[184:187], v248, s[8:11], s37 offen offset:256 sc1
    buffer_store_dwordx4 v[200:203], v248, s[8:11], s38 offen offset:256 sc1
    buffer_store_dwordx4 v[216:219], v248, s[8:11], s39 offen offset:256 sc1
    v_cvt_pk_bf16_f32 v172, v128, v129
    v_cvt_pk_bf16_f32 v173, v130, v131
    v_cvt_pk_bf16_f32 v174, v144, v145
    v_cvt_pk_bf16_f32 v175, v146, v147
    v_cvt_pk_bf16_f32 v188, v132, v133
    v_cvt_pk_bf16_f32 v189, v134, v135
    v_cvt_pk_bf16_f32 v190, v148, v149
    v_cvt_pk_bf16_f32 v191, v150, v151
    v_cvt_pk_bf16_f32 v204, v136, v137
    v_cvt_pk_bf16_f32 v205, v138, v139
    v_cvt_pk_bf16_f32 v206, v152, v153
    v_cvt_pk_bf16_f32 v207, v154, v155
    v_cvt_pk_bf16_f32 v220, v140, v141
    v_cvt_pk_bf16_f32 v221, v142, v143
    v_cvt_pk_bf16_f32 v222, v156, v157
    v_cvt_pk_bf16_f32 v223, v158, v159
    v_permlane16_swap_b32 v172, v174
    v_permlane16_swap_b32 v173, v175
    v_permlane16_swap_b32 v188, v190
    v_permlane16_swap_b32 v189, v191
    v_permlane16_swap_b32 v204, v206
    v_permlane16_swap_b32 v205, v207
    v_permlane16_swap_b32 v220, v222
    v_permlane16_swap_b32 v221, v223
    buffer_store_dwordx4 v[172:175], v248, s[8:11], s36 offen offset:384 sc1
    buffer_store_dwordx4 v[188:191], v248, s[8:11], s37 offen offset:384 sc1
    buffer_store_dwordx4 v[204:207], v248, s[8:11], s38 offen offset:384 sc1
    buffer_store_dwordx4 v[220:223], v248, s[8:11], s39 offen offset:384 sc1
    s_lshl_b32 s42, s4, 10
    s_lshl_b32 s6, s3, 4
    s_lshl_b32 s7, s5, 2
    s_add_u32 s42, s42, s6
    s_add_u32 s42, s42, s7
    s_add_u32 s42, s42, 131072
    s_load_dwordx2 s[56:57], s[0:1], 112
    s_load_dwordx2 s[58:59], s[0:1], 0
    s_load_dwordx4 s[60:63], s[0:1], 48
    s_load_dwordx4 s[36:39], s[0:1], 64
    s_load_dwordx2 s[6:7], s[0:1], 96
    s_getreg_b32 s50, hwreg(HW_REG_XCC_ID, 0, 4)
    v_lshrrev_b32 v1, 6, v0
    s_nop 0
    v_readfirstlane_b32 s5, v1
    v_and_b32 v1, 63, v0
    s_and_b32 s3, s2, 7
    s_lshl_b32 s3, s3, 2
    s_bfe_u32 s4, s2, 0x20003
    s_add_u32 s3, s3, s4
    s_lshr_b32 s4, s2, 5
    s_add_u32 s50, s50, 1
    s_lshl_b32 s41, s3, 10
    s_add_u32 s41, s41, 131072
    s_waitcnt lgkmcnt(0)
    s_mov_b32 s8, s56
    s_mov_b32 s9, s57
    s_mov_b32 s10, 0x10000000
    s_mov_b32 s11, 0x00020000
    s_mov_b32 s28, s58
    s_mov_b32 s29, s59
    s_mov_b32 s30, 0x200000
    s_mov_b32 s31, 0x00020000
    s_mov_b32 s32, s6
    s_mov_b32 s33, s7
    s_mov_b32 s34, 0x200000
    s_mov_b32 s35, 0x00020000
    s_mov_b32 s12, s60
    s_mov_b32 s13, s61
    s_mov_b32 s14, 0x80000
    s_mov_b32 s15, 0x00020000
    s_mov_b32 s16, s62
    s_mov_b32 s17, s63
    s_mov_b32 s18, 0x80000
    s_mov_b32 s19, 0x00020000
    s_mov_b32 s20, s36
    s_mov_b32 s21, s37
    s_mov_b32 s22, 0x1c0000
    s_mov_b32 s23, 0x00020000
    s_mov_b32 s24, s38
    s_mov_b32 s25, s39
    s_mov_b32 s26, 0x1c0000
    s_mov_b32 s27, 0x00020000
    v_lshlrev_b32 v38, 4, v1
    v_lshrrev_b32 v39, 3, v1
    v_and_b32 v47, 3, v1
    v_lshlrev_b32 v47, 4, v47
    v_lshl_add_u32 v47, v39, 6, v47
    v_bfe_u32 v39, v1, 2, 1
    v_lshl_add_u32 v39, v39, 10, v47
    s_lshl_b32 s6, s3, 5
    s_lshl_b32 s7, s4, 2
    s_add_u32 s6, s6, s7
    s_add_u32 s6, s6, s5
    s_lshl_b32 s36, s6, 11
    buffer_load_dwordx4 v[144:147], v39, s[28:31], s36 offen offset:0
    buffer_load_dwordx4 v[148:151], v39, s[28:31], s36 offen offset:512
    s_mov_b32 s37, 26624
    buffer_load_dwordx4 v[152:155], v47, s[8:11], s37 offen offset:0 sc1
    buffer_load_dwordx4 v[156:159], v47, s[8:11], s37 offen offset:512 sc1
    buffer_load_dwordx4 v[160:163], v47, s[8:11], s37 offen offset:1024 sc1
    buffer_load_dwordx4 v[164:167], v47, s[8:11], s37 offen offset:1536 sc1
    buffer_load_dwordx4 v[168:171], v47, s[8:11], s37 offen offset:2048 sc1
    buffer_load_dwordx4 v[172:175], v47, s[8:11], s37 offen offset:2560 sc1
    s_lshl_b32 s6, s4, 2
    s_add_u32 s6, s6, s41
    v_mov_b32 v35, s50
    buffer_store_dword v35, off, s[8:11], s6 sc1
    v_lshrrev_b32 v44, 3, v1
    v_lshlrev_b32 v45, 10, v44
    v_and_b32 v44, 2, v44
    v_and_b32 v8, 7, v1
    v_xor_b32 v44, v44, v8
    v_lshl_add_u32 v8, v44, 4, v45
    v_xor_b32 v9, 64, v8
    v_add_u32 v9, 7168, v9
    v_xor_b32 v10, 0, v8
    v_add_u32 v10, 14336, v10
    v_xor_b32 v11, 64, v8
    v_add_u32 v11, 21504, v11
    s_lshl_b32 s7, s5, 8
    s_mul_i32 s6, s4, 229376
    s_add_u32 s45, s6, s7
    s_lshl_b32 s62, s5, 13
    s_lshl_b32 s63, s5, 14
    s_lshl_b32 s7, s4, 7
    s_lshl_b32 s6, s5, 17
    s_add_u32 s55, s6, s7
    s_barrier
    s_add_u32 m0, s63, 32768
    s_nop 0
    buffer_load_dwordx4 v8, s[12:15], s55 offen offset:0 lds
    buffer_load_dwordx4 v9, s[12:15], s55 offen offset:1024 lds
    buffer_load_dwordx4 v10, s[12:15], s55 offen offset:2048 lds
    buffer_load_dwordx4 v11, s[12:15], s55 offen offset:3072 lds
    s_add_u32 s55, s55, 32768
    s_add_u32 m0, s63, 36864
    s_nop 0
    buffer_load_dwordx4 v8, s[12:15], s55 offen offset:0 lds
    buffer_load_dwordx4 v9, s[12:15], s55 offen offset:1024 lds
    buffer_load_dwordx4 v10, s[12:15], s55 offen offset:2048 lds
    buffer_load_dwordx4 v11, s[12:15], s55 offen offset:3072 lds
    s_add_u32 s55, s55, 32768
    v_lshrrev_b32 v2, 4, v1
    v_and_b32 v3, 15, v1
    v_and_b32 v44, 1, v2
    v_lshrrev_b32 v45, 1, v2
    v_lshl_add_u32 v44, v44, 1, v45
    v_lshlrev_b32 v31, 4, v44
    v_lshl_add_u32 v30, v3, 10, v31
    v_and_b32 v44, 1, v3
    v_lshlrev_b32 v44, 6, v44
    v_lshrrev_b32 v45, 1, v3
    v_lshl_add_u32 v46, v45, 11, v44
    v_lshl_add_u32 v4, v2, 4, v46
    v_add_u32 v5, v31, v46
    s_bfe_u32 s6, s4, 0x10001
    s_xor_b32 s6, s6, 1
    s_mul_i32 s7, s6, 3
    s_add_u32 s56, s3, s6
    s_lshl_b32 s56, s56, 11
    s_lshl_b32 s57, s4, 8
    s_add_u32 s56, s56, s57
    s_add_u32 s56, s56, 163840
    s_cmp_eq_u32 s7, s5
    s_cselect_b32 s56, s56, 0x40000000
    s_mul_i32 s6, s6, 7
    v_add_u32 v46, v44, v31
    v_add_u32 v46, s56, v46
    v_mov_b32 v36, 2.0
    v_cmp_eq_u32 vcc, s6, v45
    s_nop 1
    v_cndmask_b32 v36, v36, v46, vcc
    s_cmp_eq_u32 s5, 3
    s_cselect_b32 s6, 1, 0
    s_add_u32 s6, s6, s3
    s_lshl_b32 s56, s6, 11
    s_add_u32 s56, s56, 163840
    s_and_b32 s6, s6, 31
    s_cmp_eq_u32 s6, 0
    s_cselect_b32 s56, 0x40000000, s56
    s_lshl_b32 s57, s3, 16
    s_add_u32 s57, s57, 7340032
    s_cmp_lt_u32 s5, 2
    s_cselect_b32 s58, 1, 0
    s_lshl_b32 s59, s5, 4
    s_xor_b32 s6, s58, 0
    s_add_u32 s46, s6, 0
    s_mul_i32 s6, s6, 2
    s_add_u32 s6, s6, s59
    s_sub_u32 s6, s6, 1
    v_add_u32 v44, s6, v3
    v_lshrrev_b32 v45, 1, v44
    v_lshlrev_b32 v45, 11, v45
    v_add_u32 v45, s57, v45
    v_mov_b32 v46, s56
    v_cmp_gt_u32 vcc, 64, v44
    s_nop 1
    v_cndmask_b32 v45, v46, v45, vcc
    v_and_b32 v44, 1, v44
    v_lshl_add_u32 v45, v44, 6, v45
    v_lshl_add_u32 v45, v2, 4, v45
    s_lshl_b32 s6, s46, 9
    v_add_u32 v40, s6, v45
    s_lshl_b32 s46, s46, 14
    s_add_u32 s46, s46, 98304
    s_xor_b32 s6, s58, 0
    s_add_u32 s47, s6, 2
    s_mul_i32 s6, s6, 4
    s_add_u32 s6, s6, s59
    s_sub_u32 s6, s6, 2
    v_add_u32 v44, s6, v3
    v_lshrrev_b32 v45, 1, v44
    v_lshlrev_b32 v45, 11, v45
    v_add_u32 v45, s57, v45
    v_mov_b32 v46, s56
    v_cmp_gt_u32 vcc, 64, v44
    s_nop 1
    v_cndmask_b32 v45, v46, v45, vcc
    v_and_b32 v44, 1, v44
    v_lshl_add_u32 v45, v44, 6, v45
    v_lshl_add_u32 v45, v2, 4, v45
    s_lshl_b32 s6, s47, 9
    v_add_u32 v41, s6, v45
    s_lshl_b32 s47, s47, 14
    s_add_u32 s47, s47, 98304
    s_xor_b32 s6, s58, 1
    s_add_u32 s48, s6, 0
    s_mul_i32 s6, s6, 2
    s_add_u32 s6, s6, s59
    s_sub_u32 s6, s6, 1
    v_add_u32 v44, s6, v3
    v_lshrrev_b32 v45, 1, v44
    v_lshlrev_b32 v45, 11, v45
    v_add_u32 v45, s57, v45
    v_mov_b32 v46, s56
    v_cmp_gt_u32 vcc, 64, v44
    s_nop 1
    v_cndmask_b32 v45, v46, v45, vcc
    v_and_b32 v44, 1, v44
    v_lshl_add_u32 v45, v44, 6, v45
    v_lshl_add_u32 v45, v2, 4, v45
    s_lshl_b32 s6, s48, 9
    v_add_u32 v42, s6, v45
    s_lshl_b32 s48, s48, 14
    s_add_u32 s48, s48, 98304
    s_xor_b32 s6, s58, 1
    s_add_u32 s49, s6, 2
    s_mul_i32 s6, s6, 4
    s_add_u32 s6, s6, s59
    s_sub_u32 s6, s6, 2
    v_add_u32 v44, s6, v3
    v_lshrrev_b32 v45, 1, v44
    v_lshlrev_b32 v45, 11, v45
    v_add_u32 v45, s57, v45
    v_mov_b32 v46, s56
    v_cmp_gt_u32 vcc, 64, v44
    s_nop 1
    v_cndmask_b32 v45, v46, v45, vcc
    v_and_b32 v44, 1, v44
    v_lshl_add_u32 v45, v44, 6, v45
    v_lshl_add_u32 v45, v2, 4, v45
    s_lshl_b32 s6, s49, 9
    v_add_u32 v43, s6, v45
    s_lshl_b32 s49, s49, 14
    s_add_u32 s49, s49, 98304
    v_bfe_u32 v44, v1, 2, 2
    v_and_b32 v45, 3, v1
    v_lshlrev_b32 v46, 10, v2
    v_lshl_add_u32 v46, v44, 7, v46
    v_lshl_add_u32 v46, v45, 3, v46
    v_lshrrev_b32 v47, 1, v44
    v_lshl_add_u32 v46, v47, 5, v46
    v_and_b32 v47, 1, v2
    v_lshl_add_u32 v12, v47, 6, v46
    v_xor_b32 v13, 32, v12
    v_xor_b32 v14, 64, v12
    v_xor_b32 v15, 96, v12
    v_lshrrev_b32 v46, 1, v2
    v_lshl_add_u32 v46, v46, 4, v44
    v_lshl_add_u32 v46, v47, 2, v46
    v_mul_u32_u24 v46, 224, v46
    v_lshl_add_u32 v27, v45, 3, v46
    v_add_u32 v28, 57344, v27
    v_add_u32 v29, 98304, v27
    v_add_u32 v44, 0, v1
    v_mul_u32_u24 v45, 4682, v44
    v_lshrrev_b32 v45, 16, v45
    v_mul_u32_u24 v46, 14, v45
    v_sub_u32 v44, v44, v46
    v_and_b32 v46, 0x13, v45
    v_bfe_u32 v47, v45, 2, 1
    v_lshl_add_u32 v46, v47, 3, v46
    v_bfe_u32 v47, v45, 3, 1
    v_lshl_add_u32 v46, v47, 2, v46
    v_mul_u32_u24 v46, 3584, v46
    v_lshl_add_u32 v20, v44, 4, v46
    v_add_u32 v44, 64, v1
    v_mul_u32_u24 v45, 4682, v44
    v_lshrrev_b32 v45, 16, v45
    v_mul_u32_u24 v46, 14, v45
    v_sub_u32 v44, v44, v46
    v_and_b32 v46, 0x13, v45
    v_bfe_u32 v47, v45, 2, 1
    v_lshl_add_u32 v46, v47, 3, v46
    v_bfe_u32 v47, v45, 3, 1
    v_lshl_add_u32 v46, v47, 2, v46
    v_mul_u32_u24 v46, 3584, v46
    v_lshl_add_u32 v21, v44, 4, v46
    v_subrev_u32 v21, 1024, v21
    v_add_u32 v44, 128, v1
    v_mul_u32_u24 v45, 4682, v44
    v_lshrrev_b32 v45, 16, v45
    v_mul_u32_u24 v46, 14, v45
    v_sub_u32 v44, v44, v46
    v_and_b32 v46, 0x13, v45
    v_bfe_u32 v47, v45, 2, 1
    v_lshl_add_u32 v46, v47, 3, v46
    v_bfe_u32 v47, v45, 3, 1
    v_lshl_add_u32 v46, v47, 2, v46
    v_mul_u32_u24 v46, 3584, v46
    v_lshl_add_u32 v22, v44, 4, v46
    v_subrev_u32 v22, 2048, v22
    v_add_u32 v44, 192, v1
    v_mul_u32_u24 v45, 4682, v44
    v_lshrrev_b32 v45, 16, v45
    v_mul_u32_u24 v46, 14, v45
    v_sub_u32 v44, v44, v46
    v_and_b32 v46, 0x13, v45
    v_bfe_u32 v47, v45, 2, 1
    v_lshl_add_u32 v46, v47, 3, v46
    v_bfe_u32 v47, v45, 3, 1
    v_lshl_add_u32 v46, v47, 2, v46
    v_mul_u32_u24 v46, 3584, v46
    v_lshl_add_u32 v23, v44, 4, v46
    v_subrev_u32 v23, 3072, v23
    v_add_u32 v44, 256, v1
    v_mul_u32_u24 v45, 4682, v44
    v_lshrrev_b32 v45, 16, v45
    v_mul_u32_u24 v46, 14, v45
    v_sub_u32 v44, v44, v46
    v_and_b32 v46, 0x13, v45
    v_bfe_u32 v47, v45, 2, 1
    v_lshl_add_u32 v46, v47, 3, v46
    v_bfe_u32 v47, v45, 3, 1
    v_lshl_add_u32 v46, v47, 2, v46
    v_mul_u32_u24 v46, 3584, v46
    v_lshl_add_u32 v24, v44, 4, v46
    v_add_u32 v44, 320, v1
    v_mul_u32_u24 v45, 4682, v44
    v_lshrrev_b32 v45, 16, v45
    v_mul_u32_u24 v46, 14, v45
    v_sub_u32 v44, v44, v46
    v_and_b32 v46, 0x13, v45
    v_bfe_u32 v47, v45, 2, 1
    v_lshl_add_u32 v46, v47, 3, v46
    v_bfe_u32 v47, v45, 3, 1
    v_lshl_add_u32 v46, v47, 2, v46
    v_mul_u32_u24 v46, 3584, v46
    v_lshl_add_u32 v25, v44, 4, v46
    v_subrev_u32 v25, 1024, v25
    v_add_u32 v44, 384, v1
    v_mul_u32_u24 v45, 4682, v44
    v_lshrrev_b32 v45, 16, v45
    v_mul_u32_u24 v46, 14, v45
    v_sub_u32 v44, v44, v46
    v_and_b32 v46, 0x13, v45
    v_bfe_u32 v47, v45, 2, 1
    v_lshl_add_u32 v46, v47, 3, v46
    v_bfe_u32 v47, v45, 3, 1
    v_lshl_add_u32 v46, v47, 2, v46
    v_mul_u32_u24 v46, 3584, v46
    v_lshl_add_u32 v26, v44, 4, v46
    v_subrev_u32 v26, 2048, v26
    v_and_b32 v44, 7, v1
    v_lshlrev_b32 v37, 2, v44
    s_lshl_b32 s6, s5, 5
    v_add_u32 v32, s6, v37
    v_and_b32 v44, 31, v1
    v_min_u32 v44, 23, v44
    s_lshl_b32 s6, s5, 3
    s_sub_u32 s6, s6, 8
    v_add_u32 v44, s6, v44
    v_max_i32 v44, 0, v44
    v_min_u32 v44, 31, v44
    v_lshlrev_b32 v33, 2, v44
    v_mov_b32 v34, 1
    s_lshl_b32 s6, s4, 4
    s_lshl_b32 s7, s5, 2
    s_add_u32 s6, s6, s7
    s_add_u32 s51, s6, s41
    s_lshl_b32 s6, s5, 5
    s_lshl_b32 s7, s4, 2
    s_add_u32 s6, s6, s7
    s_add_u32 s52, s6, s41
    s_lshl_b32 s6, s3, 16
    s_lshl_b32 s7, s5, 14
    s_add_u32 s43, s6, s7
    s_lshl_b32 s7, s4, 8
    s_add_u32 s44, s43, s7
    s_mul_i32 s6, s5, 114688
    s_mul_i32 s7, s4, 448
    s_add_u32 s53, s6, s7
    s_mul_i32 s54, s5, 7168
    v_and_b32 v192, 31, v1
    v_lshlrev_b32 v192, 2, v192
    s_waitcnt vmcnt(17)
    buffer_store_dword v34, off, s[8:11], s42 offset:640 sc1
    s_mov_b32 s42, 30000
T_P1:
    buffer_load_dword v35, v192, s[8:11], s41 offen offset:640 sc1
T_W1:
    s_waitcnt vmcnt(0)
    v_cmp_eq_u32 vcc, 0, v35
    s_sub_u32 s42, s42, 1
    s_cbranch_vccz T_Q1
    s_cmp_lg_u32 s42, 0
    s_cbranch_scc1 T_P1
T_Q1:
    s_add_u32 s37, s36, 13631488
    buffer_load_dwordx4 v[80:83], v38, s[8:11], s37 offen offset:0 sc1
    buffer_load_dwordx4 v[84:87], v38, s[8:11], s37 offen offset:1024 sc1
    s_add_u32 s37, s37, 2097152
    buffer_load_dwordx4 v[88:91], v38, s[8:11], s37 offen offset:0 sc1
    buffer_load_dwordx4 v[92:95], v38, s[8:11], s37 offen offset:1024 sc1
    s_add_u32 s37, s37, 2097152
    buffer_load_dwordx4 v[96:99], v38, s[8:11], s37 offen offset:0 sc1
    buffer_load_dwordx4 v[100:103], v38, s[8:11], s37 offen offset:1024 sc1
    s_add_u32 s37, s37, 2097152
    buffer_load_dwordx4 v[104:107], v38, s[8:11], s37 offen offset:0 sc1
    buffer_load_dwordx4 v[108:111], v38, s[8:11], s37 offen offset:1024 sc1
    s_add_u32 s37, s37, 2097152
    buffer_load_dwordx4 v[112:115], v38, s[8:11], s37 offen offset:0 sc1
    buffer_load_dwordx4 v[116:119], v38, s[8:11], s37 offen offset:1024 sc1
    s_add_u32 s37, s37, 2097152
    buffer_load_dwordx4 v[120:123], v38, s[8:11], s37 offen offset:0 sc1
    buffer_load_dwordx4 v[124:127], v38, s[8:11], s37 offen offset:1024 sc1
    s_add_u32 s37, s37, 2097152
    buffer_load_dwordx4 v[128:131], v38, s[8:11], s37 offen offset:0 sc1
    buffer_load_dwordx4 v[132:135], v38, s[8:11], s37 offen offset:1024 sc1
    s_add_u32 s37, s37, 2097152
    buffer_load_dwordx4 v[136:139], v38, s[8:11], s37 offen offset:0 sc1
    buffer_load_dwordx4 v[140:143], v38, s[8:11], s37 offen offset:1024 sc1
    s_add_u32 m0, s63, 40960
    s_nop 0
    buffer_load_dwordx4 v8, s[12:15], s55 offen offset:0 lds
    buffer_load_dwordx4 v9, s[12:15], s55 offen offset:1024 lds
    buffer_load_dwordx4 v10, s[12:15], s55 offen offset:2048 lds
    buffer_load_dwordx4 v11, s[12:15], s55 offen offset:3072 lds
    s_add_u32 s55, s55, 32768
    s_add_u32 m0, s63, 45056
    s_nop 0
    buffer_load_dwordx4 v8, s[12:15], s55 offen offset:0 lds
    buffer_load_dwordx4 v9, s[12:15], s55 offen offset:1024 lds
    buffer_load_dwordx4 v10, s[12:15], s55 offen offset:2048 lds
    buffer_load_dwordx4 v11, s[12:15], s55 offen offset:3072 lds
    s_add_u32 s55, s55, 32768
    buffer_load_dword v35, v37, s[8:11], s41 offen sc1
    s_waitcnt vmcnt(23)
    v_lshlrev_b32 v176, 16, v80
    v_and_b32 v177, 0xffff0000, v80
    v_lshlrev_b32 v178, 16, v81
    v_and_b32 v179, 0xffff0000, v81
    v_lshlrev_b32 v180, 16, v82
    v_and_b32 v181, 0xffff0000, v82
    v_lshlrev_b32 v182, 16, v83
    v_and_b32 v183, 0xffff0000, v83
    v_lshlrev_b32 v184, 16, v84
    v_and_b32 v185, 0xffff0000, v84
    v_lshlrev_b32 v186, 16, v85
    v_and_b32 v187, 0xffff0000, v85
    v_lshlrev_b32 v188, 16, v86
    v_and_b32 v189, 0xffff0000, v86
    v_lshlrev_b32 v190, 16, v87
    v_and_b32 v191, 0xffff0000, v87
    s_add_u32 m0, s62, 0
    s_nop 0
    buffer_load_dwordx4 v8, s[24:27], s45 offen offset:0 lds
    s_waitcnt vmcnt(22)
    v_lshlrev_b32 v192, 16, v88
    v_and_b32 v193, 0xffff0000, v88
    v_lshlrev_b32 v194, 16, v89
    v_and_b32 v195, 0xffff0000, v89
    v_lshlrev_b32 v196, 16, v90
    v_and_b32 v197, 0xffff0000, v90
    v_lshlrev_b32 v198, 16, v91
    v_and_b32 v199, 0xffff0000, v91
    v_lshlrev_b32 v200, 16, v92
    v_and_b32 v201, 0xffff0000, v92
    v_lshlrev_b32 v202, 16, v93
    v_and_b32 v203, 0xffff0000, v93
    v_lshlrev_b32 v204, 16, v94
    v_and_b32 v205, 0xffff0000, v94
    v_lshlrev_b32 v206, 16, v95
    v_and_b32 v207, 0xffff0000, v95
    v_pk_add_f32 v[176:177], v[176:177], v[192:193]
    v_pk_add_f32 v[178:179], v[178:179], v[194:195]
    v_pk_add_f32 v[180:181], v[180:181], v[196:197]
    v_pk_add_f32 v[182:183], v[182:183], v[198:199]
    v_pk_add_f32 v[184:185], v[184:185], v[200:201]
    v_pk_add_f32 v[186:187], v[186:187], v[202:203]
    v_pk_add_f32 v[188:189], v[188:189], v[204:205]
    v_pk_add_f32 v[190:191], v[190:191], v[206:207]
    buffer_load_dwordx4 v9, s[24:27], s45 offen offset:1024 lds
    s_waitcnt vmcnt(21)
    v_lshlrev_b32 v192, 16, v96
    v_and_b32 v193, 0xffff0000, v96
    v_lshlrev_b32 v194, 16, v97
    v_and_b32 v195, 0xffff0000, v97
    v_lshlrev_b32 v196, 16, v98
    v_and_b32 v197, 0xffff0000, v98
    v_lshlrev_b32 v198, 16, v99
    v_and_b32 v199, 0xffff0000, v99
    v_lshlrev_b32 v200, 16, v100
    v_and_b32 v201, 0xffff0000, v100
    v_lshlrev_b32 v202, 16, v101
    v_and_b32 v203, 0xffff0000, v101
    v_lshlrev_b32 v204, 16, v102
    v_and_b32 v205, 0xffff0000, v102
    v_lshlrev_b32 v206, 16, v103
    v_and_b32 v207, 0xffff0000, v103
    v_pk_add_f32 v[176:177], v[176:177], v[192:193]
    v_pk_add_f32 v[178:179], v[178:179], v[194:195]
    v_pk_add_f32 v[180:181], v[180:181], v[196:197]
    v_pk_add_f32 v[182:183], v[182:183], v[198:199]
    v_pk_add_f32 v[184:185], v[184:185], v[200:201]
    v_pk_add_f32 v[186:187], v[186:187], v[202:203]
    v_pk_add_f32 v[188:189], v[188:189], v[204:205]
    v_pk_add_f32 v[190:191], v[190:191], v[206:207]
    buffer_load_dwordx4 v10, s[24:27], s45 offen offset:2048 lds
    s_waitcnt vmcnt(20)
    v_lshlrev_b32 v192, 16, v104
    v_and_b32 v193, 0xffff0000, v104
    v_lshlrev_b32 v194, 16, v105
    v_and_b32 v195, 0xffff0000, v105
    v_lshlrev_b32 v196, 16, v106
    v_and_b32 v197, 0xffff0000, v106
    v_lshlrev_b32 v198, 16, v107
    v_and_b32 v199, 0xffff0000, v107
    v_lshlrev_b32 v200, 16, v108
    v_and_b32 v201, 0xffff0000, v108
    v_lshlrev_b32 v202, 16, v109
    v_and_b32 v203, 0xffff0000, v109
    v_lshlrev_b32 v204, 16, v110
    v_and_b32 v205, 0xffff0000, v110
    v_lshlrev_b32 v206, 16, v111
    v_and_b32 v207, 0xffff0000, v111
    v_pk_add_f32 v[176:177], v[176:177], v[192:193]
    v_pk_add_f32 v[178:179], v[178:179], v[194:195]
    v_pk_add_f32 v[180:181], v[180:181], v[196:197]
    v_pk_add_f32 v[182:183], v[182:183], v[198:199]
    v_pk_add_f32 v[184:185], v[184:185], v[200:201]
    v_pk_add_f32 v[186:187], v[186:187], v[202:203]
    v_pk_add_f32 v[188:189], v[188:189], v[204:205]
    v_pk_add_f32 v[190:191], v[190:191], v[206:207]
    buffer_load_dwordx4 v11, s[24:27], s45 offen offset:3072 lds
    s_add_u32 s45, s45, 128
    s_waitcnt vmcnt(19)
    v_lshlrev_b32 v192, 16, v112
    v_and_b32 v193, 0xffff0000, v112
    v_lshlrev_b32 v194, 16, v113
    v_and_b32 v195, 0xffff0000, v113
    v_lshlrev_b32 v196, 16, v114
    v_and_b32 v197, 0xffff0000, v114
    v_lshlrev_b32 v198, 16, v115
    v_and_b32 v199, 0xffff0000, v115
    v_lshlrev_b32 v200, 16, v116
    v_and_b32 v201, 0xffff0000, v116
    v_lshlrev_b32 v202, 16, v117
    v_and_b32 v203, 0xffff0000, v117
    v_lshlrev_b32 v204, 16, v118
    v_and_b32 v205, 0xffff0000, v118
    v_lshlrev_b32 v206, 16, v119
    v_and_b32 v207, 0xffff0000, v119
    v_pk_add_f32 v[176:177], v[176:177], v[192:193]
    v_pk_add_f32 v[178:179], v[178:179], v[194:195]
    v_pk_add_f32 v[180:181], v[180:181], v[196:197]
    v_pk_add_f32 v[182:183], v[182:183], v[198:199]
    v_pk_add_f32 v[184:185], v[184:185], v[200:201]
    v_pk_add_f32 v[186:187], v[186:187], v[202:203]
    v_pk_add_f32 v[188:189], v[188:189], v[204:205]
    v_pk_add_f32 v[190:191], v[190:191], v[206:207]
    s_add_u32 m0, s62, 4096
    s_nop 0
    buffer_load_dwordx4 v8, s[24:27], s45 offen offset:0 lds
    s_waitcnt vmcnt(18)
    v_lshlrev_b32 v192, 16, v120
    v_and_b32 v193, 0xffff0000, v120
    v_lshlrev_b32 v194, 16, v121
    v_and_b32 v195, 0xffff0000, v121
    v_lshlrev_b32 v196, 16, v122
    v_and_b32 v197, 0xffff0000, v122
    v_lshlrev_b32 v198, 16, v123
    v_and_b32 v199, 0xffff0000, v123
    v_lshlrev_b32 v200, 16, v124
    v_and_b32 v201, 0xffff0000, v124
    v_lshlrev_b32 v202, 16, v125
    v_and_b32 v203, 0xffff0000, v125
    v_lshlrev_b32 v204, 16, v126
    v_and_b32 v205, 0xffff0000, v126
    v_lshlrev_b32 v206, 16, v127
    v_and_b32 v207, 0xffff0000, v127
    v_pk_add_f32 v[176:177], v[176:177], v[192:193]
    v_pk_add_f32 v[178:179], v[178:179], v[194:195]
    v_pk_add_f32 v[180:181], v[180:181], v[196:197]
    v_pk_add_f32 v[182:183], v[182:183], v[198:199]
    v_pk_add_f32 v[184:185], v[184:185], v[200:201]
    v_pk_add_f32 v[186:187], v[186:187], v[202:203]
    v_pk_add_f32 v[188:189], v[188:189], v[204:205]
    v_pk_add_f32 v[190:191], v[190:191], v[206:207]
    buffer_load_dwordx4 v9, s[24:27], s45 offen offset:1024 lds
    s_waitcnt vmcnt(17)
    v_lshlrev_b32 v192, 16, v128
    v_and_b32 v193, 0xffff0000, v128
    v_lshlrev_b32 v194, 16, v129
    v_and_b32 v195, 0xffff0000, v129
    v_lshlrev_b32 v196, 16, v130
    v_and_b32 v197, 0xffff0000, v130
    v_lshlrev_b32 v198, 16, v131
    v_and_b32 v199, 0xffff0000, v131
    v_lshlrev_b32 v200, 16, v132
    v_and_b32 v201, 0xffff0000, v132
    v_lshlrev_b32 v202, 16, v133
    v_and_b32 v203, 0xffff0000, v133
    v_lshlrev_b32 v204, 16, v134
    v_and_b32 v205, 0xffff0000, v134
    v_lshlrev_b32 v206, 16, v135
    v_and_b32 v207, 0xffff0000, v135
    v_pk_add_f32 v[176:177], v[176:177], v[192:193]
    v_pk_add_f32 v[178:179], v[178:179], v[194:195]
    v_pk_add_f32 v[180:181], v[180:181], v[196:197]
    v_pk_add_f32 v[182:183], v[182:183], v[198:199]
    v_pk_add_f32 v[184:185], v[184:185], v[200:201]
    v_pk_add_f32 v[186:187], v[186:187], v[202:203]
    v_pk_add_f32 v[188:189], v[188:189], v[204:205]
    v_pk_add_f32 v[190:191], v[190:191], v[206:207]
    buffer_load_dwordx4 v10, s[24:27], s45 offen offset:2048 lds
    s_waitcnt vmcnt(16)
    v_lshlrev_b32 v192, 16, v136
    v_and_b32 v193, 0xffff0000, v136
    v_lshlrev_b32 v194, 16, v137
    v_and_b32 v195, 0xffff0000, v137
    v_lshlrev_b32 v196, 16, v138
    v_and_b32 v197, 0xffff0000, v138
    v_lshlrev_b32 v198, 16, v139
    v_and_b32 v199, 0xffff0000, v139
    v_lshlrev_b32 v200, 16, v140
    v_and_b32 v201, 0xffff0000, v140
    v_lshlrev_b32 v202, 16, v141
    v_and_b32 v203, 0xffff0000, v141
    v_lshlrev_b32 v204, 16, v142
    v_and_b32 v205, 0xffff0000, v142
    v_lshlrev_b32 v206, 16, v143
    v_and_b32 v207, 0xffff0000, v143
    v_pk_add_f32 v[176:177], v[176:177], v[192:193]
    v_pk_add_f32 v[178:179], v[178:179], v[194:195]
    v_pk_add_f32 v[180:181], v[180:181], v[196:197]
    v_pk_add_f32 v[182:183], v[182:183], v[198:199]
    v_pk_add_f32 v[184:185], v[184:185], v[200:201]
    v_pk_add_f32 v[186:187], v[186:187], v[202:203]
    v_pk_add_f32 v[188:189], v[188:189], v[204:205]
    v_pk_add_f32 v[190:191], v[190:191], v[206:207]
    buffer_load_dwordx4 v11, s[24:27], s45 offen offset:3072 lds
    s_add_u32 s45, s45, 32640
    v_lshlrev_b32 v192, 16, v144
    v_and_b32 v193, 0xffff0000, v144
    v_lshlrev_b32 v194, 16, v145
    v_and_b32 v195, 0xffff0000, v145
    v_lshlrev_b32 v196, 16, v146
    v_and_b32 v197, 0xffff0000, v146
    v_lshlrev_b32 v198, 16, v147
    v_and_b32 v199, 0xffff0000, v147
    v_lshlrev_b32 v200, 16, v148
    v_and_b32 v201, 0xffff0000, v148
    v_lshlrev_b32 v202, 16, v149
    v_and_b32 v203, 0xffff0000, v149
    v_lshlrev_b32 v204, 16, v150
    v_and_b32 v205, 0xffff0000, v150
    v_lshlrev_b32 v206, 16, v151
    v_and_b32 v207, 0xffff0000, v151
    v_lshlrev_b32 v80, 16, v152
    v_and_b32 v81, 0xffff0000, v152
    v_lshlrev_b32 v82, 16, v153
    v_and_b32 v83, 0xffff0000, v153
    v_lshlrev_b32 v84, 16, v154
    v_and_b32 v85, 0xffff0000, v154
    v_lshlrev_b32 v86, 16, v155
    v_and_b32 v87, 0xffff0000, v155
    v_lshlrev_b32 v88, 16, v156
    v_and_b32 v89, 0xffff0000, v156
    v_lshlrev_b32 v90, 16, v157
    v_and_b32 v91, 0xffff0000, v157
    v_lshlrev_b32 v92, 16, v158
    v_and_b32 v93, 0xffff0000, v158
    v_lshlrev_b32 v94, 16, v159
    v_and_b32 v95, 0xffff0000, v159
    v_lshlrev_b32 v96, 16, v160
    v_and_b32 v97, 0xffff0000, v160
    v_lshlrev_b32 v98, 16, v161
    v_and_b32 v99, 0xffff0000, v161
    v_lshlrev_b32 v100, 16, v162
    v_and_b32 v101, 0xffff0000, v162
    v_lshlrev_b32 v102, 16, v163
    v_and_b32 v103, 0xffff0000, v163
    v_lshlrev_b32 v104, 16, v164
    v_and_b32 v105, 0xffff0000, v164
    v_lshlrev_b32 v106, 16, v165
    v_and_b32 v107, 0xffff0000, v165
    v_lshlrev_b32 v108, 16, v166
    v_and_b32 v109, 0xffff0000, v166
    v_lshlrev_b32 v110, 16, v167
    v_and_b32 v111, 0xffff0000, v167
    v_lshlrev_b32 v112, 16, v168
    v_and_b32 v113, 0xffff0000, v168
    v_lshlrev_b32 v114, 16, v169
    v_and_b32 v115, 0xffff0000, v169
    v_lshlrev_b32 v116, 16, v170
    v_and_b32 v117, 0xffff0000, v170
    v_lshlrev_b32 v118, 16, v171
    v_and_b32 v119, 0xffff0000, v171
    v_lshlrev_b32 v120, 16, v172
    v_and_b32 v121, 0xffff0000, v172
    v_lshlrev_b32 v122, 16, v173
    v_and_b32 v123, 0xffff0000, v173
    v_lshlrev_b32 v124, 16, v174
    v_and_b32 v125, 0xffff0000, v174
    v_lshlrev_b32 v126, 16, v175
    v_and_b32 v127, 0xffff0000, v175
    v_pk_fma_f32 v[176:177], v[176:177], v[80:81], v[192:193]
    v_pk_fma_f32 v[178:179], v[178:179], v[82:83], v[194:195]
    v_pk_fma_f32 v[180:181], v[180:181], v[84:85], v[196:197]
    v_pk_fma_f32 v[182:183], v[182:183], v[86:87], v[198:199]
    v_pk_fma_f32 v[184:185], v[184:185], v[88:89], v[200:201]
    v_pk_fma_f32 v[186:187], v[186:187], v[90:91], v[202:203]
    v_pk_fma_f32 v[188:189], v[188:189], v[92:93], v[204:205]
    v_pk_fma_f32 v[190:191], v[190:191], v[94:95], v[206:207]
    v_cvt_pk_bf16_f32 v208, v176, v177
    v_cvt_pk_bf16_f32 v209, v178, v179
    v_cvt_pk_bf16_f32 v210, v180, v181
    v_cvt_pk_bf16_f32 v211, v182, v183
    v_cvt_pk_bf16_f32 v212, v184, v185
    v_cvt_pk_bf16_f32 v213, v186, v187
    v_cvt_pk_bf16_f32 v214, v188, v189
    v_cvt_pk_bf16_f32 v215, v190, v191
    v_lshlrev_b32 v176, 16, v208
    v_and_b32 v177, 0xffff0000, v208
    v_lshlrev_b32 v178, 16, v209
    v_and_b32 v179, 0xffff0000, v209
    v_lshlrev_b32 v180, 16, v210
    v_and_b32 v181, 0xffff0000, v210
    v_lshlrev_b32 v182, 16, v211
    v_and_b32 v183, 0xffff0000, v211
    v_lshlrev_b32 v184, 16, v212
    v_and_b32 v185, 0xffff0000, v212
    v_lshlrev_b32 v186, 16, v213
    v_and_b32 v187, 0xffff0000, v213
    v_lshlrev_b32 v188, 16, v214
    v_and_b32 v189, 0xffff0000, v214
    v_lshlrev_b32 v190, 16, v215
    v_and_b32 v191, 0xffff0000, v215
    v_add_f32 v192, v176, v177
    v_add_f32 v193, v178, v179
    v_add_f32 v192, v192, v180
    v_add_f32 v193, v193, v181
    v_add_f32 v192, v192, v182
    v_add_f32 v193, v193, v183
    v_add_f32 v192, v192, v184
    v_add_f32 v193, v193, v185
    v_add_f32 v192, v192, v186
    v_add_f32 v193, v193, v187
    v_add_f32 v192, v192, v188
    v_add_f32 v193, v193, v189
    v_add_f32 v192, v192, v190
    v_add_f32 v193, v193, v191
    v_add_f32 v192, v192, v193
    s_nop 1
    v_add_f32_dpp v192, v192, v192 quad_perm:[1,0,3,2] row_mask:0xf bank_mask:0xf
    s_nop 1
    v_add_f32_dpp v192, v192, v192 quad_perm:[2,3,0,1] row_mask:0xf bank_mask:0xf
    s_nop 1
    v_add_f32_dpp v192, v192, v192 row_ror:8 row_mask:0xf bank_mask:0xf
    v_mov_b32 v196, v192
    s_nop 1
    v_permlane16_swap_b32 v192, v196
    v_add_f32 v192, v192, v196
    v_mov_b32 v196, v192
    s_nop 1
    v_permlane32_swap_b32 v192, v196
    v_add_f32 v192, v192, v196
    v_mul_f32 v192, 0xbb000000, v192
    v_pk_add_f32 v[176:177], v[176:177], v[192:193] op_sel_hi:[1,0]
    v_pk_add_f32 v[178:179], v[178:179], v[192:193] op_sel_hi:[1,0]
    v_pk_add_f32 v[180:181], v[180:181], v[192:193] op_sel_hi:[1,0]
    v_pk_add_f32 v[182:183], v[182:183], v[192:193] op_sel_hi:[1,0]
    v_pk_add_f32 v[184:185], v[184:185], v[192:193] op_sel_hi:[1,0]
    v_pk_add_f32 v[186:187], v[186:187], v[192:193] op_sel_hi:[1,0]
    v_pk_add_f32 v[188:189], v[188:189], v[192:193] op_sel_hi:[1,0]
    v_pk_add_f32 v[190:191], v[190:191], v[192:193] op_sel_hi:[1,0]
    v_pk_mul_f32 v[194:195], v[176:177], v[176:177]
    v_pk_mul_f32 v[196:197], v[178:179], v[178:179]
    v_pk_fma_f32 v[194:195], v[180:181], v[180:181], v[194:195]
    v_pk_fma_f32 v[196:197], v[182:183], v[182:183], v[196:197]
    v_pk_fma_f32 v[194:195], v[184:185], v[184:185], v[194:195]
    v_pk_fma_f32 v[196:197], v[186:187], v[186:187], v[196:197]
    v_pk_fma_f32 v[194:195], v[188:189], v[188:189], v[194:195]
    v_pk_fma_f32 v[196:197], v[190:191], v[190:191], v[196:197]
    v_pk_add_f32 v[194:195], v[194:195], v[196:197]
    v_add_f32 v194, v194, v195
    s_nop 1
    v_add_f32_dpp v194, v194, v194 quad_perm:[1,0,3,2] row_mask:0xf bank_mask:0xf
    s_nop 1
    v_add_f32_dpp v194, v194, v194 quad_perm:[2,3,0,1] row_mask:0xf bank_mask:0xf
    s_nop 1
    v_add_f32_dpp v194, v194, v194 row_ror:8 row_mask:0xf bank_mask:0xf
    v_mov_b32 v196, v194
    s_nop 1
    v_permlane16_swap_b32 v194, v196
    v_add_f32 v194, v194, v196
    v_mov_b32 v196, v194
    s_nop 1
    v_permlane32_swap_b32 v194, v196
    v_add_f32 v194, v194, v196
    v_mov_b32 v192, 0x3727c5ac
    v_fmac_f32 v192, 0x3b000000, v194
    v_rsq_f32 v192, v192
    s_nop 0
    v_pk_mul_f32 v[176:177], v[176:177], v[192:193] op_sel_hi:[1,0]
    v_pk_mul_f32 v[178:179], v[178:179], v[192:193] op_sel_hi:[1,0]
    v_pk_mul_f32 v[180:181], v[180:181], v[192:193] op_sel_hi:[1,0]
    v_pk_mul_f32 v[182:183], v[182:183], v[192:193] op_sel_hi:[1,0]
    v_pk_mul_f32 v[184:185], v[184:185], v[192:193] op_sel_hi:[1,0]
    v_pk_mul_f32 v[186:187], v[186:187], v[192:193] op_sel_hi:[1,0]
    v_pk_mul_f32 v[188:189], v[188:189], v[192:193] op_sel_hi:[1,0]
    v_pk_mul_f32 v[190:191], v[190:191], v[192:193] op_sel_hi:[1,0]
    v_pk_fma_f32 v[176:177], v[176:177], v[112:113], v[96:97]
    v_pk_fma_f32 v[178:179], v[178:179], v[114:115], v[98:99]
    v_pk_fma_f32 v[180:181], v[180:181], v[116:117], v[100:101]
    v_pk_fma_f32 v[182:183], v[182:183], v[118:119], v[102:103]
    v_pk_fma_f32 v[184:185], v[184:185], v[120:121], v[104:105]
    v_pk_fma_f32 v[186:187], v[186:187], v[122:123], v[106:107]
    v_pk_fma_f32 v[188:189], v[188:189], v[124:125], v[108:109]
    v_pk_fma_f32 v[190:191], v[190:191], v[126:127], v[110:111]
    v_cvt_pk_bf16_f32 v216, v176, v177
    v_cvt_pk_bf16_f32 v217, v178, v179
    v_cvt_pk_bf16_f32 v218, v180, v181
    v_cvt_pk_bf16_f32 v219, v182, v183
    v_cvt_pk_bf16_f32 v220, v184, v185
    v_cvt_pk_bf16_f32 v221, v186, v187
    v_cvt_pk_bf16_f32 v222, v188, v189
    v_cvt_pk_bf16_f32 v223, v190, v191
    v_lshlrev_b32 v176, 16, v216
    v_and_b32 v177, 0xffff0000, v216
    v_lshlrev_b32 v178, 16, v217
    v_and_b32 v179, 0xffff0000, v217
    v_lshlrev_b32 v180, 16, v218
    v_and_b32 v181, 0xffff0000, v218
    v_lshlrev_b32 v182, 16, v219
    v_and_b32 v183, 0xffff0000, v219
    v_lshlrev_b32 v184, 16, v220
    v_and_b32 v185, 0xffff0000, v220
    v_lshlrev_b32 v186, 16, v221
    v_and_b32 v187, 0xffff0000, v221
    v_lshlrev_b32 v188, 16, v222
    v_and_b32 v189, 0xffff0000, v222
    v_lshlrev_b32 v190, 16, v223
    v_and_b32 v191, 0xffff0000, v223
    v_add_f32 v192, v176, v177
    v_add_f32 v193, v178, v179
    v_add_f32 v192, v192, v180
    v_add_f32 v193, v193, v181
    v_add_f32 v192, v192, v182
    v_add_f32 v193, v193, v183
    v_add_f32 v192, v192, v184
    v_add_f32 v193, v193, v185
    v_add_f32 v192, v192, v186
    v_add_f32 v193, v193, v187
    v_add_f32 v192, v192, v188
    v_add_f32 v193, v193, v189
    v_add_f32 v192, v192, v190
    v_add_f32 v193, v193, v191
    v_add_f32 v192, v192, v193
    s_nop 1
    v_add_f32_dpp v192, v192, v192 quad_perm:[1,0,3,2] row_mask:0xf bank_mask:0xf
    s_nop 1
    v_add_f32_dpp v192, v192, v192 quad_perm:[2,3,0,1] row_mask:0xf bank_mask:0xf
    s_nop 1
    v_add_f32_dpp v192, v192, v192 row_ror:8 row_mask:0xf bank_mask:0xf
    v_mov_b32 v196, v192
    s_nop 1
    v_permlane16_swap_b32 v192, v196
    v_add_f32 v192, v192, v196
    v_mov_b32 v196, v192
    s_nop 1
    v_permlane32_swap_b32 v192, v196
    v_add_f32 v192, v192, v196
    v_mul_f32 v192, 0xbb000000, v192
    v_pk_add_f32 v[176:177], v[176:177], v[192:193] op_sel_hi:[1,0]
    v_pk_add_f32 v[178:179], v[178:179], v[192:193] op_sel_hi:[1,0]
    v_pk_add_f32 v[180:181], v[180:181], v[192:193] op_sel_hi:[1,0]
    v_pk_add_f32 v[182:183], v[182:183], v[192:193] op_sel_hi:[1,0]
    v_pk_add_f32 v[184:185], v[184:185], v[192:193] op_sel_hi:[1,0]
    v_pk_add_f32 v[186:187], v[186:187], v[192:193] op_sel_hi:[1,0]
    v_pk_add_f32 v[188:189], v[188:189], v[192:193] op_sel_hi:[1,0]
    v_pk_add_f32 v[190:191], v[190:191], v[192:193] op_sel_hi:[1,0]
    v_pk_mul_f32 v[194:195], v[176:177], v[176:177]
    v_pk_mul_f32 v[196:197], v[178:179], v[178:179]
    v_pk_fma_f32 v[194:195], v[180:181], v[180:181], v[194:195]
    v_pk_fma_f32 v[196:197], v[182:183], v[182:183], v[196:197]
    v_pk_fma_f32 v[194:195], v[184:185], v[184:185], v[194:195]
    v_pk_fma_f32 v[196:197], v[186:187], v[186:187], v[196:197]
    v_pk_fma_f32 v[194:195], v[188:189], v[188:189], v[194:195]
    v_pk_fma_f32 v[196:197], v[190:191], v[190:191], v[196:197]
    v_pk_add_f32 v[194:195], v[194:195], v[196:197]
    v_add_f32 v194, v194, v195
    s_nop 1
    v_add_f32_dpp v194, v194, v194 quad_perm:[1,0,3,2] row_mask:0xf bank_mask:0xf
    s_nop 1
    v_add_f32_dpp v194, v194, v194 quad_perm:[2,3,0,1] row_mask:0xf bank_mask:0xf
    s_nop 1
    v_add_f32_dpp v194, v194, v194 row_ror:8 row_mask:0xf bank_mask:0xf
    v_mov_b32 v196, v194
    s_nop 1
    v_permlane16_swap_b32 v194, v196
    v_add_f32 v194, v194, v196
    v_mov_b32 v196, v194
    s_nop 1
    v_permlane32_swap_b32 v194, v196
    v_add_f32 v194, v194, v196
    v_mov_b32 v192, 0x3727c5ac
    v_fmac_f32 v192, 0x3b000000, v194
    v_rsq_f32 v192, v192
    s_nop 0
    v_pk_mul_f32 v[176:177], v[176:177], v[192:193] op_sel_hi:[1,0]
    v_pk_mul_f32 v[178:179], v[178:179], v[192:193] op_sel_hi:[1,0]
    v_pk_mul_f32 v[180:181], v[180:181], v[192:193] op_sel_hi:[1,0]
    v_pk_mul_f32 v[182:183], v[182:183], v[192:193] op_sel_hi:[1,0]
    v_pk_mul_f32 v[184:185], v[184:185], v[192:193] op_sel_hi:[1,0]
    v_pk_mul_f32 v[186:187], v[186:187], v[192:193] op_sel_hi:[1,0]
    v_pk_mul_f32 v[188:189], v[188:189], v[192:193] op_sel_hi:[1,0]
    v_pk_mul_f32 v[190:191], v[190:191], v[192:193] op_sel_hi:[1,0]
    v_cvt_pk_bf16_f32 v224, v176, v177
    v_cvt_pk_bf16_f32 v225, v178, v179
    v_cvt_pk_bf16_f32 v226, v180, v181
    v_cvt_pk_bf16_f32 v227, v182, v183
    v_cvt_pk_bf16_f32 v228, v184, v185
    v_cvt_pk_bf16_f32 v229, v186, v187
    v_cvt_pk_bf16_f32 v230, v188, v189
    v_cvt_pk_bf16_f32 v231, v190, v191
    s_waitcnt vmcnt(8)
    v_cmp_eq_u32 vcc, 0, v35
    s_cbranch_vccz T_M
    s_mov_b32 s42, 30000
T_P2:
    buffer_load_dword v35, v37, s[8:11], s41 offen offset:0 sc1
T_W2:
    s_waitcnt vmcnt(0)
    v_cmp_eq_u32 vcc, 0, v35
    s_sub_u32 s42, s42, 1
    s_cbranch_vccz T_Q2
    s_cmp_lg_u32 s42, 0
    s_cbranch_scc1 T_P2
T_Q2:
T_M:
    v_cmp_ne_u32 vcc, s50, v35
    s_or_b32 s40, vcc_lo, vcc_hi
    s_add_u32 s37, s36, 11534336
    s_add_u32 s38, s36, 5242880
    s_add_u32 s39, s36, 3145728
    s_cmp_lg_u32 s40, 0
    s_cbranch_scc1 T_S3
    buffer_store_dwordx4 v[224:227], v38, s[8:11], s37 offen offset:0
    buffer_store_dwordx4 v[228:231], v38, s[8:11], s37 offen offset:1024
    buffer_store_dwordx4 v[216:219], v38, s[8:11], s38 offen offset:0
    buffer_store_dwordx4 v[220:223], v38, s[8:11], s38 offen offset:1024
    buffer_store_dwordx4 v[208:211], v38, s[8:11], s39 offen offset:0
    buffer_store_dwordx4 v[212:215], v38, s[8:11], s39 offen offset:1024
    s_branch T_D3
T_S3:
    buffer_store_dwordx4 v[224:227], v38, s[8:11], s37 offen offset:0 sc1
    buffer_store_dwordx4 v[228:231], v38, s[8:11], s37 offen offset:1024 sc1
    buffer_store_dwordx4 v[216:219], v38, s[8:11], s38 offen offset:0 sc1
    buffer_store_dwordx4 v[220:223], v38, s[8:11], s38 offen offset:1024 sc1
    buffer_store_dwordx4 v[208:211], v38, s[8:11], s39 offen offset:0 sc1
    buffer_store_dwordx4 v[212:215], v38, s[8:11], s39 offen offset:1024 sc1
T_D3:
    s_add_u32 m0, s63, 98304
    s_nop 0
    buffer_load_dwordx4 v8, s[24:27], s45 offen offset:0 lds
    buffer_load_dwordx4 v9, s[24:27], s45 offen offset:1024 lds
    buffer_load_dwordx4 v10, s[24:27], s45 offen offset:2048 lds
    buffer_load_dwordx4 v11, s[24:27], s45 offen offset:3072 lds
    s_add_u32 s45, s45, 128
    s_waitcnt vmcnt(4)
    s_cmp_lg_u32 s40, 0
    s_cbranch_scc1 T_S4
    buffer_store_dword v34, off, s[8:11], s51 offset:128
    s_branch T_D4
T_S4:
    buffer_store_dword v34, off, s[8:11], s51 offset:128 sc1
T_D4:
    s_add_u32 m0, s63, 102400
    s_nop 0
    buffer_load_dwordx4 v8, s[24:27], s45 offen offset:0 lds
    buffer_load_dwordx4 v9, s[24:27], s45 offen offset:1024 lds
    buffer_load_dwordx4 v10, s[24:27], s45 offen offset:2048 lds
    buffer_load_dwordx4 v11, s[24:27], s45 offen offset:3072 lds
    s_add_u32 s45, s45, 32640
    s_add_u32 m0, s63, 106496
    s_nop 0
    buffer_load_dwordx4 v8, s[24:27], s45 offen offset:0 lds
    buffer_load_dwordx4 v9, s[24:27], s45 offen offset:1024 lds
    buffer_load_dwordx4 v10, s[24:27], s45 offen offset:2048 lds
    buffer_load_dwordx4 v11, s[24:27], s45 offen offset:3072 lds
    s_add_u32 s45, s45, 128
    s_add_u32 m0, s63, 110592
    s_nop 0
    buffer_load_dwordx4 v8, s[24:27], s45 offen offset:0 lds
    buffer_load_dwordx4 v9, s[24:27], s45 offen offset:1024 lds
    buffer_load_dwordx4 v10, s[24:27], s45 offen offset:2048 lds
    buffer_load_dwordx4 v11, s[24:27], s45 offen offset:3072 lds
    s_add_u32 s45, s45, 32640
    s_add_u32 s6, s62, 0
    v_add_u32 v44, s6, v12
    v_add_u32 v45, s6, v13
    v_add_u32 v46, s6, v14
    v_add_u32 v47, s6, v15
    ds_read_b64_tr_b16 a[0:1], v44 offset:0
    ds_read_b64_tr_b16 a[2:3], v44 offset:512
    ds_read_b64_tr_b16 a[4:5], v45 offset:0
    ds_read_b64_tr_b16 a[6:7], v45 offset:512
    ds_read_b64_tr_b16 a[8:9], v46 offset:0
    ds_read_b64_tr_b16 a[10:11], v46 offset:512
    ds_read_b64_tr_b16 a[12:13], v47 offset:0
    ds_read_b64_tr_b16 a[14:15], v47 offset:512
    ds_read_b64_tr_b16 a[16:17], v44 offset:4096
    ds_read_b64_tr_b16 a[18:19], v44 offset:4608
    ds_read_b64_tr_b16 a[20:21], v45 offset:4096
    ds_read_b64_tr_b16 a[22:23], v45 offset:4608
    ds_read_b64_tr_b16 a[24:25], v46 offset:4096
    ds_read_b64_tr_b16 a[26:27], v46 offset:4608
    s_waitcnt lgkmcnt(10)
    ds_read_b64_tr_b16 a[28:29], v47 offset:4096
    ds_read_b64_tr_b16 a[30:31], v47 offset:4608
    s_waitcnt lgkmcnt(0)
    s_barrier
    v_add_u32 v16, 32768, v12
    v_add_u32 v17, 32768, v13
    v_add_u32 v18, 32768, v14
    v_add_u32 v19, 32768, v15
    ds_read_b64_tr_b16 v[48:49], v16 offset:0
    ds_read_b64_tr_b16 v[50:51], v16 offset:512
    ds_read_b64_tr_b16 v[52:53], v17 offset:0
    ds_read_b64_tr_b16 v[54:55], v17 offset:512
    ds_read_b64_tr_b16 v[56:57], v18 offset:0
    ds_read_b64_tr_b16 v[58:59], v18 offset:512
    ds_read_b64_tr_b16 v[60:61], v19 offset:0
    ds_read_b64_tr_b16 v[62:63], v19 offset:512
    ds_read_b64_tr_b16 v[64:65], v16 offset:4096
    ds_read_b64_tr_b16 v[66:67], v16 offset:4608
    ds_read_b64_tr_b16 v[68:69], v17 offset:4096
    ds_read_b64_tr_b16 v[70:71], v17 offset:4608
    ds_read_b64_tr_b16 v[72:73], v18 offset:4096
    ds_read_b64_tr_b16 v[74:75], v18 offset:4608
    s_mov_b32 s42, 30000
T_P5:
    buffer_load_dword v35, v32, s[8:11], s41 offen offset:128 sc1
T_W5:
    s_waitcnt vmcnt(0)
    v_cmp_eq_u32 vcc, 0, v35
    s_sub_u32 s42, s42, 1
    s_cbranch_vccz T_Q5
    s_cmp_lg_u32 s42, 0
    s_cbranch_scc1 T_P5
T_Q5:
    s_add_u32 s36, s43, 11534336
    buffer_load_dwordx4 v[80:83], v4, s[8:11], s36 offen offset:0 sc1
    buffer_load_dwordx4 v[84:87], v4, s[8:11], s36 offen offset:128 sc1
    buffer_load_dwordx4 v[88:91], v4, s[8:11], s36 offen offset:256 sc1
    buffer_load_dwordx4 v[92:95], v4, s[8:11], s36 offen offset:384 sc1
    buffer_load_dwordx4 v[96:99], v4, s[8:11], s36 offen offset:512 sc1
    buffer_load_dwordx4 v[100:103], v4, s[8:11], s36 offen offset:640 sc1
    buffer_load_dwordx4 v[104:107], v4, s[8:11], s36 offen offset:768 sc1
    buffer_load_dwordx4 v[108:111], v4, s[8:11], s36 offen offset:896 sc1
    buffer_load_dwordx4 v[112:115], v4, s[8:11], s36 offen offset:1024 sc1
    buffer_load_dwordx4 v[116:119], v4, s[8:11], s36 offen offset:1152 sc1
    buffer_load_dwordx4 v[120:123], v4, s[8:11], s36 offen offset:1280 sc1
    buffer_load_dwordx4 v[124:127], v4, s[8:11], s36 offen offset:1408 sc1
    buffer_load_dwordx4 v[128:131], v4, s[8:11], s36 offen offset:1536 sc1
    buffer_load_dwordx4 v[132:135], v4, s[8:11], s36 offen offset:1664 sc1
    buffer_load_dwordx4 v[136:139], v4, s[8:11], s36 offen offset:1792 sc1
    buffer_load_dwordx4 v[140:143], v4, s[8:11], s36 offen offset:1920 sc1
    s_add_u32 s6, s63, 98304
    v_add_u32 v44, s6, v12
    v_add_u32 v45, s6, v13
    v_add_u32 v46, s6, v14
    v_add_u32 v47, s6, v15
    s_waitcnt lgkmcnt(10)
    ds_read_b64_tr_b16 a[32:33], v44 offset:0
    ds_read_b64_tr_b16 a[34:35], v44 offset:512
    ds_read_b64_tr_b16 a[36:37], v45 offset:0
    ds_read_b64_tr_b16 a[38:39], v45 offset:512
    s_waitcnt lgkmcnt(10)
    ds_read_b64_tr_b16 a[40:41], v46 offset:0
    ds_read_b64_tr_b16 a[42:43], v46 offset:512
    ds_read_b64_tr_b16 a[44:45], v47 offset:0
    ds_read_b64_tr_b16 a[46:47], v47 offset:512
    s_waitcnt lgkmcnt(10)
    ds_read_b64_tr_b16 a[48:49], v44 offset:4096
    ds_read_b64_tr_b16 a[50:51], v44 offset:4608
    ds_read_b64_tr_b16 a[52:53], v45 offset:4096
    ds_read_b64_tr_b16 a[54:55], v45 offset:4608
    s_waitcnt lgkmcnt(10)
    ds_read_b64_tr_b16 a[56:57], v46 offset:4096
    ds_read_b64_tr_b16 a[58:59], v46 offset:4608
    ds_read_b64_tr_b16 a[60:61], v47 offset:4096
    ds_read_b64_tr_b16 a[62:63], v47 offset:4608
    s_waitcnt lgkmcnt(10)
    ds_read_b64_tr_b16 a[64:65], v44 offset:8192
    ds_read_b64_tr_b16 a[66:67], v44 offset:8704
    ds_read_b64_tr_b16 a[68:69], v45 offset:8192
    ds_read_b64_tr_b16 a[70:71], v45 offset:8704
    s_waitcnt lgkmcnt(10)
    ds_read_b64_tr_b16 a[72:73], v46 offset:8192
    ds_read_b64_tr_b16 a[74:75], v46 offset:8704
    ds_read_b64_tr_b16 a[76:77], v47 offset:8192
    ds_read_b64_tr_b16 a[78:79], v47 offset:8704
    s_waitcnt lgkmcnt(10)
    ds_read_b64_tr_b16 a[80:81], v44 offset:12288
    ds_read_b64_tr_b16 a[82:83], v44 offset:12800
    ds_read_b64_tr_b16 a[84:85], v45 offset:12288
    ds_read_b64_tr_b16 a[86:87], v45 offset:12800
    s_waitcnt lgkmcnt(10)
    ds_read_b64_tr_b16 a[88:89], v46 offset:12288
    ds_read_b64_tr_b16 a[90:91], v46 offset:12800
    ds_read_b64_tr_b16 a[92:93], v47 offset:12288
    ds_read_b64_tr_b16 a[94:95], v47 offset:12800
    s_waitcnt lgkmcnt(0)
    s_lshl_b32 s6, s5, 17
    s_lshl_b32 s7, s4, 7
    s_add_u32 s55, s6, s7
    v_mov_b32 v168, 0xc0135761
    v_mov_b32 v170, 0xbdd2d3e8
    v_mov_b32 v172, 1.0
    s_waitcnt lgkmcnt(12)
    s_waitcnt vmcnt(15)
    v_mfma_f32_16x16x32_bf16 v[144:147], v[48:51], v[80:83], 0
    ds_read_b64_tr_b16 v[76:77], v19 offset:4096
    ds_read_b64_tr_b16 v[78:79], v19 offset:4608
    s_waitcnt lgkmcnt(12)
    v_mfma_f32_16x16x32_bf16 v[148:151], v[52:55], v[80:83], 0
    ds_read_b64_tr_b16 v[48:49], v16 offset:8192
    ds_read_b64_tr_b16 v[50:51], v16 offset:8704
    s_add_u32 m0, s63, 98304
    s_nop 0
    buffer_load_dwordx4 v8, s[16:19], s55 offen offset:0 lds
    s_waitcnt lgkmcnt(12)
    v_mfma_f32_16x16x32_bf16 v[152:155], v[56:59], v[80:83], 0
    ds_read_b64_tr_b16 v[52:53], v17 offset:8192
    ds_read_b64_tr_b16 v[54:55], v17 offset:8704
    s_waitcnt lgkmcnt(12)
    v_mfma_f32_16x16x32_bf16 v[156:159], v[60:63], v[80:83], 0
    ds_read_b64_tr_b16 v[56:57], v18 offset:8192
    ds_read_b64_tr_b16 v[58:59], v18 offset:8704
    s_waitcnt lgkmcnt(12)
    s_waitcnt vmcnt(15)
    v_mfma_f32_16x16x32_bf16 v[144:147], v[64:67], v[84:87], v[144:147]
    ds_read_b64_tr_b16 v[60:61], v19 offset:8192
    ds_read_b64_tr_b16 v[62:63], v19 offset:8704
    s_waitcnt lgkmcnt(12)
    v_mfma_f32_16x16x32_bf16 v[148:151], v[68:71], v[84:87], v[148:151]
    ds_read_b64_tr_b16 v[64:65], v16 offset:12288
    ds_read_b64_tr_b16 v[66:67], v16 offset:12800
    buffer_load_dwordx4 v9, s[16:19], s55 offen offset:1024 lds
    s_waitcnt lgkmcnt(12)
    v_mfma_f32_16x16x32_bf16 v[152:155], v[72:75], v[84:87], v[152:155]
    ds_read_b64_tr_b16 v[68:69], v17 offset:12288
    ds_read_b64_tr_b16 v[70:71], v17 offset:12800
    s_waitcnt lgkmcnt(12)
    v_mfma_f32_16x16x32_bf16 v[156:159], v[76:79], v[84:87], v[156:159]
    ds_read_b64_tr_b16 v[72:73], v18 offset:12288
    ds_read_b64_tr_b16 v[74:75], v18 offset:12800
    s_waitcnt lgkmcnt(12)
    s_waitcnt vmcnt(15)
    v_mfma_f32_16x16x32_bf16 v[144:147], v[48:51], v[88:91], v[144:147]
    ds_read_b64_tr_b16 v[76:77], v19 offset:12288
    ds_read_b64_tr_b16 v[78:79], v19 offset:12800
    s_waitcnt lgkmcnt(12)
    v_mfma_f32_16x16x32_bf16 v[148:151], v[52:55], v[88:91], v[148:151]
    ds_read_b64_tr_b16 v[48:49], v16 offset:16384
    ds_read_b64_tr_b16 v[50:51], v16 offset:16896
    buffer_load_dwordx4 v10, s[16:19], s55 offen offset:2048 lds
    s_waitcnt lgkmcnt(12)
    v_mfma_f32_16x16x32_bf16 v[152:155], v[56:59], v[88:91], v[152:155]
    ds_read_b64_tr_b16 v[52:53], v17 offset:16384
    ds_read_b64_tr_b16 v[54:55], v17 offset:16896
    s_waitcnt lgkmcnt(12)
    v_mfma_f32_16x16x32_bf16 v[156:159], v[60:63], v[88:91], v[156:159]
    ds_read_b64_tr_b16 v[56:57], v18 offset:16384
    ds_read_b64_tr_b16 v[58:59], v18 offset:16896
    s_waitcnt lgkmcnt(12)
    s_waitcnt vmcnt(15)
    v_mfma_f32_16x16x32_bf16 v[144:147], v[64:67], v[92:95], v[144:147]
    ds_read_b64_tr_b16 v[60:61], v19 offset:16384
    ds_read_b64_tr_b16 v[62:63], v19 offset:16896
    s_waitcnt lgkmcnt(12)
    v_mfma_f32_16x16x32_bf16 v[148:151], v[68:71], v[92:95], v[148:151]
    ds_read_b64_tr_b16 v[64:65], v16 offset:20480
    ds_read_b64_tr_b16 v[66:67], v16 offset:20992
    buffer_load_dwordx4 v11, s[16:19], s55 offen offset:3072 lds
    s_add_u32 s55, s55, 32768
    s_waitcnt lgkmcnt(12)
    v_mfma_f32_16x16x32_bf16 v[152:155], v[72:75], v[92:95], v[152:155]
    ds_read_b64_tr_b16 v[68:69], v17 offset:20480
    ds_read_b64_tr_b16 v[70:71], v17 offset:20992
    s_waitcnt lgkmcnt(12)
    v_mfma_f32_16x16x32_bf16 v[156:159], v[76:79], v[92:95], v[156:159]
    ds_read_b64_tr_b16 v[72:73], v18 offset:20480
    ds_read_b64_tr_b16 v[74:75], v18 offset:20992
    s_waitcnt lgkmcnt(12)
    s_waitcnt vmcnt(15)
    v_mfma_f32_16x16x32_bf16 v[144:147], v[48:51], v[96:99], v[144:147]
    ds_read_b64_tr_b16 v[76:77], v19 offset:20480
    ds_read_b64_tr_b16 v[78:79], v19 offset:20992
    s_waitcnt lgkmcnt(12)
    v_mfma_f32_16x16x32_bf16 v[148:151], v[52:55], v[96:99], v[148:151]
    ds_read_b64_tr_b16 v[48:49], v16 offset:24576
    ds_read_b64_tr_b16 v[50:51], v16 offset:25088
    s_add_u32 m0, s63, 102400
    s_nop 0
    buffer_load_dwordx4 v8, s[16:19], s55 offen offset:0 lds
    s_waitcnt lgkmcnt(12)
    v_mfma_f32_16x16x32_bf16 v[152:155], v[56:59], v[96:99], v[152:155]
    ds_read_b64_tr_b16 v[52:53], v17 offset:24576
    ds_read_b64_tr_b16 v[54:55], v17 offset:25088
    s_waitcnt lgkmcnt(12)
    v_mfma_f32_16x16x32_bf16 v[156:159], v[60:63], v[96:99], v[156:159]
    ds_read_b64_tr_b16 v[56:57], v18 offset:24576
    ds_read_b64_tr_b16 v[58:59], v18 offset:25088
    s_waitcnt lgkmcnt(12)
    s_waitcnt vmcnt(15)
    v_mfma_f32_16x16x32_bf16 v[144:147], v[64:67], v[100:103], v[144:147]
    ds_read_b64_tr_b16 v[60:61], v19 offset:24576
    ds_read_b64_tr_b16 v[62:63], v19 offset:25088
    s_waitcnt lgkmcnt(12)
    v_mfma_f32_16x16x32_bf16 v[148:151], v[68:71], v[100:103], v[148:151]
    ds_read_b64_tr_b16 v[64:65], v16 offset:28672
    ds_read_b64_tr_b16 v[66:67], v16 offset:29184
    buffer_load_dwordx4 v9, s[16:19], s55 offen offset:1024 lds
    s_waitcnt lgkmcnt(12)
    v_mfma_f32_16x16x32_bf16 v[152:155], v[72:75], v[100:103], v[152:155]
    ds_read_b64_tr_b16 v[68:69], v17 offset:28672
    ds_read_b64_tr_b16 v[70:71], v17 offset:29184
    s_waitcnt lgkmcnt(12)
    v_mfma_f32_16x16x32_bf16 v[156:159], v[76:79], v[100:103], v[156:159]
    ds_read_b64_tr_b16 v[72:73], v18 offset:28672
    ds_read_b64_tr_b16 v[74:75], v18 offset:29184
    s_waitcnt lgkmcnt(12)
    s_waitcnt vmcnt(15)
    v_mfma_f32_16x16x32_bf16 v[144:147], v[48:51], v[104:107], v[144:147]
    ds_read_b64_tr_b16 v[76:77], v19 offset:28672
    ds_read_b64_tr_b16 v[78:79], v19 offset:29184
    s_waitcnt lgkmcnt(12)
    v_mfma_f32_16x16x32_bf16 v[148:151], v[52:55], v[104:107], v[148:151]
    ds_read_b64_tr_b16 v[48:49], v16 offset:32768
    ds_read_b64_tr_b16 v[50:51], v16 offset:33280
    buffer_load_dwordx4 v10, s[16:19], s55 offen offset:2048 lds
    s_waitcnt lgkmcnt(12)
    v_mfma_f32_16x16x32_bf16 v[152:155], v[56:59], v[104:107], v[152:155]
    ds_read_b64_tr_b16 v[52:53], v17 offset:32768
    ds_read_b64_tr_b16 v[54:55], v17 offset:33280
    s_waitcnt lgkmcnt(12)
    v_mfma_f32_16x16x32_bf16 v[156:159], v[60:63], v[104:107], v[156:159]
    ds_read_b64_tr_b16 v[56:57], v18 offset:32768
    ds_read_b64_tr_b16 v[58:59], v18 offset:33280
    s_waitcnt lgkmcnt(12)
    s_waitcnt vmcnt(15)
    v_mfma_f32_16x16x32_bf16 v[144:147], v[64:67], v[108:111], v[144:147]
    ds_read_b64_tr_b16 v[60:61], v19 offset:32768
    ds_read_b64_tr_b16 v[62:63], v19 offset:33280
    s_waitcnt lgkmcnt(12)
    v_mfma_f32_16x16x32_bf16 v[148:151], v[68:71], v[108:111], v[148:151]
    ds_read_b64_tr_b16 v[64:65], v16 offset:36864
    ds_read_b64_tr_b16 v[66:67], v16 offset:37376
    buffer_load_dwordx4 v11, s[16:19], s55 offen offset:3072 lds
    s_add_u32 s55, s55, 32768
    s_waitcnt lgkmcnt(12)
    v_mfma_f32_16x16x32_bf16 v[152:155], v[72:75], v[108:111], v[152:155]
    ds_read_b64_tr_b16 v[68:69], v17 offset:36864
    ds_read_b64_tr_b16 v[70:71], v17 offset:37376
    s_waitcnt lgkmcnt(12)
    v_mfma_f32_16x16x32_bf16 v[156:159], v[76:79], v[108:111], v[156:159]
    ds_read_b64_tr_b16 v[72:73], v18 offset:36864
    ds_read_b64_tr_b16 v[74:75], v18 offset:37376
    s_waitcnt lgkmcnt(12)
    s_waitcnt vmcnt(15)
    v_mfma_f32_16x16x32_bf16 v[144:147], v[48:51], v[112:115], v[144:147]
    ds_read_b64_tr_b16 v[76:77], v19 offset:36864
    ds_read_b64_tr_b16 v[78:79], v19 offset:37376
    s_waitcnt lgkmcnt(12)
    v_mfma_f32_16x16x32_bf16 v[148:151], v[52:55], v[112:115], v[148:151]
    ds_read_b64_tr_b16 v[48:49], v16 offset:40960
    ds_read_b64_tr_b16 v[50:51], v16 offset:41472
    s_add_u32 m0, s63, 106496
    s_nop 0
    buffer_load_dwordx4 v8, s[16:19], s55 offen offset:0 lds
    s_waitcnt lgkmcnt(12)
    v_mfma_f32_16x16x32_bf16 v[152:155], v[56:59], v[112:115], v[152:155]
    ds_read_b64_tr_b16 v[52:53], v17 offset:40960
    ds_read_b64_tr_b16 v[54:55], v17 offset:41472
    s_waitcnt lgkmcnt(12)
    v_mfma_f32_16x16x32_bf16 v[156:159], v[60:63], v[112:115], v[156:159]
    ds_read_b64_tr_b16 v[56:57], v18 offset:40960
    ds_read_b64_tr_b16 v[58:59], v18 offset:41472
    s_waitcnt lgkmcnt(12)
    s_waitcnt vmcnt(15)
    v_mfma_f32_16x16x32_bf16 v[144:147], v[64:67], v[116:119], v[144:147]
    ds_read_b64_tr_b16 v[60:61], v19 offset:40960
    ds_read_b64_tr_b16 v[62:63], v19 offset:41472
    s_waitcnt lgkmcnt(12)
    v_mfma_f32_16x16x32_bf16 v[148:151], v[68:71], v[116:119], v[148:151]
    ds_read_b64_tr_b16 v[64:65], v16 offset:45056
    ds_read_b64_tr_b16 v[66:67], v16 offset:45568
    buffer_load_dwordx4 v9, s[16:19], s55 offen offset:1024 lds
    s_waitcnt lgkmcnt(12)
    v_mfma_f32_16x16x32_bf16 v[152:155], v[72:75], v[116:119], v[152:155]
    ds_read_b64_tr_b16 v[68:69], v17 offset:45056
    ds_read_b64_tr_b16 v[70:71], v17 offset:45568
    s_waitcnt lgkmcnt(12)
    v_mfma_f32_16x16x32_bf16 v[156:159], v[76:79], v[116:119], v[156:159]
    ds_read_b64_tr_b16 v[72:73], v18 offset:45056
    ds_read_b64_tr_b16 v[74:75], v18 offset:45568
    s_waitcnt lgkmcnt(12)
    s_waitcnt vmcnt(15)
    v_mfma_f32_16x16x32_bf16 v[144:147], v[48:51], v[120:123], v[144:147]
    ds_read_b64_tr_b16 v[76:77], v19 offset:45056
    ds_read_b64_tr_b16 v[78:79], v19 offset:45568
    s_waitcnt lgkmcnt(12)
    v_mfma_f32_16x16x32_bf16 v[148:151], v[52:55], v[120:123], v[148:151]
    ds_read_b64_tr_b16 v[48:49], v16 offset:49152
    ds_read_b64_tr_b16 v[50:51], v16 offset:49664
    buffer_load_dwordx4 v10, s[16:19], s55 offen offset:2048 lds
    s_waitcnt lgkmcnt(12)
    v_mfma_f32_16x16x32_bf16 v[152:155], v[56:59], v[120:123], v[152:155]
    ds_read_b64_tr_b16 v[52:53], v17 offset:49152
    ds_read_b64_tr_b16 v[54:55], v17 offset:49664
    s_waitcnt lgkmcnt(12)
    v_mfma_f32_16x16x32_bf16 v[156:159], v[60:63], v[120:123], v[156:159]
    ds_read_b64_tr_b16 v[56:57], v18 offset:49152
    ds_read_b64_tr_b16 v[58:59], v18 offset:49664
    s_waitcnt lgkmcnt(12)
    s_waitcnt vmcnt(15)
    v_mfma_f32_16x16x32_bf16 v[144:147], v[64:67], v[124:127], v[144:147]
    ds_read_b64_tr_b16 v[60:61], v19 offset:49152
    ds_read_b64_tr_b16 v[62:63], v19 offset:49664
    s_waitcnt lgkmcnt(12)
    v_mfma_f32_16x16x32_bf16 v[148:151], v[68:71], v[124:127], v[148:151]
    ds_read_b64_tr_b16 v[64:65], v16 offset:53248
    ds_read_b64_tr_b16 v[66:67], v16 offset:53760
    buffer_load_dwordx4 v11, s[16:19], s55 offen offset:3072 lds
    s_add_u32 s55, s55, 32768
    s_waitcnt lgkmcnt(12)
    v_mfma_f32_16x16x32_bf16 v[152:155], v[72:75], v[124:127], v[152:155]
    ds_read_b64_tr_b16 v[68:69], v17 offset:53248
    ds_read_b64_tr_b16 v[70:71], v17 offset:53760
    s_waitcnt lgkmcnt(12)
    v_mfma_f32_16x16x32_bf16 v[156:159], v[76:79], v[124:127], v[156:159]
    ds_read_b64_tr_b16 v[72:73], v18 offset:53248
    ds_read_b64_tr_b16 v[74:75], v18 offset:53760
    s_waitcnt lgkmcnt(12)
    s_waitcnt vmcnt(15)
    v_mfma_f32_16x16x32_bf16 v[144:147], v[48:51], v[128:131], v[144:147]
    ds_read_b64_tr_b16 v[76:77], v19 offset:53248
    ds_read_b64_tr_b16 v[78:79], v19 offset:53760
    s_waitcnt lgkmcnt(12)
    v_mfma_f32_16x16x32_bf16 v[148:151], v[52:55], v[128:131], v[148:151]
    ds_read_b64_tr_b16 v[48:49], v16 offset:57344
    ds_read_b64_tr_b16 v[50:51], v16 offset:57856
    s_add_u32 m0, s63, 110592
    s_nop 0
    buffer_load_dwordx4 v8, s[16:19], s55 offen offset:0 lds
    s_waitcnt lgkmcnt(12)
    v_mfma_f32_16x16x32_bf16 v[152:155], v[56:59], v[128:131], v[152:155]
    ds_read_b64_tr_b16 v[52:53], v17 offset:57344
    ds_read_b64_tr_b16 v[54:55], v17 offset:57856
    s_waitcnt lgkmcnt(12)
    v_mfma_f32_16x16x32_bf16 v[156:159], v[60:63], v[128:131], v[156:159]
    ds_read_b64_tr_b16 v[56:57], v18 offset:57344
    ds_read_b64_tr_b16 v[58:59], v18 offset:57856
    s_waitcnt lgkmcnt(12)
    s_waitcnt vmcnt(15)
    v_mfma_f32_16x16x32_bf16 v[144:147], v[64:67], v[132:135], v[144:147]
    ds_read_b64_tr_b16 v[60:61], v19 offset:57344
    ds_read_b64_tr_b16 v[62:63], v19 offset:57856
    s_waitcnt lgkmcnt(12)
    v_mfma_f32_16x16x32_bf16 v[148:151], v[68:71], v[132:135], v[148:151]
    ds_read_b64_tr_b16 v[64:65], v16 offset:61440
    ds_read_b64_tr_b16 v[66:67], v16 offset:61952
    buffer_load_dwordx4 v9, s[16:19], s55 offen offset:1024 lds
    s_waitcnt lgkmcnt(12)
    v_mfma_f32_16x16x32_bf16 v[152:155], v[72:75], v[132:135], v[152:155]
    ds_read_b64_tr_b16 v[68:69], v17 offset:61440
    ds_read_b64_tr_b16 v[70:71], v17 offset:61952
    s_waitcnt lgkmcnt(12)
    v_mfma_f32_16x16x32_bf16 v[156:159], v[76:79], v[132:135], v[156:159]
    ds_read_b64_tr_b16 v[72:73], v18 offset:61440
    ds_read_b64_tr_b16 v[74:75], v18 offset:61952
    s_waitcnt lgkmcnt(12)
    s_waitcnt vmcnt(15)
    v_mfma_f32_16x16x32_bf16 v[144:147], v[48:51], v[136:139], v[144:147]
    ds_read_b64_tr_b16 v[76:77], v19 offset:61440
    ds_read_b64_tr_b16 v[78:79], v19 offset:61952
    s_waitcnt lgkmcnt(12)
    v_mfma_f32_16x16x32_bf16 v[148:151], v[52:55], v[136:139], v[148:151]
    buffer_load_dwordx4 v10, s[16:19], s55 offen offset:2048 lds
    s_waitcnt lgkmcnt(10)
    v_mfma_f32_16x16x32_bf16 v[152:155], v[56:59], v[136:139], v[152:155]
    s_waitcnt lgkmcnt(8)
    v_mfma_f32_16x16x32_bf16 v[156:159], v[60:63], v[136:139], v[156:159]
    s_waitcnt lgkmcnt(6)
    s_waitcnt vmcnt(15)
    v_mfma_f32_16x16x32_bf16 v[144:147], v[64:67], v[140:143], v[144:147]
    s_waitcnt lgkmcnt(4)
    v_mfma_f32_16x16x32_bf16 v[148:151], v[68:71], v[140:143], v[148:151]
    buffer_load_dwordx4 v11, s[16:19], s55 offen offset:3072 lds
    s_add_u32 s55, s55, 32768
    s_waitcnt lgkmcnt(2)
    v_mfma_f32_16x16x32_bf16 v[152:155], v[72:75], v[140:143], v[152:155]
    s_waitcnt lgkmcnt(0)
    v_mfma_f32_16x16x32_bf16 v[156:159], v[76:79], v[140:143], v[156:159]
    v_pk_mul_f32 v[176:177], v[144:145], v[144:145]
    v_pk_mul_f32 v[178:179], v[146:147], v[146:147]
    v_pk_mul_f32 v[180:181], v[148:149], v[148:149]
    v_pk_mul_f32 v[182:183], v[150:151], v[150:151]
    s_nop 1
    v_pk_mul_f32 v[184:185], v[152:153], v[152:153]
    v_pk_mul_f32 v[186:187], v[154:155], v[154:155]
    v_pk_mul_f32 v[188:189], v[156:157], v[156:157]
    v_pk_mul_f32 v[190:191], v[158:159], v[158:159]
    v_pk_fma_f32 v[176:177], v[176:177], v[170:171], v[168:169] op_sel_hi:[1,0,0]
    v_pk_fma_f32 v[178:179], v[178:179], v[170:171], v[168:169] op_sel_hi:[1,0,0]
    v_pk_fma_f32 v[180:181], v[180:181], v[170:171], v[168:169] op_sel_hi:[1,0,0]
    v_pk_fma_f32 v[182:183], v[182:183], v[170:171], v[168:169] op_sel_hi:[1,0,0]
    v_pk_fma_f32 v[184:185], v[184:185], v[170:171], v[168:169] op_sel_hi:[1,0,0]
    v_pk_fma_f32 v[186:187], v[186:187], v[170:171], v[168:169] op_sel_hi:[1,0,0]
    v_pk_fma_f32 v[188:189], v[188:189], v[170:171], v[168:169] op_sel_hi:[1,0,0]
    v_pk_fma_f32 v[190:191], v[190:191], v[170:171], v[168:169] op_sel_hi:[1,0,0]
    v_pk_mul_f32 v[176:177], v[176:177], v[144:145]
    v_pk_mul_f32 v[178:179], v[178:179], v[146:147]
    v_pk_mul_f32 v[180:181], v[180:181], v[148:149]
    v_pk_mul_f32 v[182:183], v[182:183], v[150:151]
    v_pk_mul_f32 v[184:185], v[184:185], v[152:153]
    v_pk_mul_f32 v[186:187], v[186:187], v[154:155]
    v_pk_mul_f32 v[188:189], v[188:189], v[156:157]
    v_pk_mul_f32 v[190:191], v[190:191], v[158:159]
    v_exp_f32 v176, v176
    v_exp_f32 v177, v177
    v_exp_f32 v178, v178
    v_exp_f32 v179, v179
    v_exp_f32 v180, v180
    v_exp_f32 v181, v181
    v_exp_f32 v182, v182
    v_exp_f32 v183, v183
    v_exp_f32 v184, v184
    v_exp_f32 v185, v185
    v_exp_f32 v186, v186
    v_exp_f32 v187, v187
    v_exp_f32 v188, v188
    v_exp_f32 v189, v189
    v_exp_f32 v190, v190
    v_exp_f32 v191, v191
    v_pk_fma_f32 v[176:177], v[176:177], v[172:173], v[172:173] op_sel_hi:[1,0,0]
    v_pk_fma_f32 v[178:179], v[178:179], v[172:173], v[172:173] op_sel_hi:[1,0,0]
    v_pk_fma_f32 v[180:181], v[180:181], v[172:173], v[172:173] op_sel_hi:[1,0,0]
    v_pk_fma_f32 v[182:183], v[182:183], v[172:173], v[172:173] op_sel_hi:[1,0,0]
    v_pk_fma_f32 v[184:185], v[184:185], v[172:173], v[172:173] op_sel_hi:[1,0,0]
    v_pk_fma_f32 v[186:187], v[186:187], v[172:173], v[172:173] op_sel_hi:[1,0,0]
    v_pk_fma_f32 v[188:189], v[188:189], v[172:173], v[172:173] op_sel_hi:[1,0,0]
    v_pk_fma_f32 v[190:191], v[190:191], v[172:173], v[172:173] op_sel_hi:[1,0,0]
    v_rcp_f32 v176, v176
    v_rcp_f32 v177, v177
    v_rcp_f32 v178, v178
    v_rcp_f32 v179, v179
    v_rcp_f32 v180, v180
    v_rcp_f32 v181, v181
    v_rcp_f32 v182, v182
    v_rcp_f32 v183, v183
    v_rcp_f32 v184, v184
    v_rcp_f32 v185, v185
    v_rcp_f32 v186, v186
    v_rcp_f32 v187, v187
    v_rcp_f32 v188, v188
    v_rcp_f32 v189, v189
    v_rcp_f32 v190, v190
    v_rcp_f32 v191, v191
    v_pk_mul_f32 v[144:145], v[144:145], v[176:177]
    v_pk_mul_f32 v[146:147], v[146:147], v[178:179]
    v_pk_mul_f32 v[148:149], v[148:149], v[180:181]
    v_pk_mul_f32 v[150:151], v[150:151], v[182:183]
    v_pk_mul_f32 v[152:153], v[152:153], v[184:185]
    v_pk_mul_f32 v[154:155], v[154:155], v[186:187]
    v_pk_mul_f32 v[156:157], v[156:157], v[188:189]
    v_pk_mul_f32 v[158:159], v[158:159], v[190:191]
    v_cvt_pk_bf16_f32 v176, v144, v145
    v_cvt_pk_bf16_f32 v177, v146, v147
    v_cvt_pk_bf16_f32 v178, v148, v149
    v_cvt_pk_bf16_f32 v179, v150, v151
    v_cvt_pk_bf16_f32 v180, v152, v153
    v_cvt_pk_bf16_f32 v181, v154, v155
    v_cvt_pk_bf16_f32 v182, v156, v157
    v_cvt_pk_bf16_f32 v183, v158, v159
    v_permlane16_swap_b32 v176, v178
    v_permlane16_swap_b32 v177, v179
    v_permlane16_swap_b32 v180, v182
    v_permlane16_swap_b32 v181, v183
    s_add_u32 s36, s44, 7340032
    s_cmp_lg_u32 s40, 0
    s_cbranch_scc1 T_S6
    buffer_store_dwordx4 v[176:179], v5, s[8:11], s36 offen offset:0
    buffer_store_dwordx4 v[180:183], v5, s[8:11], s36 offen offset:128
    s_branch T_D6
T_S6:
    buffer_store_dwordx4 v[176:179], v5, s[8:11], s36 offen offset:0 sc1
    buffer_store_dwordx4 v[180:183], v5, s[8:11], s36 offen offset:128 sc1
T_D6:
    buffer_store_dwordx4 v[176:179], v36, s[8:11], 0 offen offset:0 sc1
    buffer_store_dwordx4 v[180:183], v36, s[8:11], 0 offen offset:128 sc1
    s_add_u32 m0, s62, 0
    s_nop 0
    buffer_load_dwordx4 v8, s[24:27], s45 offen offset:0 lds
    buffer_load_dwordx4 v9, s[24:27], s45 offen offset:1024 lds
    buffer_load_dwordx4 v10, s[24:27], s45 offen offset:2048 lds
    buffer_load_dwordx4 v11, s[24:27], s45 offen offset:3072 lds
    s_add_u32 s45, s45, 128
    s_waitcnt vmcnt(6)
    s_cmp_lg_u32 s40, 0
    s_cbranch_scc1 T_S7
    buffer_store_dword v34, off, s[8:11], s52 offset:256
    s_branch T_D7
T_S7:
    buffer_store_dword v34, off, s[8:11], s52 offset:256 sc1
T_D7:
    s_add_u32 s36, s44, 5242880
    s_add_u32 s37, s44, 3145728
    buffer_load_dwordx4 v[160:163], v5, s[8:11], s36 offen offset:0 sc1
    buffer_load_dwordx4 a[224:227], v5, s[8:11], s37 offen offset:0 sc1
    buffer_load_dwordx4 v[164:167], v5, s[8:11], s36 offen offset:128 sc1
    buffer_load_dwordx4 a[228:231], v5, s[8:11], s37 offen offset:128 sc1
    s_add_u32 m0, s62, 4096
    s_nop 0
    buffer_load_dwordx4 v8, s[24:27], s45 offen offset:0 lds
    buffer_load_dwordx4 v9, s[24:27], s45 offen offset:1024 lds
    buffer_load_dwordx4 v10, s[24:27], s45 offen offset:2048 lds
    buffer_load_dwordx4 v11, s[24:27], s45 offen offset:3072 lds
    s_add_u32 s45, s45, 32640
    s_barrier
    v_add_u32 v16, s46, v12
    v_add_u32 v17, s46, v13
    v_add_u32 v18, s46, v14
    v_add_u32 v19, s46, v15
    ds_read_b64_tr_b16 v[48:49], v16 offset:0
    ds_read_b64_tr_b16 v[50:51], v16 offset:512
    ds_read_b64_tr_b16 v[52:53], v17 offset:0
    ds_read_b64_tr_b16 v[54:55], v17 offset:512
    ds_read_b64_tr_b16 v[56:57], v18 offset:0
    ds_read_b64_tr_b16 v[58:59], v18 offset:512
    ds_read_b64_tr_b16 v[60:61], v19 offset:0
    ds_read_b64_tr_b16 v[62:63], v19 offset:512
    ds_read_b64_tr_b16 v[64:65], v16 offset:4096
    ds_read_b64_tr_b16 v[66:67], v16 offset:4608
    ds_read_b64_tr_b16 v[68:69], v17 offset:4096
    ds_read_b64_tr_b16 v[70:71], v17 offset:4608
    ds_read_b64_tr_b16 v[72:73], v18 offset:4096
    ds_read_b64_tr_b16 v[74:75], v18 offset:4608
    s_mov_b32 s42, 30000
T_P8:
    buffer_load_dword v35, v33, s[8:11], s41 offen offset:256 sc1
T_W8:
    s_waitcnt vmcnt(0)
    v_cmp_eq_u32 vcc, 0, v35
    s_sub_u32 s42, s42, 1
    s_cbranch_vccz T_Q8
    s_cmp_lg_u32 s42, 0
    s_cbranch_scc1 T_P8
T_Q8:
    buffer_load_dwordx4 v[80:83], v40, s[8:11], 0 offen offset:0 sc1
    buffer_load_dwordx4 v[84:87], v40, s[8:11], 0 offen offset:128 sc1
    buffer_load_dwordx4 v[88:91], v40, s[8:11], 0 offen offset:256 sc1
    buffer_load_dwordx4 v[92:95], v40, s[8:11], 0 offen offset:384 sc1
    buffer_load_dwordx4 v[96:99], v41, s[8:11], 0 offen offset:0 sc1
    buffer_load_dwordx4 v[100:103], v41, s[8:11], 0 offen offset:128 sc1
    buffer_load_dwordx4 v[104:107], v41, s[8:11], 0 offen offset:256 sc1
    buffer_load_dwordx4 v[108:111], v41, s[8:11], 0 offen offset:384 sc1
    buffer_load_dwordx4 v[112:115], v42, s[8:11], 0 offen offset:0 sc1
    buffer_load_dwordx4 v[116:119], v42, s[8:11], 0 offen offset:128 sc1
    buffer_load_dwordx4 v[120:123], v42, s[8:11], 0 offen offset:256 sc1
    buffer_load_dwordx4 v[124:127], v42, s[8:11], 0 offen offset:384 sc1
    buffer_load_dwordx4 v[128:131], v43, s[8:11], 0 offen offset:0 sc1
    buffer_load_dwordx4 v[132:135], v43, s[8:11], 0 offen offset:128 sc1
    buffer_load_dwordx4 v[136:139], v43, s[8:11], 0 offen offset:256 sc1
    buffer_load_dwordx4 v[140:143], v43, s[8:11], 0 offen offset:384 sc1
    s_add_u32 s6, s62, 0
    v_add_u32 v44, s6, v12
    v_add_u32 v45, s6, v13
    v_add_u32 v46, s6, v14
    v_add_u32 v47, s6, v15
    s_waitcnt lgkmcnt(10)
    ds_read_b64_tr_b16 a[96:97], v44 offset:0
    ds_read_b64_tr_b16 a[98:99], v44 offset:512
    ds_read_b64_tr_b16 a[100:101], v45 offset:0
    ds_read_b64_tr_b16 a[102:103], v45 offset:512
    s_waitcnt lgkmcnt(10)
    ds_read_b64_tr_b16 a[104:105], v46 offset:0
    ds_read_b64_tr_b16 a[106:107], v46 offset:512
    ds_read_b64_tr_b16 a[108:109], v47 offset:0
    ds_read_b64_tr_b16 a[110:111], v47 offset:512
    s_waitcnt lgkmcnt(10)
    ds_read_b64_tr_b16 a[112:113], v44 offset:4096
    ds_read_b64_tr_b16 a[114:115], v44 offset:4608
    ds_read_b64_tr_b16 a[116:117], v45 offset:4096
    ds_read_b64_tr_b16 a[118:119], v45 offset:4608
    s_waitcnt lgkmcnt(10)
    ds_read_b64_tr_b16 a[120:121], v46 offset:4096
    ds_read_b64_tr_b16 a[122:123], v46 offset:4608
    ds_read_b64_tr_b16 a[124:125], v47 offset:4096
    ds_read_b64_tr_b16 a[126:127], v47 offset:4608
    s_waitcnt lgkmcnt(0)
    s_waitcnt lgkmcnt(12)
    s_waitcnt vmcnt(15)
    v_mfma_f32_16x16x32_bf16 v[144:147], v[48:51], v[80:83], 0
    ds_read_b64_tr_b16 v[76:77], v19 offset:4096
    ds_read_b64_tr_b16 v[78:79], v19 offset:4608
    s_waitcnt lgkmcnt(12)
    v_mfma_f32_16x16x32_bf16 v[148:151], v[52:55], v[80:83], 0
    ds_read_b64_tr_b16 v[48:49], v16 offset:8192
    ds_read_b64_tr_b16 v[50:51], v16 offset:8704
    s_add_u32 m0, s63, 32768
    s_nop 0
    buffer_load_dwordx4 v8, s[24:27], s45 offen offset:0 lds
    s_waitcnt lgkmcnt(12)
    v_mfma_f32_16x16x32_bf16 v[152:155], v[56:59], v[80:83], 0
    ds_read_b64_tr_b16 v[52:53], v17 offset:8192
    ds_read_b64_tr_b16 v[54:55], v17 offset:8704
    s_waitcnt lgkmcnt(12)
    v_mfma_f32_16x16x32_bf16 v[156:159], v[60:63], v[80:83], 0
    ds_read_b64_tr_b16 v[56:57], v18 offset:8192
    ds_read_b64_tr_b16 v[58:59], v18 offset:8704
    s_waitcnt lgkmcnt(12)
    s_waitcnt vmcnt(15)
    v_mfma_f32_16x16x32_bf16 v[144:147], v[64:67], v[84:87], v[144:147]
    ds_read_b64_tr_b16 v[60:61], v19 offset:8192
    ds_read_b64_tr_b16 v[62:63], v19 offset:8704
    s_waitcnt lgkmcnt(12)
    v_mfma_f32_16x16x32_bf16 v[148:151], v[68:71], v[84:87], v[148:151]
    ds_read_b64_tr_b16 v[64:65], v16 offset:12288
    ds_read_b64_tr_b16 v[66:67], v16 offset:12800
    buffer_load_dwordx4 v9, s[24:27], s45 offen offset:1024 lds
    s_waitcnt lgkmcnt(12)
    v_mfma_f32_16x16x32_bf16 v[152:155], v[72:75], v[84:87], v[152:155]
    ds_read_b64_tr_b16 v[68:69], v17 offset:12288
    ds_read_b64_tr_b16 v[70:71], v17 offset:12800
    s_waitcnt lgkmcnt(12)
    v_mfma_f32_16x16x32_bf16 v[156:159], v[76:79], v[84:87], v[156:159]
    ds_read_b64_tr_b16 v[72:73], v18 offset:12288
    ds_read_b64_tr_b16 v[74:75], v18 offset:12800
    s_waitcnt lgkmcnt(12)
    s_waitcnt vmcnt(15)
    v_mfma_f32_16x16x32_bf16 v[144:147], v[48:51], v[88:91], v[144:147]
    ds_read_b64_tr_b16 v[76:77], v19 offset:12288
    ds_read_b64_tr_b16 v[78:79], v19 offset:12800
    s_waitcnt lgkmcnt(12)
    v_mfma_f32_16x16x32_bf16 v[148:151], v[52:55], v[88:91], v[148:151]
    v_add_u32 v16, s47, v12
    v_add_u32 v17, s47, v13
    v_add_u32 v18, s47, v14
    v_add_u32 v19, s47, v15
    ds_read_b64_tr_b16 v[48:49], v16 offset:0
    ds_read_b64_tr_b16 v[50:51], v16 offset:512
    buffer_load_dwordx4 v10, s[24:27], s45 offen offset:2048 lds
    s_waitcnt lgkmcnt(12)
    v_mfma_f32_16x16x32_bf16 v[152:155], v[56:59], v[88:91], v[152:155]
    ds_read_b64_tr_b16 v[52:53], v17 offset:0
    ds_read_b64_tr_b16 v[54:55], v17 offset:512
    s_waitcnt lgkmcnt(12)
    v_mfma_f32_16x16x32_bf16 v[156:159], v[60:63], v[88:91], v[156:159]
    ds_read_b64_tr_b16 v[56:57], v18 offset:0
    ds_read_b64_tr_b16 v[58:59], v18 offset:512
    s_waitcnt lgkmcnt(12)
    s_waitcnt vmcnt(15)
    v_mfma_f32_16x16x32_bf16 v[144:147], v[64:67], v[92:95], v[144:147]
    ds_read_b64_tr_b16 v[60:61], v19 offset:0
    ds_read_b64_tr_b16 v[62:63], v19 offset:512
    s_waitcnt lgkmcnt(12)
    v_mfma_f32_16x16x32_bf16 v[148:151], v[68:71], v[92:95], v[148:151]
    ds_read_b64_tr_b16 v[64:65], v16 offset:4096
    ds_read_b64_tr_b16 v[66:67], v16 offset:4608
    buffer_load_dwordx4 v11, s[24:27], s45 offen offset:3072 lds
    s_add_u32 s45, s45, 128
    s_waitcnt lgkmcnt(12)
    v_mfma_f32_16x16x32_bf16 v[152:155], v[72:75], v[92:95], v[152:155]
    ds_read_b64_tr_b16 v[68:69], v17 offset:4096
    ds_read_b64_tr_b16 v[70:71], v17 offset:4608
    s_waitcnt lgkmcnt(12)
    v_mfma_f32_16x16x32_bf16 v[156:159], v[76:79], v[92:95], v[156:159]
    ds_read_b64_tr_b16 v[72:73], v18 offset:4096
    ds_read_b64_tr_b16 v[74:75], v18 offset:4608
    s_waitcnt lgkmcnt(12)
    s_waitcnt vmcnt(15)
    v_mfma_f32_16x16x32_bf16 v[144:147], v[48:51], v[96:99], v[144:147]
    ds_read_b64_tr_b16 v[76:77], v19 offset:4096
    ds_read_b64_tr_b16 v[78:79], v19 offset:4608
    s_waitcnt lgkmcnt(12)
    v_mfma_f32_16x16x32_bf16 v[148:151], v[52:55], v[96:99], v[148:151]
    ds_read_b64_tr_b16 v[48:49], v16 offset:8192
    ds_read_b64_tr_b16 v[50:51], v16 offset:8704
    s_add_u32 m0, s63, 36864
    s_nop 0
    buffer_load_dwordx4 v8, s[24:27], s45 offen offset:0 lds
    s_waitcnt lgkmcnt(12)
    v_mfma_f32_16x16x32_bf16 v[152:155], v[56:59], v[96:99], v[152:155]
    ds_read_b64_tr_b16 v[52:53], v17 offset:8192
    ds_read_b64_tr_b16 v[54:55], v17 offset:8704
    s_waitcnt lgkmcnt(12)
    v_mfma_f32_16x16x32_bf16 v[156:159], v[60:63], v[96:99], v[156:159]
    ds_read_b64_tr_b16 v[56:57], v18 offset:8192
    ds_read_b64_tr_b16 v[58:59], v18 offset:8704
    s_waitcnt lgkmcnt(12)
    s_waitcnt vmcnt(15)
    v_mfma_f32_16x16x32_bf16 v[144:147], v[64:67], v[100:103], v[144:147]
    ds_read_b64_tr_b16 v[60:61], v19 offset:8192
    ds_read_b64_tr_b16 v[62:63], v19 offset:8704
    s_waitcnt lgkmcnt(12)
    v_mfma_f32_16x16x32_bf16 v[148:151], v[68:71], v[100:103], v[148:151]
    ds_read_b64_tr_b16 v[64:65], v16 offset:12288
    ds_read_b64_tr_b16 v[66:67], v16 offset:12800
    buffer_load_dwordx4 v9, s[24:27], s45 offen offset:1024 lds
    s_waitcnt lgkmcnt(12)
    v_mfma_f32_16x16x32_bf16 v[152:155], v[72:75], v[100:103], v[152:155]
    ds_read_b64_tr_b16 v[68:69], v17 offset:12288
    ds_read_b64_tr_b16 v[70:71], v17 offset:12800
    s_waitcnt lgkmcnt(12)
    v_mfma_f32_16x16x32_bf16 v[156:159], v[76:79], v[100:103], v[156:159]
    ds_read_b64_tr_b16 v[72:73], v18 offset:12288
    ds_read_b64_tr_b16 v[74:75], v18 offset:12800
    s_waitcnt lgkmcnt(12)
    s_waitcnt vmcnt(15)
    v_mfma_f32_16x16x32_bf16 v[144:147], v[48:51], v[104:107], v[144:147]
    ds_read_b64_tr_b16 v[76:77], v19 offset:12288
    ds_read_b64_tr_b16 v[78:79], v19 offset:12800
    s_waitcnt lgkmcnt(12)
    v_mfma_f32_16x16x32_bf16 v[148:151], v[52:55], v[104:107], v[148:151]
    v_add_u32 v16, s48, v12
    v_add_u32 v17, s48, v13
    v_add_u32 v18, s48, v14
    v_add_u32 v19, s48, v15
    ds_read_b64_tr_b16 v[48:49], v16 offset:0
    ds_read_b64_tr_b16 v[50:51], v16 offset:512
    buffer_load_dwordx4 v10, s[24:27], s45 offen offset:2048 lds
    s_waitcnt lgkmcnt(12)
    v_mfma_f32_16x16x32_bf16 v[152:155], v[56:59], v[104:107], v[152:155]
    ds_read_b64_tr_b16 v[52:53], v17 offset:0
    ds_read_b64_tr_b16 v[54:55], v17 offset:512
    s_waitcnt lgkmcnt(12)
    v_mfma_f32_16x16x32_bf16 v[156:159], v[60:63], v[104:107], v[156:159]
    ds_read_b64_tr_b16 v[56:57], v18 offset:0
    ds_read_b64_tr_b16 v[58:59], v18 offset:512
    s_waitcnt lgkmcnt(12)
    s_waitcnt vmcnt(15)
    v_mfma_f32_16x16x32_bf16 v[144:147], v[64:67], v[108:111], v[144:147]
    ds_read_b64_tr_b16 v[60:61], v19 offset:0
    ds_read_b64_tr_b16 v[62:63], v19 offset:512
    s_waitcnt lgkmcnt(12)
    v_mfma_f32_16x16x32_bf16 v[148:151], v[68:71], v[108:111], v[148:151]
    ds_read_b64_tr_b16 v[64:65], v16 offset:4096
    ds_read_b64_tr_b16 v[66:67], v16 offset:4608
    buffer_load_dwordx4 v11, s[24:27], s45 offen offset:3072 lds
    s_add_u32 s45, s45, 32640
    s_waitcnt lgkmcnt(12)
    v_mfma_f32_16x16x32_bf16 v[152:155], v[72:75], v[108:111], v[152:155]
    ds_read_b64_tr_b16 v[68:69], v17 offset:4096
    ds_read_b64_tr_b16 v[70:71], v17 offset:4608
    s_waitcnt lgkmcnt(12)
    v_mfma_f32_16x16x32_bf16 v[156:159], v[76:79], v[108:111], v[156:159]
    ds_read_b64_tr_b16 v[72:73], v18 offset:4096
    ds_read_b64_tr_b16 v[74:75], v18 offset:4608
    s_waitcnt lgkmcnt(12)
    s_waitcnt vmcnt(8)
    s_mov_b32 s42, 30000
T_H0:
    v_max3_u32 v44, v112, v116, v120
    v_max3_u32 v45, v124, v128, v132
    v_max3_u32 v44, v44, v136, v140
    v_max_u32 v44, v44, v45
    v_cmp_eq_u32 vcc, -1, v44
    s_sub_u32 s42, s42, 1
    s_cbranch_vccz T_H1
    s_cmp_eq_u32 s42, 0
    s_cbranch_scc1 T_H1
    buffer_load_dwordx4 v[112:115], v42, s[8:11], 0 offen offset:0 sc1
    buffer_load_dwordx4 v[116:119], v42, s[8:11], 0 offen offset:128 sc1
    buffer_load_dwordx4 v[120:123], v42, s[8:11], 0 offen offset:256 sc1
    buffer_load_dwordx4 v[124:127], v42, s[8:11], 0 offen offset:384 sc1
    buffer_load_dwordx4 v[128:131], v43, s[8:11], 0 offen offset:0 sc1
    buffer_load_dwordx4 v[132:135], v43, s[8:11], 0 offen offset:128 sc1
    buffer_load_dwordx4 v[136:139], v43, s[8:11], 0 offen offset:256 sc1
    buffer_load_dwordx4 v[140:143], v43, s[8:11], 0 offen offset:384 sc1
    s_waitcnt vmcnt(0)
    s_branch T_H0
T_H1:
    v_mfma_f32_16x16x32_bf16 v[144:147], v[48:51], v[112:115], v[144:147]
    ds_read_b64_tr_b16 v[76:77], v19 offset:4096
    ds_read_b64_tr_b16 v[78:79], v19 offset:4608
    s_waitcnt lgkmcnt(12)
    v_mfma_f32_16x16x32_bf16 v[148:151], v[52:55], v[112:115], v[148:151]
    ds_read_b64_tr_b16 v[48:49], v16 offset:8192
    ds_read_b64_tr_b16 v[50:51], v16 offset:8704
    s_add_u32 m0, s63, 40960
    s_nop 0
    buffer_load_dwordx4 v8, s[24:27], s45 offen offset:0 lds
    s_waitcnt lgkmcnt(12)
    v_mfma_f32_16x16x32_bf16 v[152:155], v[56:59], v[112:115], v[152:155]
    ds_read_b64_tr_b16 v[52:53], v17 offset:8192
    ds_read_b64_tr_b16 v[54:55], v17 offset:8704
    s_waitcnt lgkmcnt(12)
    v_mfma_f32_16x16x32_bf16 v[156:159], v[60:63], v[112:115], v[156:159]
    ds_read_b64_tr_b16 v[56:57], v18 offset:8192
    ds_read_b64_tr_b16 v[58:59], v18 offset:8704
    s_waitcnt lgkmcnt(12)
    v_mfma_f32_16x16x32_bf16 v[144:147], v[64:67], v[116:119], v[144:147]
    ds_read_b64_tr_b16 v[60:61], v19 offset:8192
    ds_read_b64_tr_b16 v[62:63], v19 offset:8704
    s_waitcnt lgkmcnt(12)
    v_mfma_f32_16x16x32_bf16 v[148:151], v[68:71], v[116:119], v[148:151]
    ds_read_b64_tr_b16 v[64:65], v16 offset:12288
    ds_read_b64_tr_b16 v[66:67], v16 offset:12800
    buffer_load_dwordx4 v9, s[24:27], s45 offen offset:1024 lds
    s_waitcnt lgkmcnt(12)
    v_mfma_f32_16x16x32_bf16 v[152:155], v[72:75], v[116:119], v[152:155]
    ds_read_b64_tr_b16 v[68:69], v17 offset:12288
    ds_read_b64_tr_b16 v[70:71], v17 offset:12800
    s_waitcnt lgkmcnt(12)
    v_mfma_f32_16x16x32_bf16 v[156:159], v[76:79], v[116:119], v[156:159]
    ds_read_b64_tr_b16 v[72:73], v18 offset:12288
    ds_read_b64_tr_b16 v[74:75], v18 offset:12800
    s_waitcnt lgkmcnt(12)
    v_mfma_f32_16x16x32_bf16 v[144:147], v[48:51], v[120:123], v[144:147]
    ds_read_b64_tr_b16 v[76:77], v19 offset:12288
    ds_read_b64_tr_b16 v[78:79], v19 offset:12800
    s_waitcnt lgkmcnt(12)
    v_mfma_f32_16x16x32_bf16 v[148:151], v[52:55], v[120:123], v[148:151]
    v_add_u32 v16, s49, v12
    v_add_u32 v17, s49, v13
    v_add_u32 v18, s49, v14
    v_add_u32 v19, s49, v15
    ds_read_b64_tr_b16 v[48:49], v16 offset:0
    ds_read_b64_tr_b16 v[50:51], v16 offset:512
    buffer_load_dwordx4 v10, s[24:27], s45 offen offset:2048 lds
    s_waitcnt lgkmcnt(12)
    v_mfma_f32_16x16x32_bf16 v[152:155], v[56:59], v[120:123], v[152:155]
    ds_read_b64_tr_b16 v[52:53], v17 offset:0
    ds_read_b64_tr_b16 v[54:55], v17 offset:512
    s_waitcnt lgkmcnt(12)
    v_mfma_f32_16x16x32_bf16 v[156:159], v[60:63], v[120:123], v[156:159]
    ds_read_b64_tr_b16 v[56:57], v18 offset:0
    ds_read_b64_tr_b16 v[58:59], v18 offset:512
    s_waitcnt lgkmcnt(12)
    v_mfma_f32_16x16x32_bf16 v[144:147], v[64:67], v[124:127], v[144:147]
    ds_read_b64_tr_b16 v[60:61], v19 offset:0
    ds_read_b64_tr_b16 v[62:63], v19 offset:512
    s_waitcnt lgkmcnt(12)
    v_mfma_f32_16x16x32_bf16 v[148:151], v[68:71], v[124:127], v[148:151]
    ds_read_b64_tr_b16 v[64:65], v16 offset:4096
    ds_read_b64_tr_b16 v[66:67], v16 offset:4608
    buffer_load_dwordx4 v11, s[24:27], s45 offen offset:3072 lds
    s_add_u32 s45, s45, 128
    s_waitcnt lgkmcnt(12)
    v_mfma_f32_16x16x32_bf16 v[152:155], v[72:75], v[124:127], v[152:155]
    ds_read_b64_tr_b16 v[68:69], v17 offset:4096
    ds_read_b64_tr_b16 v[70:71], v17 offset:4608
    s_waitcnt lgkmcnt(12)
    v_mfma_f32_16x16x32_bf16 v[156:159], v[76:79], v[124:127], v[156:159]
    ds_read_b64_tr_b16 v[72:73], v18 offset:4096
    ds_read_b64_tr_b16 v[74:75], v18 offset:4608
    s_waitcnt lgkmcnt(12)
    v_mfma_f32_16x16x32_bf16 v[144:147], v[48:51], v[128:131], v[144:147]
    ds_read_b64_tr_b16 v[76:77], v19 offset:4096
    ds_read_b64_tr_b16 v[78:79], v19 offset:4608
    s_waitcnt lgkmcnt(12)
    v_mfma_f32_16x16x32_bf16 v[148:151], v[52:55], v[128:131], v[148:151]
    ds_read_b64_tr_b16 v[48:49], v16 offset:8192
    ds_read_b64_tr_b16 v[50:51], v16 offset:8704
    s_add_u32 m0, s63, 45056
    s_nop 0
    buffer_load_dwordx4 v8, s[24:27], s45 offen offset:0 lds
    s_waitcnt lgkmcnt(12)
    v_mfma_f32_16x16x32_bf16 v[152:155], v[56:59], v[128:131], v[152:155]
    ds_read_b64_tr_b16 v[52:53], v17 offset:8192
    ds_read_b64_tr_b16 v[54:55], v17 offset:8704
    s_waitcnt lgkmcnt(12)
    v_mfma_f32_16x16x32_bf16 v[156:159], v[60:63], v[128:131], v[156:159]
    ds_read_b64_tr_b16 v[56:57], v18 offset:8192
    ds_read_b64_tr_b16 v[58:59], v18 offset:8704
    s_waitcnt lgkmcnt(12)
    v_mfma_f32_16x16x32_bf16 v[144:147], v[64:67], v[132:135], v[144:147]
    ds_read_b64_tr_b16 v[60:61], v19 offset:8192
    ds_read_b64_tr_b16 v[62:63], v19 offset:8704
    s_waitcnt lgkmcnt(12)
    v_mfma_f32_16x16x32_bf16 v[148:151], v[68:71], v[132:135], v[148:151]
    ds_read_b64_tr_b16 v[64:65], v16 offset:12288
    ds_read_b64_tr_b16 v[66:67], v16 offset:12800
    buffer_load_dwordx4 v9, s[24:27], s45 offen offset:1024 lds
    s_waitcnt lgkmcnt(12)
    v_mfma_f32_16x16x32_bf16 v[152:155], v[72:75], v[132:135], v[152:155]
    ds_read_b64_tr_b16 v[68:69], v17 offset:12288
    ds_read_b64_tr_b16 v[70:71], v17 offset:12800
    s_waitcnt lgkmcnt(12)
    v_mfma_f32_16x16x32_bf16 v[156:159], v[76:79], v[132:135], v[156:159]
    ds_read_b64_tr_b16 v[72:73], v18 offset:12288
    ds_read_b64_tr_b16 v[74:75], v18 offset:12800
    s_waitcnt lgkmcnt(12)
    v_mfma_f32_16x16x32_bf16 v[144:147], v[48:51], v[136:139], v[144:147]
    ds_read_b64_tr_b16 v[76:77], v19 offset:12288
    ds_read_b64_tr_b16 v[78:79], v19 offset:12800
    s_waitcnt lgkmcnt(12)
    v_mfma_f32_16x16x32_bf16 v[148:151], v[52:55], v[136:139], v[148:151]
    buffer_load_dwordx4 v10, s[24:27], s45 offen offset:2048 lds
    s_waitcnt lgkmcnt(10)
    v_mfma_f32_16x16x32_bf16 v[152:155], v[56:59], v[136:139], v[152:155]
    s_waitcnt lgkmcnt(8)
    v_mfma_f32_16x16x32_bf16 v[156:159], v[60:63], v[136:139], v[156:159]
    s_waitcnt lgkmcnt(6)
    v_mfma_f32_16x16x32_bf16 v[144:147], v[64:67], v[140:143], v[144:147]
    s_waitcnt lgkmcnt(4)
    v_mfma_f32_16x16x32_bf16 v[148:151], v[68:71], v[140:143], v[148:151]
    buffer_load_dwordx4 v11, s[24:27], s45 offen offset:3072 lds
    s_add_u32 s45, s45, 32640
    s_waitcnt lgkmcnt(2)
    v_mfma_f32_16x16x32_bf16 v[152:155], v[72:75], v[140:143], v[152:155]
    s_waitcnt lgkmcnt(0)
    v_mfma_f32_16x16x32_bf16 v[156:159], v[76:79], v[140:143], v[156:159]
    v_lshlrev_b32 v176, 16, v160
    v_and_b32 v177, 0xffff0000, v160
    v_lshlrev_b32 v178, 16, v161
    v_and_b32 v179, 0xffff0000, v161
    v_lshlrev_b32 v180, 16, v162
    v_and_b32 v181, 0xffff0000, v162
    v_lshlrev_b32 v182, 16, v163
    v_and_b32 v183, 0xffff0000, v163
    v_lshlrev_b32 v184, 16, v164
    v_and_b32 v185, 0xffff0000, v164
    v_lshlrev_b32 v186, 16, v165
    v_and_b32 v187, 0xffff0000, v165
    v_lshlrev_b32 v188, 16, v166
    v_and_b32 v189, 0xffff0000, v166
    v_lshlrev_b32 v190, 16, v167
    v_and_b32 v191, 0xffff0000, v167
    v_permlane16_swap_b32 v144, v148
    v_permlane16_swap_b32 v145, v149
    v_permlane16_swap_b32 v146, v150
    v_permlane16_swap_b32 v147, v151
    v_permlane16_swap_b32 v152, v156
    v_permlane16_swap_b32 v153, v157
    v_permlane16_swap_b32 v154, v158
    v_permlane16_swap_b32 v155, v159
    v_pk_add_f32 v[176:177], v[176:177], v[144:145]
    v_pk_add_f32 v[178:179], v[178:179], v[146:147]
    v_pk_add_f32 v[180:181], v[180:181], v[148:149]
    v_pk_add_f32 v[182:183], v[182:183], v[150:151]
    v_pk_add_f32 v[184:185], v[184:185], v[152:153]
    v_pk_add_f32 v[186:187], v[186:187], v[154:155]
    v_pk_add_f32 v[188:189], v[188:189], v[156:157]
    v_pk_add_f32 v[190:191], v[190:191], v[158:159]
    v_cvt_pk_bf16_f32 v160, v176, v177
    v_cvt_pk_bf16_f32 v161, v178, v179
    v_cvt_pk_bf16_f32 v162, v180, v181
    v_cvt_pk_bf16_f32 v163, v182, v183
    v_cvt_pk_bf16_f32 v164, v184, v185
    v_cvt_pk_bf16_f32 v165, v186, v187
    v_cvt_pk_bf16_f32 v166, v188, v189
    v_cvt_pk_bf16_f32 v167, v190, v191
    s_add_u32 s36, s44, 9437184
    s_cmp_lg_u32 s40, 0
    s_cbranch_scc1 T_S9
    buffer_store_dwordx4 v[160:163], v5, s[8:11], s36 offen offset:0
    buffer_store_dwordx4 v[164:167], v5, s[8:11], s36 offen offset:128
    s_branch T_D9
T_S9:
    buffer_store_dwordx4 v[160:163], v5, s[8:11], s36 offen offset:0 sc1
    buffer_store_dwordx4 v[164:167], v5, s[8:11], s36 offen offset:128 sc1
T_D9:
    s_add_u32 m0, s62, 0
    s_nop 0
    buffer_load_dwordx4 v8, s[24:27], s45 offen offset:0 lds
    buffer_load_dwordx4 v9, s[24:27], s45 offen offset:1024 lds
    buffer_load_dwordx4 v10, s[24:27], s45 offen offset:2048 lds
    buffer_load_dwordx4 v11, s[24:27], s45 offen offset:3072 lds
    s_add_u32 s45, s45, 128
    v_accvgpr_write_b32 a232, v160
    v_accvgpr_write_b32 a233, v161
    v_accvgpr_write_b32 a234, v162
    v_accvgpr_write_b32 a235, v163
    v_accvgpr_write_b32 a236, v164
    v_accvgpr_write_b32 a237, v165
    v_accvgpr_write_b32 a238, v166
    v_accvgpr_write_b32 a239, v167
    s_waitcnt vmcnt(4)
    s_cmp_lg_u32 s40, 0
    s_cbranch_scc1 T_S10
    buffer_store_dword v34, off, s[8:11], s52 offset:384
    s_branch T_D10
T_S10:
    buffer_store_dword v34, off, s[8:11], s52 offset:384 sc1
T_D10:
    s_add_u32 m0, s62, 4096
    s_nop 0
    buffer_load_dwordx4 v8, s[24:27], s45 offen offset:0 lds
    buffer_load_dwordx4 v9, s[24:27], s45 offen offset:1024 lds
    buffer_load_dwordx4 v10, s[24:27], s45 offen offset:2048 lds
    buffer_load_dwordx4 v11, s[24:27], s45 offen offset:3072 lds
    s_add_u32 s45, s45, 32640
    s_barrier
    s_add_u32 s37, s53, 0
    s_add_u32 m0, s54, 98304
    s_nop 0
    buffer_load_dwordx4 v20, s[20:23], s37 offen offset:0 lds
    buffer_load_dwordx4 v21, s[20:23], s37 offen offset:1024 lds
    buffer_load_dwordx4 v22, s[20:23], s37 offen offset:2048 lds
    buffer_load_dwordx4 v23, s[20:23], s37 offen offset:3072 lds
    s_add_u32 m0, s54, 102400
    s_nop 0
    buffer_load_dwordx4 v24, s[20:23], s37 offen offset:0 lds
    buffer_load_dwordx4 v25, s[20:23], s37 offen offset:1024 lds
    buffer_load_dwordx4 v26, s[20:23], s37 offen offset:2048 lds
    s_mov_b32 s42, 30000
T_P11:
    buffer_load_dword v35, v32, s[8:11], s41 offen offset:384 sc1
T_W11:
    s_waitcnt vmcnt(0)
    v_cmp_eq_u32 vcc, 0, v35
    s_sub_u32 s42, s42, 1
    s_cbranch_vccz T_Q11
    s_cmp_lg_u32 s42, 0
    s_cbranch_scc1 T_P11
T_Q11:
    s_add_u32 s36, s43, 9437184
    buffer_load_dwordx4 v[80:83], v4, s[8:11], s36 offen offset:0 sc1
    buffer_load_dwordx4 v[84:87], v4, s[8:11], s36 offen offset:128 sc1
    buffer_load_dwordx4 v[88:91], v4, s[8:11], s36 offen offset:256 sc1
    buffer_load_dwordx4 v[92:95], v4, s[8:11], s36 offen offset:384 sc1
    buffer_load_dwordx4 v[96:99], v4, s[8:11], s36 offen offset:512 sc1
    buffer_load_dwordx4 v[100:103], v4, s[8:11], s36 offen offset:640 sc1
    buffer_load_dwordx4 v[104:107], v4, s[8:11], s36 offen offset:768 sc1
    buffer_load_dwordx4 v[108:111], v4, s[8:11], s36 offen offset:896 sc1
    buffer_load_dwordx4 v[112:115], v4, s[8:11], s36 offen offset:1024 sc1
    buffer_load_dwordx4 v[116:119], v4, s[8:11], s36 offen offset:1152 sc1
    buffer_load_dwordx4 v[120:123], v4, s[8:11], s36 offen offset:1280 sc1
    buffer_load_dwordx4 v[124:127], v4, s[8:11], s36 offen offset:1408 sc1
    buffer_load_dwordx4 v[128:131], v4, s[8:11], s36 offen offset:1536 sc1
    buffer_load_dwordx4 v[132:135], v4, s[8:11], s36 offen offset:1664 sc1
    buffer_load_dwordx4 v[136:139], v4, s[8:11], s36 offen offset:1792 sc1
    buffer_load_dwordx4 v[140:143], v4, s[8:11], s36 offen offset:1920 sc1
    s_add_u32 s37, s53, 458752
    s_add_u32 m0, s54, 126976
    s_nop 0
    buffer_load_dwordx4 v20, s[20:23], s37 offen offset:0 lds
    buffer_load_dwordx4 v21, s[20:23], s37 offen offset:1024 lds
    buffer_load_dwordx4 v22, s[20:23], s37 offen offset:2048 lds
    buffer_load_dwordx4 v23, s[20:23], s37 offen offset:3072 lds
    s_add_u32 m0, s54, 131072
    s_nop 0
    buffer_load_dwordx4 v24, s[20:23], s37 offen offset:0 lds
    buffer_load_dwordx4 v25, s[20:23], s37 offen offset:1024 lds
    buffer_load_dwordx4 v26, s[20:23], s37 offen offset:2048 lds
    s_mul_i32 s6, s4, 896
    s_add_u32 s38, s6, 16384
    v_lshlrev_b32 v33, 4, v2
    s_add_u32 s6, s63, 32768
    v_add_u32 v44, s6, v12
    v_add_u32 v45, s6, v13
    v_add_u32 v46, s6, v14
    v_add_u32 v47, s6, v15
    ds_read_b64_tr_b16 a[128:129], v44 offset:0
    ds_read_b64_tr_b16 a[130:131], v44 offset:512
    ds_read_b64_tr_b16 a[132:133], v45 offset:0
    ds_read_b64_tr_b16 a[134:135], v45 offset:512
    ds_read_b64_tr_b16 a[136:137], v46 offset:0
    ds_read_b64_tr_b16 a[138:139], v46 offset:512
    ds_read_b64_tr_b16 a[140:141], v47 offset:0
    ds_read_b64_tr_b16 a[142:143], v47 offset:512
    ds_read_b64_tr_b16 a[144:145], v44 offset:4096
    ds_read_b64_tr_b16 a[146:147], v44 offset:4608
    ds_read_b64_tr_b16 a[148:149], v45 offset:4096
    ds_read_b64_tr_b16 a[150:151], v45 offset:4608
    ds_read_b64_tr_b16 a[152:153], v46 offset:4096
    ds_read_b64_tr_b16 a[154:155], v46 offset:4608
    s_waitcnt lgkmcnt(10)
    ds_read_b64_tr_b16 a[156:157], v47 offset:4096
    ds_read_b64_tr_b16 a[158:159], v47 offset:4608
    ds_read_b64_tr_b16 a[160:161], v44 offset:8192
    ds_read_b64_tr_b16 a[162:163], v44 offset:8704
    s_waitcnt lgkmcnt(10)
    ds_read_b64_tr_b16 a[164:165], v45 offset:8192
    ds_read_b64_tr_b16 a[166:167], v45 offset:8704
    ds_read_b64_tr_b16 a[168:169], v46 offset:8192
    ds_read_b64_tr_b16 a[170:171], v46 offset:8704
    s_waitcnt lgkmcnt(10)
    ds_read_b64_tr_b16 a[172:173], v47 offset:8192
    ds_read_b64_tr_b16 a[174:175], v47 offset:8704
    ds_read_b64_tr_b16 a[176:177], v44 offset:12288
    ds_read_b64_tr_b16 a[178:179], v44 offset:12800
    s_waitcnt lgkmcnt(10)
    ds_read_b64_tr_b16 a[180:181], v45 offset:12288
    ds_read_b64_tr_b16 a[182:183], v45 offset:12800
    ds_read_b64_tr_b16 a[184:185], v46 offset:12288
    ds_read_b64_tr_b16 a[186:187], v46 offset:12800
    s_waitcnt lgkmcnt(10)
    ds_read_b64_tr_b16 a[188:189], v47 offset:12288
    ds_read_b64_tr_b16 a[190:191], v47 offset:12800
    s_waitcnt lgkmcnt(0)
    s_add_u32 s6, s62, 0
    v_add_u32 v44, s6, v12
    v_add_u32 v45, s6, v13
    v_add_u32 v46, s6, v14
    v_add_u32 v47, s6, v15
    ds_read_b64_tr_b16 a[192:193], v44 offset:0
    ds_read_b64_tr_b16 a[194:195], v44 offset:512
    ds_read_b64_tr_b16 a[196:197], v45 offset:0
    ds_read_b64_tr_b16 a[198:199], v45 offset:512
    ds_read_b64_tr_b16 a[200:201], v46 offset:0
    ds_read_b64_tr_b16 a[202:203], v46 offset:512
    ds_read_b64_tr_b16 a[204:205], v47 offset:0
    ds_read_b64_tr_b16 a[206:207], v47 offset:512
    ds_read_b64_tr_b16 a[208:209], v44 offset:4096
    ds_read_b64_tr_b16 a[210:211], v44 offset:4608
    ds_read_b64_tr_b16 a[212:213], v45 offset:4096
    ds_read_b64_tr_b16 a[214:215], v45 offset:4608
    ds_read_b64_tr_b16 a[216:217], v46 offset:4096
    ds_read_b64_tr_b16 a[218:219], v46 offset:4608
    s_waitcnt lgkmcnt(10)
    ds_read_b64_tr_b16 a[220:221], v47 offset:4096
    ds_read_b64_tr_b16 a[222:223], v47 offset:4608
    s_waitcnt lgkmcnt(0)
    v_mov_b32 v44, 0x3f803f80
    v_mov_b32 v45, 0x3f803f80
    v_mov_b32 v46, 0x3f803f80
    v_mov_b32 v47, 0x3f803f80
    s_barrier
    s_add_u32 s37, s53, 917504
    s_add_u32 m0, s54, 0
    s_nop 0
    buffer_load_dwordx4 v20, s[20:23], s37 offen offset:0 lds
    buffer_load_dwordx4 v21, s[20:23], s37 offen offset:1024 lds
    buffer_load_dwordx4 v22, s[20:23], s37 offen offset:2048 lds
    buffer_load_dwordx4 v23, s[20:23], s37 offen offset:3072 lds
    s_add_u32 m0, s54, 4096
    s_nop 0
    buffer_load_dwordx4 v24, s[20:23], s37 offen offset:0 lds
    buffer_load_dwordx4 v25, s[20:23], s37 offen offset:1024 lds
    buffer_load_dwordx4 v26, s[20:23], s37 offen offset:2048 lds
    ds_read_b64_tr_b16 v[48:49], v29 offset:0
    ds_read_b64_tr_b16 v[50:51], v29 offset:1792
    ds_read_b64_tr_b16 v[52:53], v29 offset:32
    ds_read_b64_tr_b16 v[54:55], v29 offset:1824
    ds_read_b64_tr_b16 v[56:57], v29 offset:64
    ds_read_b64_tr_b16 v[58:59], v29 offset:1856
    ds_read_b64_tr_b16 v[60:61], v29 offset:96
    ds_read_b64_tr_b16 v[62:63], v29 offset:1888
    ds_read_b64_tr_b16 v[64:65], v29 offset:128
    ds_read_b64_tr_b16 v[66:67], v29 offset:1920
    ds_read_b64_tr_b16 v[68:69], v29 offset:160
    ds_read_b64_tr_b16 v[70:71], v29 offset:1952
    ds_read_b64_tr_b16 v[72:73], v29 offset:192
    ds_read_b64_tr_b16 v[74:75], v29 offset:1984
    s_waitcnt lgkmcnt(12)
    s_waitcnt vmcnt(29)
    v_mfma_f32_16x16x32_bf16 v[40:43], v[44:47], v[80:83], 0
    v_mfma_f32_16x16x32_bf16 v[16:19], v[80:83], v[80:83], 0
    v_mfma_f32_16x16x32_bf16 v[144:147], v[48:51], v[80:83], 0
    ds_read_b64_tr_b16 v[76:77], v29 offset:7168
    ds_read_b64_tr_b16 v[78:79], v29 offset:8960
    s_add_u32 s37, s53, 1376256
    s_add_u32 m0, s54, 28672
    s_nop 0
    buffer_load_dwordx4 v20, s[20:23], s37 offen offset:0 lds
    s_waitcnt lgkmcnt(12)
    v_mfma_f32_16x16x32_bf16 v[148:151], v[52:55], v[80:83], 0
    ds_read_b64_tr_b16 v[48:49], v29 offset:7200
    ds_read_b64_tr_b16 v[50:51], v29 offset:8992
    s_waitcnt lgkmcnt(12)
    v_mfma_f32_16x16x32_bf16 v[152:155], v[56:59], v[80:83], 0
    ds_read_b64_tr_b16 v[52:53], v29 offset:7232
    ds_read_b64_tr_b16 v[54:55], v29 offset:9024
    s_waitcnt lgkmcnt(12)
    v_mfma_f32_16x16x32_bf16 v[156:159], v[60:63], v[80:83], 0
    ds_read_b64_tr_b16 v[56:57], v29 offset:7264
    ds_read_b64_tr_b16 v[58:59], v29 offset:9056
    buffer_load_dwordx4 v21, s[20:23], s37 offen offset:1024 lds
    s_waitcnt lgkmcnt(12)
    v_mfma_f32_16x16x32_bf16 v[160:163], v[64:67], v[80:83], 0
    ds_read_b64_tr_b16 v[60:61], v29 offset:7296
    ds_read_b64_tr_b16 v[62:63], v29 offset:9088
    s_waitcnt lgkmcnt(12)
    v_mfma_f32_16x16x32_bf16 v[164:167], v[68:71], v[80:83], 0
    ds_read_b64_tr_b16 v[64:65], v29 offset:7328
    ds_read_b64_tr_b16 v[66:67], v29 offset:9120
    s_waitcnt lgkmcnt(12)
    v_mfma_f32_16x16x32_bf16 v[168:171], v[72:75], v[80:83], 0
    ds_read_b64_tr_b16 v[68:69], v29 offset:7360
    ds_read_b64_tr_b16 v[70:71], v29 offset:9152
    buffer_load_dwordx4 v22, s[20:23], s37 offen offset:2048 lds
    s_waitcnt lgkmcnt(12)
    s_waitcnt vmcnt(31)
    v_mfma_f32_16x16x32_bf16 v[40:43], v[44:47], v[84:87], v[40:43]
    v_mfma_f32_16x16x32_bf16 v[16:19], v[84:87], v[84:87], v[16:19]
    v_mfma_f32_16x16x32_bf16 v[144:147], v[76:79], v[84:87], v[144:147]
    ds_read_b64_tr_b16 v[72:73], v29 offset:14336
    ds_read_b64_tr_b16 v[74:75], v29 offset:16128
    s_waitcnt lgkmcnt(12)
    v_mfma_f32_16x16x32_bf16 v[148:151], v[48:51], v[84:87], v[148:151]
    ds_read_b64_tr_b16 v[76:77], v29 offset:14368
    ds_read_b64_tr_b16 v[78:79], v29 offset:16160
    s_waitcnt lgkmcnt(12)
    v_mfma_f32_16x16x32_bf16 v[152:155], v[52:55], v[84:87], v[152:155]
    ds_read_b64_tr_b16 v[48:49], v29 offset:14400
    ds_read_b64_tr_b16 v[50:51], v29 offset:16192
    buffer_load_dwordx4 v23, s[20:23], s37 offen offset:3072 lds
    s_waitcnt lgkmcnt(12)
    v_mfma_f32_16x16x32_bf16 v[156:159], v[56:59], v[84:87], v[156:159]
    ds_read_b64_tr_b16 v[52:53], v29 offset:14432
    ds_read_b64_tr_b16 v[54:55], v29 offset:16224
    s_waitcnt lgkmcnt(12)
    v_mfma_f32_16x16x32_bf16 v[160:163], v[60:63], v[84:87], v[160:163]
    ds_read_b64_tr_b16 v[56:57], v29 offset:14464
    ds_read_b64_tr_b16 v[58:59], v29 offset:16256
    s_waitcnt lgkmcnt(12)
    v_mfma_f32_16x16x32_bf16 v[164:167], v[64:67], v[84:87], v[164:167]
    ds_read_b64_tr_b16 v[60:61], v29 offset:14496
    ds_read_b64_tr_b16 v[62:63], v29 offset:16288
    s_add_u32 m0, s54, 32768
    s_nop 0
    buffer_load_dwordx4 v24, s[20:23], s37 offen offset:0 lds
    s_waitcnt lgkmcnt(12)
    v_mfma_f32_16x16x32_bf16 v[168:171], v[68:71], v[84:87], v[168:171]
    ds_read_b64_tr_b16 v[64:65], v29 offset:14528
    ds_read_b64_tr_b16 v[66:67], v29 offset:16320
    s_waitcnt lgkmcnt(12)
    s_waitcnt vmcnt(32)
    v_mfma_f32_16x16x32_bf16 v[40:43], v[44:47], v[88:91], v[40:43]
    v_mfma_f32_16x16x32_bf16 v[16:19], v[88:91], v[88:91], v[16:19]
    v_mfma_f32_16x16x32_bf16 v[144:147], v[72:75], v[88:91], v[144:147]
    ds_read_b64_tr_b16 v[68:69], v29 offset:21504
    ds_read_b64_tr_b16 v[70:71], v29 offset:23296
    s_waitcnt lgkmcnt(12)
    v_mfma_f32_16x16x32_bf16 v[148:151], v[76:79], v[88:91], v[148:151]
    ds_read_b64_tr_b16 v[72:73], v29 offset:21536
    ds_read_b64_tr_b16 v[74:75], v29 offset:23328
    buffer_load_dwordx4 v25, s[20:23], s37 offen offset:1024 lds
    s_waitcnt lgkmcnt(12)
    v_mfma_f32_16x16x32_bf16 v[152:155], v[48:51], v[88:91], v[152:155]
    ds_read_b64_tr_b16 v[76:77], v29 offset:21568
    ds_read_b64_tr_b16 v[78:79], v29 offset:23360
    s_waitcnt lgkmcnt(12)
    v_mfma_f32_16x16x32_bf16 v[156:159], v[52:55], v[88:91], v[156:159]
    ds_read_b64_tr_b16 v[48:49], v29 offset:21600
    ds_read_b64_tr_b16 v[50:51], v29 offset:23392
    s_waitcnt lgkmcnt(12)
    v_mfma_f32_16x16x32_bf16 v[160:163], v[56:59], v[88:91], v[160:163]
    ds_read_b64_tr_b16 v[52:53], v29 offset:21632
    ds_read_b64_tr_b16 v[54:55], v29 offset:23424
    buffer_load_dwordx4 v26, s[20:23], s37 offen offset:2048 lds
    s_waitcnt lgkmcnt(12)
    v_mfma_f32_16x16x32_bf16 v[164:167], v[60:63], v[88:91], v[164:167]
    ds_read_b64_tr_b16 v[56:57], v29 offset:21664
    ds_read_b64_tr_b16 v[58:59], v29 offset:23456
    s_waitcnt lgkmcnt(12)
    v_mfma_f32_16x16x32_bf16 v[168:171], v[64:67], v[88:91], v[168:171]
    ds_read_b64_tr_b16 v[60:61], v29 offset:21696
    ds_read_b64_tr_b16 v[62:63], v29 offset:23488
    s_waitcnt lgkmcnt(12)
    s_waitcnt vmcnt(33)
    v_mfma_f32_16x16x32_bf16 v[40:43], v[44:47], v[92:95], v[40:43]
    v_mfma_f32_16x16x32_bf16 v[16:19], v[92:95], v[92:95], v[16:19]
    v_mfma_f32_16x16x32_bf16 v[144:147], v[68:71], v[92:95], v[144:147]
    s_waitcnt vmcnt(14)
    s_barrier
    ds_read_b64_tr_b16 v[64:65], v29 offset:28672
    ds_read_b64_tr_b16 v[66:67], v29 offset:30464
    s_add_u32 s37, s53, 224
    s_add_u32 m0, s54, 57344
    s_nop 0
    buffer_load_dwordx4 v20, s[20:23], s37 offen offset:0 lds
    s_waitcnt lgkmcnt(12)
    v_mfma_f32_16x16x32_bf16 v[148:151], v[72:75], v[92:95], v[148:151]
    ds_read_b64_tr_b16 v[68:69], v29 offset:28704
    ds_read_b64_tr_b16 v[70:71], v29 offset:30496
    s_waitcnt lgkmcnt(12)
    v_mfma_f32_16x16x32_bf16 v[152:155], v[76:79], v[92:95], v[152:155]
    ds_read_b64_tr_b16 v[72:73], v29 offset:28736
    ds_read_b64_tr_b16 v[74:75], v29 offset:30528
    s_waitcnt lgkmcnt(12)
    v_mfma_f32_16x16x32_bf16 v[156:159], v[48:51], v[92:95], v[156:159]
    ds_read_b64_tr_b16 v[76:77], v29 offset:28768
    ds_read_b64_tr_b16 v[78:79], v29 offset:30560
    buffer_load_dwordx4 v21, s[20:23], s37 offen offset:1024 lds
    s_waitcnt lgkmcnt(12)
    v_mfma_f32_16x16x32_bf16 v[160:163], v[52:55], v[92:95], v[160:163]
    ds_read_b64_tr_b16 v[48:49], v29 offset:28800
    ds_read_b64_tr_b16 v[50:51], v29 offset:30592
    s_waitcnt lgkmcnt(12)
    v_mfma_f32_16x16x32_bf16 v[164:167], v[56:59], v[92:95], v[164:167]
    ds_read_b64_tr_b16 v[52:53], v29 offset:28832
    ds_read_b64_tr_b16 v[54:55], v29 offset:30624
    s_waitcnt lgkmcnt(12)
    v_mfma_f32_16x16x32_bf16 v[168:171], v[60:63], v[92:95], v[168:171]
    ds_read_b64_tr_b16 v[56:57], v29 offset:28864
    ds_read_b64_tr_b16 v[58:59], v29 offset:30656
    buffer_load_dwordx4 v22, s[20:23], s37 offen offset:2048 lds
    s_waitcnt lgkmcnt(12)
    s_waitcnt vmcnt(17)
    v_mfma_f32_16x16x32_bf16 v[40:43], v[44:47], v[96:99], v[40:43]
    v_mfma_f32_16x16x32_bf16 v[16:19], v[96:99], v[96:99], v[16:19]
    v_mfma_f32_16x16x32_bf16 v[144:147], v[64:67], v[96:99], v[144:147]
    ds_read_b64_tr_b16 v[60:61], v29 offset:35840
    ds_read_b64_tr_b16 v[62:63], v29 offset:37632
    s_waitcnt lgkmcnt(12)
    v_mfma_f32_16x16x32_bf16 v[148:151], v[68:71], v[96:99], v[148:151]
    ds_read_b64_tr_b16 v[64:65], v29 offset:35872
    ds_read_b64_tr_b16 v[66:67], v29 offset:37664
    s_waitcnt lgkmcnt(12)
    v_mfma_f32_16x16x32_bf16 v[152:155], v[72:75], v[96:99], v[152:155]
    ds_read_b64_tr_b16 v[68:69], v29 offset:35904
    ds_read_b64_tr_b16 v[70:71], v29 offset:37696
    buffer_load_dwordx4 v23, s[20:23], s37 offen offset:3072 lds
    s_waitcnt lgkmcnt(12)
    v_mfma_f32_16x16x32_bf16 v[156:159], v[76:79], v[96:99], v[156:159]
    ds_read_b64_tr_b16 v[72:73], v29 offset:35936
    ds_read_b64_tr_b16 v[74:75], v29 offset:37728
    s_waitcnt lgkmcnt(12)
    v_mfma_f32_16x16x32_bf16 v[160:163], v[48:51], v[96:99], v[160:163]
    ds_read_b64_tr_b16 v[76:77], v29 offset:35968
    ds_read_b64_tr_b16 v[78:79], v29 offset:37760
    s_waitcnt lgkmcnt(12)
    v_mfma_f32_16x16x32_bf16 v[164:167], v[52:55], v[96:99], v[164:167]
    ds_read_b64_tr_b16 v[48:49], v29 offset:36000
    ds_read_b64_tr_b16 v[50:51], v29 offset:37792
    s_add_u32 m0, s54, 61440
    s_nop 0
    buffer_load_dwordx4 v24, s[20:23], s37 offen offset:0 lds
    s_waitcnt lgkmcnt(12)
    v_mfma_f32_16x16x32_bf16 v[168:171], v[56:59], v[96:99], v[168:171]
    ds_read_b64_tr_b16 v[52:53], v29 offset:36032
    ds_read_b64_tr_b16 v[54:55], v29 offset:37824
    s_waitcnt lgkmcnt(12)
    s_waitcnt vmcnt(19)
    v_mfma_f32_16x16x32_bf16 v[40:43], v[44:47], v[100:103], v[40:43]
    v_mfma_f32_16x16x32_bf16 v[16:19], v[100:103], v[100:103], v[16:19]
    v_mfma_f32_16x16x32_bf16 v[144:147], v[60:63], v[100:103], v[144:147]
    ds_read_b64_tr_b16 v[56:57], v29 offset:43008
    ds_read_b64_tr_b16 v[58:59], v29 offset:44800
    s_waitcnt lgkmcnt(12)
    v_mfma_f32_16x16x32_bf16 v[148:151], v[64:67], v[100:103], v[148:151]
    ds_read_b64_tr_b16 v[60:61], v29 offset:43040
    ds_read_b64_tr_b16 v[62:63], v29 offset:44832
    buffer_load_dwordx4 v25, s[20:23], s37 offen offset:1024 lds
    s_waitcnt lgkmcnt(12)
    v_mfma_f32_16x16x32_bf16 v[152:155], v[68:71], v[100:103], v[152:155]
    ds_read_b64_tr_b16 v[64:65], v29 offset:43072
    ds_read_b64_tr_b16 v[66:67], v29 offset:44864
    s_waitcnt lgkmcnt(12)
    v_mfma_f32_16x16x32_bf16 v[156:159], v[72:75], v[100:103], v[156:159]
    ds_read_b64_tr_b16 v[68:69], v29 offset:43104
    ds_read_b64_tr_b16 v[70:71], v29 offset:44896
    s_waitcnt lgkmcnt(12)
    v_mfma_f32_16x16x32_bf16 v[160:163], v[76:79], v[100:103], v[160:163]
    ds_read_b64_tr_b16 v[72:73], v29 offset:43136
    ds_read_b64_tr_b16 v[74:75], v29 offset:44928
    buffer_load_dwordx4 v26, s[20:23], s37 offen offset:2048 lds
    s_waitcnt lgkmcnt(12)
    v_mfma_f32_16x16x32_bf16 v[164:167], v[48:51], v[100:103], v[164:167]
    ds_read_b64_tr_b16 v[76:77], v29 offset:43168
    ds_read_b64_tr_b16 v[78:79], v29 offset:44960
    s_waitcnt lgkmcnt(12)
    v_mfma_f32_16x16x32_bf16 v[168:171], v[52:55], v[100:103], v[168:171]
    ds_read_b64_tr_b16 v[48:49], v29 offset:43200
    ds_read_b64_tr_b16 v[50:51], v29 offset:44992
    s_waitcnt lgkmcnt(12)
    s_waitcnt vmcnt(21)
    v_mfma_f32_16x16x32_bf16 v[40:43], v[44:47], v[104:107], v[40:43]
    v_mfma_f32_16x16x32_bf16 v[16:19], v[104:107], v[104:107], v[16:19]
    v_mfma_f32_16x16x32_bf16 v[144:147], v[56:59], v[104:107], v[144:147]
    ds_read_b64_tr_b16 v[52:53], v29 offset:50176
    ds_read_b64_tr_b16 v[54:55], v29 offset:51968
    s_waitcnt lgkmcnt(12)
    v_mfma_f32_16x16x32_bf16 v[148:151], v[60:63], v[104:107], v[148:151]
    ds_read_b64_tr_b16 v[56:57], v29 offset:50208
    ds_read_b64_tr_b16 v[58:59], v29 offset:52000
    s_waitcnt lgkmcnt(12)
    v_mfma_f32_16x16x32_bf16 v[152:155], v[64:67], v[104:107], v[152:155]
    ds_read_b64_tr_b16 v[60:61], v29 offset:50240
    ds_read_b64_tr_b16 v[62:63], v29 offset:52032
    s_waitcnt lgkmcnt(12)
    v_mfma_f32_16x16x32_bf16 v[156:159], v[68:71], v[104:107], v[156:159]
    ds_read_b64_tr_b16 v[64:65], v29 offset:50272
    ds_read_b64_tr_b16 v[66:67], v29 offset:52064
    s_waitcnt lgkmcnt(12)
    v_mfma_f32_16x16x32_bf16 v[160:163], v[72:75], v[104:107], v[160:163]
    ds_read_b64_tr_b16 v[68:69], v29 offset:50304
    ds_read_b64_tr_b16 v[70:71], v29 offset:52096
    s_waitcnt lgkmcnt(12)
    v_mfma_f32_16x16x32_bf16 v[164:167], v[76:79], v[104:107], v[164:167]
    ds_read_b64_tr_b16 v[72:73], v29 offset:50336
    ds_read_b64_tr_b16 v[74:75], v29 offset:52128
    s_waitcnt lgkmcnt(12)
    v_mfma_f32_16x16x32_bf16 v[168:171], v[48:51], v[104:107], v[168:171]
    ds_read_b64_tr_b16 v[76:77], v29 offset:50368
    ds_read_b64_tr_b16 v[78:79], v29 offset:52160
    s_waitcnt lgkmcnt(12)
    s_waitcnt vmcnt(21)
    v_mfma_f32_16x16x32_bf16 v[40:43], v[44:47], v[108:111], v[40:43]
    v_mfma_f32_16x16x32_bf16 v[16:19], v[108:111], v[108:111], v[16:19]
    v_mfma_f32_16x16x32_bf16 v[144:147], v[52:55], v[108:111], v[144:147]
    s_waitcnt vmcnt(14)
    s_barrier
    ds_read_b64_tr_b16 v[48:49], v27 offset:0
    ds_read_b64_tr_b16 v[50:51], v27 offset:1792
    s_waitcnt lgkmcnt(12)
    v_mfma_f32_16x16x32_bf16 v[148:151], v[56:59], v[108:111], v[148:151]
    ds_read_b64_tr_b16 v[52:53], v27 offset:32
    ds_read_b64_tr_b16 v[54:55], v27 offset:1824
    s_waitcnt lgkmcnt(12)
    v_mfma_f32_16x16x32_bf16 v[152:155], v[60:63], v[108:111], v[152:155]
    ds_read_b64_tr_b16 v[56:57], v27 offset:64
    ds_read_b64_tr_b16 v[58:59], v27 offset:1856
    s_add_u32 s37, s53, 458976
    s_add_u32 m0, s54, 98304
    s_nop 0
    buffer_load_dwordx4 v20, s[20:23], s37 offen offset:0 lds
    s_waitcnt lgkmcnt(12)
    v_mfma_f32_16x16x32_bf16 v[156:159], v[64:67], v[108:111], v[156:159]
    ds_read_b64_tr_b16 v[60:61], v27 offset:96
    ds_read_b64_tr_b16 v[62:63], v27 offset:1888
    s_waitcnt lgkmcnt(12)
    v_mfma_f32_16x16x32_bf16 v[160:163], v[68:71], v[108:111], v[160:163]
    ds_read_b64_tr_b16 v[64:65], v27 offset:128
    ds_read_b64_tr_b16 v[66:67], v27 offset:1920
    s_waitcnt lgkmcnt(12)
    v_mfma_f32_16x16x32_bf16 v[164:167], v[72:75], v[108:111], v[164:167]
    ds_read_b64_tr_b16 v[68:69], v27 offset:160
    ds_read_b64_tr_b16 v[70:71], v27 offset:1952
    buffer_load_dwordx4 v21, s[20:23], s37 offen offset:1024 lds
    s_waitcnt lgkmcnt(12)
    v_mfma_f32_16x16x32_bf16 v[168:171], v[76:79], v[108:111], v[168:171]
    ds_read_b64_tr_b16 v[72:73], v27 offset:192
    ds_read_b64_tr_b16 v[74:75], v27 offset:1984
    s_waitcnt lgkmcnt(12)
    s_waitcnt vmcnt(16)
    v_mfma_f32_16x16x32_bf16 v[40:43], v[44:47], v[112:115], v[40:43]
    v_mfma_f32_16x16x32_bf16 v[16:19], v[112:115], v[112:115], v[16:19]
    v_mfma_f32_16x16x32_bf16 v[144:147], v[48:51], v[112:115], v[144:147]
    ds_read_b64_tr_b16 v[76:77], v27 offset:7168
    ds_read_b64_tr_b16 v[78:79], v27 offset:8960
    s_waitcnt lgkmcnt(12)
    v_mfma_f32_16x16x32_bf16 v[148:151], v[52:55], v[112:115], v[148:151]
    ds_read_b64_tr_b16 v[48:49], v27 offset:7200
    ds_read_b64_tr_b16 v[50:51], v27 offset:8992
    buffer_load_dwordx4 v22, s[20:23], s37 offen offset:2048 lds
    s_waitcnt lgkmcnt(12)
    v_mfma_f32_16x16x32_bf16 v[152:155], v[56:59], v[112:115], v[152:155]
    ds_read_b64_tr_b16 v[52:53], v27 offset:7232
    ds_read_b64_tr_b16 v[54:55], v27 offset:9024
    s_waitcnt lgkmcnt(12)
    v_mfma_f32_16x16x32_bf16 v[156:159], v[60:63], v[112:115], v[156:159]
    ds_read_b64_tr_b16 v[56:57], v27 offset:7264
    ds_read_b64_tr_b16 v[58:59], v27 offset:9056
    s_waitcnt lgkmcnt(12)
    v_mfma_f32_16x16x32_bf16 v[160:163], v[64:67], v[112:115], v[160:163]
    ds_read_b64_tr_b16 v[60:61], v27 offset:7296
    ds_read_b64_tr_b16 v[62:63], v27 offset:9088
    buffer_load_dwordx4 v23, s[20:23], s37 offen offset:3072 lds
    s_waitcnt lgkmcnt(12)
    v_mfma_f32_16x16x32_bf16 v[164:167], v[68:71], v[112:115], v[164:167]
    ds_read_b64_tr_b16 v[64:65], v27 offset:7328
    ds_read_b64_tr_b16 v[66:67], v27 offset:9120
    s_waitcnt lgkmcnt(12)
    v_mfma_f32_16x16x32_bf16 v[168:171], v[72:75], v[112:115], v[168:171]
    ds_read_b64_tr_b16 v[68:69], v27 offset:7360
    ds_read_b64_tr_b16 v[70:71], v27 offset:9152
    s_waitcnt lgkmcnt(12)
    s_waitcnt vmcnt(18)
    v_mfma_f32_16x16x32_bf16 v[40:43], v[44:47], v[116:119], v[40:43]
    v_mfma_f32_16x16x32_bf16 v[16:19], v[116:119], v[116:119], v[16:19]
    v_mfma_f32_16x16x32_bf16 v[144:147], v[76:79], v[116:119], v[144:147]
    ds_read_b64_tr_b16 v[72:73], v27 offset:14336
    ds_read_b64_tr_b16 v[74:75], v27 offset:16128
    s_add_u32 m0, s54, 102400
    s_nop 0
    buffer_load_dwordx4 v24, s[20:23], s37 offen offset:0 lds
    s_waitcnt lgkmcnt(12)
    v_mfma_f32_16x16x32_bf16 v[148:151], v[48:51], v[116:119], v[148:151]
    ds_read_b64_tr_b16 v[76:77], v27 offset:14368
    ds_read_b64_tr_b16 v[78:79], v27 offset:16160
    s_waitcnt lgkmcnt(12)
    v_mfma_f32_16x16x32_bf16 v[152:155], v[52:55], v[116:119], v[152:155]
    ds_read_b64_tr_b16 v[48:49], v27 offset:14400
    ds_read_b64_tr_b16 v[50:51], v27 offset:16192
    s_waitcnt lgkmcnt(12)
    v_mfma_f32_16x16x32_bf16 v[156:159], v[56:59], v[116:119], v[156:159]
    ds_read_b64_tr_b16 v[52:53], v27 offset:14432
    ds_read_b64_tr_b16 v[54:55], v27 offset:16224
    buffer_load_dwordx4 v25, s[20:23], s37 offen offset:1024 lds
    s_waitcnt lgkmcnt(12)
    v_mfma_f32_16x16x32_bf16 v[160:163], v[60:63], v[116:119], v[160:163]
    ds_read_b64_tr_b16 v[56:57], v27 offset:14464
    ds_read_b64_tr_b16 v[58:59], v27 offset:16256
    s_waitcnt lgkmcnt(12)
    v_mfma_f32_16x16x32_bf16 v[164:167], v[64:67], v[116:119], v[164:167]
    ds_read_b64_tr_b16 v[60:61], v27 offset:14496
    ds_read_b64_tr_b16 v[62:63], v27 offset:16288
    s_waitcnt lgkmcnt(12)
    v_mfma_f32_16x16x32_bf16 v[168:171], v[68:71], v[116:119], v[168:171]
    ds_read_b64_tr_b16 v[64:65], v27 offset:14528
    ds_read_b64_tr_b16 v[66:67], v27 offset:16320
    buffer_load_dwordx4 v26, s[20:23], s37 offen offset:2048 lds
    s_waitcnt lgkmcnt(12)
    s_waitcnt vmcnt(21)
    v_mfma_f32_16x16x32_bf16 v[40:43], v[44:47], v[120:123], v[40:43]
    v_mfma_f32_16x16x32_bf16 v[16:19], v[120:123], v[120:123], v[16:19]
    v_mfma_f32_16x16x32_bf16 v[144:147], v[72:75], v[120:123], v[144:147]
    ds_read_b64_tr_b16 v[68:69], v27 offset:21504
    ds_read_b64_tr_b16 v[70:71], v27 offset:23296
    s_waitcnt lgkmcnt(12)
    v_mfma_f32_16x16x32_bf16 v[148:151], v[76:79], v[120:123], v[148:151]
    ds_read_b64_tr_b16 v[72:73], v27 offset:21536
    ds_read_b64_tr_b16 v[74:75], v27 offset:23328
    s_waitcnt lgkmcnt(12)
    v_mfma_f32_16x16x32_bf16 v[152:155], v[48:51], v[120:123], v[152:155]
    ds_read_b64_tr_b16 v[76:77], v27 offset:21568
    ds_read_b64_tr_b16 v[78:79], v27 offset:23360
    s_waitcnt lgkmcnt(12)
    v_mfma_f32_16x16x32_bf16 v[156:159], v[52:55], v[120:123], v[156:159]
    ds_read_b64_tr_b16 v[48:49], v27 offset:21600
    ds_read_b64_tr_b16 v[50:51], v27 offset:23392
    s_waitcnt lgkmcnt(12)
    v_mfma_f32_16x16x32_bf16 v[160:163], v[56:59], v[120:123], v[160:163]
    ds_read_b64_tr_b16 v[52:53], v27 offset:21632
    ds_read_b64_tr_b16 v[54:55], v27 offset:23424
    s_waitcnt lgkmcnt(12)
    v_mfma_f32_16x16x32_bf16 v[164:167], v[60:63], v[120:123], v[164:167]
    ds_read_b64_tr_b16 v[56:57], v27 offset:21664
    ds_read_b64_tr_b16 v[58:59], v27 offset:23456
    s_waitcnt lgkmcnt(12)
    v_mfma_f32_16x16x32_bf16 v[168:171], v[64:67], v[120:123], v[168:171]
    ds_read_b64_tr_b16 v[60:61], v27 offset:21696
    ds_read_b64_tr_b16 v[62:63], v27 offset:23488
    s_waitcnt lgkmcnt(12)
    s_waitcnt vmcnt(21)
    v_mfma_f32_16x16x32_bf16 v[40:43], v[44:47], v[124:127], v[40:43]
    v_mfma_f32_16x16x32_bf16 v[16:19], v[124:127], v[124:127], v[16:19]
    v_mfma_f32_16x16x32_bf16 v[144:147], v[68:71], v[124:127], v[144:147]
    s_waitcnt vmcnt(14)
    s_barrier
    ds_read_b64_tr_b16 v[64:65], v27 offset:28672
    ds_read_b64_tr_b16 v[66:67], v27 offset:30464
    s_waitcnt lgkmcnt(12)
    v_mfma_f32_16x16x32_bf16 v[148:151], v[72:75], v[124:127], v[148:151]
    ds_read_b64_tr_b16 v[68:69], v27 offset:28704
    ds_read_b64_tr_b16 v[70:71], v27 offset:30496
    s_add_u32 s37, s53, 917728
    s_add_u32 m0, s54, 126976
    s_nop 0
    buffer_load_dwordx4 v20, s[20:23], s37 offen offset:0 lds
    s_waitcnt lgkmcnt(12)
    v_mfma_f32_16x16x32_bf16 v[152:155], v[76:79], v[124:127], v[152:155]
    ds_read_b64_tr_b16 v[72:73], v27 offset:28736
    ds_read_b64_tr_b16 v[74:75], v27 offset:30528
    s_waitcnt lgkmcnt(12)
    v_mfma_f32_16x16x32_bf16 v[156:159], v[48:51], v[124:127], v[156:159]
    ds_read_b64_tr_b16 v[76:77], v27 offset:28768
    ds_read_b64_tr_b16 v[78:79], v27 offset:30560
    s_waitcnt lgkmcnt(12)
    v_mfma_f32_16x16x32_bf16 v[160:163], v[52:55], v[124:127], v[160:163]
    ds_read_b64_tr_b16 v[48:49], v27 offset:28800
    ds_read_b64_tr_b16 v[50:51], v27 offset:30592
    buffer_load_dwordx4 v21, s[20:23], s37 offen offset:1024 lds
    s_waitcnt lgkmcnt(12)
    v_mfma_f32_16x16x32_bf16 v[164:167], v[56:59], v[124:127], v[164:167]
    ds_read_b64_tr_b16 v[52:53], v27 offset:28832
    ds_read_b64_tr_b16 v[54:55], v27 offset:30624
    s_waitcnt lgkmcnt(12)
    v_mfma_f32_16x16x32_bf16 v[168:171], v[60:63], v[124:127], v[168:171]
    ds_read_b64_tr_b16 v[56:57], v27 offset:28864
    ds_read_b64_tr_b16 v[58:59], v27 offset:30656
    s_waitcnt lgkmcnt(12)
    s_waitcnt vmcnt(16)
    v_mfma_f32_16x16x32_bf16 v[40:43], v[44:47], v[128:131], v[40:43]
    v_mfma_f32_16x16x32_bf16 v[16:19], v[128:131], v[128:131], v[16:19]
    v_mfma_f32_16x16x32_bf16 v[144:147], v[64:67], v[128:131], v[144:147]
    ds_read_b64_tr_b16 v[60:61], v27 offset:35840
    ds_read_b64_tr_b16 v[62:63], v27 offset:37632
    buffer_load_dwordx4 v22, s[20:23], s37 offen offset:2048 lds
    s_waitcnt lgkmcnt(12)
    v_mfma_f32_16x16x32_bf16 v[148:151], v[68:71], v[128:131], v[148:151]
    ds_read_b64_tr_b16 v[64:65], v27 offset:35872
    ds_read_b64_tr_b16 v[66:67], v27 offset:37664
    s_waitcnt lgkmcnt(12)
    v_mfma_f32_16x16x32_bf16 v[152:155], v[72:75], v[128:131], v[152:155]
    ds_read_b64_tr_b16 v[68:69], v27 offset:35904
    ds_read_b64_tr_b16 v[70:71], v27 offset:37696
    s_waitcnt lgkmcnt(12)
    v_mfma_f32_16x16x32_bf16 v[156:159], v[76:79], v[128:131], v[156:159]
    ds_read_b64_tr_b16 v[72:73], v27 offset:35936
    ds_read_b64_tr_b16 v[74:75], v27 offset:37728
    buffer_load_dwordx4 v23, s[20:23], s37 offen offset:3072 lds
    s_waitcnt lgkmcnt(12)
    v_mfma_f32_16x16x32_bf16 v[160:163], v[48:51], v[128:131], v[160:163]
    ds_read_b64_tr_b16 v[76:77], v27 offset:35968
    ds_read_b64_tr_b16 v[78:79], v27 offset:37760
    s_waitcnt lgkmcnt(12)
    v_mfma_f32_16x16x32_bf16 v[164:167], v[52:55], v[128:131], v[164:167]
    ds_read_b64_tr_b16 v[48:49], v27 offset:36000
    ds_read_b64_tr_b16 v[50:51], v27 offset:37792
    s_waitcnt lgkmcnt(12)
    v_mfma_f32_16x16x32_bf16 v[168:171], v[56:59], v[128:131], v[168:171]
    ds_read_b64_tr_b16 v[52:53], v27 offset:36032
    ds_read_b64_tr_b16 v[54:55], v27 offset:37824
    s_add_u32 m0, s54, 131072
    s_nop 0
    buffer_load_dwordx4 v24, s[20:23], s37 offen offset:0 lds
    s_waitcnt lgkmcnt(12)
    s_waitcnt vmcnt(19)
    v_mfma_f32_16x16x32_bf16 v[40:43], v[44:47], v[132:135], v[40:43]
    v_mfma_f32_16x16x32_bf16 v[16:19], v[132:135], v[132:135], v[16:19]
    v_mfma_f32_16x16x32_bf16 v[144:147], v[60:63], v[132:135], v[144:147]
    ds_read_b64_tr_b16 v[56:57], v27 offset:43008
    ds_read_b64_tr_b16 v[58:59], v27 offset:44800
    s_waitcnt lgkmcnt(12)
    v_mfma_f32_16x16x32_bf16 v[148:151], v[64:67], v[132:135], v[148:151]
    ds_read_b64_tr_b16 v[60:61], v27 offset:43040
    ds_read_b64_tr_b16 v[62:63], v27 offset:44832
    s_waitcnt lgkmcnt(12)
    v_mfma_f32_16x16x32_bf16 v[152:155], v[68:71], v[132:135], v[152:155]
    ds_read_b64_tr_b16 v[64:65], v27 offset:43072
    ds_read_b64_tr_b16 v[66:67], v27 offset:44864
    buffer_load_dwordx4 v25, s[20:23], s37 offen offset:1024 lds
    s_waitcnt lgkmcnt(12)
    v_mfma_f32_16x16x32_bf16 v[156:159], v[72:75], v[132:135], v[156:159]
    ds_read_b64_tr_b16 v[68:69], v27 offset:43104
    ds_read_b64_tr_b16 v[70:71], v27 offset:44896
    s_waitcnt lgkmcnt(12)
    v_mfma_f32_16x16x32_bf16 v[160:163], v[76:79], v[132:135], v[160:163]
    ds_read_b64_tr_b16 v[72:73], v27 offset:43136
    ds_read_b64_tr_b16 v[74:75], v27 offset:44928
    s_waitcnt lgkmcnt(12)
    v_mfma_f32_16x16x32_bf16 v[164:167], v[48:51], v[132:135], v[164:167]
    ds_read_b64_tr_b16 v[76:77], v27 offset:43168
    ds_read_b64_tr_b16 v[78:79], v27 offset:44960
    buffer_load_dwordx4 v26, s[20:23], s37 offen offset:2048 lds
    s_waitcnt lgkmcnt(12)
    v_mfma_f32_16x16x32_bf16 v[168:171], v[52:55], v[132:135], v[168:171]
    ds_read_b64_tr_b16 v[48:49], v27 offset:43200
    ds_read_b64_tr_b16 v[50:51], v27 offset:44992
    s_waitcnt lgkmcnt(12)
    s_waitcnt vmcnt(21)
    v_mfma_f32_16x16x32_bf16 v[40:43], v[44:47], v[136:139], v[40:43]
    v_mfma_f32_16x16x32_bf16 v[16:19], v[136:139], v[136:139], v[16:19]
    v_mfma_f32_16x16x32_bf16 v[144:147], v[56:59], v[136:139], v[144:147]
    ds_read_b64_tr_b16 v[52:53], v27 offset:50176
    ds_read_b64_tr_b16 v[54:55], v27 offset:51968
    s_waitcnt lgkmcnt(12)
    v_mfma_f32_16x16x32_bf16 v[148:151], v[60:63], v[136:139], v[148:151]
    ds_read_b64_tr_b16 v[56:57], v27 offset:50208
    ds_read_b64_tr_b16 v[58:59], v27 offset:52000
    s_waitcnt lgkmcnt(12)
    v_mfma_f32_16x16x32_bf16 v[152:155], v[64:67], v[136:139], v[152:155]
    ds_read_b64_tr_b16 v[60:61], v27 offset:50240
    ds_read_b64_tr_b16 v[62:63], v27 offset:52032
    s_waitcnt lgkmcnt(12)
    v_mfma_f32_16x16x32_bf16 v[156:159], v[68:71], v[136:139], v[156:159]
    ds_read_b64_tr_b16 v[64:65], v27 offset:50272
    ds_read_b64_tr_b16 v[66:67], v27 offset:52064
    s_waitcnt lgkmcnt(12)
    v_mfma_f32_16x16x32_bf16 v[160:163], v[72:75], v[136:139], v[160:163]
    ds_read_b64_tr_b16 v[68:69], v27 offset:50304
    ds_read_b64_tr_b16 v[70:71], v27 offset:52096
    s_waitcnt lgkmcnt(12)
    v_mfma_f32_16x16x32_bf16 v[164:167], v[76:79], v[136:139], v[164:167]
    ds_read_b64_tr_b16 v[72:73], v27 offset:50336
    ds_read_b64_tr_b16 v[74:75], v27 offset:52128
    s_waitcnt lgkmcnt(12)
    v_mfma_f32_16x16x32_bf16 v[168:171], v[48:51], v[136:139], v[168:171]
    ds_read_b64_tr_b16 v[76:77], v27 offset:50368
    ds_read_b64_tr_b16 v[78:79], v27 offset:52160
    s_waitcnt lgkmcnt(12)
    s_waitcnt vmcnt(21)
    v_mfma_f32_16x16x32_bf16 v[40:43], v[44:47], v[140:143], v[40:43]
    v_mfma_f32_16x16x32_bf16 v[16:19], v[140:143], v[140:143], v[16:19]
    v_mfma_f32_16x16x32_bf16 v[144:147], v[52:55], v[140:143], v[144:147]
    s_waitcnt vmcnt(14)
    s_barrier
    ds_read_b64_tr_b16 v[48:49], v28 offset:0
    ds_read_b64_tr_b16 v[50:51], v28 offset:1792
    s_add_u32 s37, s53, 1376480
    s_add_u32 m0, s54, 0
    s_nop 0
    buffer_load_dwordx4 v20, s[20:23], s37 offen offset:0 lds
    s_waitcnt lgkmcnt(12)
    v_mfma_f32_16x16x32_bf16 v[148:151], v[56:59], v[140:143], v[148:151]
    ds_read_b64_tr_b16 v[52:53], v28 offset:32
    ds_read_b64_tr_b16 v[54:55], v28 offset:1824
    s_waitcnt lgkmcnt(12)
    v_mfma_f32_16x16x32_bf16 v[152:155], v[60:63], v[140:143], v[152:155]
    ds_read_b64_tr_b16 v[56:57], v28 offset:64
    ds_read_b64_tr_b16 v[58:59], v28 offset:1856
    s_waitcnt lgkmcnt(12)
    v_mfma_f32_16x16x32_bf16 v[156:159], v[64:67], v[140:143], v[156:159]
    ds_read_b64_tr_b16 v[60:61], v28 offset:96
    ds_read_b64_tr_b16 v[62:63], v28 offset:1888
    buffer_load_dwordx4 v21, s[20:23], s37 offen offset:1024 lds
    s_waitcnt lgkmcnt(12)
    v_mfma_f32_16x16x32_bf16 v[160:163], v[68:71], v[140:143], v[160:163]
    ds_read_b64_tr_b16 v[64:65], v28 offset:128
    ds_read_b64_tr_b16 v[66:67], v28 offset:1920
    s_waitcnt lgkmcnt(12)
    v_mfma_f32_16x16x32_bf16 v[164:167], v[72:75], v[140:143], v[164:167]
    ds_read_b64_tr_b16 v[68:69], v28 offset:160
    ds_read_b64_tr_b16 v[70:71], v28 offset:1952
    s_waitcnt lgkmcnt(12)
    v_mfma_f32_16x16x32_bf16 v[168:171], v[76:79], v[140:143], v[168:171]
    ds_read_b64_tr_b16 v[72:73], v28 offset:192
    ds_read_b64_tr_b16 v[74:75], v28 offset:1984
    buffer_load_dwordx4 v22, s[20:23], s37 offen offset:2048 lds
    s_waitcnt lgkmcnt(12)
    v_mfma_f32_16x16x32_bf16 v[172:175], v[48:51], v[80:83], 0
    ds_read_b64_tr_b16 v[76:77], v28 offset:7168
    ds_read_b64_tr_b16 v[78:79], v28 offset:8960
    s_waitcnt lgkmcnt(12)
    v_mfma_f32_16x16x32_bf16 v[176:179], v[52:55], v[80:83], 0
    ds_read_b64_tr_b16 v[48:49], v28 offset:7200
    ds_read_b64_tr_b16 v[50:51], v28 offset:8992
    s_waitcnt lgkmcnt(12)
    v_mfma_f32_16x16x32_bf16 v[180:183], v[56:59], v[80:83], 0
    ds_read_b64_tr_b16 v[52:53], v28 offset:7232
    ds_read_b64_tr_b16 v[54:55], v28 offset:9024
    buffer_load_dwordx4 v23, s[20:23], s37 offen offset:3072 lds
    s_waitcnt lgkmcnt(12)
    v_mfma_f32_16x16x32_bf16 v[184:187], v[60:63], v[80:83], 0
    ds_read_b64_tr_b16 v[56:57], v28 offset:7264
    ds_read_b64_tr_b16 v[58:59], v28 offset:9056
    s_waitcnt lgkmcnt(12)
    v_mfma_f32_16x16x32_bf16 v[188:191], v[64:67], v[80:83], 0
    ds_read_b64_tr_b16 v[60:61], v28 offset:7296
    ds_read_b64_tr_b16 v[62:63], v28 offset:9088
    s_waitcnt lgkmcnt(12)
    v_mfma_f32_16x16x32_bf16 v[192:195], v[68:71], v[80:83], 0
    ds_read_b64_tr_b16 v[64:65], v28 offset:7328
    ds_read_b64_tr_b16 v[66:67], v28 offset:9120
    s_add_u32 m0, s54, 4096
    s_nop 0
    buffer_load_dwordx4 v24, s[20:23], s37 offen offset:0 lds
    s_waitcnt lgkmcnt(12)
    v_mfma_f32_16x16x32_bf16 v[196:199], v[72:75], v[80:83], 0
    ds_read_b64_tr_b16 v[68:69], v28 offset:7360
    ds_read_b64_tr_b16 v[70:71], v28 offset:9152
    s_waitcnt lgkmcnt(12)
    v_mfma_f32_16x16x32_bf16 v[172:175], v[76:79], v[84:87], v[172:175]
    ds_read_b64_tr_b16 v[72:73], v28 offset:14336
    ds_read_b64_tr_b16 v[74:75], v28 offset:16128
    s_waitcnt lgkmcnt(12)
    v_mfma_f32_16x16x32_bf16 v[176:179], v[48:51], v[84:87], v[176:179]
    ds_read_b64_tr_b16 v[76:77], v28 offset:14368
    ds_read_b64_tr_b16 v[78:79], v28 offset:16160
    buffer_load_dwordx4 v25, s[20:23], s37 offen offset:1024 lds
    s_waitcnt lgkmcnt(12)
    v_mfma_f32_16x16x32_bf16 v[180:183], v[52:55], v[84:87], v[180:183]
    ds_read_b64_tr_b16 v[48:49], v28 offset:14400
    ds_read_b64_tr_b16 v[50:51], v28 offset:16192
    s_waitcnt lgkmcnt(12)
    v_mfma_f32_16x16x32_bf16 v[184:187], v[56:59], v[84:87], v[184:187]
    ds_read_b64_tr_b16 v[52:53], v28 offset:14432
    ds_read_b64_tr_b16 v[54:55], v28 offset:16224
    s_waitcnt lgkmcnt(12)
    v_mfma_f32_16x16x32_bf16 v[188:191], v[60:63], v[84:87], v[188:191]
    ds_read_b64_tr_b16 v[56:57], v28 offset:14464
    ds_read_b64_tr_b16 v[58:59], v28 offset:16256
    buffer_load_dwordx4 v26, s[20:23], s37 offen offset:2048 lds
    s_waitcnt lgkmcnt(12)
    v_mfma_f32_16x16x32_bf16 v[192:195], v[64:67], v[84:87], v[192:195]
    ds_read_b64_tr_b16 v[60:61], v28 offset:14496
    ds_read_b64_tr_b16 v[62:63], v28 offset:16288
    s_waitcnt lgkmcnt(12)
    v_mfma_f32_16x16x32_bf16 v[196:199], v[68:71], v[84:87], v[196:199]
    ds_read_b64_tr_b16 v[64:65], v28 offset:14528
    ds_read_b64_tr_b16 v[66:67], v28 offset:16320
    s_waitcnt lgkmcnt(12)
    v_mfma_f32_16x16x32_bf16 v[172:175], v[72:75], v[88:91], v[172:175]
    ds_read_b64_tr_b16 v[68:69], v28 offset:21504
    ds_read_b64_tr_b16 v[70:71], v28 offset:23296
    s_waitcnt lgkmcnt(12)
    v_mfma_f32_16x16x32_bf16 v[176:179], v[76:79], v[88:91], v[176:179]
    ds_read_b64_tr_b16 v[72:73], v28 offset:21536
    ds_read_b64_tr_b16 v[74:75], v28 offset:23328
    s_waitcnt lgkmcnt(12)
    v_mfma_f32_16x16x32_bf16 v[180:183], v[48:51], v[88:91], v[180:183]
    ds_read_b64_tr_b16 v[76:77], v28 offset:21568
    ds_read_b64_tr_b16 v[78:79], v28 offset:23360
    s_waitcnt lgkmcnt(12)
    v_mfma_f32_16x16x32_bf16 v[184:187], v[52:55], v[88:91], v[184:187]
    ds_read_b64_tr_b16 v[48:49], v28 offset:21600
    ds_read_b64_tr_b16 v[50:51], v28 offset:23392
    s_waitcnt lgkmcnt(12)
    v_mfma_f32_16x16x32_bf16 v[188:191], v[56:59], v[88:91], v[188:191]
    ds_read_b64_tr_b16 v[52:53], v28 offset:21632
    ds_read_b64_tr_b16 v[54:55], v28 offset:23424
    s_waitcnt lgkmcnt(12)
    v_mfma_f32_16x16x32_bf16 v[192:195], v[60:63], v[88:91], v[192:195]
    ds_read_b64_tr_b16 v[56:57], v28 offset:21664
    ds_read_b64_tr_b16 v[58:59], v28 offset:23456
    s_waitcnt lgkmcnt(12)
    v_mfma_f32_16x16x32_bf16 v[196:199], v[64:67], v[88:91], v[196:199]
    ds_read_b64_tr_b16 v[60:61], v28 offset:21696
    ds_read_b64_tr_b16 v[62:63], v28 offset:23488
    s_waitcnt lgkmcnt(12)
    v_mfma_f32_16x16x32_bf16 v[172:175], v[68:71], v[92:95], v[172:175]
    s_waitcnt vmcnt(14)
    s_barrier
    ds_read_b64_tr_b16 v[64:65], v29 offset:0
    ds_read_b64_tr_b16 v[66:67], v29 offset:1792
    s_waitcnt lgkmcnt(12)
    v_mfma_f32_16x16x32_bf16 v[176:179], v[72:75], v[92:95], v[176:179]
    ds_read_b64_tr_b16 v[68:69], v29 offset:32
    ds_read_b64_tr_b16 v[70:71], v29 offset:1824
    s_waitcnt lgkmcnt(12)
    v_mfma_f32_16x16x32_bf16 v[180:183], v[76:79], v[92:95], v[180:183]
    ds_read_b64_tr_b16 v[72:73], v29 offset:64
    ds_read_b64_tr_b16 v[74:75], v29 offset:1856
    buffer_load_dwordx4 v[200:203], v33, s[8:11], s38 offen offset:0 sc1
    s_waitcnt lgkmcnt(12)
    v_mfma_f32_16x16x32_bf16 v[184:187], v[48:51], v[92:95], v[184:187]
    ds_read_b64_tr_b16 v[76:77], v29 offset:96
    ds_read_b64_tr_b16 v[78:79], v29 offset:1888
    s_waitcnt lgkmcnt(12)
    v_mfma_f32_16x16x32_bf16 v[188:191], v[52:55], v[92:95], v[188:191]
    ds_read_b64_tr_b16 v[48:49], v29 offset:128
    ds_read_b64_tr_b16 v[50:51], v29 offset:1920
    s_waitcnt lgkmcnt(12)
    v_mfma_f32_16x16x32_bf16 v[192:195], v[56:59], v[92:95], v[192:195]
    ds_read_b64_tr_b16 v[52:53], v29 offset:160
    ds_read_b64_tr_b16 v[54:55], v29 offset:1952
    buffer_load_dwordx4 v[204:207], v33, s[8:11], s38 offen offset:64 sc1
    s_waitcnt lgkmcnt(12)
    v_mfma_f32_16x16x32_bf16 v[196:199], v[60:63], v[92:95], v[196:199]
    ds_read_b64_tr_b16 v[56:57], v29 offset:192
    ds_read_b64_tr_b16 v[58:59], v29 offset:1984
    s_waitcnt lgkmcnt(12)
    v_mfma_f32_16x16x32_bf16 v[172:175], v[64:67], v[96:99], v[172:175]
    ds_read_b64_tr_b16 v[60:61], v29 offset:7168
    ds_read_b64_tr_b16 v[62:63], v29 offset:8960
    s_waitcnt lgkmcnt(12)
    v_mfma_f32_16x16x32_bf16 v[176:179], v[68:71], v[96:99], v[176:179]
    ds_read_b64_tr_b16 v[64:65], v29 offset:7200
    ds_read_b64_tr_b16 v[66:67], v29 offset:8992
    buffer_load_dwordx4 v[208:211], v33, s[8:11], s38 offen offset:128 sc1
    s_waitcnt lgkmcnt(12)
    v_mfma_f32_16x16x32_bf16 v[180:183], v[72:75], v[96:99], v[180:183]
    ds_read_b64_tr_b16 v[68:69], v29 offset:7232
    ds_read_b64_tr_b16 v[70:71], v29 offset:9024
    s_waitcnt lgkmcnt(12)
    v_mfma_f32_16x16x32_bf16 v[184:187], v[76:79], v[96:99], v[184:187]
    ds_read_b64_tr_b16 v[72:73], v29 offset:7264
    ds_read_b64_tr_b16 v[74:75], v29 offset:9056
    s_waitcnt lgkmcnt(12)
    v_mfma_f32_16x16x32_bf16 v[188:191], v[48:51], v[96:99], v[188:191]
    ds_read_b64_tr_b16 v[76:77], v29 offset:7296
    ds_read_b64_tr_b16 v[78:79], v29 offset:9088
    buffer_load_dwordx4 v[212:215], v33, s[8:11], s38 offen offset:192 sc1
    s_waitcnt lgkmcnt(12)
    v_mfma_f32_16x16x32_bf16 v[192:195], v[52:55], v[96:99], v[192:195]
    ds_read_b64_tr_b16 v[48:49], v29 offset:7328
    ds_read_b64_tr_b16 v[50:51], v29 offset:9120
    s_waitcnt lgkmcnt(12)
    v_mfma_f32_16x16x32_bf16 v[196:199], v[56:59], v[96:99], v[196:199]
    ds_read_b64_tr_b16 v[52:53], v29 offset:7360
    ds_read_b64_tr_b16 v[54:55], v29 offset:9152
    s_waitcnt lgkmcnt(12)
    v_mfma_f32_16x16x32_bf16 v[172:175], v[60:63], v[100:103], v[172:175]
    ds_read_b64_tr_b16 v[56:57], v29 offset:14336
    ds_read_b64_tr_b16 v[58:59], v29 offset:16128
    buffer_load_dwordx4 v[216:219], v33, s[8:11], s38 offen offset:256 sc1
    s_waitcnt lgkmcnt(12)
    v_mfma_f32_16x16x32_bf16 v[176:179], v[64:67], v[100:103], v[176:179]
    ds_read_b64_tr_b16 v[60:61], v29 offset:14368
    ds_read_b64_tr_b16 v[62:63], v29 offset:16160
    s_waitcnt lgkmcnt(12)
    v_mfma_f32_16x16x32_bf16 v[180:183], v[68:71], v[100:103], v[180:183]
    ds_read_b64_tr_b16 v[64:65], v29 offset:14400
    ds_read_b64_tr_b16 v[66:67], v29 offset:16192
    s_waitcnt lgkmcnt(12)
    v_mfma_f32_16x16x32_bf16 v[184:187], v[72:75], v[100:103], v[184:187]
    ds_read_b64_tr_b16 v[68:69], v29 offset:14432
    ds_read_b64_tr_b16 v[70:71], v29 offset:16224
    buffer_load_dwordx4 v[220:223], v33, s[8:11], s38 offen offset:320 sc1
    s_waitcnt lgkmcnt(12)
    v_mfma_f32_16x16x32_bf16 v[188:191], v[76:79], v[100:103], v[188:191]
    ds_read_b64_tr_b16 v[72:73], v29 offset:14464
    ds_read_b64_tr_b16 v[74:75], v29 offset:16256
    s_waitcnt lgkmcnt(12)
    v_mfma_f32_16x16x32_bf16 v[192:195], v[48:51], v[100:103], v[192:195]
    ds_read_b64_tr_b16 v[76:77], v29 offset:14496
    ds_read_b64_tr_b16 v[78:79], v29 offset:16288
    s_waitcnt lgkmcnt(12)
    v_mfma_f32_16x16x32_bf16 v[196:199], v[52:55], v[100:103], v[196:199]
    ds_read_b64_tr_b16 v[48:49], v29 offset:14528
    ds_read_b64_tr_b16 v[50:51], v29 offset:16320
    buffer_load_dwordx4 v[224:227], v33, s[8:11], s38 offen offset:384 sc1
    s_waitcnt lgkmcnt(12)
    v_mfma_f32_16x16x32_bf16 v[172:175], v[56:59], v[104:107], v[172:175]
    ds_read_b64_tr_b16 v[52:53], v29 offset:21504
    ds_read_b64_tr_b16 v[54:55], v29 offset:23296
    s_waitcnt lgkmcnt(12)
    v_mfma_f32_16x16x32_bf16 v[176:179], v[60:63], v[104:107], v[176:179]
    ds_read_b64_tr_b16 v[56:57], v29 offset:21536
    ds_read_b64_tr_b16 v[58:59], v29 offset:23328
    s_waitcnt lgkmcnt(12)
    v_mfma_f32_16x16x32_bf16 v[180:183], v[64:67], v[104:107], v[180:183]
    ds_read_b64_tr_b16 v[60:61], v29 offset:21568
    ds_read_b64_tr_b16 v[62:63], v29 offset:23360
    buffer_load_dwordx4 v[228:231], v33, s[8:11], s38 offen offset:448 sc1
    s_waitcnt lgkmcnt(12)
    v_mfma_f32_16x16x32_bf16 v[184:187], v[68:71], v[104:107], v[184:187]
    ds_read_b64_tr_b16 v[64:65], v29 offset:21600
    ds_read_b64_tr_b16 v[66:67], v29 offset:23392
    s_waitcnt lgkmcnt(12)
    v_mfma_f32_16x16x32_bf16 v[188:191], v[72:75], v[104:107], v[188:191]
    ds_read_b64_tr_b16 v[68:69], v29 offset:21632
    ds_read_b64_tr_b16 v[70:71], v29 offset:23424
    s_waitcnt lgkmcnt(12)
    v_mfma_f32_16x16x32_bf16 v[192:195], v[76:79], v[104:107], v[192:195]
    ds_read_b64_tr_b16 v[72:73], v29 offset:21664
    ds_read_b64_tr_b16 v[74:75], v29 offset:23456
    buffer_load_dwordx4 v[232:235], v33, s[8:11], s38 offen offset:512 sc1
    s_waitcnt lgkmcnt(12)
    v_mfma_f32_16x16x32_bf16 v[196:199], v[48:51], v[104:107], v[196:199]
    ds_read_b64_tr_b16 v[76:77], v29 offset:21696
    ds_read_b64_tr_b16 v[78:79], v29 offset:23488
    s_waitcnt lgkmcnt(12)
    v_mfma_f32_16x16x32_bf16 v[172:175], v[52:55], v[108:111], v[172:175]
    s_waitcnt vmcnt(16)
    s_barrier
    ds_read_b64_tr_b16 v[48:49], v29 offset:28672
    ds_read_b64_tr_b16 v[50:51], v29 offset:30464
    s_waitcnt lgkmcnt(12)
    v_mfma_f32_16x16x32_bf16 v[176:179], v[56:59], v[108:111], v[176:179]
    ds_read_b64_tr_b16 v[52:53], v29 offset:28704
    ds_read_b64_tr_b16 v[54:55], v29 offset:30496
    buffer_load_dwordx4 v[236:239], v33, s[8:11], s38 offen offset:576 sc1
    s_waitcnt lgkmcnt(12)
    v_mfma_f32_16x16x32_bf16 v[180:183], v[60:63], v[108:111], v[180:183]
    ds_read_b64_tr_b16 v[56:57], v29 offset:28736
    ds_read_b64_tr_b16 v[58:59], v29 offset:30528
    s_waitcnt lgkmcnt(12)
    v_mfma_f32_16x16x32_bf16 v[184:187], v[64:67], v[108:111], v[184:187]
    ds_read_b64_tr_b16 v[60:61], v29 offset:28768
    ds_read_b64_tr_b16 v[62:63], v29 offset:30560
    s_waitcnt lgkmcnt(12)
    v_mfma_f32_16x16x32_bf16 v[188:191], v[68:71], v[108:111], v[188:191]
    ds_read_b64_tr_b16 v[64:65], v29 offset:28800
    ds_read_b64_tr_b16 v[66:67], v29 offset:30592
    buffer_load_dwordx4 v[240:243], v33, s[8:11], s38 offen offset:640 sc1
    s_waitcnt lgkmcnt(12)
    v_mfma_f32_16x16x32_bf16 v[192:195], v[72:75], v[108:111], v[192:195]
    ds_read_b64_tr_b16 v[68:69], v29 offset:28832
    ds_read_b64_tr_b16 v[70:71], v29 offset:30624
    s_waitcnt lgkmcnt(12)
    v_mfma_f32_16x16x32_bf16 v[196:199], v[76:79], v[108:111], v[196:199]
    ds_read_b64_tr_b16 v[72:73], v29 offset:28864
    ds_read_b64_tr_b16 v[74:75], v29 offset:30656
    s_waitcnt lgkmcnt(12)
    v_mfma_f32_16x16x32_bf16 v[172:175], v[48:51], v[112:115], v[172:175]
    ds_read_b64_tr_b16 v[76:77], v29 offset:35840
    ds_read_b64_tr_b16 v[78:79], v29 offset:37632
    buffer_load_dwordx4 v[244:247], v33, s[8:11], s38 offen offset:704 sc1
    s_waitcnt lgkmcnt(12)
    v_mfma_f32_16x16x32_bf16 v[176:179], v[52:55], v[112:115], v[176:179]
    ds_read_b64_tr_b16 v[48:49], v29 offset:35872
    ds_read_b64_tr_b16 v[50:51], v29 offset:37664
    s_waitcnt lgkmcnt(12)
    v_mfma_f32_16x16x32_bf16 v[180:183], v[56:59], v[112:115], v[180:183]
    ds_read_b64_tr_b16 v[52:53], v29 offset:35904
    ds_read_b64_tr_b16 v[54:55], v29 offset:37696
    s_waitcnt lgkmcnt(12)
    v_mfma_f32_16x16x32_bf16 v[184:187], v[60:63], v[112:115], v[184:187]
    ds_read_b64_tr_b16 v[56:57], v29 offset:35936
    ds_read_b64_tr_b16 v[58:59], v29 offset:37728
    buffer_load_dwordx4 v[248:251], v33, s[8:11], s38 offen offset:768 sc1
    s_waitcnt lgkmcnt(12)
    v_mfma_f32_16x16x32_bf16 v[188:191], v[64:67], v[112:115], v[188:191]
    ds_read_b64_tr_b16 v[60:61], v29 offset:35968
    ds_read_b64_tr_b16 v[62:63], v29 offset:37760
    s_waitcnt lgkmcnt(12)
    v_mfma_f32_16x16x32_bf16 v[192:195], v[68:71], v[112:115], v[192:195]
    ds_read_b64_tr_b16 v[64:65], v29 offset:36000
    ds_read_b64_tr_b16 v[66:67], v29 offset:37792
    s_waitcnt lgkmcnt(12)
    v_mfma_f32_16x16x32_bf16 v[196:199], v[72:75], v[112:115], v[196:199]
    ds_read_b64_tr_b16 v[68:69], v29 offset:36032
    ds_read_b64_tr_b16 v[70:71], v29 offset:37824
    buffer_load_dwordx4 v[252:255], v33, s[8:11], s38 offen offset:832 sc1
    s_waitcnt lgkmcnt(12)
    v_mfma_f32_16x16x32_bf16 v[172:175], v[76:79], v[116:119], v[172:175]
    ds_read_b64_tr_b16 v[72:73], v29 offset:43008
    ds_read_b64_tr_b16 v[74:75], v29 offset:44800
    s_waitcnt lgkmcnt(12)
    v_mfma_f32_16x16x32_bf16 v[176:179], v[48:51], v[116:119], v[176:179]
    ds_read_b64_tr_b16 v[76:77], v29 offset:43040
    ds_read_b64_tr_b16 v[78:79], v29 offset:44832
    s_waitcnt lgkmcnt(12)
    v_mfma_f32_16x16x32_bf16 v[180:183], v[52:55], v[116:119], v[180:183]
    ds_read_b64_tr_b16 v[48:49], v29 offset:43072
    ds_read_b64_tr_b16 v[50:51], v29 offset:44864
    s_waitcnt lgkmcnt(12)
    v_mfma_f32_16x16x32_bf16 v[184:187], v[56:59], v[116:119], v[184:187]
    ds_read_b64_tr_b16 v[52:53], v29 offset:43104
    ds_read_b64_tr_b16 v[54:55], v29 offset:44896
    s_waitcnt lgkmcnt(12)
    v_mfma_f32_16x16x32_bf16 v[188:191], v[60:63], v[116:119], v[188:191]
    ds_read_b64_tr_b16 v[56:57], v29 offset:43136
    ds_read_b64_tr_b16 v[58:59], v29 offset:44928
    s_waitcnt lgkmcnt(12)
    v_mfma_f32_16x16x32_bf16 v[192:195], v[64:67], v[116:119], v[192:195]
    ds_read_b64_tr_b16 v[60:61], v29 offset:43168
    ds_read_b64_tr_b16 v[62:63], v29 offset:44960
    s_waitcnt lgkmcnt(12)
    v_mfma_f32_16x16x32_bf16 v[196:199], v[68:71], v[116:119], v[196:199]
    ds_read_b64_tr_b16 v[64:65], v29 offset:43200
    ds_read_b64_tr_b16 v[66:67], v29 offset:44992
    s_waitcnt lgkmcnt(12)
    v_mfma_f32_16x16x32_bf16 v[172:175], v[72:75], v[120:123], v[172:175]
    ds_read_b64_tr_b16 v[68:69], v29 offset:50176
    ds_read_b64_tr_b16 v[70:71], v29 offset:51968
    s_waitcnt lgkmcnt(12)
    v_mfma_f32_16x16x32_bf16 v[176:179], v[76:79], v[120:123], v[176:179]
    ds_read_b64_tr_b16 v[72:73], v29 offset:50208
    ds_read_b64_tr_b16 v[74:75], v29 offset:52000
    s_waitcnt lgkmcnt(12)
    v_mfma_f32_16x16x32_bf16 v[180:183], v[48:51], v[120:123], v[180:183]
    ds_read_b64_tr_b16 v[76:77], v29 offset:50240
    ds_read_b64_tr_b16 v[78:79], v29 offset:52032
    s_waitcnt lgkmcnt(12)
    v_mfma_f32_16x16x32_bf16 v[184:187], v[52:55], v[120:123], v[184:187]
    ds_read_b64_tr_b16 v[48:49], v29 offset:50272
    ds_read_b64_tr_b16 v[50:51], v29 offset:52064
    s_waitcnt lgkmcnt(12)
    v_mfma_f32_16x16x32_bf16 v[188:191], v[56:59], v[120:123], v[188:191]
    ds_read_b64_tr_b16 v[52:53], v29 offset:50304
    ds_read_b64_tr_b16 v[54:55], v29 offset:52096
    s_waitcnt lgkmcnt(12)
    v_mfma_f32_16x16x32_bf16 v[192:195], v[60:63], v[120:123], v[192:195]
    ds_read_b64_tr_b16 v[56:57], v29 offset:50336
    ds_read_b64_tr_b16 v[58:59], v29 offset:52128
    s_waitcnt lgkmcnt(12)
    v_mfma_f32_16x16x32_bf16 v[196:199], v[64:67], v[120:123], v[196:199]
    ds_read_b64_tr_b16 v[60:61], v29 offset:50368
    ds_read_b64_tr_b16 v[62:63], v29 offset:52160
    s_waitcnt lgkmcnt(12)
    v_mfma_f32_16x16x32_bf16 v[172:175], v[68:71], v[124:127], v[172:175]
    s_waitcnt vmcnt(14)
    s_barrier
    ds_read_b64_tr_b16 v[64:65], v27 offset:0
    ds_read_b64_tr_b16 v[66:67], v27 offset:1792
    s_waitcnt lgkmcnt(12)
    v_mfma_f32_16x16x32_bf16 v[176:179], v[72:75], v[124:127], v[176:179]
    ds_read_b64_tr_b16 v[68:69], v27 offset:32
    ds_read_b64_tr_b16 v[70:71], v27 offset:1824
    s_waitcnt lgkmcnt(12)
    v_mfma_f32_16x16x32_bf16 v[180:183], v[76:79], v[124:127], v[180:183]
    ds_read_b64_tr_b16 v[72:73], v27 offset:64
    ds_read_b64_tr_b16 v[74:75], v27 offset:1856
    s_waitcnt lgkmcnt(12)
    v_mfma_f32_16x16x32_bf16 v[184:187], v[48:51], v[124:127], v[184:187]
    ds_read_b64_tr_b16 v[76:77], v27 offset:96
    ds_read_b64_tr_b16 v[78:79], v27 offset:1888
    s_waitcnt lgkmcnt(12)
    v_mfma_f32_16x16x32_bf16 v[188:191], v[52:55], v[124:127], v[188:191]
    ds_read_b64_tr_b16 v[48:49], v27 offset:128
    ds_read_b64_tr_b16 v[50:51], v27 offset:1920
    s_waitcnt lgkmcnt(12)
    v_mfma_f32_16x16x32_bf16 v[192:195], v[56:59], v[124:127], v[192:195]
    ds_read_b64_tr_b16 v[52:53], v27 offset:160
    ds_read_b64_tr_b16 v[54:55], v27 offset:1952
    s_waitcnt lgkmcnt(12)
    v_mfma_f32_16x16x32_bf16 v[196:199], v[60:63], v[124:127], v[196:199]
    ds_read_b64_tr_b16 v[56:57], v27 offset:192
    ds_read_b64_tr_b16 v[58:59], v27 offset:1984
    s_waitcnt lgkmcnt(12)
    v_mfma_f32_16x16x32_bf16 v[172:175], v[64:67], v[128:131], v[172:175]
    ds_read_b64_tr_b16 v[60:61], v27 offset:7168
    ds_read_b64_tr_b16 v[62:63], v27 offset:8960
    s_waitcnt lgkmcnt(12)
    v_mfma_f32_16x16x32_bf16 v[176:179], v[68:71], v[128:131], v[176:179]
    ds_read_b64_tr_b16 v[64:65], v27 offset:7200
    ds_read_b64_tr_b16 v[66:67], v27 offset:8992
    s_waitcnt lgkmcnt(12)
    v_mfma_f32_16x16x32_bf16 v[180:183], v[72:75], v[128:131], v[180:183]
    ds_read_b64_tr_b16 v[68:69], v27 offset:7232
    ds_read_b64_tr_b16 v[70:71], v27 offset:9024
    s_waitcnt lgkmcnt(12)
    v_mfma_f32_16x16x32_bf16 v[184:187], v[76:79], v[128:131], v[184:187]
    ds_read_b64_tr_b16 v[72:73], v27 offset:7264
    ds_read_b64_tr_b16 v[74:75], v27 offset:9056
    s_waitcnt lgkmcnt(12)
    v_mfma_f32_16x16x32_bf16 v[188:191], v[48:51], v[128:131], v[188:191]
    ds_read_b64_tr_b16 v[76:77], v27 offset:7296
    ds_read_b64_tr_b16 v[78:79], v27 offset:9088
    s_waitcnt lgkmcnt(12)
    v_mfma_f32_16x16x32_bf16 v[192:195], v[52:55], v[128:131], v[192:195]
    ds_read_b64_tr_b16 v[48:49], v27 offset:7328
    ds_read_b64_tr_b16 v[50:51], v27 offset:9120
    s_waitcnt lgkmcnt(12)
    v_mfma_f32_16x16x32_bf16 v[196:199], v[56:59], v[128:131], v[196:199]
    ds_read_b64_tr_b16 v[52:53], v27 offset:7360
    ds_read_b64_tr_b16 v[54:55], v27 offset:9152
    s_waitcnt lgkmcnt(12)
    v_mfma_f32_16x16x32_bf16 v[172:175], v[60:63], v[132:135], v[172:175]
    ds_read_b64_tr_b16 v[56:57], v27 offset:14336
    ds_read_b64_tr_b16 v[58:59], v27 offset:16128
    s_waitcnt lgkmcnt(12)
    v_mfma_f32_16x16x32_bf16 v[176:179], v[64:67], v[132:135], v[176:179]
    ds_read_b64_tr_b16 v[60:61], v27 offset:14368
    ds_read_b64_tr_b16 v[62:63], v27 offset:16160
    s_waitcnt lgkmcnt(12)
    v_mfma_f32_16x16x32_bf16 v[180:183], v[68:71], v[132:135], v[180:183]
    ds_read_b64_tr_b16 v[64:65], v27 offset:14400
    ds_read_b64_tr_b16 v[66:67], v27 offset:16192
    s_waitcnt lgkmcnt(12)
    v_mfma_f32_16x16x32_bf16 v[184:187], v[72:75], v[132:135], v[184:187]
    ds_read_b64_tr_b16 v[68:69], v27 offset:14432
    ds_read_b64_tr_b16 v[70:71], v27 offset:16224
    s_waitcnt lgkmcnt(12)
    v_mfma_f32_16x16x32_bf16 v[188:191], v[76:79], v[132:135], v[188:191]
    ds_read_b64_tr_b16 v[72:73], v27 offset:14464
    ds_read_b64_tr_b16 v[74:75], v27 offset:16256
    s_waitcnt lgkmcnt(12)
    v_mfma_f32_16x16x32_bf16 v[192:195], v[48:51], v[132:135], v[192:195]
    ds_read_b64_tr_b16 v[76:77], v27 offset:14496
    ds_read_b64_tr_b16 v[78:79], v27 offset:16288
    s_waitcnt lgkmcnt(12)
    v_mfma_f32_16x16x32_bf16 v[196:199], v[52:55], v[132:135], v[196:199]
    ds_read_b64_tr_b16 v[48:49], v27 offset:14528
    ds_read_b64_tr_b16 v[50:51], v27 offset:16320
    s_waitcnt lgkmcnt(12)
    v_mfma_f32_16x16x32_bf16 v[172:175], v[56:59], v[136:139], v[172:175]
    ds_read_b64_tr_b16 v[52:53], v27 offset:21504
    ds_read_b64_tr_b16 v[54:55], v27 offset:23296
    s_waitcnt lgkmcnt(12)
    v_mfma_f32_16x16x32_bf16 v[176:179], v[60:63], v[136:139], v[176:179]
    ds_read_b64_tr_b16 v[56:57], v27 offset:21536
    ds_read_b64_tr_b16 v[58:59], v27 offset:23328
    s_waitcnt lgkmcnt(12)
    v_mfma_f32_16x16x32_bf16 v[180:183], v[64:67], v[136:139], v[180:183]
    ds_read_b64_tr_b16 v[60:61], v27 offset:21568
    ds_read_b64_tr_b16 v[62:63], v27 offset:23360
    s_waitcnt lgkmcnt(12)
    v_mfma_f32_16x16x32_bf16 v[184:187], v[68:71], v[136:139], v[184:187]
    ds_read_b64_tr_b16 v[64:65], v27 offset:21600
    ds_read_b64_tr_b16 v[66:67], v27 offset:23392
    s_waitcnt lgkmcnt(12)
    v_mfma_f32_16x16x32_bf16 v[188:191], v[72:75], v[136:139], v[188:191]
    ds_read_b64_tr_b16 v[68:69], v27 offset:21632
    ds_read_b64_tr_b16 v[70:71], v27 offset:23424
    s_waitcnt lgkmcnt(12)
    v_mfma_f32_16x16x32_bf16 v[192:195], v[76:79], v[136:139], v[192:195]
    ds_read_b64_tr_b16 v[72:73], v27 offset:21664
    ds_read_b64_tr_b16 v[74:75], v27 offset:23456
    s_waitcnt lgkmcnt(12)
    v_mfma_f32_16x16x32_bf16 v[196:199], v[48:51], v[136:139], v[196:199]
    ds_read_b64_tr_b16 v[76:77], v27 offset:21696
    ds_read_b64_tr_b16 v[78:79], v27 offset:23488
    s_waitcnt lgkmcnt(12)
    v_mfma_f32_16x16x32_bf16 v[172:175], v[52:55], v[140:143], v[172:175]
    s_waitcnt lgkmcnt(10)
    v_mfma_f32_16x16x32_bf16 v[176:179], v[56:59], v[140:143], v[176:179]
    s_waitcnt lgkmcnt(8)
    v_mfma_f32_16x16x32_bf16 v[180:183], v[60:63], v[140:143], v[180:183]
    s_waitcnt lgkmcnt(6)
    v_mfma_f32_16x16x32_bf16 v[184:187], v[64:67], v[140:143], v[184:187]
    s_waitcnt lgkmcnt(4)
    v_mfma_f32_16x16x32_bf16 v[188:191], v[68:71], v[140:143], v[188:191]
    s_waitcnt lgkmcnt(2)
    v_mfma_f32_16x16x32_bf16 v[192:195], v[72:75], v[140:143], v[192:195]
    s_waitcnt lgkmcnt(0)
    v_mfma_f32_16x16x32_bf16 v[196:199], v[76:79], v[140:143], v[196:199]
    v_and_b32 v56, 3, v3
    v_cmp_eq_u32 vcc, 1, v56
    s_nop 1
    v_cndmask_b32 v16, v16, v17, vcc
    v_cmp_eq_u32 vcc, 2, v56
    s_nop 1
    v_cndmask_b32 v16, v16, v18, vcc
    v_cmp_eq_u32 vcc, 3, v56
    s_nop 1
    v_cndmask_b32 v16, v16, v19, vcc
    v_lshrrev_b32 v56, 2, v3
    v_cmp_eq_u32 vcc, v56, v2
    s_nop 1
    v_cndmask_b32 v16, 0, v16, vcc
    v_mov_b32 v56, v16
    s_nop 1
    v_permlane16_swap_b32 v16, v56
    v_add_f32 v16, v16, v56
    v_mov_b32 v56, v16
    s_nop 1
    v_permlane32_swap_b32 v16, v56
    v_add_f32 v16, v16, v56
    v_mul_f32 v48, 0xbb000000, v40
    v_mul_f32 v16, 0x3b000000, v16
    v_fma_f32 v16, -v48, v48, v16
    v_max_f32 v16, 0, v16
    v_add_f32 v16, 0x3727c5ac, v16
    v_rsq_f32 v56, v16
    s_nop 0
    v_mul_f32 v54, v16, v56
    v_mul_f32 v50, 0xc0135761, v56
    v_mul_f32 v52, v56, v56
    v_mul_f32 v52, v52, v56
    v_mul_f32 v52, 0xbdd2d3e8, v52
    s_add_u32 s6, s54, 28672
    v_lshlrev_b32 v33, 4, v3
    v_lshl_add_u32 v33, v31, 4, v33
    v_add_u32 v33, s6, v33
    s_waitcnt vmcnt(0)
    v_pk_fma_f32 v[144:145], v[200:201], v[48:49], v[144:145] op_sel_hi:[1,0,1]
    v_pk_fma_f32 v[146:147], v[202:203], v[48:49], v[146:147] op_sel_hi:[1,0,1]
    v_pk_fma_f32 v[148:149], v[204:205], v[48:49], v[148:149] op_sel_hi:[1,0,1]
    v_pk_fma_f32 v[150:151], v[206:207], v[48:49], v[150:151] op_sel_hi:[1,0,1]
    v_pk_fma_f32 v[152:153], v[208:209], v[48:49], v[152:153] op_sel_hi:[1,0,1]
    v_pk_fma_f32 v[154:155], v[210:211], v[48:49], v[154:155] op_sel_hi:[1,0,1]
    v_pk_fma_f32 v[156:157], v[212:213], v[48:49], v[156:157] op_sel_hi:[1,0,1]
    v_pk_fma_f32 v[158:159], v[214:215], v[48:49], v[158:159] op_sel_hi:[1,0,1]
    v_pk_fma_f32 v[160:161], v[216:217], v[48:49], v[160:161] op_sel_hi:[1,0,1]
    v_pk_fma_f32 v[162:163], v[218:219], v[48:49], v[162:163] op_sel_hi:[1,0,1]
    v_pk_fma_f32 v[164:165], v[220:221], v[48:49], v[164:165] op_sel_hi:[1,0,1]
    v_pk_fma_f32 v[166:167], v[222:223], v[48:49], v[166:167] op_sel_hi:[1,0,1]
    v_pk_fma_f32 v[168:169], v[224:225], v[48:49], v[168:169] op_sel_hi:[1,0,1]
    v_pk_fma_f32 v[170:171], v[226:227], v[48:49], v[170:171] op_sel_hi:[1,0,1]
    v_pk_fma_f32 v[172:173], v[228:229], v[48:49], v[172:173] op_sel_hi:[1,0,1]
    v_pk_fma_f32 v[174:175], v[230:231], v[48:49], v[174:175] op_sel_hi:[1,0,1]
    v_pk_mul_f32 v[80:81], v[144:145], v[144:145]
    v_pk_mul_f32 v[82:83], v[146:147], v[146:147]
    v_pk_mul_f32 v[84:85], v[148:149], v[148:149]
    v_pk_mul_f32 v[86:87], v[150:151], v[150:151]
    v_pk_mul_f32 v[88:89], v[152:153], v[152:153]
    v_pk_mul_f32 v[90:91], v[154:155], v[154:155]
    v_pk_mul_f32 v[92:93], v[156:157], v[156:157]
    v_pk_mul_f32 v[94:95], v[158:159], v[158:159]
    v_pk_mul_f32 v[96:97], v[160:161], v[160:161]
    v_pk_mul_f32 v[98:99], v[162:163], v[162:163]
    v_pk_mul_f32 v[100:101], v[164:165], v[164:165]
    v_pk_mul_f32 v[102:103], v[166:167], v[166:167]
    v_pk_mul_f32 v[104:105], v[168:169], v[168:169]
    v_pk_mul_f32 v[106:107], v[170:171], v[170:171]
    v_pk_mul_f32 v[108:109], v[172:173], v[172:173]
    v_pk_mul_f32 v[110:111], v[174:175], v[174:175]
    v_pk_fma_f32 v[80:81], v[80:81], v[52:53], v[50:51] op_sel_hi:[1,0,0]
    v_pk_fma_f32 v[82:83], v[82:83], v[52:53], v[50:51] op_sel_hi:[1,0,0]
    v_pk_fma_f32 v[84:85], v[84:85], v[52:53], v[50:51] op_sel_hi:[1,0,0]
    v_pk_fma_f32 v[86:87], v[86:87], v[52:53], v[50:51] op_sel_hi:[1,0,0]
    v_pk_fma_f32 v[88:89], v[88:89], v[52:53], v[50:51] op_sel_hi:[1,0,0]
    v_pk_fma_f32 v[90:91], v[90:91], v[52:53], v[50:51] op_sel_hi:[1,0,0]
    v_pk_fma_f32 v[92:93], v[92:93], v[52:53], v[50:51] op_sel_hi:[1,0,0]
    v_pk_fma_f32 v[94:95], v[94:95], v[52:53], v[50:51] op_sel_hi:[1,0,0]
    v_pk_fma_f32 v[96:97], v[96:97], v[52:53], v[50:51] op_sel_hi:[1,0,0]
    v_pk_fma_f32 v[98:99], v[98:99], v[52:53], v[50:51] op_sel_hi:[1,0,0]
    v_pk_fma_f32 v[100:101], v[100:101], v[52:53], v[50:51] op_sel_hi:[1,0,0]
    v_pk_fma_f32 v[102:103], v[102:103], v[52:53], v[50:51] op_sel_hi:[1,0,0]
    v_pk_fma_f32 v[104:105], v[104:105], v[52:53], v[50:51] op_sel_hi:[1,0,0]
    v_pk_fma_f32 v[106:107], v[106:107], v[52:53], v[50:51] op_sel_hi:[1,0,0]
    v_pk_fma_f32 v[108:109], v[108:109], v[52:53], v[50:51] op_sel_hi:[1,0,0]
    v_pk_fma_f32 v[110:111], v[110:111], v[52:53], v[50:51] op_sel_hi:[1,0,0]
    v_pk_mul_f32 v[80:81], v[80:81], v[144:145]
    v_pk_mul_f32 v[82:83], v[82:83], v[146:147]
    v_pk_mul_f32 v[84:85], v[84:85], v[148:149]
    v_pk_mul_f32 v[86:87], v[86:87], v[150:151]
    v_pk_mul_f32 v[88:89], v[88:89], v[152:153]
    v_pk_mul_f32 v[90:91], v[90:91], v[154:155]
    v_pk_mul_f32 v[92:93], v[92:93], v[156:157]
    v_pk_mul_f32 v[94:95], v[94:95], v[158:159]
    v_pk_mul_f32 v[96:97], v[96:97], v[160:161]
    v_pk_mul_f32 v[98:99], v[98:99], v[162:163]
    v_pk_mul_f32 v[100:101], v[100:101], v[164:165]
    v_pk_mul_f32 v[102:103], v[102:103], v[166:167]
    v_pk_mul_f32 v[104:105], v[104:105], v[168:169]
    v_pk_mul_f32 v[106:107], v[106:107], v[170:171]
    v_pk_mul_f32 v[108:109], v[108:109], v[172:173]
    v_pk_mul_f32 v[110:111], v[110:111], v[174:175]
    v_exp_f32 v80, v80
    v_exp_f32 v81, v81
    v_exp_f32 v82, v82
    v_exp_f32 v83, v83
    v_exp_f32 v84, v84
    v_exp_f32 v85, v85
    v_exp_f32 v86, v86
    v_exp_f32 v87, v87
    v_exp_f32 v88, v88
    v_exp_f32 v89, v89
    v_exp_f32 v90, v90
    v_exp_f32 v91, v91
    v_exp_f32 v92, v92
    v_exp_f32 v93, v93
    v_exp_f32 v94, v94
    v_exp_f32 v95, v95
    v_exp_f32 v96, v96
    v_exp_f32 v97, v97
    v_exp_f32 v98, v98
    v_exp_f32 v99, v99
    v_exp_f32 v100, v100
    v_exp_f32 v101, v101
    v_exp_f32 v102, v102
    v_exp_f32 v103, v103
    v_exp_f32 v104, v104
    v_exp_f32 v105, v105
    v_exp_f32 v106, v106
    v_exp_f32 v107, v107
    v_exp_f32 v108, v108
    v_exp_f32 v109, v109
    v_exp_f32 v110, v110
    v_exp_f32 v111, v111
    v_pk_fma_f32 v[80:81], v[80:81], v[54:55], v[54:55] op_sel_hi:[1,0,0]
    v_pk_fma_f32 v[82:83], v[82:83], v[54:55], v[54:55] op_sel_hi:[1,0,0]
    v_pk_fma_f32 v[84:85], v[84:85], v[54:55], v[54:55] op_sel_hi:[1,0,0]
    v_pk_fma_f32 v[86:87], v[86:87], v[54:55], v[54:55] op_sel_hi:[1,0,0]
    v_pk_fma_f32 v[88:89], v[88:89], v[54:55], v[54:55] op_sel_hi:[1,0,0]
    v_pk_fma_f32 v[90:91], v[90:91], v[54:55], v[54:55] op_sel_hi:[1,0,0]
    v_pk_fma_f32 v[92:93], v[92:93], v[54:55], v[54:55] op_sel_hi:[1,0,0]
    v_pk_fma_f32 v[94:95], v[94:95], v[54:55], v[54:55] op_sel_hi:[1,0,0]
    v_pk_fma_f32 v[96:97], v[96:97], v[54:55], v[54:55] op_sel_hi:[1,0,0]
    v_pk_fma_f32 v[98:99], v[98:99], v[54:55], v[54:55] op_sel_hi:[1,0,0]
    v_pk_fma_f32 v[100:101], v[100:101], v[54:55], v[54:55] op_sel_hi:[1,0,0]
    v_pk_fma_f32 v[102:103], v[102:103], v[54:55], v[54:55] op_sel_hi:[1,0,0]
    v_pk_fma_f32 v[104:105], v[104:105], v[54:55], v[54:55] op_sel_hi:[1,0,0]
    v_pk_fma_f32 v[106:107], v[106:107], v[54:55], v[54:55] op_sel_hi:[1,0,0]
    v_pk_fma_f32 v[108:109], v[108:109], v[54:55], v[54:55] op_sel_hi:[1,0,0]
    v_pk_fma_f32 v[110:111], v[110:111], v[54:55], v[54:55] op_sel_hi:[1,0,0]
    v_rcp_f32 v80, v80
    v_rcp_f32 v81, v81
    v_rcp_f32 v82, v82
    v_rcp_f32 v83, v83
    v_rcp_f32 v84, v84
    v_rcp_f32 v85, v85
    v_rcp_f32 v86, v86
    v_rcp_f32 v87, v87
    v_rcp_f32 v88, v88
    v_rcp_f32 v89, v89
    v_rcp_f32 v90, v90
    v_rcp_f32 v91, v91
    v_rcp_f32 v92, v92
    v_rcp_f32 v93, v93
    v_rcp_f32 v94, v94
    v_rcp_f32 v95, v95
    v_rcp_f32 v96, v96
    v_rcp_f32 v97, v97
    v_rcp_f32 v98, v98
    v_rcp_f32 v99, v99
    v_rcp_f32 v100, v100
    v_rcp_f32 v101, v101
    v_rcp_f32 v102, v102
    v_rcp_f32 v103, v103
    v_rcp_f32 v104, v104
    v_rcp_f32 v105, v105
    v_rcp_f32 v106, v106
    v_rcp_f32 v107, v107
    v_rcp_f32 v108, v108
    v_rcp_f32 v109, v109
    v_rcp_f32 v110, v110
    v_rcp_f32 v111, v111
    v_pk_mul_f32 v[144:145], v[144:145], v[80:81]
    v_pk_mul_f32 v[146:147], v[146:147], v[82:83]
    v_pk_mul_f32 v[148:149], v[148:149], v[84:85]
    v_pk_mul_f32 v[150:151], v[150:151], v[86:87]
    v_pk_mul_f32 v[152:153], v[152:153], v[88:89]
    v_pk_mul_f32 v[154:155], v[154:155], v[90:91]
    v_pk_mul_f32 v[156:157], v[156:157], v[92:93]
    v_pk_mul_f32 v[158:159], v[158:159], v[94:95]
    v_pk_mul_f32 v[160:161], v[160:161], v[96:97]
    v_pk_mul_f32 v[162:163], v[162:163], v[98:99]
    v_pk_mul_f32 v[164:165], v[164:165], v[100:101]
    v_pk_mul_f32 v[166:167], v[166:167], v[102:103]
    v_pk_mul_f32 v[168:169], v[168:169], v[104:105]
    v_pk_mul_f32 v[170:171], v[170:171], v[106:107]
    v_pk_mul_f32 v[172:173], v[172:173], v[108:109]
    v_pk_mul_f32 v[174:175], v[174:175], v[110:111]
    v_cvt_pk_bf16_f32 v200, v144, v145
    v_cvt_pk_bf16_f32 v201, v146, v147
    v_cvt_pk_bf16_f32 v202, v148, v149
    v_cvt_pk_bf16_f32 v203, v150, v151
    v_cvt_pk_bf16_f32 v204, v152, v153
    v_cvt_pk_bf16_f32 v205, v154, v155
    v_cvt_pk_bf16_f32 v206, v156, v157
    v_cvt_pk_bf16_f32 v207, v158, v159
    v_cvt_pk_bf16_f32 v208, v160, v161
    v_cvt_pk_bf16_f32 v209, v162, v163
    v_cvt_pk_bf16_f32 v210, v164, v165
    v_cvt_pk_bf16_f32 v211, v166, v167
    v_cvt_pk_bf16_f32 v212, v168, v169
    v_cvt_pk_bf16_f32 v213, v170, v171
    v_cvt_pk_bf16_f32 v214, v172, v173
    v_cvt_pk_bf16_f32 v215, v174, v175
    v_permlane16_swap_b32 v200, v202
    v_permlane16_swap_b32 v201, v203
    v_permlane16_swap_b32 v204, v206
    v_permlane16_swap_b32 v205, v207
    v_permlane16_swap_b32 v208, v210
    v_permlane16_swap_b32 v209, v211
    v_permlane16_swap_b32 v212, v214
    v_permlane16_swap_b32 v213, v215
    ds_write_b128 v33, v[200:203] offset:0
    ds_write_b128 v33, v[204:207] offset:1024
    ds_write_b128 v33, v[208:211] offset:2048
    ds_write_b128 v33, v[212:215] offset:3072
    v_pk_fma_f32 v[176:177], v[232:233], v[48:49], v[176:177] op_sel_hi:[1,0,1]
    v_pk_fma_f32 v[178:179], v[234:235], v[48:49], v[178:179] op_sel_hi:[1,0,1]
    v_pk_fma_f32 v[180:181], v[236:237], v[48:49], v[180:181] op_sel_hi:[1,0,1]
    v_pk_fma_f32 v[182:183], v[238:239], v[48:49], v[182:183] op_sel_hi:[1,0,1]
    v_pk_fma_f32 v[184:185], v[240:241], v[48:49], v[184:185] op_sel_hi:[1,0,1]
    v_pk_fma_f32 v[186:187], v[242:243], v[48:49], v[186:187] op_sel_hi:[1,0,1]
    v_pk_fma_f32 v[188:189], v[244:245], v[48:49], v[188:189] op_sel_hi:[1,0,1]
    v_pk_fma_f32 v[190:191], v[246:247], v[48:49], v[190:191] op_sel_hi:[1,0,1]
    v_pk_fma_f32 v[192:193], v[248:249], v[48:49], v[192:193] op_sel_hi:[1,0,1]
    v_pk_fma_f32 v[194:195], v[250:251], v[48:49], v[194:195] op_sel_hi:[1,0,1]
    v_pk_fma_f32 v[196:197], v[252:253], v[48:49], v[196:197] op_sel_hi:[1,0,1]
    v_pk_fma_f32 v[198:199], v[254:255], v[48:49], v[198:199] op_sel_hi:[1,0,1]
    v_pk_mul_f32 v[80:81], v[176:177], v[176:177]
    v_pk_mul_f32 v[82:83], v[178:179], v[178:179]
    v_pk_mul_f32 v[84:85], v[180:181], v[180:181]
    v_pk_mul_f32 v[86:87], v[182:183], v[182:183]
    v_pk_mul_f32 v[88:89], v[184:185], v[184:185]
    v_pk_mul_f32 v[90:91], v[186:187], v[186:187]
    v_pk_mul_f32 v[92:93], v[188:189], v[188:189]
    v_pk_mul_f32 v[94:95], v[190:191], v[190:191]
    v_pk_mul_f32 v[96:97], v[192:193], v[192:193]
    v_pk_mul_f32 v[98:99], v[194:195], v[194:195]
    v_pk_mul_f32 v[100:101], v[196:197], v[196:197]
    v_pk_mul_f32 v[102:103], v[198:199], v[198:199]
    v_pk_fma_f32 v[80:81], v[80:81], v[52:53], v[50:51] op_sel_hi:[1,0,0]
    v_pk_fma_f32 v[82:83], v[82:83], v[52:53], v[50:51] op_sel_hi:[1,0,0]
    v_pk_fma_f32 v[84:85], v[84:85], v[52:53], v[50:51] op_sel_hi:[1,0,0]
    v_pk_fma_f32 v[86:87], v[86:87], v[52:53], v[50:51] op_sel_hi:[1,0,0]
    v_pk_fma_f32 v[88:89], v[88:89], v[52:53], v[50:51] op_sel_hi:[1,0,0]
    v_pk_fma_f32 v[90:91], v[90:91], v[52:53], v[50:51] op_sel_hi:[1,0,0]
    v_pk_fma_f32 v[92:93], v[92:93], v[52:53], v[50:51] op_sel_hi:[1,0,0]
    v_pk_fma_f32 v[94:95], v[94:95], v[52:53], v[50:51] op_sel_hi:[1,0,0]
    v_pk_fma_f32 v[96:97], v[96:97], v[52:53], v[50:51] op_sel_hi:[1,0,0]
    v_pk_fma_f32 v[98:99], v[98:99], v[52:53], v[50:51] op_sel_hi:[1,0,0]
    v_pk_fma_f32 v[100:101], v[100:101], v[52:53], v[50:51] op_sel_hi:[1,0,0]
    v_pk_fma_f32 v[102:103], v[102:103], v[52:53], v[50:51] op_sel_hi:[1,0,0]
    v_pk_mul_f32 v[80:81], v[80:81], v[176:177]
    v_pk_mul_f32 v[82:83], v[82:83], v[178:179]
    v_pk_mul_f32 v[84:85], v[84:85], v[180:181]
    v_pk_mul_f32 v[86:87], v[86:87], v[182:183]
    v_pk_mul_f32 v[88:89], v[88:89], v[184:185]
    v_pk_mul_f32 v[90:91], v[90:91], v[186:187]
    v_pk_mul_f32 v[92:93], v[92:93], v[188:189]
    v_pk_mul_f32 v[94:95], v[94:95], v[190:191]
    v_pk_mul_f32 v[96:97], v[96:97], v[192:193]
    v_pk_mul_f32 v[98:99], v[98:99], v[194:195]
    v_pk_mul_f32 v[100:101], v[100:101], v[196:197]
    v_pk_mul_f32 v[102:103], v[102:103], v[198:199]
    v_exp_f32 v80, v80
    v_exp_f32 v81, v81
    v_exp_f32 v82, v82
    v_exp_f32 v83, v83
    v_exp_f32 v84, v84
    v_exp_f32 v85, v85
    v_exp_f32 v86, v86
    v_exp_f32 v87, v87
    v_exp_f32 v88, v88
    v_exp_f32 v89, v89
    v_exp_f32 v90, v90
    v_exp_f32 v91, v91
    v_exp_f32 v92, v92
    v_exp_f32 v93, v93
    v_exp_f32 v94, v94
    v_exp_f32 v95, v95
    v_exp_f32 v96, v96
    v_exp_f32 v97, v97
    v_exp_f32 v98, v98
    v_exp_f32 v99, v99
    v_exp_f32 v100, v100
    v_exp_f32 v101, v101
    v_exp_f32 v102, v102
    v_exp_f32 v103, v103
    v_pk_fma_f32 v[80:81], v[80:81], v[54:55], v[54:55] op_sel_hi:[1,0,0]
    v_pk_fma_f32 v[82:83], v[82:83], v[54:55], v[54:55] op_sel_hi:[1,0,0]
    v_pk_fma_f32 v[84:85], v[84:85], v[54:55], v[54:55] op_sel_hi:[1,0,0]
    v_pk_fma_f32 v[86:87], v[86:87], v[54:55], v[54:55] op_sel_hi:[1,0,0]
    v_pk_fma_f32 v[88:89], v[88:89], v[54:55], v[54:55] op_sel_hi:[1,0,0]
    v_pk_fma_f32 v[90:91], v[90:91], v[54:55], v[54:55] op_sel_hi:[1,0,0]
    v_pk_fma_f32 v[92:93], v[92:93], v[54:55], v[54:55] op_sel_hi:[1,0,0]
    v_pk_fma_f32 v[94:95], v[94:95], v[54:55], v[54:55] op_sel_hi:[1,0,0]
    v_pk_fma_f32 v[96:97], v[96:97], v[54:55], v[54:55] op_sel_hi:[1,0,0]
    v_pk_fma_f32 v[98:99], v[98:99], v[54:55], v[54:55] op_sel_hi:[1,0,0]
    v_pk_fma_f32 v[100:101], v[100:101], v[54:55], v[54:55] op_sel_hi:[1,0,0]
    v_pk_fma_f32 v[102:103], v[102:103], v[54:55], v[54:55] op_sel_hi:[1,0,0]
    v_rcp_f32 v80, v80
    v_rcp_f32 v81, v81
    v_rcp_f32 v82, v82
    v_rcp_f32 v83, v83
    v_rcp_f32 v84, v84
    v_rcp_f32 v85, v85
    v_rcp_f32 v86, v86
    v_rcp_f32 v87, v87
    v_rcp_f32 v88, v88
    v_rcp_f32 v89, v89
    v_rcp_f32 v90, v90
    v_rcp_f32 v91, v91
    v_rcp_f32 v92, v92
    v_rcp_f32 v93, v93
    v_rcp_f32 v94, v94
    v_rcp_f32 v95, v95
    v_rcp_f32 v96, v96
    v_rcp_f32 v97, v97
    v_rcp_f32 v98, v98
    v_rcp_f32 v99, v99
    v_rcp_f32 v100, v100
    v_rcp_f32 v101, v101
    v_rcp_f32 v102, v102
    v_rcp_f32 v103, v103
    v_pk_mul_f32 v[176:177], v[176:177], v[80:81]
    v_pk_mul_f32 v[178:179], v[178:179], v[82:83]
    v_pk_mul_f32 v[180:181], v[180:181], v[84:85]
    v_pk_mul_f32 v[182:183], v[182:183], v[86:87]
    v_pk_mul_f32 v[184:185], v[184:185], v[88:89]
    v_pk_mul_f32 v[186:187], v[186:187], v[90:91]
    v_pk_mul_f32 v[188:189], v[188:189], v[92:93]
    v_pk_mul_f32 v[190:191], v[190:191], v[94:95]
    v_pk_mul_f32 v[192:193], v[192:193], v[96:97]
    v_pk_mul_f32 v[194:195], v[194:195], v[98:99]
    v_pk_mul_f32 v[196:197], v[196:197], v[100:101]
    v_pk_mul_f32 v[198:199], v[198:199], v[102:103]
    v_cvt_pk_bf16_f32 v216, v176, v177
    v_cvt_pk_bf16_f32 v217, v178, v179
    v_cvt_pk_bf16_f32 v218, v180, v181
    v_cvt_pk_bf16_f32 v219, v182, v183
    v_cvt_pk_bf16_f32 v220, v184, v185
    v_cvt_pk_bf16_f32 v221, v186, v187
    v_cvt_pk_bf16_f32 v222, v188, v189
    v_cvt_pk_bf16_f32 v223, v190, v191
    v_cvt_pk_bf16_f32 v224, v192, v193
    v_cvt_pk_bf16_f32 v225, v194, v195
    v_cvt_pk_bf16_f32 v226, v196, v197
    v_cvt_pk_bf16_f32 v227, v198, v199
    v_permlane16_swap_b32 v216, v218
    v_permlane16_swap_b32 v217, v219
    v_permlane16_swap_b32 v220, v222
    v_permlane16_swap_b32 v221, v223
    v_permlane16_swap_b32 v224, v226
    v_permlane16_swap_b32 v225, v227
    ds_write_b128 v33, v[216:219] offset:4096
    ds_write_b128 v33, v[220:223] offset:5120
    ds_write_b128 v33, v[224:227] offset:6144
    v_lshlrev_b32 v44, 4, v1
    v_add_u32 v45, 28672, v44
    s_lshl_b32 s7, s4, 7
    s_add_u32 s56, s7, 29696
    s_add_u32 s57, s7, s43
    buffer_load_dwordx4 v[248:251], v31, s[8:11], s56 offen offset:0 sc1
    buffer_load_dwordx4 v[252:255], v31, s[8:11], s56 offen offset:64 sc1
    s_cmp_eq_u32 s40, 0
    s_mov_b32 s7, 41943040
    s_cselect_b32 s7, 13631488, s7
    s_lshl_b32 s6, s3, 16
    s_add_u32 s6, s6, s7
    s_lshl_b32 s7, s5, 22
    s_add_u32 s36, s6, s7
    s_lshl_b32 s7, s4, 11
    s_add_u32 s36, s36, s7
    s_add_u32 s37, s36, 2097152
    s_lshl_b32 s7, s4, 21
    s_add_u32 s38, s6, s7
    s_add_u32 s38, s38, s63
    s_lshr_b32 s7, s4, 1
    s_lshl_b32 s7, s7, 5
    v_add_u32 v32, s7, v37
    s_waitcnt lgkmcnt(0)
    s_barrier
    ds_read_b128 v[112:115], v45 offset:0
    ds_read_b128 v[116:119], v45 offset:1024
    ds_read_b128 v[120:123], v45 offset:2048
    ds_read_b128 v[124:127], v45 offset:3072
    ds_read_b128 v[128:131], v45 offset:4096
    ds_read_b128 v[132:135], v45 offset:5120
    ds_read_b128 v[136:139], v45 offset:6144
    ds_read_b128 v[140:143], v45 offset:7168
    ds_read_b128 v[144:147], v45 offset:8192
    ds_read_b128 v[148:151], v45 offset:9216
    ds_read_b128 v[152:155], v45 offset:10240
    ds_read_b128 v[156:159], v45 offset:11264
    ds_read_b128 v[160:163], v45 offset:12288
    ds_read_b128 v[164:167], v45 offset:13312
    s_waitcnt lgkmcnt(13)
    v_mfma_f32_16x16x32_bf16 v[48:51], a[0:3], v[112:115], 0
    ds_read_b128 v[168:171], v45 offset:14336
    v_mfma_f32_16x16x32_bf16 v[52:55], a[4:7], v[112:115], 0
    v_mfma_f32_16x16x32_bf16 v[56:59], a[8:11], v[112:115], 0
    v_mfma_f32_16x16x32_bf16 v[60:63], a[12:15], v[112:115], 0
    v_mfma_f32_16x16x32_bf16 v[64:67], a[16:19], v[112:115], 0
    v_mfma_f32_16x16x32_bf16 v[68:71], a[20:23], v[112:115], 0
    v_mfma_f32_16x16x32_bf16 v[72:75], a[24:27], v[112:115], 0
    v_mfma_f32_16x16x32_bf16 v[76:79], a[28:31], v[112:115], 0
    s_waitcnt lgkmcnt(13)
    v_mfma_f32_16x16x32_bf16 v[48:51], a[32:35], v[116:119], v[48:51]
    ds_read_b128 v[172:175], v45 offset:15360
    v_mfma_f32_16x16x32_bf16 v[52:55], a[36:39], v[116:119], v[52:55]
    v_mfma_f32_16x16x32_bf16 v[56:59], a[40:43], v[116:119], v[56:59]
    v_mfma_f32_16x16x32_bf16 v[60:63], a[44:47], v[116:119], v[60:63]
    v_mfma_f32_16x16x32_bf16 v[64:67], a[48:51], v[116:119], v[64:67]
    v_mfma_f32_16x16x32_bf16 v[68:71], a[52:55], v[116:119], v[68:71]
    v_mfma_f32_16x16x32_bf16 v[72:75], a[56:59], v[116:119], v[72:75]
    v_mfma_f32_16x16x32_bf16 v[76:79], a[60:63], v[116:119], v[76:79]
    s_waitcnt lgkmcnt(13)
    v_mfma_f32_16x16x32_bf16 v[48:51], a[64:67], v[120:123], v[48:51]
    ds_read_b128 v[176:179], v45 offset:16384
    v_mfma_f32_16x16x32_bf16 v[52:55], a[68:71], v[120:123], v[52:55]
    v_mfma_f32_16x16x32_bf16 v[56:59], a[72:75], v[120:123], v[56:59]
    v_mfma_f32_16x16x32_bf16 v[60:63], a[76:79], v[120:123], v[60:63]
    v_mfma_f32_16x16x32_bf16 v[64:67], a[80:83], v[120:123], v[64:67]
    v_mfma_f32_16x16x32_bf16 v[68:71], a[84:87], v[120:123], v[68:71]
    v_mfma_f32_16x16x32_bf16 v[72:75], a[88:91], v[120:123], v[72:75]
    v_mfma_f32_16x16x32_bf16 v[76:79], a[92:95], v[120:123], v[76:79]
    s_waitcnt lgkmcnt(13)
    v_mfma_f32_16x16x32_bf16 v[48:51], a[96:99], v[124:127], v[48:51]
    ds_read_b128 v[180:183], v45 offset:17408
    v_mfma_f32_16x16x32_bf16 v[52:55], a[100:103], v[124:127], v[52:55]
    v_mfma_f32_16x16x32_bf16 v[56:59], a[104:107], v[124:127], v[56:59]
    v_mfma_f32_16x16x32_bf16 v[60:63], a[108:111], v[124:127], v[60:63]
    v_mfma_f32_16x16x32_bf16 v[64:67], a[112:115], v[124:127], v[64:67]
    v_mfma_f32_16x16x32_bf16 v[68:71], a[116:119], v[124:127], v[68:71]
    v_mfma_f32_16x16x32_bf16 v[72:75], a[120:123], v[124:127], v[72:75]
    v_mfma_f32_16x16x32_bf16 v[76:79], a[124:127], v[124:127], v[76:79]
    s_waitcnt lgkmcnt(13)
    v_mfma_f32_16x16x32_bf16 v[48:51], a[128:131], v[128:131], v[48:51]
    ds_read_b128 v[184:187], v45 offset:18432
    v_mfma_f32_16x16x32_bf16 v[52:55], a[132:135], v[128:131], v[52:55]
    v_mfma_f32_16x16x32_bf16 v[56:59], a[136:139], v[128:131], v[56:59]
    v_mfma_f32_16x16x32_bf16 v[60:63], a[140:143], v[128:131], v[60:63]
    v_mfma_f32_16x16x32_bf16 v[64:67], a[144:147], v[128:131], v[64:67]
    v_mfma_f32_16x16x32_bf16 v[68:71], a[148:151], v[128:131], v[68:71]
    v_mfma_f32_16x16x32_bf16 v[72:75], a[152:155], v[128:131], v[72:75]
    v_mfma_f32_16x16x32_bf16 v[76:79], a[156:159], v[128:131], v[76:79]
    s_waitcnt lgkmcnt(13)
    v_mfma_f32_16x16x32_bf16 v[48:51], a[160:163], v[132:135], v[48:51]
    ds_read_b128 v[188:191], v45 offset:19456
    v_mfma_f32_16x16x32_bf16 v[52:55], a[164:167], v[132:135], v[52:55]
    v_mfma_f32_16x16x32_bf16 v[56:59], a[168:171], v[132:135], v[56:59]
    v_mfma_f32_16x16x32_bf16 v[60:63], a[172:175], v[132:135], v[60:63]
    v_mfma_f32_16x16x32_bf16 v[64:67], a[176:179], v[132:135], v[64:67]
    v_mfma_f32_16x16x32_bf16 v[68:71], a[180:183], v[132:135], v[68:71]
    v_mfma_f32_16x16x32_bf16 v[72:75], a[184:187], v[132:135], v[72:75]
    v_mfma_f32_16x16x32_bf16 v[76:79], a[188:191], v[132:135], v[76:79]
    s_waitcnt lgkmcnt(13)
    v_mfma_f32_16x16x32_bf16 v[48:51], a[192:195], v[136:139], v[48:51]
    ds_read_b128 v[192:195], v45 offset:20480
    v_mfma_f32_16x16x32_bf16 v[52:55], a[196:199], v[136:139], v[52:55]
    v_mfma_f32_16x16x32_bf16 v[56:59], a[200:203], v[136:139], v[56:59]
    v_mfma_f32_16x16x32_bf16 v[60:63], a[204:207], v[136:139], v[60:63]
    v_mfma_f32_16x16x32_bf16 v[64:67], a[208:211], v[136:139], v[64:67]
    v_mfma_f32_16x16x32_bf16 v[68:71], a[212:215], v[136:139], v[68:71]
    v_mfma_f32_16x16x32_bf16 v[72:75], a[216:219], v[136:139], v[72:75]
    v_mfma_f32_16x16x32_bf16 v[76:79], a[220:223], v[136:139], v[76:79]
    s_waitcnt lgkmcnt(13)
    v_mfma_f32_16x16x32_bf16 v[80:83], a[0:3], v[140:143], 0
    ds_read_b128 v[196:199], v45 offset:21504
    v_mfma_f32_16x16x32_bf16 v[84:87], a[4:7], v[140:143], 0
    v_mfma_f32_16x16x32_bf16 v[88:91], a[8:11], v[140:143], 0
    v_mfma_f32_16x16x32_bf16 v[92:95], a[12:15], v[140:143], 0
    v_mfma_f32_16x16x32_bf16 v[96:99], a[16:19], v[140:143], 0
    v_cvt_pk_bf16_f32 v224, v48, v49
    v_mfma_f32_16x16x32_bf16 v[100:103], a[20:23], v[140:143], 0
    v_cvt_pk_bf16_f32 v225, v50, v51
    v_mfma_f32_16x16x32_bf16 v[104:107], a[24:27], v[140:143], 0
    v_cvt_pk_bf16_f32 v226, v52, v53
    v_mfma_f32_16x16x32_bf16 v[108:111], a[28:31], v[140:143], 0
    v_cvt_pk_bf16_f32 v227, v54, v55
    s_waitcnt lgkmcnt(13)
    v_mfma_f32_16x16x32_bf16 v[80:83], a[32:35], v[144:147], v[80:83]
    ds_read_b128 v[200:203], v45 offset:22528
    v_permlane16_swap_b32 v224, v226
    v_mfma_f32_16x16x32_bf16 v[84:87], a[36:39], v[144:147], v[84:87]
    v_permlane16_swap_b32 v225, v227
    v_mfma_f32_16x16x32_bf16 v[88:91], a[40:43], v[144:147], v[88:91]
    v_cvt_pk_bf16_f32 v228, v56, v57
    v_mfma_f32_16x16x32_bf16 v[92:95], a[44:47], v[144:147], v[92:95]
    v_cvt_pk_bf16_f32 v229, v58, v59
    v_mfma_f32_16x16x32_bf16 v[96:99], a[48:51], v[144:147], v[96:99]
    v_cvt_pk_bf16_f32 v230, v60, v61
    v_mfma_f32_16x16x32_bf16 v[100:103], a[52:55], v[144:147], v[100:103]
    v_cvt_pk_bf16_f32 v231, v62, v63
    v_mfma_f32_16x16x32_bf16 v[104:107], a[56:59], v[144:147], v[104:107]
    v_permlane16_swap_b32 v228, v230
    v_mfma_f32_16x16x32_bf16 v[108:111], a[60:63], v[144:147], v[108:111]
    v_permlane16_swap_b32 v229, v231
    s_waitcnt lgkmcnt(13)
    v_mfma_f32_16x16x32_bf16 v[80:83], a[64:67], v[148:151], v[80:83]
    ds_read_b128 v[204:207], v45 offset:23552
    v_cvt_pk_bf16_f32 v232, v64, v65
    v_mfma_f32_16x16x32_bf16 v[84:87], a[68:71], v[148:151], v[84:87]
    v_cvt_pk_bf16_f32 v233, v66, v67
    v_mfma_f32_16x16x32_bf16 v[88:91], a[72:75], v[148:151], v[88:91]
    v_cvt_pk_bf16_f32 v234, v68, v69
    v_mfma_f32_16x16x32_bf16 v[92:95], a[76:79], v[148:151], v[92:95]
    v_cvt_pk_bf16_f32 v235, v70, v71
    v_mfma_f32_16x16x32_bf16 v[96:99], a[80:83], v[148:151], v[96:99]
    v_permlane16_swap_b32 v232, v234
    v_mfma_f32_16x16x32_bf16 v[100:103], a[84:87], v[148:151], v[100:103]
    v_permlane16_swap_b32 v233, v235
    v_mfma_f32_16x16x32_bf16 v[104:107], a[88:91], v[148:151], v[104:107]
    v_cvt_pk_bf16_f32 v236, v72, v73
    v_mfma_f32_16x16x32_bf16 v[108:111], a[92:95], v[148:151], v[108:111]
    v_cvt_pk_bf16_f32 v237, v74, v75
    s_waitcnt lgkmcnt(13)
    v_mfma_f32_16x16x32_bf16 v[80:83], a[96:99], v[152:155], v[80:83]
    ds_read_b128 v[208:211], v45 offset:24576
    v_cvt_pk_bf16_f32 v238, v76, v77
    v_mfma_f32_16x16x32_bf16 v[84:87], a[100:103], v[152:155], v[84:87]
    v_cvt_pk_bf16_f32 v239, v78, v79
    v_mfma_f32_16x16x32_bf16 v[88:91], a[104:107], v[152:155], v[88:91]
    v_permlane16_swap_b32 v236, v238
    v_mfma_f32_16x16x32_bf16 v[92:95], a[108:111], v[152:155], v[92:95]
    v_permlane16_swap_b32 v237, v239
    v_mfma_f32_16x16x32_bf16 v[96:99], a[112:115], v[152:155], v[96:99]
    v_mfma_f32_16x16x32_bf16 v[100:103], a[116:119], v[152:155], v[100:103]
    v_mfma_f32_16x16x32_bf16 v[104:107], a[120:123], v[152:155], v[104:107]
    v_mfma_f32_16x16x32_bf16 v[108:111], a[124:127], v[152:155], v[108:111]
    s_waitcnt lgkmcnt(13)
    v_mfma_f32_16x16x32_bf16 v[80:83], a[128:131], v[156:159], v[80:83]
    ds_read_b128 v[212:215], v45 offset:25600
    s_cmp_lg_u32 s40, 0
    s_cbranch_scc1 T_S12
    buffer_store_dwordx4 v[224:227], v44, s[8:11], s36 offen offset:0
    buffer_store_dwordx4 v[228:231], v44, s[8:11], s36 offen offset:1024
    buffer_store_dwordx4 v[232:235], v44, s[8:11], s37 offen offset:0
    buffer_store_dwordx4 v[236:239], v44, s[8:11], s37 offen offset:1024
    s_branch T_D12
T_S12:
    buffer_store_dwordx4 v[224:227], v44, s[8:11], s36 offen offset:0 sc1
    buffer_store_dwordx4 v[228:231], v44, s[8:11], s36 offen offset:1024 sc1
    buffer_store_dwordx4 v[232:235], v44, s[8:11], s37 offen offset:0 sc1
    buffer_store_dwordx4 v[236:239], v44, s[8:11], s37 offen offset:1024 sc1
T_D12:
    s_add_u32 s36, s36, 16384
    s_add_u32 s37, s37, 16384
    v_mfma_f32_16x16x32_bf16 v[84:87], a[132:135], v[156:159], v[84:87]
    v_mfma_f32_16x16x32_bf16 v[88:91], a[136:139], v[156:159], v[88:91]
    v_mfma_f32_16x16x32_bf16 v[92:95], a[140:143], v[156:159], v[92:95]
    v_mfma_f32_16x16x32_bf16 v[96:99], a[144:147], v[156:159], v[96:99]
    v_mfma_f32_16x16x32_bf16 v[100:103], a[148:151], v[156:159], v[100:103]
    v_mfma_f32_16x16x32_bf16 v[104:107], a[152:155], v[156:159], v[104:107]
    v_mfma_f32_16x16x32_bf16 v[108:111], a[156:159], v[156:159], v[108:111]
    s_waitcnt lgkmcnt(13)
    v_mfma_f32_16x16x32_bf16 v[80:83], a[160:163], v[160:163], v[80:83]
    ds_read_b128 v[216:219], v45 offset:26624
    v_mfma_f32_16x16x32_bf16 v[84:87], a[164:167], v[160:163], v[84:87]
    v_mfma_f32_16x16x32_bf16 v[88:91], a[168:171], v[160:163], v[88:91]
    v_mfma_f32_16x16x32_bf16 v[92:95], a[172:175], v[160:163], v[92:95]
    v_mfma_f32_16x16x32_bf16 v[96:99], a[176:179], v[160:163], v[96:99]
    v_mfma_f32_16x16x32_bf16 v[100:103], a[180:183], v[160:163], v[100:103]
    v_mfma_f32_16x16x32_bf16 v[104:107], a[184:187], v[160:163], v[104:107]
    v_mfma_f32_16x16x32_bf16 v[108:111], a[188:191], v[160:163], v[108:111]
    s_waitcnt lgkmcnt(13)
    v_mfma_f32_16x16x32_bf16 v[80:83], a[192:195], v[164:167], v[80:83]
    ds_read_b128 v[220:223], v45 offset:27648
    v_mfma_f32_16x16x32_bf16 v[84:87], a[196:199], v[164:167], v[84:87]
    v_mfma_f32_16x16x32_bf16 v[88:91], a[200:203], v[164:167], v[88:91]
    v_mfma_f32_16x16x32_bf16 v[92:95], a[204:207], v[164:167], v[92:95]
    v_mfma_f32_16x16x32_bf16 v[96:99], a[208:211], v[164:167], v[96:99]
    v_mfma_f32_16x16x32_bf16 v[100:103], a[212:215], v[164:167], v[100:103]
    v_mfma_f32_16x16x32_bf16 v[104:107], a[216:219], v[164:167], v[104:107]
    v_mfma_f32_16x16x32_bf16 v[108:111], a[220:223], v[164:167], v[108:111]
    s_waitcnt lgkmcnt(13)
    v_mfma_f32_16x16x32_bf16 v[48:51], a[0:3], v[168:171], 0
    v_mfma_f32_16x16x32_bf16 v[52:55], a[4:7], v[168:171], 0
    v_mfma_f32_16x16x32_bf16 v[56:59], a[8:11], v[168:171], 0
    v_mfma_f32_16x16x32_bf16 v[60:63], a[12:15], v[168:171], 0
    v_mfma_f32_16x16x32_bf16 v[64:67], a[16:19], v[168:171], 0
    v_cvt_pk_bf16_f32 v224, v80, v81
    v_mfma_f32_16x16x32_bf16 v[68:71], a[20:23], v[168:171], 0
    v_cvt_pk_bf16_f32 v225, v82, v83
    v_mfma_f32_16x16x32_bf16 v[72:75], a[24:27], v[168:171], 0
    v_cvt_pk_bf16_f32 v226, v84, v85
    v_mfma_f32_16x16x32_bf16 v[76:79], a[28:31], v[168:171], 0
    v_cvt_pk_bf16_f32 v227, v86, v87
    s_waitcnt lgkmcnt(12)
    v_mfma_f32_16x16x32_bf16 v[48:51], a[32:35], v[172:175], v[48:51]
    v_permlane16_swap_b32 v224, v226
    v_mfma_f32_16x16x32_bf16 v[52:55], a[36:39], v[172:175], v[52:55]
    v_permlane16_swap_b32 v225, v227
    v_mfma_f32_16x16x32_bf16 v[56:59], a[40:43], v[172:175], v[56:59]
    v_cvt_pk_bf16_f32 v228, v88, v89
    v_mfma_f32_16x16x32_bf16 v[60:63], a[44:47], v[172:175], v[60:63]
    v_cvt_pk_bf16_f32 v229, v90, v91
    v_mfma_f32_16x16x32_bf16 v[64:67], a[48:51], v[172:175], v[64:67]
    v_cvt_pk_bf16_f32 v230, v92, v93
    v_mfma_f32_16x16x32_bf16 v[68:71], a[52:55], v[172:175], v[68:71]
    v_cvt_pk_bf16_f32 v231, v94, v95
    v_mfma_f32_16x16x32_bf16 v[72:75], a[56:59], v[172:175], v[72:75]
    v_permlane16_swap_b32 v228, v230
    v_mfma_f32_16x16x32_bf16 v[76:79], a[60:63], v[172:175], v[76:79]
    v_permlane16_swap_b32 v229, v231
    s_waitcnt lgkmcnt(11)
    v_mfma_f32_16x16x32_bf16 v[48:51], a[64:67], v[176:179], v[48:51]
    v_cvt_pk_bf16_f32 v232, v96, v97
    v_mfma_f32_16x16x32_bf16 v[52:55], a[68:71], v[176:179], v[52:55]
    v_cvt_pk_bf16_f32 v233, v98, v99
    v_mfma_f32_16x16x32_bf16 v[56:59], a[72:75], v[176:179], v[56:59]
    v_cvt_pk_bf16_f32 v234, v100, v101
    v_mfma_f32_16x16x32_bf16 v[60:63], a[76:79], v[176:179], v[60:63]
    v_cvt_pk_bf16_f32 v235, v102, v103
    v_mfma_f32_16x16x32_bf16 v[64:67], a[80:83], v[176:179], v[64:67]
    v_permlane16_swap_b32 v232, v234
    v_mfma_f32_16x16x32_bf16 v[68:71], a[84:87], v[176:179], v[68:71]
    v_permlane16_swap_b32 v233, v235
    v_mfma_f32_16x16x32_bf16 v[72:75], a[88:91], v[176:179], v[72:75]
    v_cvt_pk_bf16_f32 v236, v104, v105
    v_mfma_f32_16x16x32_bf16 v[76:79], a[92:95], v[176:179], v[76:79]
    v_cvt_pk_bf16_f32 v237, v106, v107
    s_waitcnt lgkmcnt(10)
    v_mfma_f32_16x16x32_bf16 v[48:51], a[96:99], v[180:183], v[48:51]
    v_cvt_pk_bf16_f32 v238, v108, v109
    v_mfma_f32_16x16x32_bf16 v[52:55], a[100:103], v[180:183], v[52:55]
    v_cvt_pk_bf16_f32 v239, v110, v111
    v_mfma_f32_16x16x32_bf16 v[56:59], a[104:107], v[180:183], v[56:59]
    v_permlane16_swap_b32 v236, v238
    v_mfma_f32_16x16x32_bf16 v[60:63], a[108:111], v[180:183], v[60:63]
    v_permlane16_swap_b32 v237, v239
    v_mfma_f32_16x16x32_bf16 v[64:67], a[112:115], v[180:183], v[64:67]
    v_mfma_f32_16x16x32_bf16 v[68:71], a[116:119], v[180:183], v[68:71]
    v_mfma_f32_16x16x32_bf16 v[72:75], a[120:123], v[180:183], v[72:75]
    v_mfma_f32_16x16x32_bf16 v[76:79], a[124:127], v[180:183], v[76:79]
    s_waitcnt lgkmcnt(9)
    v_mfma_f32_16x16x32_bf16 v[48:51], a[128:131], v[184:187], v[48:51]
    s_cmp_lg_u32 s40, 0
    s_cbranch_scc1 T_S13
    buffer_store_dwordx4 v[224:227], v44, s[8:11], s36 offen offset:0
    buffer_store_dwordx4 v[228:231], v44, s[8:11], s36 offen offset:1024
    buffer_store_dwordx4 v[232:235], v44, s[8:11], s37 offen offset:0
    buffer_store_dwordx4 v[236:239], v44, s[8:11], s37 offen offset:1024
    s_branch T_D13
T_S13:
    buffer_store_dwordx4 v[224:227], v44, s[8:11], s36 offen offset:0 sc1
    buffer_store_dwordx4 v[228:231], v44, s[8:11], s36 offen offset:1024 sc1
    buffer_store_dwordx4 v[232:235], v44, s[8:11], s37 offen offset:0 sc1
    buffer_store_dwordx4 v[236:239], v44, s[8:11], s37 offen offset:1024 sc1
T_D13:
    s_add_u32 s36, s36, 16384
    s_add_u32 s37, s37, 16384
    v_mfma_f32_16x16x32_bf16 v[52:55], a[132:135], v[184:187], v[52:55]
    v_mfma_f32_16x16x32_bf16 v[56:59], a[136:139], v[184:187], v[56:59]
    v_mfma_f32_16x16x32_bf16 v[60:63], a[140:143], v[184:187], v[60:63]
    v_mfma_f32_16x16x32_bf16 v[64:67], a[144:147], v[184:187], v[64:67]
    v_mfma_f32_16x16x32_bf16 v[68:71], a[148:151], v[184:187], v[68:71]
    v_mfma_f32_16x16x32_bf16 v[72:75], a[152:155], v[184:187], v[72:75]
    v_mfma_f32_16x16x32_bf16 v[76:79], a[156:159], v[184:187], v[76:79]
    s_waitcnt lgkmcnt(8)
    v_mfma_f32_16x16x32_bf16 v[48:51], a[160:163], v[188:191], v[48:51]
    v_mfma_f32_16x16x32_bf16 v[52:55], a[164:167], v[188:191], v[52:55]
    v_mfma_f32_16x16x32_bf16 v[56:59], a[168:171], v[188:191], v[56:59]
    v_mfma_f32_16x16x32_bf16 v[60:63], a[172:175], v[188:191], v[60:63]
    v_mfma_f32_16x16x32_bf16 v[64:67], a[176:179], v[188:191], v[64:67]
    v_mfma_f32_16x16x32_bf16 v[68:71], a[180:183], v[188:191], v[68:71]
    v_mfma_f32_16x16x32_bf16 v[72:75], a[184:187], v[188:191], v[72:75]
    v_mfma_f32_16x16x32_bf16 v[76:79], a[188:191], v[188:191], v[76:79]
    s_waitcnt lgkmcnt(7)
    v_mfma_f32_16x16x32_bf16 v[48:51], a[192:195], v[192:195], v[48:51]
    v_mfma_f32_16x16x32_bf16 v[52:55], a[196:199], v[192:195], v[52:55]
    v_mfma_f32_16x16x32_bf16 v[56:59], a[200:203], v[192:195], v[56:59]
    v_mfma_f32_16x16x32_bf16 v[60:63], a[204:207], v[192:195], v[60:63]
    v_mfma_f32_16x16x32_bf16 v[64:67], a[208:211], v[192:195], v[64:67]
    v_mfma_f32_16x16x32_bf16 v[68:71], a[212:215], v[192:195], v[68:71]
    v_mfma_f32_16x16x32_bf16 v[72:75], a[216:219], v[192:195], v[72:75]
    v_mfma_f32_16x16x32_bf16 v[76:79], a[220:223], v[192:195], v[76:79]
    s_waitcnt lgkmcnt(6)
    v_mfma_f32_16x16x32_bf16 v[80:83], a[0:3], v[196:199], 0
    v_mfma_f32_16x16x32_bf16 v[84:87], a[4:7], v[196:199], 0
    v_mfma_f32_16x16x32_bf16 v[88:91], a[8:11], v[196:199], 0
    v_mfma_f32_16x16x32_bf16 v[92:95], a[12:15], v[196:199], 0
    v_mfma_f32_16x16x32_bf16 v[96:99], a[16:19], v[196:199], 0
    v_cvt_pk_bf16_f32 v224, v48, v49
    v_mfma_f32_16x16x32_bf16 v[100:103], a[20:23], v[196:199], 0
    v_cvt_pk_bf16_f32 v225, v50, v51
    v_mfma_f32_16x16x32_bf16 v[104:107], a[24:27], v[196:199], 0
    v_cvt_pk_bf16_f32 v226, v52, v53
    v_mfma_f32_16x16x32_bf16 v[108:111], a[28:31], v[196:199], 0
    v_cvt_pk_bf16_f32 v227, v54, v55
    s_waitcnt lgkmcnt(5)
    v_mfma_f32_16x16x32_bf16 v[80:83], a[32:35], v[200:203], v[80:83]
    v_permlane16_swap_b32 v224, v226
    v_mfma_f32_16x16x32_bf16 v[84:87], a[36:39], v[200:203], v[84:87]
    v_permlane16_swap_b32 v225, v227
    v_mfma_f32_16x16x32_bf16 v[88:91], a[40:43], v[200:203], v[88:91]
    v_cvt_pk_bf16_f32 v228, v56, v57
    v_mfma_f32_16x16x32_bf16 v[92:95], a[44:47], v[200:203], v[92:95]
    v_cvt_pk_bf16_f32 v229, v58, v59
    v_mfma_f32_16x16x32_bf16 v[96:99], a[48:51], v[200:203], v[96:99]
    v_cvt_pk_bf16_f32 v230, v60, v61
    v_mfma_f32_16x16x32_bf16 v[100:103], a[52:55], v[200:203], v[100:103]
    v_cvt_pk_bf16_f32 v231, v62, v63
    v_mfma_f32_16x16x32_bf16 v[104:107], a[56:59], v[200:203], v[104:107]
    v_permlane16_swap_b32 v228, v230
    v_mfma_f32_16x16x32_bf16 v[108:111], a[60:63], v[200:203], v[108:111]
    v_permlane16_swap_b32 v229, v231
    s_waitcnt lgkmcnt(4)
    v_mfma_f32_16x16x32_bf16 v[80:83], a[64:67], v[204:207], v[80:83]
    v_cvt_pk_bf16_f32 v232, v64, v65
    v_mfma_f32_16x16x32_bf16 v[84:87], a[68:71], v[204:207], v[84:87]
    v_cvt_pk_bf16_f32 v233, v66, v67
    v_mfma_f32_16x16x32_bf16 v[88:91], a[72:75], v[204:207], v[88:91]
    v_cvt_pk_bf16_f32 v234, v68, v69
    v_mfma_f32_16x16x32_bf16 v[92:95], a[76:79], v[204:207], v[92:95]
    v_cvt_pk_bf16_f32 v235, v70, v71
    v_mfma_f32_16x16x32_bf16 v[96:99], a[80:83], v[204:207], v[96:99]
    v_permlane16_swap_b32 v232, v234
    v_mfma_f32_16x16x32_bf16 v[100:103], a[84:87], v[204:207], v[100:103]
    v_permlane16_swap_b32 v233, v235
    v_mfma_f32_16x16x32_bf16 v[104:107], a[88:91], v[204:207], v[104:107]
    v_cvt_pk_bf16_f32 v236, v72, v73
    v_mfma_f32_16x16x32_bf16 v[108:111], a[92:95], v[204:207], v[108:111]
    v_cvt_pk_bf16_f32 v237, v74, v75
    s_waitcnt lgkmcnt(3)
    v_mfma_f32_16x16x32_bf16 v[80:83], a[96:99], v[208:211], v[80:83]
    v_cvt_pk_bf16_f32 v238, v76, v77
    v_mfma_f32_16x16x32_bf16 v[84:87], a[100:103], v[208:211], v[84:87]
    v_cvt_pk_bf16_f32 v239, v78, v79
    v_mfma_f32_16x16x32_bf16 v[88:91], a[104:107], v[208:211], v[88:91]
    v_permlane16_swap_b32 v236, v238
    v_mfma_f32_16x16x32_bf16 v[92:95], a[108:111], v[208:211], v[92:95]
    v_permlane16_swap_b32 v237, v239
    v_mfma_f32_16x16x32_bf16 v[96:99], a[112:115], v[208:211], v[96:99]
    v_mfma_f32_16x16x32_bf16 v[100:103], a[116:119], v[208:211], v[100:103]
    v_mfma_f32_16x16x32_bf16 v[104:107], a[120:123], v[208:211], v[104:107]
    v_mfma_f32_16x16x32_bf16 v[108:111], a[124:127], v[208:211], v[108:111]
    s_waitcnt lgkmcnt(2)
    v_mfma_f32_16x16x32_bf16 v[80:83], a[128:131], v[212:215], v[80:83]
    s_cmp_lg_u32 s40, 0
    s_cbranch_scc1 T_S14
    buffer_store_dwordx4 v[224:227], v44, s[8:11], s36 offen offset:0
    buffer_store_dwordx4 v[228:231], v44, s[8:11], s36 offen offset:1024
    buffer_store_dwordx4 v[232:235], v44, s[8:11], s37 offen offset:0
    buffer_store_dwordx4 v[236:239], v44, s[8:11], s37 offen offset:1024
    s_branch T_D14
T_S14:
    buffer_store_dwordx4 v[224:227], v44, s[8:11], s36 offen offset:0 sc1
    buffer_store_dwordx4 v[228:231], v44, s[8:11], s36 offen offset:1024 sc1
    buffer_store_dwordx4 v[232:235], v44, s[8:11], s37 offen offset:0 sc1
    buffer_store_dwordx4 v[236:239], v44, s[8:11], s37 offen offset:1024 sc1
T_D14:
    s_add_u32 s36, s36, 16384
    s_add_u32 s37, s37, 16384
    v_mfma_f32_16x16x32_bf16 v[84:87], a[132:135], v[212:215], v[84:87]
    v_mfma_f32_16x16x32_bf16 v[88:91], a[136:139], v[212:215], v[88:91]
    v_mfma_f32_16x16x32_bf16 v[92:95], a[140:143], v[212:215], v[92:95]
    v_mfma_f32_16x16x32_bf16 v[96:99], a[144:147], v[212:215], v[96:99]
    v_mfma_f32_16x16x32_bf16 v[100:103], a[148:151], v[212:215], v[100:103]
    v_mfma_f32_16x16x32_bf16 v[104:107], a[152:155], v[212:215], v[104:107]
    v_mfma_f32_16x16x32_bf16 v[108:111], a[156:159], v[212:215], v[108:111]
    s_waitcnt lgkmcnt(1)
    v_mfma_f32_16x16x32_bf16 v[80:83], a[160:163], v[216:219], v[80:83]
    v_mfma_f32_16x16x32_bf16 v[84:87], a[164:167], v[216:219], v[84:87]
    v_mfma_f32_16x16x32_bf16 v[88:91], a[168:171], v[216:219], v[88:91]
    v_mfma_f32_16x16x32_bf16 v[92:95], a[172:175], v[216:219], v[92:95]
    v_mfma_f32_16x16x32_bf16 v[96:99], a[176:179], v[216:219], v[96:99]
    v_mfma_f32_16x16x32_bf16 v[100:103], a[180:183], v[216:219], v[100:103]
    v_mfma_f32_16x16x32_bf16 v[104:107], a[184:187], v[216:219], v[104:107]
    v_mfma_f32_16x16x32_bf16 v[108:111], a[188:191], v[216:219], v[108:111]
    s_waitcnt lgkmcnt(0)
    v_mfma_f32_16x16x32_bf16 v[80:83], a[192:195], v[220:223], v[80:83]
    v_mfma_f32_16x16x32_bf16 v[84:87], a[196:199], v[220:223], v[84:87]
    v_mfma_f32_16x16x32_bf16 v[88:91], a[200:203], v[220:223], v[88:91]
    v_mfma_f32_16x16x32_bf16 v[92:95], a[204:207], v[220:223], v[92:95]
    v_mfma_f32_16x16x32_bf16 v[96:99], a[208:211], v[220:223], v[96:99]
    v_mfma_f32_16x16x32_bf16 v[100:103], a[212:215], v[220:223], v[100:103]
    v_mfma_f32_16x16x32_bf16 v[104:107], a[216:219], v[220:223], v[104:107]
    v_mfma_f32_16x16x32_bf16 v[108:111], a[220:223], v[220:223], v[108:111]
    s_nop 0
    v_cvt_pk_bf16_f32 v224, v80, v81
    v_cvt_pk_bf16_f32 v225, v82, v83
    v_cvt_pk_bf16_f32 v226, v84, v85
    v_cvt_pk_bf16_f32 v227, v86, v87
    s_nop 0
    v_permlane16_swap_b32 v224, v226
    v_permlane16_swap_b32 v225, v227
    v_cvt_pk_bf16_f32 v228, v88, v89
    v_cvt_pk_bf16_f32 v229, v90, v91
    v_cvt_pk_bf16_f32 v230, v92, v93
    v_cvt_pk_bf16_f32 v231, v94, v95
    s_nop 0
    v_permlane16_swap_b32 v228, v230
    v_permlane16_swap_b32 v229, v231
    v_cvt_pk_bf16_f32 v232, v96, v97
    v_cvt_pk_bf16_f32 v233, v98, v99
    v_cvt_pk_bf16_f32 v234, v100, v101
    v_cvt_pk_bf16_f32 v235, v102, v103
    s_nop 0
    v_permlane16_swap_b32 v232, v234
    v_permlane16_swap_b32 v233, v235
    v_cvt_pk_bf16_f32 v236, v104, v105
    v_cvt_pk_bf16_f32 v237, v106, v107
    v_cvt_pk_bf16_f32 v238, v108, v109
    v_cvt_pk_bf16_f32 v239, v110, v111
    s_nop 0
    v_permlane16_swap_b32 v236, v238
    v_permlane16_swap_b32 v237, v239
    s_cmp_lg_u32 s40, 0
    s_cbranch_scc1 T_S15
    buffer_store_dwordx4 v[224:227], v44, s[8:11], s36 offen offset:0
    buffer_store_dwordx4 v[228:231], v44, s[8:11], s36 offen offset:1024
    buffer_store_dwordx4 v[232:235], v44, s[8:11], s37 offen offset:0
    buffer_store_dwordx4 v[236:239], v44, s[8:11], s37 offen offset:1024
    s_branch T_D15
T_S15:
    buffer_store_dwordx4 v[224:227], v44, s[8:11], s36 offen offset:0 sc1
    buffer_store_dwordx4 v[228:231], v44, s[8:11], s36 offen offset:1024 sc1
    buffer_store_dwordx4 v[232:235], v44, s[8:11], s37 offen offset:0 sc1
    buffer_store_dwordx4 v[236:239], v44, s[8:11], s37 offen offset:1024 sc1
T_D15:
    s_add_u32 s36, s36, 16384
    s_add_u32 s37, s37, 16384
    v_accvgpr_read_b32 v96, a224
    v_accvgpr_read_b32 v104, a232
    v_accvgpr_read_b32 v97, a225
    v_accvgpr_read_b32 v105, a233
    v_accvgpr_read_b32 v98, a226
    v_accvgpr_read_b32 v106, a234
    v_accvgpr_read_b32 v99, a227
    v_accvgpr_read_b32 v107, a235
    v_accvgpr_read_b32 v100, a228
    v_accvgpr_read_b32 v108, a236
    v_accvgpr_read_b32 v101, a229
    v_accvgpr_read_b32 v109, a237
    v_accvgpr_read_b32 v102, a230
    v_accvgpr_read_b32 v110, a238
    v_accvgpr_read_b32 v103, a231
    v_accvgpr_read_b32 v111, a239
    v_lshlrev_b32 v48, 16, v96
    v_and_b32 v49, 0xffff0000, v96
    v_lshlrev_b32 v50, 16, v97
    v_and_b32 v51, 0xffff0000, v97
    v_lshlrev_b32 v52, 16, v98
    v_and_b32 v53, 0xffff0000, v98
    v_lshlrev_b32 v54, 16, v99
    v_and_b32 v55, 0xffff0000, v99
    v_lshlrev_b32 v56, 16, v100
    v_and_b32 v57, 0xffff0000, v100
    v_lshlrev_b32 v58, 16, v101
    v_and_b32 v59, 0xffff0000, v101
    v_lshlrev_b32 v60, 16, v102
    v_and_b32 v61, 0xffff0000, v102
    v_lshlrev_b32 v62, 16, v103
    v_and_b32 v63, 0xffff0000, v103
    v_lshlrev_b32 v64, 16, v104
    v_and_b32 v65, 0xffff0000, v104
    v_lshlrev_b32 v66, 16, v105
    v_and_b32 v67, 0xffff0000, v105
    v_lshlrev_b32 v68, 16, v106
    v_and_b32 v69, 0xffff0000, v106
    v_lshlrev_b32 v70, 16, v107
    v_and_b32 v71, 0xffff0000, v107
    v_lshlrev_b32 v72, 16, v108
    v_and_b32 v73, 0xffff0000, v108
    v_lshlrev_b32 v74, 16, v109
    v_and_b32 v75, 0xffff0000, v109
    v_lshlrev_b32 v76, 16, v110
    v_and_b32 v77, 0xffff0000, v110
    v_lshlrev_b32 v78, 16, v111
    v_and_b32 v79, 0xffff0000, v111
    v_lshlrev_b32 v80, 16, v248
    v_and_b32 v81, 0xffff0000, v248
    v_lshlrev_b32 v82, 16, v249
    v_and_b32 v83, 0xffff0000, v249
    v_lshlrev_b32 v84, 16, v250
    v_and_b32 v85, 0xffff0000, v250
    v_lshlrev_b32 v86, 16, v251
    v_and_b32 v87, 0xffff0000, v251
    v_lshlrev_b32 v88, 16, v252
    v_and_b32 v89, 0xffff0000, v252
    v_lshlrev_b32 v90, 16, v253
    v_and_b32 v91, 0xffff0000, v253
    v_lshlrev_b32 v92, 16, v254
    v_and_b32 v93, 0xffff0000, v254
    v_lshlrev_b32 v94, 16, v255
    v_and_b32 v95, 0xffff0000, v255
    s_waitcnt vmcnt(0)
    s_cmp_lg_u32 s40, 0
    s_cbranch_scc1 T_S16
    buffer_store_dword v34, off, s[8:11], s52 offset:512
    s_branch T_D16
T_S16:
    buffer_store_dword v34, off, s[8:11], s52 offset:512 sc1
T_D16:
    s_mov_b32 s42, 30000
T_P17:
    buffer_load_dword v35, v32, s[8:11], s41 offen offset:512 sc1
T_W17:
    s_waitcnt vmcnt(0)
    v_cmp_eq_u32 vcc, 0, v35
    s_sub_u32 s42, s42, 1
    s_cbranch_vccz T_Q17
    s_cmp_lg_u32 s42, 0
    s_cbranch_scc1 T_P17
T_Q17:
    buffer_load_dwordx4 v[112:115], v44, s[8:11], s38 offen offset:0 sc1
    buffer_load_dwordx4 v[116:119], v44, s[8:11], s38 offen offset:1024 sc1
    buffer_load_dwordx4 v[120:123], v44, s[8:11], s38 offen offset:2048 sc1
    buffer_load_dwordx4 v[124:127], v44, s[8:11], s38 offen offset:3072 sc1
    s_add_u32 s38, s38, 4096
    buffer_load_dwordx4 v[128:131], v44, s[8:11], s38 offen offset:0 sc1
    buffer_load_dwordx4 v[132:135], v44, s[8:11], s38 offen offset:1024 sc1
    buffer_load_dwordx4 v[136:139], v44, s[8:11], s38 offen offset:2048 sc1
    buffer_load_dwordx4 v[140:143], v44, s[8:11], s38 offen offset:3072 sc1
    s_add_u32 s38, s38, 4096
    buffer_load_dwordx4 v[144:147], v44, s[8:11], s38 offen offset:0 sc1
    buffer_load_dwordx4 v[148:151], v44, s[8:11], s38 offen offset:1024 sc1
    buffer_load_dwordx4 v[152:155], v44, s[8:11], s38 offen offset:2048 sc1
    buffer_load_dwordx4 v[156:159], v44, s[8:11], s38 offen offset:3072 sc1
    s_add_u32 s38, s38, 4096
    buffer_load_dwordx4 v[160:163], v44, s[8:11], s38 offen offset:0 sc1
    buffer_load_dwordx4 v[164:167], v44, s[8:11], s38 offen offset:1024 sc1
    buffer_load_dwordx4 v[168:171], v44, s[8:11], s38 offen offset:2048 sc1
    buffer_load_dwordx4 v[172:175], v44, s[8:11], s38 offen offset:3072 sc1
    s_add_u32 s38, s38, 4096
    s_waitcnt vmcnt(14)
    v_lshlrev_b32 v176, 16, v112
    v_and_b32 v177, 0xffff0000, v112
    v_lshlrev_b32 v178, 16, v113
    v_and_b32 v179, 0xffff0000, v113
    v_lshlrev_b32 v180, 16, v114
    v_and_b32 v181, 0xffff0000, v114
    v_lshlrev_b32 v182, 16, v115
    v_and_b32 v183, 0xffff0000, v115
    v_lshlrev_b32 v184, 16, v116
    v_and_b32 v185, 0xffff0000, v116
    v_lshlrev_b32 v186, 16, v117
    v_and_b32 v187, 0xffff0000, v117
    v_lshlrev_b32 v188, 16, v118
    v_and_b32 v189, 0xffff0000, v118
    v_lshlrev_b32 v190, 16, v119
    v_and_b32 v191, 0xffff0000, v119
    v_pk_add_f32 v[64:65], v[64:65], v[176:177]
    v_pk_add_f32 v[66:67], v[66:67], v[178:179]
    v_pk_add_f32 v[68:69], v[68:69], v[180:181]
    v_pk_add_f32 v[70:71], v[70:71], v[182:183]
    v_pk_add_f32 v[72:73], v[72:73], v[184:185]
    v_pk_add_f32 v[74:75], v[74:75], v[186:187]
    v_pk_add_f32 v[76:77], v[76:77], v[188:189]
    v_pk_add_f32 v[78:79], v[78:79], v[190:191]
    s_waitcnt vmcnt(12)
    v_lshlrev_b32 v176, 16, v120
    v_and_b32 v177, 0xffff0000, v120
    v_lshlrev_b32 v178, 16, v121
    v_and_b32 v179, 0xffff0000, v121
    v_lshlrev_b32 v180, 16, v122
    v_and_b32 v181, 0xffff0000, v122
    v_lshlrev_b32 v182, 16, v123
    v_and_b32 v183, 0xffff0000, v123
    v_lshlrev_b32 v184, 16, v124
    v_and_b32 v185, 0xffff0000, v124
    v_lshlrev_b32 v186, 16, v125
    v_and_b32 v187, 0xffff0000, v125
    v_lshlrev_b32 v188, 16, v126
    v_and_b32 v189, 0xffff0000, v126
    v_lshlrev_b32 v190, 16, v127
    v_and_b32 v191, 0xffff0000, v127
    v_pk_add_f32 v[64:65], v[64:65], v[176:177]
    v_pk_add_f32 v[66:67], v[66:67], v[178:179]
    v_pk_add_f32 v[68:69], v[68:69], v[180:181]
    v_pk_add_f32 v[70:71], v[70:71], v[182:183]
    v_pk_add_f32 v[72:73], v[72:73], v[184:185]
    v_pk_add_f32 v[74:75], v[74:75], v[186:187]
    v_pk_add_f32 v[76:77], v[76:77], v[188:189]
    v_pk_add_f32 v[78:79], v[78:79], v[190:191]
    s_waitcnt vmcnt(10)
    v_lshlrev_b32 v176, 16, v128
    v_and_b32 v177, 0xffff0000, v128
    v_lshlrev_b32 v178, 16, v129
    v_and_b32 v179, 0xffff0000, v129
    v_lshlrev_b32 v180, 16, v130
    v_and_b32 v181, 0xffff0000, v130
    v_lshlrev_b32 v182, 16, v131
    v_and_b32 v183, 0xffff0000, v131
    v_lshlrev_b32 v184, 16, v132
    v_and_b32 v185, 0xffff0000, v132
    v_lshlrev_b32 v186, 16, v133
    v_and_b32 v187, 0xffff0000, v133
    v_lshlrev_b32 v188, 16, v134
    v_and_b32 v189, 0xffff0000, v134
    v_lshlrev_b32 v190, 16, v135
    v_and_b32 v191, 0xffff0000, v135
    v_pk_add_f32 v[64:65], v[64:65], v[176:177]
    v_pk_add_f32 v[66:67], v[66:67], v[178:179]
    v_pk_add_f32 v[68:69], v[68:69], v[180:181]
    v_pk_add_f32 v[70:71], v[70:71], v[182:183]
    v_pk_add_f32 v[72:73], v[72:73], v[184:185]
    v_pk_add_f32 v[74:75], v[74:75], v[186:187]
    v_pk_add_f32 v[76:77], v[76:77], v[188:189]
    v_pk_add_f32 v[78:79], v[78:79], v[190:191]
    s_waitcnt vmcnt(8)
    v_lshlrev_b32 v176, 16, v136
    v_and_b32 v177, 0xffff0000, v136
    v_lshlrev_b32 v178, 16, v137
    v_and_b32 v179, 0xffff0000, v137
    v_lshlrev_b32 v180, 16, v138
    v_and_b32 v181, 0xffff0000, v138
    v_lshlrev_b32 v182, 16, v139
    v_and_b32 v183, 0xffff0000, v139
    v_lshlrev_b32 v184, 16, v140
    v_and_b32 v185, 0xffff0000, v140
    v_lshlrev_b32 v186, 16, v141
    v_and_b32 v187, 0xffff0000, v141
    v_lshlrev_b32 v188, 16, v142
    v_and_b32 v189, 0xffff0000, v142
    v_lshlrev_b32 v190, 16, v143
    v_and_b32 v191, 0xffff0000, v143
    v_pk_add_f32 v[64:65], v[64:65], v[176:177]
    v_pk_add_f32 v[66:67], v[66:67], v[178:179]
    v_pk_add_f32 v[68:69], v[68:69], v[180:181]
    v_pk_add_f32 v[70:71], v[70:71], v[182:183]
    v_pk_add_f32 v[72:73], v[72:73], v[184:185]
    v_pk_add_f32 v[74:75], v[74:75], v[186:187]
    v_pk_add_f32 v[76:77], v[76:77], v[188:189]
    v_pk_add_f32 v[78:79], v[78:79], v[190:191]
    s_waitcnt vmcnt(6)
    v_lshlrev_b32 v176, 16, v144
    v_and_b32 v177, 0xffff0000, v144
    v_lshlrev_b32 v178, 16, v145
    v_and_b32 v179, 0xffff0000, v145
    v_lshlrev_b32 v180, 16, v146
    v_and_b32 v181, 0xffff0000, v146
    v_lshlrev_b32 v182, 16, v147
    v_and_b32 v183, 0xffff0000, v147
    v_lshlrev_b32 v184, 16, v148
    v_and_b32 v185, 0xffff0000, v148
    v_lshlrev_b32 v186, 16, v149
    v_and_b32 v187, 0xffff0000, v149
    v_lshlrev_b32 v188, 16, v150
    v_and_b32 v189, 0xffff0000, v150
    v_lshlrev_b32 v190, 16, v151
    v_and_b32 v191, 0xffff0000, v151
    v_pk_add_f32 v[64:65], v[64:65], v[176:177]
    v_pk_add_f32 v[66:67], v[66:67], v[178:179]
    v_pk_add_f32 v[68:69], v[68:69], v[180:181]
    v_pk_add_f32 v[70:71], v[70:71], v[182:183]
    v_pk_add_f32 v[72:73], v[72:73], v[184:185]
    v_pk_add_f32 v[74:75], v[74:75], v[186:187]
    v_pk_add_f32 v[76:77], v[76:77], v[188:189]
    v_pk_add_f32 v[78:79], v[78:79], v[190:191]
    s_waitcnt vmcnt(4)
    v_lshlrev_b32 v176, 16, v152
    v_and_b32 v177, 0xffff0000, v152
    v_lshlrev_b32 v178, 16, v153
    v_and_b32 v179, 0xffff0000, v153
    v_lshlrev_b32 v180, 16, v154
    v_and_b32 v181, 0xffff0000, v154
    v_lshlrev_b32 v182, 16, v155
    v_and_b32 v183, 0xffff0000, v155
    v_lshlrev_b32 v184, 16, v156
    v_and_b32 v185, 0xffff0000, v156
    v_lshlrev_b32 v186, 16, v157
    v_and_b32 v187, 0xffff0000, v157
    v_lshlrev_b32 v188, 16, v158
    v_and_b32 v189, 0xffff0000, v158
    v_lshlrev_b32 v190, 16, v159
    v_and_b32 v191, 0xffff0000, v159
    v_pk_add_f32 v[64:65], v[64:65], v[176:177]
    v_pk_add_f32 v[66:67], v[66:67], v[178:179]
    v_pk_add_f32 v[68:69], v[68:69], v[180:181]
    v_pk_add_f32 v[70:71], v[70:71], v[182:183]
    v_pk_add_f32 v[72:73], v[72:73], v[184:185]
    v_pk_add_f32 v[74:75], v[74:75], v[186:187]
    v_pk_add_f32 v[76:77], v[76:77], v[188:189]
    v_pk_add_f32 v[78:79], v[78:79], v[190:191]
    s_waitcnt vmcnt(2)
    v_lshlrev_b32 v176, 16, v160
    v_and_b32 v177, 0xffff0000, v160
    v_lshlrev_b32 v178, 16, v161
    v_and_b32 v179, 0xffff0000, v161
    v_lshlrev_b32 v180, 16, v162
    v_and_b32 v181, 0xffff0000, v162
    v_lshlrev_b32 v182, 16, v163
    v_and_b32 v183, 0xffff0000, v163
    v_lshlrev_b32 v184, 16, v164
    v_and_b32 v185, 0xffff0000, v164
    v_lshlrev_b32 v186, 16, v165
    v_and_b32 v187, 0xffff0000, v165
    v_lshlrev_b32 v188, 16, v166
    v_and_b32 v189, 0xffff0000, v166
    v_lshlrev_b32 v190, 16, v167
    v_and_b32 v191, 0xffff0000, v167
    v_pk_add_f32 v[64:65], v[64:65], v[176:177]
    v_pk_add_f32 v[66:67], v[66:67], v[178:179]
    v_pk_add_f32 v[68:69], v[68:69], v[180:181]
    v_pk_add_f32 v[70:71], v[70:71], v[182:183]
    v_pk_add_f32 v[72:73], v[72:73], v[184:185]
    v_pk_add_f32 v[74:75], v[74:75], v[186:187]
    v_pk_add_f32 v[76:77], v[76:77], v[188:189]
    v_pk_add_f32 v[78:79], v[78:79], v[190:191]
    s_waitcnt vmcnt(0)
    v_lshlrev_b32 v176, 16, v168
    v_and_b32 v177, 0xffff0000, v168
    v_lshlrev_b32 v178, 16, v169
    v_and_b32 v179, 0xffff0000, v169
    v_lshlrev_b32 v180, 16, v170
    v_and_b32 v181, 0xffff0000, v170
    v_lshlrev_b32 v182, 16, v171
    v_and_b32 v183, 0xffff0000, v171
    v_lshlrev_b32 v184, 16, v172
    v_and_b32 v185, 0xffff0000, v172
    v_lshlrev_b32 v186, 16, v173
    v_and_b32 v187, 0xffff0000, v173
    v_lshlrev_b32 v188, 16, v174
    v_and_b32 v189, 0xffff0000, v174
    v_lshlrev_b32 v190, 16, v175
    v_and_b32 v191, 0xffff0000, v175
    v_pk_add_f32 v[64:65], v[64:65], v[176:177]
    v_pk_add_f32 v[66:67], v[66:67], v[178:179]
    v_pk_add_f32 v[68:69], v[68:69], v[180:181]
    v_pk_add_f32 v[70:71], v[70:71], v[182:183]
    v_pk_add_f32 v[72:73], v[72:73], v[184:185]
    v_pk_add_f32 v[74:75], v[74:75], v[186:187]
    v_pk_add_f32 v[76:77], v[76:77], v[188:189]
    v_pk_add_f32 v[78:79], v[78:79], v[190:191]
    v_pk_fma_f32 v[48:49], v[64:65], v[80:81], v[48:49]
    v_pk_fma_f32 v[50:51], v[66:67], v[82:83], v[50:51]
    v_pk_fma_f32 v[52:53], v[68:69], v[84:85], v[52:53]
    v_pk_fma_f32 v[54:55], v[70:71], v[86:87], v[54:55]
    v_pk_fma_f32 v[56:57], v[72:73], v[88:89], v[56:57]
    v_pk_fma_f32 v[58:59], v[74:75], v[90:91], v[58:59]
    v_pk_fma_f32 v[60:61], v[76:77], v[92:93], v[60:61]
    v_pk_fma_f32 v[62:63], v[78:79], v[94:95], v[62:63]
    v_cvt_pk_bf16_f32 v96, v48, v49
    v_cvt_pk_bf16_f32 v97, v50, v51
    v_cvt_pk_bf16_f32 v98, v52, v53
    v_cvt_pk_bf16_f32 v99, v54, v55
    v_cvt_pk_bf16_f32 v100, v56, v57
    v_cvt_pk_bf16_f32 v101, v58, v59
    v_cvt_pk_bf16_f32 v102, v60, v61
    v_cvt_pk_bf16_f32 v103, v62, v63
    buffer_store_dwordx4 v[96:99], v30, s[32:35], s57 offen offset:0
    buffer_store_dwordx4 v[100:103], v30, s[32:35], s57 offen offset:64
K1_END:
    s_endpgm
K1_FALLBACK:
    s_waitcnt vmcnt(0) lgkmcnt(0)
    s_mov_b32 s34, 1
    v_mov_b32 v144, 0xff800000
    v_mov_b32 v145, 0xff800000
    v_mov_b32 v146, 0xff800000
    v_mov_b32 v147, 0xff800000
    s_mov_b32 s28, s32
    s_mov_b32 s31, 32
K1_FB_LOOP:
    s_barrier
    s_add_u32 m0, s33, 8192
    s_nop 0
    buffer_load_dwordx4 v18, s[12:15], s28 offen offset:0 lds
    buffer_load_dwordx4 v19, s[12:15], s28 offen offset:1024 lds
    buffer_load_dwordx4 v20, s[12:15], s28 offen offset:2048 lds
    buffer_load_dwordx4 v21, s[12:15], s28 offen offset:3072 lds
    s_add_u32 s28, s28, 16384
    s_waitcnt vmcnt(0)
    s_barrier
    ds_read_b128 a[128:131], v224 offset:8192
    ds_read_b128 a[132:135], v224 offset:32768
    ds_read_b128 a[136:139], v225 offset:8192
    ds_read_b128 a[140:143], v225 offset:32768
    ds_read_b128 a[144:147], v226 offset:8192
    ds_read_b128 a[148:151], v226 offset:32768
    ds_read_b128 a[152:155], v227 offset:8192
    ds_read_b128 a[156:159], v227 offset:32768
    s_waitcnt lgkmcnt(0)
    v_mfma_f32_16x16x32_bf16 v[32:35], a[128:131], v[160:163], 0
    v_mfma_f32_16x16x32_bf16 v[40:43], a[128:131], v[176:179], 0
    v_mfma_f32_16x16x32_bf16 v[48:51], a[128:131], v[192:195], 0
    v_mfma_f32_16x16x32_bf16 v[56:59], a[128:131], v[208:211], 0
    v_mfma_f32_16x16x32_bf16 v[36:39], a[132:135], v[160:163], 0
    v_mfma_f32_16x16x32_bf16 v[44:47], a[132:135], v[176:179], 0
    v_mfma_f32_16x16x32_bf16 v[52:55], a[132:135], v[192:195], 0
    v_mfma_f32_16x16x32_bf16 v[60:63], a[132:135], v[208:211], 0
    v_mfma_f32_16x16x32_bf16 v[32:35], a[136:139], v[164:167], v[32:35]
    v_mfma_f32_16x16x32_bf16 v[40:43], a[136:139], v[180:183], v[40:43]
    v_mfma_f32_16x16x32_bf16 v[48:51], a[136:139], v[196:199], v[48:51]
    v_mfma_f32_16x16x32_bf16 v[56:59], a[136:139], v[212:215], v[56:59]
    v_mfma_f32_16x16x32_bf16 v[36:39], a[140:143], v[164:167], v[36:39]
    v_mfma_f32_16x16x32_bf16 v[44:47], a[140:143], v[180:183], v[44:47]
    v_mfma_f32_16x16x32_bf16 v[52:55], a[140:143], v[196:199], v[52:55]
    v_mfma_f32_16x16x32_bf16 v[60:63], a[140:143], v[212:215], v[60:63]
    v_mfma_f32_16x16x32_bf16 v[32:35], a[144:147], v[168:171], v[32:35]
    v_mfma_f32_16x16x32_bf16 v[40:43], a[144:147], v[184:187], v[40:43]
    v_mfma_f32_16x16x32_bf16 v[48:51], a[144:147], v[200:203], v[48:51]
    v_mfma_f32_16x16x32_bf16 v[56:59], a[144:147], v[216:219], v[56:59]
    v_mfma_f32_16x16x32_bf16 v[36:39], a[148:151], v[168:171], v[36:39]
    v_mfma_f32_16x16x32_bf16 v[44:47], a[148:151], v[184:187], v[44:47]
    v_mfma_f32_16x16x32_bf16 v[52:55], a[148:151], v[200:203], v[52:55]
    v_mfma_f32_16x16x32_bf16 v[60:63], a[148:151], v[216:219], v[60:63]
    v_mfma_f32_16x16x32_bf16 v[32:35], a[152:155], v[172:175], v[32:35]
    v_mfma_f32_16x16x32_bf16 v[40:43], a[152:155], v[188:191], v[40:43]
    v_mfma_f32_16x16x32_bf16 v[48:51], a[152:155], v[204:207], v[48:51]
    v_mfma_f32_16x16x32_bf16 v[56:59], a[152:155], v[220:223], v[56:59]
    v_mfma_f32_16x16x32_bf16 v[36:39], a[156:159], v[172:175], v[36:39]
    v_mfma_f32_16x16x32_bf16 v[44:47], a[156:159], v[188:191], v[44:47]
    v_mfma_f32_16x16x32_bf16 v[52:55], a[156:159], v[204:207], v[52:55]
    v_mfma_f32_16x16x32_bf16 v[60:63], a[156:159], v[220:223], v[60:63]
    s_nop 0
    v_max3_f32 v144, v144, v32, v33
    v_max3_f32 v145, v145, v40, v41
    v_max3_f32 v146, v146, v48, v49
    v_max3_f32 v147, v147, v56, v57
    v_max3_f32 v144, v144, v34, v35
    v_max3_f32 v145, v145, v42, v43
    v_max3_f32 v146, v146, v50, v51
    v_max3_f32 v147, v147, v58, v59
    v_max3_f32 v144, v144, v36, v37
    v_max3_f32 v145, v145, v44, v45
    v_max3_f32 v146, v146, v52, v53
    v_max3_f32 v147, v147, v60, v61
    v_max3_f32 v144, v144, v38, v39
    v_max3_f32 v145, v145, v46, v47
    v_max3_f32 v146, v146, v54, v55
    v_max3_f32 v147, v147, v62, v63
    ds_read_b128 a[128:131], v228 offset:8192
    ds_read_b128 a[132:135], v228 offset:32768
    ds_read_b128 a[136:139], v229 offset:8192
    ds_read_b128 a[140:143], v229 offset:32768
    ds_read_b128 a[144:147], v230 offset:8192
    ds_read_b128 a[148:151], v230 offset:32768
    ds_read_b128 a[152:155], v231 offset:8192
    ds_read_b128 a[156:159], v231 offset:32768
    s_waitcnt lgkmcnt(0)
    v_mfma_f32_16x16x32_bf16 v[32:35], a[128:131], v[160:163], 0
    v_mfma_f32_16x16x32_bf16 v[40:43], a[128:131], v[176:179], 0
    v_mfma_f32_16x16x32_bf16 v[48:51], a[128:131], v[192:195], 0
    v_mfma_f32_16x16x32_bf16 v[56:59], a[128:131], v[208:211], 0
    v_mfma_f32_16x16x32_bf16 v[36:39], a[132:135], v[160:163], 0
    v_mfma_f32_16x16x32_bf16 v[44:47], a[132:135], v[176:179], 0
    v_mfma_f32_16x16x32_bf16 v[52:55], a[132:135], v[192:195], 0
    v_mfma_f32_16x16x32_bf16 v[60:63], a[132:135], v[208:211], 0
    v_mfma_f32_16x16x32_bf16 v[32:35], a[136:139], v[164:167], v[32:35]
    v_mfma_f32_16x16x32_bf16 v[40:43], a[136:139], v[180:183], v[40:43]
    v_mfma_f32_16x16x32_bf16 v[48:51], a[136:139], v[196:199], v[48:51]
    v_mfma_f32_16x16x32_bf16 v[56:59], a[136:139], v[212:215], v[56:59]
    v_mfma_f32_16x16x32_bf16 v[36:39], a[140:143], v[164:167], v[36:39]
    v_mfma_f32_16x16x32_bf16 v[44:47], a[140:143], v[180:183], v[44:47]
    v_mfma_f32_16x16x32_bf16 v[52:55], a[140:143], v[196:199], v[52:55]
    v_mfma_f32_16x16x32_bf16 v[60:63], a[140:143], v[212:215], v[60:63]
    v_mfma_f32_16x16x32_bf16 v[32:35], a[144:147], v[168:171], v[32:35]
    v_mfma_f32_16x16x32_bf16 v[40:43], a[144:147], v[184:187], v[40:43]
    v_mfma_f32_16x16x32_bf16 v[48:51], a[144:147], v[200:203], v[48:51]
    v_mfma_f32_16x16x32_bf16 v[56:59], a[144:147], v[216:219], v[56:59]
    v_mfma_f32_16x16x32_bf16 v[36:39], a[148:151], v[168:171], v[36:39]
    v_mfma_f32_16x16x32_bf16 v[44:47], a[148:151], v[184:187], v[44:47]
    v_mfma_f32_16x16x32_bf16 v[52:55], a[148:151], v[200:203], v[52:55]
    v_mfma_f32_16x16x32_bf16 v[60:63], a[148:151], v[216:219], v[60:63]
    v_mfma_f32_16x16x32_bf16 v[32:35], a[152:155], v[172:175], v[32:35]
    v_mfma_f32_16x16x32_bf16 v[40:43], a[152:155], v[188:191], v[40:43]
    v_mfma_f32_16x16x32_bf16 v[48:51], a[152:155], v[204:207], v[48:51]
    v_mfma_f32_16x16x32_bf16 v[56:59], a[152:155], v[220:223], v[56:59]
    v_mfma_f32_16x16x32_bf16 v[36:39], a[156:159], v[172:175], v[36:39]
    v_mfma_f32_16x16x32_bf16 v[44:47], a[156:159], v[188:191], v[44:47]
    v_mfma_f32_16x16x32_bf16 v[52:55], a[156:159], v[204:207], v[52:55]
    v_mfma_f32_16x16x32_bf16 v[60:63], a[156:159], v[220:223], v[60:63]
    s_nop 0
    v_max3_f32 v144, v144, v32, v33
    v_max3_f32 v145, v145, v40, v41
    v_max3_f32 v146, v146, v48, v49
    v_max3_f32 v147, v147, v56, v57
    v_max3_f32 v144, v144, v34, v35
    v_max3_f32 v145, v145, v42, v43
    v_max3_f32 v146, v146, v50, v51
    v_max3_f32 v147, v147, v58, v59
    v_max3_f32 v144, v144, v36, v37
    v_max3_f32 v145, v145, v44, v45
    v_max3_f32 v146, v146, v52, v53
    v_max3_f32 v147, v147, v60, v61
    v_max3_f32 v144, v144, v38, v39
    v_max3_f32 v145, v145, v46, v47
    v_max3_f32 v146, v146, v54, v55
    v_max3_f32 v147, v147, v62, v63
    s_sub_u32 s31, s31, 1
    s_cmp_lg_u32 s31, 0
    s_cbranch_scc1 K1_FB_LOOP
    v_mov_b32 v24, v144
    v_mov_b32 v25, v145
    v_mov_b32 v26, v146
    v_mov_b32 v27, v147
    v_permlane16_swap_b32 v144, v24
    v_permlane16_swap_b32 v145, v25
    v_permlane16_swap_b32 v146, v26
    v_permlane16_swap_b32 v147, v27
    v_max_f32 v144, v144, v24
    v_max_f32 v145, v145, v25
    v_max_f32 v146, v146, v26
    v_max_f32 v147, v147, v27
    v_mov_b32 v24, v144
    v_mov_b32 v25, v145
    v_mov_b32 v26, v146
    v_mov_b32 v27, v147
    v_permlane32_swap_b32 v144, v24
    v_permlane32_swap_b32 v145, v25
    v_permlane32_swap_b32 v146, v26
    v_permlane32_swap_b32 v147, v27
    v_max_f32 v144, v144, v24
    v_max_f32 v145, v145, v25
    v_max_f32 v146, v146, v26
    v_max_f32 v147, v147, v27
    s_barrier
    s_mov_b32 s28, s32
    s_sub_u32 s29, s32, 8192
    s_mov_b32 s30, 0
    s_add_u32 m0, s33, 8192
    s_nop 0
    buffer_load_dwordx4 v18, s[12:15], s28 offen offset:0 lds
    buffer_load_dwordx4 v19, s[12:15], s28 offen offset:1024 lds
    buffer_load_dwordx4 v20, s[12:15], s28 offen offset:2048 lds
    buffer_load_dwordx4 v21, s[12:15], s28 offen offset:3072 lds
    s_add_u32 s28, s28, 16384
    s_add_u32 m0, s33, 12288
    s_nop 0
    buffer_load_dwordx4 v18, s[12:15], s28 offen offset:0 lds
    buffer_load_dwordx4 v19, s[12:15], s28 offen offset:1024 lds
    buffer_load_dwordx4 v20, s[12:15], s28 offen offset:2048 lds
    buffer_load_dwordx4 v21, s[12:15], s28 offen offset:3072 lds
    s_add_u32 s28, s28, 16384
    s_add_u32 m0, s33, 16384
    s_nop 0
    buffer_load_dwordx4 v22, s[16:19], s29 offen offset:0 lds
    buffer_load_dwordx4 v23, s[16:19], s29 offen offset:1024 lds
    buffer_load_dwordx4 v22, s[16:19], s29 offen offset:2048 lds
    buffer_load_dwordx4 v23, s[16:19], s29 offen offset:3072 lds
    s_add_u32 s29, s29, 16384
    s_add_u32 m0, s33, 20480
    s_nop 0
    buffer_load_dwordx4 v18, s[12:15], s28 offen offset:0 lds
    buffer_load_dwordx4 v19, s[12:15], s28 offen offset:1024 lds
    buffer_load_dwordx4 v20, s[12:15], s28 offen offset:2048 lds
    buffer_load_dwordx4 v21, s[12:15], s28 offen offset:3072 lds
    s_add_u32 s28, s28, 16384
    s_add_u32 m0, s33, 0
    s_nop 0
    buffer_load_dwordx4 v22, s[16:19], s29 offen offset:0 lds
    buffer_load_dwordx4 v23, s[16:19], s29 offen offset:1024 lds
    buffer_load_dwordx4 v22, s[16:19], s29 offen offset:2048 lds
    buffer_load_dwordx4 v23, s[16:19], s29 offen offset:3072 lds
    s_add_u32 s29, s29, 16384
    s_waitcnt vmcnt(16)
    s_barrier
    ds_read_b128 a[128:131], v224 offset:8192
    ds_read_b128 a[132:135], v224 offset:32768
    ds_read_b128 a[136:139], v225 offset:8192
    ds_read_b128 a[140:143], v225 offset:32768
    ds_read_b128 a[144:147], v226 offset:8192
    ds_read_b128 a[148:151], v226 offset:32768
    ds_read_b128 a[152:155], v227 offset:8192
    ds_read_b128 a[156:159], v227 offset:32768
    s_nop 15
    s_branch K1_PRE
.section .rodata,"a"
.p2align 6
.amdhsa_kernel adaLN_cond__gqa_block_cached__mixer_s_mlp__prompt_kernel
  .amdhsa_next_free_vgpr 512
  .amdhsa_next_free_sgpr 64
  .amdhsa_accum_offset 256
  .amdhsa_group_segment_fixed_size 0
  .amdhsa_kernarg_size 120
  .amdhsa_user_sgpr_count 2
  .amdhsa_user_sgpr_kernarg_segment_ptr 1
  .amdhsa_system_sgpr_workgroup_id_x 1
.end_amdhsa_kernel
```
